```python
import torch

def _softmax(x, axis=-1):
    return torch.softmax(x, dim=axis)

def _gelu(x):
    return torch.nn.functional.gelu(x, approximate='tanh')

def _silu(x):
    return torch.nn.functional.silu(x)

def _sigmoid(x):
    return torch.sigmoid(x)

def _layernorm(x, axis=-1, eps=1e-05):
    m = x.mean(dim=axis, keepdim=True)
    v = x.var(dim=axis, keepdim=True, unbiased=False)
    return (x - m) / torch.sqrt(v + eps)

def _scatter_add(tgt, idx, src, axis=0):
    return tgt.clone().index_add_(axis, idx, src)

def _segment_sum(src, seg, n):
    out = torch.zeros((n,) + src.shape[1:], dtype=src.dtype)
    return out.index_add_(0, seg, src)

def _pad(x, pw):
    flat = tuple((v for pair in reversed(pw) for v in pair))
    return torch.nn.functional.pad(x, flat)
kernel_name = 'adaLN_cond__memory_aug_recurrent_mem_tr__glu_gated_swiglu__prompt'

def setup_inputs():

    _w = lambda a: (lambda t: t.to(torch.bfloat16) if t.is_floating_point() else t)(torch.as_tensor(a))

    def _A_setup():
        B, S, Dm = (1, 2048, 512)
        H, Dh = (32, 128)
        M, seg = (8, 32)
        seg = min(seg, S)
        S = S // seg * seg
        return {'x': _w((lambda *s: torch.randn(*s, dtype=torch.bfloat16) * 0.05)(B, S, Dm)), 'mem0': _w((lambda *s: torch.randn(*s, dtype=torch.bfloat16) * 0.8)(B, M, Dm)), 'Wq': _w((lambda *s: torch.randn(*s, dtype=torch.bfloat16) * 0.8)(Dm, H, Dh) * Dm ** (-0.5)), 'Wk': _w((lambda *s: torch.randn(*s, dtype=torch.bfloat16) * 0.8)(Dm, H, Dh) * Dm ** (-0.5)), 'Wv': _w((lambda *s: torch.randn(*s, dtype=torch.bfloat16) * 0.8)(Dm, H, Dh) * Dm ** (-0.5)), 'Wo': _w((lambda *s: torch.randn(*s, dtype=torch.bfloat16) * 0.8)(H, Dh, Dm) * (H * Dh) ** (-0.5)), 'seg_len': seg}
    _A_in = _A_setup()

    def _B_setup():
        B, S, D, F = (1, 2048, 512, 1376)
        return {'x': _w((lambda *s: torch.randn(*s, dtype=torch.bfloat16) * 0.05)(B, S, D)), 'w1': _w((lambda *s: torch.randn(*s, dtype=torch.bfloat16) * 0.4)(D, F) * (2.0 / D) ** 0.5), 'w3': _w((lambda *s: torch.randn(*s, dtype=torch.bfloat16) * 0.4)(D, F) * (2.0 / D) ** 0.5), 'w2': _w((lambda *s: torch.randn(*s, dtype=torch.bfloat16) * 0.4)(F, D) * (2.0 / F) ** 0.5)}
    _B_in = _B_setup()
    return {'A_x': _A_in['x'], 'A_mem0': _A_in['mem0'], 'A_Wq': _A_in['Wq'], 'A_Wk': _A_in['Wk'], 'A_Wv': _A_in['Wv'], 'A_Wo': _A_in['Wo'], 'A_seg_len': _A_in['seg_len'], 'B_x': _B_in['x'], 'B_w1': _B_in['w1'], 'B_w3': _B_in['w3'], 'B_w2': _B_in['w2'], 'c': _w((lambda *s: torch.randn(*s, dtype=torch.bfloat16) * 0.1)(1, 512) * 8.0), 'w_mod': _w((lambda *s: torch.randn(*s, dtype=torch.bfloat16) * 0.1)(512, 6 * 512) * 512 ** (-0.5) * 8.0)}

def reference(A_x, A_mem0, A_Wq, A_Wk, A_Wv, A_Wo, A_seg_len, B_x, B_w1, B_w3, B_w2, c, w_mod):

    def _A_ref(x, mem0, Wq, Wk, Wv, Wo, seg_len):
        B, S, Dm = x.shape
        H, Dh = (Wq.shape[1], Wq.shape[2])
        M = mem0.shape[1]
        scale = Dh ** (-0.5)
        n_seg = S // seg_len
        L = M + seg_len
        idx = torch.arange(L)
        mask = (idx[:, None] < M) | (idx[:, None] >= idx[None, :])
        mem = mem0
        outs = []
        for s in range(n_seg):
            xs = x[:, s * seg_len:(s + 1) * seg_len, :].clone()
            h = torch.concatenate([mem, xs], axis=1)
            q = torch.einsum('btd,dhe->bhte', h, Wq)
            k = torch.einsum('btd,dhe->bhte', h, Wk)
            v = torch.einsum('btd,dhe->bhte', h, Wv)
            scores = torch.einsum('bhqe,bhke->bhqk', q, k) * scale
            scores = torch.where(mask[None, None], scores, -1000000000.0)
            p = _softmax(scores, axis=-1)
            o = torch.einsum('bhqk,bhke->bhqe', p, v)
            o = torch.einsum('bhte,hed->btd', o, Wo)
            mem = o[:, :M, :].clone()
            outs.append(o[:, M:, :])
        return torch.concatenate(outs, axis=1)

    def _B_ref(x, w1, w3, w2):
        gate = torch.einsum('bsd,df->bsf', x, w1)
        up = torch.einsum('bsd,df->bsf', x, w3)
        h = _silu(gate) * up
        out = torch.einsum('bsf,fd->bsd', h, w2)
        return out
    x = A_x
    mod = (_silu(c) @ w_mod).reshape(c.shape[0], 6, 1, -1)
    sa, ca, ga, sb, cb, gb = (mod[:, 0].clone(), mod[:, 1].clone(), mod[:, 2].clone(), mod[:, 3].clone(), mod[:, 4].clone(), mod[:, 5].clone())
    h = _layernorm(x, axis=-1) * (1 + ca) + sa
    x = x + ga * _A_ref(h, A_mem0, A_Wq, A_Wk, A_Wv, A_Wo, A_seg_len)
    h = _layernorm(x, axis=-1) * (1 + cb) + sb
    x = x + gb * _B_ref(h, B_w1, B_w3, B_w2)
    return x
```

```asm
; @launch grid=(256,1,1) block=(256,1,1) lds=163840
.amdgcn_target "amdgcn-amd-amdhsa--gfx950"
.text
.globl adaLN_cond__memory_aug_recurrent_mem_tr__glu_gated_swiglu__prompt_kernel
.p2align 8
.type adaLN_cond__memory_aug_recurrent_mem_tr__glu_gated_swiglu__prompt_kernel,@function
adaLN_cond__memory_aug_recurrent_mem_tr__glu_gated_swiglu__prompt_kernel:
  s_cmp_ge_u32 s2, 256
  s_cbranch_scc1 EXIT
  s_load_dwordx16 s[64:79], s[0:1], 0
  s_load_dwordx16 s[80:95], s[0:1], 64
  s_getreg_b32 s33, hwreg(HW_REG_XCC_ID,0,4)
  v_lshrrev_b32 v1, 6, v0
  v_and_b32 v0, 63, v0
  v_readfirstlane_b32 s3, v1
  s_and_b32 s33, s33, 7
  s_mul_i32 s34, s33, s33
  s_lshl_b32 s33, s33, 6
  s_lshl_b32 s34, s34, 14
  s_add_u32 s33, s33, s34
  s_add_u32 s32, s33, 1
  s_add_u32 s4, s2, 7
  s_and_b32 s4, s4, 7
  s_lshr_b32 s5, s2, 3
  s_mov_b32 s6, 400000
  s_waitcnt lgkmcnt(0)
  s_mov_b32 s8, s94
  s_mov_b32 s9, s95
  s_mov_b32 s10, 268435456
  s_mov_b32 s11, 0x00020000
  s_mov_b32 s12, s92
  s_mov_b32 s13, s93
  s_mov_b32 s14, 256
  s_mov_b32 s15, 0x00020000
  s_lshl_b32 s33, s4, 5
  s_add_u32 s33, s33, s5
  v_mov_b32 v2, -1
  v_mov_b32 v3, -1
  v_lshlrev_b32 v4, 3, v0
  s_lshl_b32 s34, s33, 11
  s_lshl_b32 s35, s3, 9
  s_add_u32 s34, s34, s35
  s_add_u32 s34, s34, 524288
  buffer_store_dwordx2 v[2:3], v4, s[8:11], s34 offen sc1
  v_mov_b32 v6, 0
  v_mov_b32 v7, 0
  s_lshl_b32 s34, s33, 9
  s_add_u32 s34, s34, 0
  s_cmp_lg_u32 s3, 0
  s_cbranch_scc1 FLAGS_DONE
  buffer_store_dwordx2 v[6:7], v4, s[8:11], s34 offen sc1
FLAGS_DONE:
  v_mov_b32 v113, 2147483648
  s_cmp_gt_u32 s4, 5
  s_cbranch_scc1 FFN_ROLE
  s_cmp_lg_u32 s4, 0
  s_cbranch_scc1 ATT_ROLE
  s_andn2_b32 s58, s5, 4
  s_and_b32 s59, s3, 2
  s_lshl_b32 s59, s59, 1
  s_or_b32 s58, s58, s59
  s_and_b32 s59, s5, 4
  s_lshr_b32 s59, s59, 1
  s_and_b32 s33, s3, 1
  s_or_b32 s59, s59, s33
  s_mov_b32 s16, s66
  s_mov_b32 s17, s67
  s_mov_b32 s18, 8192
  s_mov_b32 s19, 0x00020000
  v_lshrrev_b32 v10, 4, v0
  v_and_b32 v11, 1, v10
  v_lshlrev_b32 v11, 10, v11
  v_lshrrev_b32 v12, 1, v10
  v_lshlrev_b32 v12, 2, v12
  v_and_b32 v13, 15, v0
  v_lshlrev_b32 v14, 3, v13
  v_add3_u32 v11, v11, v12, v14
  s_lshl_b32 s33, s59, 11
  s_lshl_b32 s34, s58, 5
  s_add_u32 s33, s33, s34
  v_lshlrev_b32 v12, 4, v10
  v_lshlrev_b32 v14, 2, v13
  s_lshl_b32 s35, s59, 6
  v_add3_u32 v12, v12, v14, s35
  v_mov_b32 v14, 2147483648
  v_cmp_gt_u32 vcc, 4, v13
  s_nop 1
  v_cndmask_b32 v11, v14, v11, vcc
  v_cndmask_b32 v113, v14, v12, vcc
  buffer_load_dword v112, v11, s[16:19], s33 offen
  v_mov_b32 v20, -1
  v_mov_b32 v21, -1
  v_mov_b32 v22, -1
  v_mov_b32 v23, -1
  v_lshlrev_b32 v10, 4, v0
  s_lshl_b32 s33, s3, 11
  s_lshl_b32 s34, s5, 13
  s_add_u32 s33, s33, s34
  s_add_u32 s33, s33, 1048576
  buffer_store_dwordx4 v[20:23], v10, s[8:11], s33 offen sc1
  buffer_store_dwordx4 v[20:23], v10, s[8:11], s33 offen offset:1024 sc1
  s_lshl_b32 s34, s58, 8
  s_add_u32 s34, s34, 196608
  s_waitcnt vmcnt(2)
  v_min_u32 v112, -2, v112
  buffer_store_dword v112, v113, s[8:11], s34 offen sc1
  s_mov_b32 s16, s74
  s_mov_b32 s17, s75
  s_mov_b32 s18, 4194304
  s_mov_b32 s19, 0x00020000
  s_mov_b32 s20, s68
  s_mov_b32 s21, s69
  s_mov_b32 s22, 4194304
  s_mov_b32 s23, 0x00020000
  s_mov_b32 s24, s70
  s_mov_b32 s25, s71
  s_mov_b32 s26, 4194304
  s_mov_b32 s27, 0x00020000
  s_mov_b32 s28, s72
  s_mov_b32 s29, s73
  s_mov_b32 s30, 4194304
  s_mov_b32 s31, 0x00020000
  v_bfe_u32 v10, v0, 4, 1
  v_lshlrev_b32 v10, 14, v10
  v_lshrrev_b32 v11, 5, v0
  v_lshlrev_b32 v11, 12, v11
  v_and_b32 v12, 15, v0
  v_lshlrev_b32 v13, 3, v12
  s_lshl_b32 s33, s3, 8
  v_add3_u32 v10, v10, v11, v13
  v_add_u32 v1, s33, v10
  v_lshrrev_b32 v10, 4, v0
  v_lshrrev_b32 v11, 1, v12
  v_xor_b32 v11, v11, v10
  v_lshlrev_b32 v11, 5, v11
  v_and_b32 v13, 1, v0
  v_lshlrev_b32 v13, 4, v13
  v_lshlrev_b32 v10, 13, v10
  v_add3_u32 v10, v10, v11, v13
  s_lshl_b32 s33, s3, 17
  v_add_u32 v2, s33, v10
  v_xor_b32 v3, 0x80, v2
  v_bfe_u32 v10, v0, 2, 2
  v_lshrrev_b32 v11, 4, v0
  v_lshlrev_b32 v13, 3, v11
  v_add_u32 v13, v13, v10
  v_lshlrev_b32 v13, 8, v13
  v_and_b32 v11, 1, v11
  v_lshlrev_b32 v11, 2, v11
  v_add_u32 v10, v10, v11
  s_lshl_b32 s33, s3, 1
  v_xor_b32 v10, s33, v10
  v_lshlrev_b32 v10, 5, v10
  v_and_b32 v11, 3, v0
  v_lshlrev_b32 v11, 3, v11
  v_add3_u32 v10, v10, v11, v13
  v_add_u32 v4, 32768, v10
  v_xor_b32 v5, 32, v4
  v_add_u32 v6, 0x10000, v4
  v_add_u32 v7, 0x10000, v5
  s_lshl_b32 s33, s3, 12
  s_add_u32 s33, s33, 32768
  v_lshlrev_b32 v10, 4, v0
  v_add_u32 v8, s33, v10
  v_add_u32 v9, 0x10000, v8
  s_lshl_b32 s36, s5, 17
  s_lshl_b32 s37, s5, 8
  s_lshl_b32 s38, s3, 12
  s_add_u32 s38, s38, 32768
  s_mov_b32 s39, 0x05040100
  s_mov_b32 s40, 0x07060302
  s_cmp_eq_u32 s3, 1
  s_cbranch_scc1 LDW1_3
  s_cmp_eq_u32 s3, 2
  s_cbranch_scc1 LDW2_4
  s_cmp_eq_u32 s3, 3
  s_cbranch_scc1 LDW3_5
LDW0_2:
  s_add_u32 s33, s36, 0
  buffer_load_dwordx2 v[16:17], v1, s[16:19], s33 offen offset:0
  buffer_load_dwordx2 v[18:19], v1, s[16:19], s33 offen offset:1024
  buffer_load_dwordx2 v[24:25], v1, s[16:19], s33 offen offset:2048
  buffer_load_dwordx2 v[26:27], v1, s[16:19], s33 offen offset:3072
  s_add_u32 s33, s36, 32768
  buffer_load_dwordx2 v[20:21], v1, s[16:19], s33 offen offset:0
  buffer_load_dwordx2 v[22:23], v1, s[16:19], s33 offen offset:1024
  buffer_load_dwordx2 v[28:29], v1, s[16:19], s33 offen offset:2048
  buffer_load_dwordx2 v[30:31], v1, s[16:19], s33 offen offset:3072
  s_add_u32 s33, s36, 8192
  buffer_load_dwordx2 v[32:33], v1, s[16:19], s33 offen offset:0
  buffer_load_dwordx2 v[34:35], v1, s[16:19], s33 offen offset:1024
  buffer_load_dwordx2 v[40:41], v1, s[16:19], s33 offen offset:2048
  buffer_load_dwordx2 v[42:43], v1, s[16:19], s33 offen offset:3072
  s_add_u32 s33, s36, 40960
  buffer_load_dwordx2 v[36:37], v1, s[16:19], s33 offen offset:0
  buffer_load_dwordx2 v[38:39], v1, s[16:19], s33 offen offset:1024
  buffer_load_dwordx2 v[44:45], v1, s[16:19], s33 offen offset:2048
  buffer_load_dwordx2 v[46:47], v1, s[16:19], s33 offen offset:3072
  s_add_u32 s33, s36, 0
  buffer_load_dwordx2 v[48:49], v1, s[16:19], s33 offen offset:128
  buffer_load_dwordx2 v[50:51], v1, s[16:19], s33 offen offset:1152
  buffer_load_dwordx2 v[56:57], v1, s[16:19], s33 offen offset:2176
  buffer_load_dwordx2 v[58:59], v1, s[16:19], s33 offen offset:3200
  s_add_u32 s33, s36, 32768
  buffer_load_dwordx2 v[52:53], v1, s[16:19], s33 offen offset:128
  buffer_load_dwordx2 v[54:55], v1, s[16:19], s33 offen offset:1152
  buffer_load_dwordx2 v[60:61], v1, s[16:19], s33 offen offset:2176
  buffer_load_dwordx2 v[62:63], v1, s[16:19], s33 offen offset:3200
  s_add_u32 s33, s36, 8192
  buffer_load_dwordx2 v[64:65], v1, s[16:19], s33 offen offset:128
  buffer_load_dwordx2 v[66:67], v1, s[16:19], s33 offen offset:1152
  buffer_load_dwordx2 v[72:73], v1, s[16:19], s33 offen offset:2176
  buffer_load_dwordx2 v[74:75], v1, s[16:19], s33 offen offset:3200
  s_add_u32 s33, s36, 40960
  buffer_load_dwordx2 v[68:69], v1, s[16:19], s33 offen offset:128
  buffer_load_dwordx2 v[70:71], v1, s[16:19], s33 offen offset:1152
  buffer_load_dwordx2 v[76:77], v1, s[16:19], s33 offen offset:2176
  buffer_load_dwordx2 v[78:79], v1, s[16:19], s33 offen offset:3200
  s_add_u32 s33, s36, 65536
  buffer_load_dwordx2 v[80:81], v1, s[16:19], s33 offen offset:0
  buffer_load_dwordx2 v[82:83], v1, s[16:19], s33 offen offset:1024
  buffer_load_dwordx2 v[88:89], v1, s[16:19], s33 offen offset:2048
  buffer_load_dwordx2 v[90:91], v1, s[16:19], s33 offen offset:3072
  s_add_u32 s33, s36, 98304
  buffer_load_dwordx2 v[84:85], v1, s[16:19], s33 offen offset:0
  buffer_load_dwordx2 v[86:87], v1, s[16:19], s33 offen offset:1024
  buffer_load_dwordx2 v[92:93], v1, s[16:19], s33 offen offset:2048
  buffer_load_dwordx2 v[94:95], v1, s[16:19], s33 offen offset:3072
  s_add_u32 s33, s36, 73728
  buffer_load_dwordx2 v[96:97], v1, s[16:19], s33 offen offset:0
  buffer_load_dwordx2 v[98:99], v1, s[16:19], s33 offen offset:1024
  buffer_load_dwordx2 v[104:105], v1, s[16:19], s33 offen offset:2048
  buffer_load_dwordx2 v[106:107], v1, s[16:19], s33 offen offset:3072
  s_add_u32 s33, s36, 106496
  buffer_load_dwordx2 v[100:101], v1, s[16:19], s33 offen offset:0
  buffer_load_dwordx2 v[102:103], v1, s[16:19], s33 offen offset:1024
  buffer_load_dwordx2 v[108:109], v1, s[16:19], s33 offen offset:2048
  buffer_load_dwordx2 v[110:111], v1, s[16:19], s33 offen offset:3072
  s_waitcnt vmcnt(40)
  s_barrier
  s_cmp_lg_u32 s3, 0
  s_cbranch_scc1 SIG_6
  s_lshl_b32 s33, s4, 2
  v_mov_b32 v10, s32
  s_mov_b64 exec, 1
  buffer_atomic_add v10, off, s[12:15], s33 offset:160 sc1
  s_mov_b64 exec, -1
SIG_6:
  v_perm_b32 v128, v18, v16, s39
  v_perm_b32 v129, v22, v20, s39
  v_perm_b32 v130, v26, v24, s39
  v_perm_b32 v131, v30, v28, s39
  v_perm_b32 v144, v18, v16, s40
  v_perm_b32 v145, v22, v20, s40
  v_perm_b32 v146, v26, v24, s40
  v_perm_b32 v147, v30, v28, s40
  v_perm_b32 v160, v19, v17, s39
  v_perm_b32 v161, v23, v21, s39
  v_perm_b32 v162, v27, v25, s39
  v_perm_b32 v163, v31, v29, s39
  v_perm_b32 v176, v19, v17, s40
  v_perm_b32 v177, v23, v21, s40
  v_perm_b32 v178, v27, v25, s40
  v_perm_b32 v179, v31, v29, s40
  s_add_u32 s33, s36, 65536
  buffer_load_dwordx2 v[16:17], v1, s[16:19], s33 offen offset:128
  buffer_load_dwordx2 v[18:19], v1, s[16:19], s33 offen offset:1152
  buffer_load_dwordx2 v[24:25], v1, s[16:19], s33 offen offset:2176
  buffer_load_dwordx2 v[26:27], v1, s[16:19], s33 offen offset:3200
  s_add_u32 s33, s36, 98304
  buffer_load_dwordx2 v[20:21], v1, s[16:19], s33 offen offset:128
  buffer_load_dwordx2 v[22:23], v1, s[16:19], s33 offen offset:1152
  buffer_load_dwordx2 v[28:29], v1, s[16:19], s33 offen offset:2176
  buffer_load_dwordx2 v[30:31], v1, s[16:19], s33 offen offset:3200
  s_waitcnt vmcnt(40)
  v_perm_b32 v132, v34, v32, s39
  v_perm_b32 v133, v38, v36, s39
  v_perm_b32 v134, v42, v40, s39
  v_perm_b32 v135, v46, v44, s39
  v_perm_b32 v148, v34, v32, s40
  v_perm_b32 v149, v38, v36, s40
  v_perm_b32 v150, v42, v40, s40
  v_perm_b32 v151, v46, v44, s40
  v_perm_b32 v164, v35, v33, s39
  v_perm_b32 v165, v39, v37, s39
  v_perm_b32 v166, v43, v41, s39
  v_perm_b32 v167, v47, v45, s39
  v_perm_b32 v180, v35, v33, s40
  v_perm_b32 v181, v39, v37, s40
  v_perm_b32 v182, v43, v41, s40
  v_perm_b32 v183, v47, v45, s40
  s_add_u32 s33, s36, 73728
  buffer_load_dwordx2 v[32:33], v1, s[16:19], s33 offen offset:128
  buffer_load_dwordx2 v[34:35], v1, s[16:19], s33 offen offset:1152
  buffer_load_dwordx2 v[40:41], v1, s[16:19], s33 offen offset:2176
  buffer_load_dwordx2 v[42:43], v1, s[16:19], s33 offen offset:3200
  s_add_u32 s33, s36, 106496
  buffer_load_dwordx2 v[36:37], v1, s[16:19], s33 offen offset:128
  buffer_load_dwordx2 v[38:39], v1, s[16:19], s33 offen offset:1152
  buffer_load_dwordx2 v[44:45], v1, s[16:19], s33 offen offset:2176
  buffer_load_dwordx2 v[46:47], v1, s[16:19], s33 offen offset:3200
  s_waitcnt vmcnt(40)
  v_perm_b32 v192, v50, v48, s39
  v_perm_b32 v193, v54, v52, s39
  v_perm_b32 v194, v58, v56, s39
  v_perm_b32 v195, v62, v60, s39
  v_perm_b32 v208, v50, v48, s40
  v_perm_b32 v209, v54, v52, s40
  v_perm_b32 v210, v58, v56, s40
  v_perm_b32 v211, v62, v60, s40
  v_perm_b32 v224, v51, v49, s39
  v_perm_b32 v225, v55, v53, s39
  v_perm_b32 v226, v59, v57, s39
  v_perm_b32 v227, v63, v61, s39
  v_perm_b32 v240, v51, v49, s40
  v_perm_b32 v241, v55, v53, s40
  v_perm_b32 v242, v59, v57, s40
  v_perm_b32 v243, v63, v61, s40
  s_add_u32 s33, s37, 0
  s_add_u32 m0, s38, 0
  s_nop 0
  buffer_load_dwordx4 v2, s[20:23], s33 offen lds
  s_add_u32 s33, s37, 32768
  s_add_u32 m0, s38, 1024
  s_nop 0
  buffer_load_dwordx4 v2, s[20:23], s33 offen lds
  s_add_u32 s33, s37, 65536
  s_add_u32 m0, s38, 2048
  s_nop 0
  buffer_load_dwordx4 v3, s[20:23], s33 offen lds
  s_add_u32 s33, s37, 98304
  s_add_u32 m0, s38, 3072
  s_nop 0
  buffer_load_dwordx4 v3, s[20:23], s33 offen lds
  s_waitcnt vmcnt(36)
  v_perm_b32 v196, v66, v64, s39
  v_perm_b32 v197, v70, v68, s39
  v_perm_b32 v198, v74, v72, s39
  v_perm_b32 v199, v78, v76, s39
  v_perm_b32 v212, v66, v64, s40
  v_perm_b32 v213, v70, v68, s40
  v_perm_b32 v214, v74, v72, s40
  v_perm_b32 v215, v78, v76, s40
  v_perm_b32 v228, v67, v65, s39
  v_perm_b32 v229, v71, v69, s39
  v_perm_b32 v230, v75, v73, s39
  v_perm_b32 v231, v79, v77, s39
  v_perm_b32 v244, v67, v65, s40
  v_perm_b32 v245, v71, v69, s40
  v_perm_b32 v246, v75, v73, s40
  v_perm_b32 v247, v79, v77, s40
  s_add_u32 s33, s37, 524288
  s_add_u32 m0, s38, 16384
  s_nop 0
  buffer_load_dwordx4 v2, s[20:23], s33 offen lds
  s_add_u32 s33, s37, 557056
  s_add_u32 m0, s38, 17408
  s_nop 0
  buffer_load_dwordx4 v2, s[20:23], s33 offen lds
  s_add_u32 s33, s37, 589824
  s_add_u32 m0, s38, 18432
  s_nop 0
  buffer_load_dwordx4 v3, s[20:23], s33 offen lds
  s_add_u32 s33, s37, 622592
  s_add_u32 m0, s38, 19456
  s_nop 0
  buffer_load_dwordx4 v3, s[20:23], s33 offen lds
  s_waitcnt vmcnt(32)
  v_perm_b32 v136, v82, v80, s39
  v_perm_b32 v137, v86, v84, s39
  v_perm_b32 v138, v90, v88, s39
  v_perm_b32 v139, v94, v92, s39
  v_perm_b32 v152, v82, v80, s40
  v_perm_b32 v153, v86, v84, s40
  v_perm_b32 v154, v90, v88, s40
  v_perm_b32 v155, v94, v92, s40
  v_perm_b32 v168, v83, v81, s39
  v_perm_b32 v169, v87, v85, s39
  v_perm_b32 v170, v91, v89, s39
  v_perm_b32 v171, v95, v93, s39
  v_perm_b32 v184, v83, v81, s40
  v_perm_b32 v185, v87, v85, s40
  v_perm_b32 v186, v91, v89, s40
  v_perm_b32 v187, v95, v93, s40
  s_add_u32 s33, s37, 1048576
  s_add_u32 m0, s38, 32768
  s_nop 0
  buffer_load_dwordx4 v2, s[20:23], s33 offen lds
  s_add_u32 s33, s37, 1081344
  s_add_u32 m0, s38, 33792
  s_nop 0
  buffer_load_dwordx4 v2, s[20:23], s33 offen lds
  s_add_u32 s33, s37, 1114112
  s_add_u32 m0, s38, 34816
  s_nop 0
  buffer_load_dwordx4 v3, s[20:23], s33 offen lds
  s_add_u32 s33, s37, 1146880
  s_add_u32 m0, s38, 35840
  s_nop 0
  buffer_load_dwordx4 v3, s[20:23], s33 offen lds
  s_waitcnt vmcnt(28)
  v_perm_b32 v140, v98, v96, s39
  v_perm_b32 v141, v102, v100, s39
  v_perm_b32 v142, v106, v104, s39
  v_perm_b32 v143, v110, v108, s39
  v_perm_b32 v156, v98, v96, s40
  v_perm_b32 v157, v102, v100, s40
  v_perm_b32 v158, v106, v104, s40
  v_perm_b32 v159, v110, v108, s40
  v_perm_b32 v172, v99, v97, s39
  v_perm_b32 v173, v103, v101, s39
  v_perm_b32 v174, v107, v105, s39
  v_perm_b32 v175, v111, v109, s39
  v_perm_b32 v188, v99, v97, s40
  v_perm_b32 v189, v103, v101, s40
  v_perm_b32 v190, v107, v105, s40
  v_perm_b32 v191, v111, v109, s40
  s_add_u32 s33, s37, 1572864
  s_add_u32 m0, s38, 49152
  s_nop 0
  buffer_load_dwordx4 v2, s[20:23], s33 offen lds
  s_add_u32 s33, s37, 1605632
  s_add_u32 m0, s38, 50176
  s_nop 0
  buffer_load_dwordx4 v2, s[20:23], s33 offen lds
  s_add_u32 s33, s37, 1638400
  s_add_u32 m0, s38, 51200
  s_nop 0
  buffer_load_dwordx4 v3, s[20:23], s33 offen lds
  s_add_u32 s33, s37, 1671168
  s_add_u32 m0, s38, 52224
  s_nop 0
  buffer_load_dwordx4 v3, s[20:23], s33 offen lds
  s_waitcnt vmcnt(24)
  v_perm_b32 v200, v18, v16, s39
  v_perm_b32 v201, v22, v20, s39
  v_perm_b32 v202, v26, v24, s39
  v_perm_b32 v203, v30, v28, s39
  v_perm_b32 v216, v18, v16, s40
  v_perm_b32 v217, v22, v20, s40
  v_perm_b32 v218, v26, v24, s40
  v_perm_b32 v219, v30, v28, s40
  v_perm_b32 v232, v19, v17, s39
  v_perm_b32 v233, v23, v21, s39
  v_perm_b32 v234, v27, v25, s39
  v_perm_b32 v235, v31, v29, s39
  v_perm_b32 v248, v19, v17, s40
  v_perm_b32 v249, v23, v21, s40
  v_perm_b32 v250, v27, v25, s40
  v_perm_b32 v251, v31, v29, s40
  s_add_u32 s33, s37, 2097152
  s_add_u32 m0, s38, 65536
  s_nop 0
  buffer_load_dwordx4 v2, s[20:23], s33 offen lds
  s_add_u32 s33, s37, 2129920
  s_add_u32 m0, s38, 66560
  s_nop 0
  buffer_load_dwordx4 v2, s[20:23], s33 offen lds
  s_add_u32 s33, s37, 2162688
  s_add_u32 m0, s38, 67584
  s_nop 0
  buffer_load_dwordx4 v3, s[20:23], s33 offen lds
  s_add_u32 s33, s37, 2195456
  s_add_u32 m0, s38, 68608
  s_nop 0
  buffer_load_dwordx4 v3, s[20:23], s33 offen lds
  s_waitcnt vmcnt(20)
  v_perm_b32 v204, v34, v32, s39
  v_perm_b32 v205, v38, v36, s39
  v_perm_b32 v206, v42, v40, s39
  v_perm_b32 v207, v46, v44, s39
  v_perm_b32 v220, v34, v32, s40
  v_perm_b32 v221, v38, v36, s40
  v_perm_b32 v222, v42, v40, s40
  v_perm_b32 v223, v46, v44, s40
  v_perm_b32 v236, v35, v33, s39
  v_perm_b32 v237, v39, v37, s39
  v_perm_b32 v238, v43, v41, s39
  v_perm_b32 v239, v47, v45, s39
  v_perm_b32 v252, v35, v33, s40
  v_perm_b32 v253, v39, v37, s40
  v_perm_b32 v254, v43, v41, s40
  v_perm_b32 v255, v47, v45, s40
  s_add_u32 s33, s37, 2621440
  s_add_u32 m0, s38, 81920
  s_nop 0
  buffer_load_dwordx4 v2, s[20:23], s33 offen lds
  s_add_u32 s33, s37, 2654208
  s_add_u32 m0, s38, 82944
  s_nop 0
  buffer_load_dwordx4 v2, s[20:23], s33 offen lds
  s_add_u32 s33, s37, 2686976
  s_add_u32 m0, s38, 83968
  s_nop 0
  buffer_load_dwordx4 v3, s[20:23], s33 offen lds
  s_add_u32 s33, s37, 2719744
  s_add_u32 m0, s38, 84992
  s_nop 0
  buffer_load_dwordx4 v3, s[20:23], s33 offen lds
  s_waitcnt vmcnt(20)
  s_barrier
  ds_read_b64_tr_b16 a[0:1], v4 offset:0
  ds_read_b64_tr_b16 a[2:3], v4 offset:1024
  ds_read_b64_tr_b16 a[4:5], v4 offset:8192
  ds_read_b64_tr_b16 a[6:7], v4 offset:9216
  ds_read_b64_tr_b16 a[8:9], v5 offset:0
  ds_read_b64_tr_b16 a[10:11], v5 offset:1024
  ds_read_b64_tr_b16 a[12:13], v5 offset:8192
  ds_read_b64_tr_b16 a[14:15], v5 offset:9216
  s_waitcnt lgkmcnt(0)
  s_add_u32 s33, s37, 3145728
  s_add_u32 m0, s38, 98304
  s_nop 0
  buffer_load_dwordx4 v2, s[20:23], s33 offen lds
  s_add_u32 s33, s37, 3178496
  s_add_u32 m0, s38, 99328
  s_nop 0
  buffer_load_dwordx4 v2, s[20:23], s33 offen lds
  s_add_u32 s33, s37, 3211264
  s_add_u32 m0, s38, 100352
  s_nop 0
  buffer_load_dwordx4 v3, s[20:23], s33 offen lds
  s_add_u32 s33, s37, 3244032
  s_add_u32 m0, s38, 101376
  s_nop 0
  buffer_load_dwordx4 v3, s[20:23], s33 offen lds
  s_waitcnt vmcnt(20)
  s_barrier
  ds_read_b64_tr_b16 a[16:17], v4 offset:16384
  ds_read_b64_tr_b16 a[18:19], v4 offset:17408
  ds_read_b64_tr_b16 a[20:21], v4 offset:24576
  ds_read_b64_tr_b16 a[22:23], v4 offset:25600
  ds_read_b64_tr_b16 a[24:25], v5 offset:16384
  ds_read_b64_tr_b16 a[26:27], v5 offset:17408
  ds_read_b64_tr_b16 a[28:29], v5 offset:24576
  ds_read_b64_tr_b16 a[30:31], v5 offset:25600
  v_mov_b32 v20, v0
  v_and_b32 v115, 7, v0
  v_lshlrev_b32 v115, 2, v115
  v_lshlrev_b32 v65, 4, v20
  s_lshl_b32 s33, s3, 11
  v_add_u32 v57, s33, v65
  s_add_u32 s33, s3, 0
  s_and_b32 s33, s33, 3
  s_lshl_b32 s33, s33, 15
  s_lshl_b32 s34, s3, 12
  s_add_u32 s33, s33, s34
  s_add_u32 s33, s33, 32768
  v_add_u32 v58, s33, v65
  s_add_u32 s33, s3, 1
  s_and_b32 s33, s33, 3
  s_lshl_b32 s34, s33, 11
  v_add_u32 v62, s34, v65
  s_lshl_b32 s33, s33, 15
  s_lshl_b32 s34, s3, 12
  s_add_u32 s33, s33, s34
  s_add_u32 s33, s33, 32768
  v_add_u32 v59, s33, v65
  s_add_u32 s33, s3, 2
  s_and_b32 s33, s33, 3
  s_lshl_b32 s34, s33, 11
  v_add_u32 v63, s34, v65
  s_lshl_b32 s33, s33, 15
  s_lshl_b32 s34, s3, 12
  s_add_u32 s33, s33, s34
  s_add_u32 s33, s33, 32768
  v_add_u32 v60, s33, v65
  s_add_u32 s33, s3, 3
  s_and_b32 s33, s33, 3
  s_lshl_b32 s34, s33, 11
  v_add_u32 v64, s34, v65
  s_lshl_b32 s33, s33, 15
  s_lshl_b32 s34, s3, 12
  s_add_u32 s33, s33, s34
  s_add_u32 s33, s33, 32768
  v_add_u32 v61, s33, v65
  v_and_b32 v21, 15, v20
  v_lshrrev_b32 v22, 4, v20
  v_lshrrev_b32 v23, 2, v21
  v_xor_b32 v24, v22, v23
  v_lshlrev_b32 v24, 3, v24
  v_lshlrev_b32 v25, 5, v21
  s_lshl_b32 s33, s3, 10
  s_add_u32 s33, s33, 16384
  v_add3_u32 v66, v24, v25, s33
  v_lshlrev_b32 v24, 2, v22
  v_add_u32 v24, v24, v23
  v_lshlrev_b32 v24, 5, v24
  v_and_b32 v25, 3, v21
  v_xor_b32 v26, v25, v22
  v_lshlrev_b32 v26, 3, v26
  s_mov_b32 s33, 16384
  v_add3_u32 v67, v24, v26, s33
  v_lshlrev_b32 v24, 6, v23
  v_and_b32 v26, 1, v21
  v_lshlrev_b32 v26, 4, v26
  v_lshlrev_b32 v27, 8, v22
  v_add3_u32 v24, v24, v26, v27
  s_lshr_b32 s33, s3, 1
  s_lshl_b32 s33, s33, 10
  s_and_b32 s34, s3, 1
  s_lshl_b32 s34, s34, 5
  s_add_u32 s33, s33, s34
  s_add_u32 s33, s33, 20480
  v_add_u32 v24, s33, v24
  v_xor_b32 v26, 32, v24
  v_add_u32 v26, 0x800, v26
  v_cmp_lt_u32 vcc, 1, v25
  s_nop 1
  v_cndmask_b32 v68, v26, v24, vcc
  v_and_b32 v26, 1, v22
  v_lshlrev_b32 v26, 11, v26
  v_and_b32 v27, 2, v22
  v_lshl_add_u32 v26, v27, 14, v26
  v_lshlrev_b32 v24, 13, v23
  v_lshlrev_b32 v27, 4, v25
  v_add3_u32 v24, v24, v26, v27
  s_lshl_b32 s33, s3, 16
  v_add_u32 v69, s33, v24
  v_mov_b32 v24, 0x44444444
  v_mov_b32 v26, 0xeeeeeeee
  v_cndmask_b32 v71, v24, v26, vcc
  v_bfe_u32 v24, v21, 2, 1
  v_lshlrev_b32 v24, 9, v24
  v_bfe_u32 v26, v21, 3, 1
  v_lshlrev_b32 v26, 7, v26
  v_and_b32 v27, 1, v21
  v_lshlrev_b32 v27, 5, v27
  v_add3_u32 v24, v24, v26, v27
  v_lshlrev_b32 v26, 3, v22
  v_and_b32 v27, 2, v21
  v_lshlrev_b32 v27, 1, v27
  v_add3_u32 v24, v24, v26, v27
  s_lshr_b32 s33, s3, 1
  s_lshl_b32 s33, s33, 10
  s_and_b32 s34, s3, 1
  s_lshl_b32 s34, s34, 8
  s_add_u32 s33, s33, s34
  s_add_u32 s33, s33, 0
  v_add_u32 v72, s33, v24
  v_mov_b32 v24, 0
  ds_write_b32 v66, v24
  ds_write_b32 v66, v24 offset:512
  s_mov_b32 s53, 0x3f80
  s_mov_b32 s64, 0x550055
  s_mov_b32 s65, 0x550055
  s_mov_b32 s66, 0x55005500
  s_mov_b32 s67, 0x55005500
  s_mov_b32 s68, 0x550055
  s_mov_b32 s69, 0x550055
  s_mov_b32 s70, 0x55005500
  s_mov_b32 s71, 0x55005500
  s_mov_b32 s54, 0x3f803f80
  s_mov_b32 s55, 0x3f803f80
  s_mov_b32 s52, 0x3e0293ee
  s_mov_b32 s41, 0
  s_mov_b32 s42, 196608
  s_lshl_b32 s33, s58, 8
  s_add_u32 s43, s33, 204800
  s_add_u32 s44, s33, 524288
  s_lshl_b32 s33, s5, 13
  s_add_u32 s45, s33, 1048576
  s_add_u32 s46, s33, 1310720
  s_add_u32 s50, s33, 16777216
  s_add_u32 s51, s33, 33554432
  s_lshl_b32 s33, s5, 6
  s_add_u32 s47, s33, 1048576
  s_add_u32 s48, s33, 1052672
  s_lshl_b32 s33, s5, 10
  s_lshl_b32 s34, s3, 2
  s_add_u32 s33, s33, s34
  s_add_u32 s49, s33, 0
  s_add_u32 s56, s49, 1008
  s_waitcnt lgkmcnt(0)
  s_add_u32 s33, s37, 3670016
  s_add_u32 m0, s38, 114688
  s_nop 0
  buffer_load_dwordx4 v2, s[20:23], s33 offen lds
  s_add_u32 s33, s37, 3702784
  s_add_u32 m0, s38, 115712
  s_nop 0
  buffer_load_dwordx4 v2, s[20:23], s33 offen lds
  s_add_u32 s33, s37, 3735552
  s_add_u32 m0, s38, 116736
  s_nop 0
  buffer_load_dwordx4 v3, s[20:23], s33 offen lds
  s_add_u32 s33, s37, 3768320
  s_add_u32 m0, s38, 117760
  s_nop 0
  buffer_load_dwordx4 v3, s[20:23], s33 offen lds
  s_waitcnt vmcnt(20)
  s_barrier
  ds_read_b64_tr_b16 a[32:33], v4 offset:32768
  ds_read_b64_tr_b16 a[34:35], v4 offset:33792
  ds_read_b64_tr_b16 a[36:37], v4 offset:40960
  ds_read_b64_tr_b16 a[38:39], v4 offset:41984
  ds_read_b64_tr_b16 a[40:41], v5 offset:32768
  ds_read_b64_tr_b16 a[42:43], v5 offset:33792
  ds_read_b64_tr_b16 a[44:45], v5 offset:40960
  ds_read_b64_tr_b16 a[46:47], v5 offset:41984
  s_waitcnt lgkmcnt(0)
  s_add_u32 s33, s37, 0
  s_add_u32 m0, s38, 0
  s_nop 0
  buffer_load_dwordx4 v2, s[24:27], s33 offen lds
  s_add_u32 s33, s37, 32768
  s_add_u32 m0, s38, 1024
  s_nop 0
  buffer_load_dwordx4 v2, s[24:27], s33 offen lds
  s_add_u32 s33, s37, 65536
  s_add_u32 m0, s38, 2048
  s_nop 0
  buffer_load_dwordx4 v3, s[24:27], s33 offen lds
  s_add_u32 s33, s37, 98304
  s_add_u32 m0, s38, 3072
  s_nop 0
  buffer_load_dwordx4 v3, s[24:27], s33 offen lds
  s_waitcnt vmcnt(20)
  s_barrier
  ds_read_b64_tr_b16 a[48:49], v4 offset:49152
  ds_read_b64_tr_b16 a[50:51], v4 offset:50176
  ds_read_b64_tr_b16 a[52:53], v4 offset:57344
  ds_read_b64_tr_b16 a[54:55], v4 offset:58368
  ds_read_b64_tr_b16 a[56:57], v5 offset:49152
  ds_read_b64_tr_b16 a[58:59], v5 offset:50176
  ds_read_b64_tr_b16 a[60:61], v5 offset:57344
  ds_read_b64_tr_b16 a[62:63], v5 offset:58368
  s_waitcnt lgkmcnt(0)
  s_add_u32 s33, s37, 524288
  s_add_u32 m0, s38, 16384
  s_nop 0
  buffer_load_dwordx4 v2, s[24:27], s33 offen lds
  s_add_u32 s33, s37, 557056
  s_add_u32 m0, s38, 17408
  s_nop 0
  buffer_load_dwordx4 v2, s[24:27], s33 offen lds
  s_add_u32 s33, s37, 589824
  s_add_u32 m0, s38, 18432
  s_nop 0
  buffer_load_dwordx4 v3, s[24:27], s33 offen lds
  s_add_u32 s33, s37, 622592
  s_add_u32 m0, s38, 19456
  s_nop 0
  buffer_load_dwordx4 v3, s[24:27], s33 offen lds
  s_waitcnt vmcnt(20)
  s_barrier
  ds_read_b64_tr_b16 a[64:65], v6 offset:0
  ds_read_b64_tr_b16 a[66:67], v6 offset:1024
  ds_read_b64_tr_b16 a[68:69], v6 offset:8192
  ds_read_b64_tr_b16 a[70:71], v6 offset:9216
  ds_read_b64_tr_b16 a[72:73], v7 offset:0
  ds_read_b64_tr_b16 a[74:75], v7 offset:1024
  ds_read_b64_tr_b16 a[76:77], v7 offset:8192
  ds_read_b64_tr_b16 a[78:79], v7 offset:9216
  s_waitcnt lgkmcnt(0)
  s_add_u32 s33, s37, 1048576
  s_add_u32 m0, s38, 32768
  s_nop 0
  buffer_load_dwordx4 v2, s[24:27], s33 offen lds
  s_add_u32 s33, s37, 1081344
  s_add_u32 m0, s38, 33792
  s_nop 0
  buffer_load_dwordx4 v2, s[24:27], s33 offen lds
  s_add_u32 s33, s37, 1114112
  s_add_u32 m0, s38, 34816
  s_nop 0
  buffer_load_dwordx4 v3, s[24:27], s33 offen lds
  s_add_u32 s33, s37, 1146880
  s_add_u32 m0, s38, 35840
  s_nop 0
  buffer_load_dwordx4 v3, s[24:27], s33 offen lds
  s_waitcnt vmcnt(20)
  s_barrier
  ds_read_b64_tr_b16 a[80:81], v6 offset:16384
  ds_read_b64_tr_b16 a[82:83], v6 offset:17408
  ds_read_b64_tr_b16 a[84:85], v6 offset:24576
  ds_read_b64_tr_b16 a[86:87], v6 offset:25600
  ds_read_b64_tr_b16 a[88:89], v7 offset:16384
  ds_read_b64_tr_b16 a[90:91], v7 offset:17408
  ds_read_b64_tr_b16 a[92:93], v7 offset:24576
  ds_read_b64_tr_b16 a[94:95], v7 offset:25600
  s_waitcnt lgkmcnt(0)
  s_add_u32 s33, s37, 1572864
  s_add_u32 m0, s38, 49152
  s_nop 0
  buffer_load_dwordx4 v2, s[24:27], s33 offen lds
  s_add_u32 s33, s37, 1605632
  s_add_u32 m0, s38, 50176
  s_nop 0
  buffer_load_dwordx4 v2, s[24:27], s33 offen lds
  s_add_u32 s33, s37, 1638400
  s_add_u32 m0, s38, 51200
  s_nop 0
  buffer_load_dwordx4 v3, s[24:27], s33 offen lds
  s_add_u32 s33, s37, 1671168
  s_add_u32 m0, s38, 52224
  s_nop 0
  buffer_load_dwordx4 v3, s[24:27], s33 offen lds
  s_waitcnt vmcnt(20)
  s_barrier
  ds_read_b64_tr_b16 a[96:97], v6 offset:32768
  ds_read_b64_tr_b16 a[98:99], v6 offset:33792
  ds_read_b64_tr_b16 a[100:101], v6 offset:40960
  ds_read_b64_tr_b16 a[102:103], v6 offset:41984
  ds_read_b64_tr_b16 a[104:105], v7 offset:32768
  ds_read_b64_tr_b16 a[106:107], v7 offset:33792
  ds_read_b64_tr_b16 a[108:109], v7 offset:40960
  ds_read_b64_tr_b16 a[110:111], v7 offset:41984
  s_waitcnt lgkmcnt(0)
  s_add_u32 s33, s37, 2097152
  s_add_u32 m0, s38, 65536
  s_nop 0
  buffer_load_dwordx4 v2, s[24:27], s33 offen lds
  s_add_u32 s33, s37, 2129920
  s_add_u32 m0, s38, 66560
  s_nop 0
  buffer_load_dwordx4 v2, s[24:27], s33 offen lds
  s_add_u32 s33, s37, 2162688
  s_add_u32 m0, s38, 67584
  s_nop 0
  buffer_load_dwordx4 v3, s[24:27], s33 offen lds
  s_add_u32 s33, s37, 2195456
  s_add_u32 m0, s38, 68608
  s_nop 0
  buffer_load_dwordx4 v3, s[24:27], s33 offen lds
  s_waitcnt vmcnt(20)
  s_barrier
  ds_read_b64_tr_b16 a[112:113], v6 offset:49152
  ds_read_b64_tr_b16 a[114:115], v6 offset:50176
  ds_read_b64_tr_b16 a[116:117], v6 offset:57344
  ds_read_b64_tr_b16 a[118:119], v6 offset:58368
  ds_read_b64_tr_b16 a[120:121], v7 offset:49152
  ds_read_b64_tr_b16 a[122:123], v7 offset:50176
  ds_read_b64_tr_b16 a[124:125], v7 offset:57344
  ds_read_b64_tr_b16 a[126:127], v7 offset:58368
  s_waitcnt lgkmcnt(0)
  s_add_u32 s33, s37, 2621440
  s_add_u32 m0, s38, 81920
  s_nop 0
  buffer_load_dwordx4 v2, s[24:27], s33 offen lds
  s_add_u32 s33, s37, 2654208
  s_add_u32 m0, s38, 82944
  s_nop 0
  buffer_load_dwordx4 v2, s[24:27], s33 offen lds
  s_add_u32 s33, s37, 2686976
  s_add_u32 m0, s38, 83968
  s_nop 0
  buffer_load_dwordx4 v3, s[24:27], s33 offen lds
  s_add_u32 s33, s37, 2719744
  s_add_u32 m0, s38, 84992
  s_nop 0
  buffer_load_dwordx4 v3, s[24:27], s33 offen lds
  s_waitcnt vmcnt(20)
  s_barrier
  ds_read_b64_tr_b16 a[128:129], v4 offset:0
  ds_read_b64_tr_b16 a[130:131], v4 offset:1024
  ds_read_b64_tr_b16 a[132:133], v4 offset:8192
  ds_read_b64_tr_b16 a[134:135], v4 offset:9216
  ds_read_b64_tr_b16 a[136:137], v5 offset:0
  ds_read_b64_tr_b16 a[138:139], v5 offset:1024
  ds_read_b64_tr_b16 a[140:141], v5 offset:8192
  ds_read_b64_tr_b16 a[142:143], v5 offset:9216
  s_waitcnt lgkmcnt(0)
  s_add_u32 s33, s37, 3145728
  s_add_u32 m0, s38, 98304
  s_nop 0
  buffer_load_dwordx4 v2, s[24:27], s33 offen lds
  s_add_u32 s33, s37, 3178496
  s_add_u32 m0, s38, 99328
  s_nop 0
  buffer_load_dwordx4 v2, s[24:27], s33 offen lds
  s_add_u32 s33, s37, 3211264
  s_add_u32 m0, s38, 100352
  s_nop 0
  buffer_load_dwordx4 v3, s[24:27], s33 offen lds
  s_add_u32 s33, s37, 3244032
  s_add_u32 m0, s38, 101376
  s_nop 0
  buffer_load_dwordx4 v3, s[24:27], s33 offen lds
  s_waitcnt vmcnt(20)
  s_barrier
  ds_read_b64_tr_b16 a[144:145], v4 offset:16384
  ds_read_b64_tr_b16 a[146:147], v4 offset:17408
  ds_read_b64_tr_b16 a[148:149], v4 offset:24576
  ds_read_b64_tr_b16 a[150:151], v4 offset:25600
  ds_read_b64_tr_b16 a[152:153], v5 offset:16384
  ds_read_b64_tr_b16 a[154:155], v5 offset:17408
  ds_read_b64_tr_b16 a[156:157], v5 offset:24576
  ds_read_b64_tr_b16 a[158:159], v5 offset:25600
  s_waitcnt lgkmcnt(0)
  s_add_u32 s33, s37, 3670016
  s_add_u32 m0, s38, 114688
  s_nop 0
  buffer_load_dwordx4 v2, s[24:27], s33 offen lds
  s_add_u32 s33, s37, 3702784
  s_add_u32 m0, s38, 115712
  s_nop 0
  buffer_load_dwordx4 v2, s[24:27], s33 offen lds
  s_add_u32 s33, s37, 3735552
  s_add_u32 m0, s38, 116736
  s_nop 0
  buffer_load_dwordx4 v3, s[24:27], s33 offen lds
  s_add_u32 s33, s37, 3768320
  s_add_u32 m0, s38, 117760
  s_nop 0
  buffer_load_dwordx4 v3, s[24:27], s33 offen lds
  s_waitcnt vmcnt(20)
  s_barrier
  ds_read_b64_tr_b16 a[160:161], v4 offset:32768
  ds_read_b64_tr_b16 a[162:163], v4 offset:33792
  ds_read_b64_tr_b16 a[164:165], v4 offset:40960
  ds_read_b64_tr_b16 a[166:167], v4 offset:41984
  ds_read_b64_tr_b16 a[168:169], v5 offset:32768
  ds_read_b64_tr_b16 a[170:171], v5 offset:33792
  ds_read_b64_tr_b16 a[172:173], v5 offset:40960
  ds_read_b64_tr_b16 a[174:175], v5 offset:41984
  s_waitcnt lgkmcnt(0)
  s_add_u32 s33, s37, 0
  s_add_u32 m0, s38, 0
  s_nop 0
  buffer_load_dwordx4 v2, s[28:31], s33 offen lds
  s_add_u32 s33, s37, 32768
  s_add_u32 m0, s38, 1024
  s_nop 0
  buffer_load_dwordx4 v2, s[28:31], s33 offen lds
  s_add_u32 s33, s37, 65536
  s_add_u32 m0, s38, 2048
  s_nop 0
  buffer_load_dwordx4 v3, s[28:31], s33 offen lds
  s_add_u32 s33, s37, 98304
  s_add_u32 m0, s38, 3072
  s_nop 0
  buffer_load_dwordx4 v3, s[28:31], s33 offen lds
  s_waitcnt vmcnt(20)
  s_barrier
  ds_read_b64_tr_b16 a[176:177], v4 offset:49152
  ds_read_b64_tr_b16 a[178:179], v4 offset:50176
  ds_read_b64_tr_b16 a[180:181], v4 offset:57344
  ds_read_b64_tr_b16 a[182:183], v4 offset:58368
  ds_read_b64_tr_b16 a[184:185], v5 offset:49152
  ds_read_b64_tr_b16 a[186:187], v5 offset:50176
  ds_read_b64_tr_b16 a[188:189], v5 offset:57344
  ds_read_b64_tr_b16 a[190:191], v5 offset:58368
  s_waitcnt lgkmcnt(0)
  s_add_u32 s33, s37, 524288
  s_add_u32 m0, s38, 16384
  s_nop 0
  buffer_load_dwordx4 v2, s[28:31], s33 offen lds
  s_add_u32 s33, s37, 557056
  s_add_u32 m0, s38, 17408
  s_nop 0
  buffer_load_dwordx4 v2, s[28:31], s33 offen lds
  s_add_u32 s33, s37, 589824
  s_add_u32 m0, s38, 18432
  s_nop 0
  buffer_load_dwordx4 v3, s[28:31], s33 offen lds
  s_add_u32 s33, s37, 622592
  s_add_u32 m0, s38, 19456
  s_nop 0
  buffer_load_dwordx4 v3, s[28:31], s33 offen lds
  s_waitcnt vmcnt(20)
  s_barrier
  ds_read_b64_tr_b16 a[192:193], v6 offset:0
  ds_read_b64_tr_b16 a[194:195], v6 offset:1024
  ds_read_b64_tr_b16 a[196:197], v6 offset:8192
  ds_read_b64_tr_b16 a[198:199], v6 offset:9216
  ds_read_b64_tr_b16 a[200:201], v7 offset:0
  ds_read_b64_tr_b16 a[202:203], v7 offset:1024
  ds_read_b64_tr_b16 a[204:205], v7 offset:8192
  ds_read_b64_tr_b16 a[206:207], v7 offset:9216
  s_waitcnt lgkmcnt(0)
  s_add_u32 s33, s37, 1048576
  s_add_u32 m0, s38, 32768
  s_nop 0
  buffer_load_dwordx4 v2, s[28:31], s33 offen lds
  s_add_u32 s33, s37, 1081344
  s_add_u32 m0, s38, 33792
  s_nop 0
  buffer_load_dwordx4 v2, s[28:31], s33 offen lds
  s_add_u32 s33, s37, 1114112
  s_add_u32 m0, s38, 34816
  s_nop 0
  buffer_load_dwordx4 v3, s[28:31], s33 offen lds
  s_add_u32 s33, s37, 1146880
  s_add_u32 m0, s38, 35840
  s_nop 0
  buffer_load_dwordx4 v3, s[28:31], s33 offen lds
  s_waitcnt vmcnt(20)
  s_barrier
  ds_read_b64_tr_b16 a[208:209], v6 offset:16384
  ds_read_b64_tr_b16 a[210:211], v6 offset:17408
  ds_read_b64_tr_b16 a[212:213], v6 offset:24576
  ds_read_b64_tr_b16 a[214:215], v6 offset:25600
  ds_read_b64_tr_b16 a[216:217], v7 offset:16384
  ds_read_b64_tr_b16 a[218:219], v7 offset:17408
  ds_read_b64_tr_b16 a[220:221], v7 offset:24576
  ds_read_b64_tr_b16 a[222:223], v7 offset:25600
  s_waitcnt lgkmcnt(0)
  s_add_u32 s33, s37, 1572864
  s_add_u32 m0, s38, 49152
  s_nop 0
  buffer_load_dwordx4 v2, s[28:31], s33 offen lds
  s_add_u32 s33, s37, 1605632
  s_add_u32 m0, s38, 50176
  s_nop 0
  buffer_load_dwordx4 v2, s[28:31], s33 offen lds
  s_add_u32 s33, s37, 1638400
  s_add_u32 m0, s38, 51200
  s_nop 0
  buffer_load_dwordx4 v3, s[28:31], s33 offen lds
  s_add_u32 s33, s37, 1671168
  s_add_u32 m0, s38, 52224
  s_nop 0
  buffer_load_dwordx4 v3, s[28:31], s33 offen lds
  s_waitcnt vmcnt(20)
  s_barrier
  ds_read_b64_tr_b16 a[224:225], v6 offset:32768
  ds_read_b64_tr_b16 a[226:227], v6 offset:33792
  ds_read_b64_tr_b16 a[228:229], v6 offset:40960
  ds_read_b64_tr_b16 a[230:231], v6 offset:41984
  ds_read_b64_tr_b16 a[232:233], v7 offset:32768
  ds_read_b64_tr_b16 a[234:235], v7 offset:33792
  ds_read_b64_tr_b16 a[236:237], v7 offset:40960
  ds_read_b64_tr_b16 a[238:239], v7 offset:41984
  s_waitcnt lgkmcnt(0)
  s_add_u32 s33, s37, 2097152
  s_add_u32 m0, s38, 65536
  s_nop 0
  buffer_load_dwordx4 v2, s[28:31], s33 offen lds
  s_add_u32 s33, s37, 2129920
  s_add_u32 m0, s38, 66560
  s_nop 0
  buffer_load_dwordx4 v2, s[28:31], s33 offen lds
  s_add_u32 s33, s37, 2162688
  s_add_u32 m0, s38, 67584
  s_nop 0
  buffer_load_dwordx4 v3, s[28:31], s33 offen lds
  s_add_u32 s33, s37, 2195456
  s_add_u32 m0, s38, 68608
  s_nop 0
  buffer_load_dwordx4 v3, s[28:31], s33 offen lds
  s_waitcnt vmcnt(20)
  s_barrier
  ds_read_b64_tr_b16 a[240:241], v6 offset:49152
  ds_read_b64_tr_b16 a[242:243], v6 offset:50176
  ds_read_b64_tr_b16 a[244:245], v6 offset:57344
  ds_read_b64_tr_b16 a[246:247], v6 offset:58368
  ds_read_b64_tr_b16 a[248:249], v7 offset:49152
  ds_read_b64_tr_b16 a[250:251], v7 offset:50176
  ds_read_b64_tr_b16 a[252:253], v7 offset:57344
  ds_read_b64_tr_b16 a[254:255], v7 offset:58368
  buffer_load_dword v116, v115, s[12:15], 0 offen offset:160 sc1
  s_waitcnt lgkmcnt(0)
  s_add_u32 s33, s37, 2621440
  s_add_u32 m0, s38, 81920
  s_nop 0
  buffer_load_dwordx4 v2, s[28:31], s33 offen lds
  s_add_u32 s33, s37, 2654208
  s_add_u32 m0, s38, 82944
  s_nop 0
  buffer_load_dwordx4 v2, s[28:31], s33 offen lds
  s_add_u32 s33, s37, 2686976
  s_add_u32 m0, s38, 83968
  s_nop 0
  buffer_load_dwordx4 v3, s[28:31], s33 offen lds
  s_add_u32 s33, s37, 2719744
  s_add_u32 m0, s38, 84992
  s_nop 0
  buffer_load_dwordx4 v3, s[28:31], s33 offen lds
  s_waitcnt vmcnt(21)
  s_barrier
  ds_read_b64_tr_b16 v[16:17], v4 offset:0
  ds_read_b64_tr_b16 v[18:19], v4 offset:1024
  ds_read_b64_tr_b16 v[20:21], v4 offset:8192
  ds_read_b64_tr_b16 v[22:23], v4 offset:9216
  ds_read_b64_tr_b16 v[24:25], v5 offset:0
  ds_read_b64_tr_b16 v[26:27], v5 offset:1024
  ds_read_b64_tr_b16 v[28:29], v5 offset:8192
  ds_read_b64_tr_b16 v[30:31], v5 offset:9216
  s_waitcnt lgkmcnt(0)
  s_add_u32 s33, s37, 3145728
  s_add_u32 m0, s38, 98304
  s_nop 0
  buffer_load_dwordx4 v2, s[28:31], s33 offen lds
  s_add_u32 s33, s37, 3178496
  s_add_u32 m0, s38, 99328
  s_nop 0
  buffer_load_dwordx4 v2, s[28:31], s33 offen lds
  s_add_u32 s33, s37, 3211264
  s_add_u32 m0, s38, 100352
  s_nop 0
  buffer_load_dwordx4 v3, s[28:31], s33 offen lds
  s_add_u32 s33, s37, 3244032
  s_add_u32 m0, s38, 101376
  s_nop 0
  buffer_load_dwordx4 v3, s[28:31], s33 offen lds
  s_waitcnt vmcnt(21)
  s_barrier
  ds_write_b128 v8, v[16:19] offset:0
  ds_write_b128 v8, v[20:23] offset:1024
  ds_write_b128 v8, v[24:27] offset:2048
  ds_write_b128 v8, v[28:31] offset:3072
  ds_read_b64_tr_b16 v[32:33], v4 offset:16384
  ds_read_b64_tr_b16 v[34:35], v4 offset:17408
  ds_read_b64_tr_b16 v[36:37], v4 offset:24576
  ds_read_b64_tr_b16 v[38:39], v4 offset:25600
  ds_read_b64_tr_b16 v[40:41], v5 offset:16384
  ds_read_b64_tr_b16 v[42:43], v5 offset:17408
  ds_read_b64_tr_b16 v[44:45], v5 offset:24576
  ds_read_b64_tr_b16 v[46:47], v5 offset:25600
  s_waitcnt lgkmcnt(0)
  s_add_u32 s33, s37, 3670016
  s_add_u32 m0, s38, 114688
  s_nop 0
  buffer_load_dwordx4 v2, s[28:31], s33 offen lds
  s_add_u32 s33, s37, 3702784
  s_add_u32 m0, s38, 115712
  s_nop 0
  buffer_load_dwordx4 v2, s[28:31], s33 offen lds
  s_add_u32 s33, s37, 3735552
  s_add_u32 m0, s38, 116736
  s_nop 0
  buffer_load_dwordx4 v3, s[28:31], s33 offen lds
  s_add_u32 s33, s37, 3768320
  s_add_u32 m0, s38, 117760
  s_nop 0
  buffer_load_dwordx4 v3, s[28:31], s33 offen lds
  s_waitcnt vmcnt(21)
  s_barrier
  ds_write_b128 v8, v[32:35] offset:16384
  ds_write_b128 v8, v[36:39] offset:17408
  ds_write_b128 v8, v[40:43] offset:18432
  ds_write_b128 v8, v[44:47] offset:19456
  ds_read_b64_tr_b16 v[16:17], v4 offset:32768
  ds_read_b64_tr_b16 v[18:19], v4 offset:33792
  ds_read_b64_tr_b16 v[20:21], v4 offset:40960
  ds_read_b64_tr_b16 v[22:23], v4 offset:41984
  ds_read_b64_tr_b16 v[24:25], v5 offset:32768
  ds_read_b64_tr_b16 v[26:27], v5 offset:33792
  ds_read_b64_tr_b16 v[28:29], v5 offset:40960
  ds_read_b64_tr_b16 v[30:31], v5 offset:41984
  s_waitcnt lgkmcnt(0)
  s_waitcnt vmcnt(17)
  s_barrier
  ds_write_b128 v8, v[16:19] offset:32768
  ds_write_b128 v8, v[20:23] offset:33792
  ds_write_b128 v8, v[24:27] offset:34816
  ds_write_b128 v8, v[28:31] offset:35840
  ds_read_b64_tr_b16 v[32:33], v4 offset:49152
  ds_read_b64_tr_b16 v[34:35], v4 offset:50176
  ds_read_b64_tr_b16 v[36:37], v4 offset:57344
  ds_read_b64_tr_b16 v[38:39], v4 offset:58368
  ds_read_b64_tr_b16 v[40:41], v5 offset:49152
  ds_read_b64_tr_b16 v[42:43], v5 offset:50176
  ds_read_b64_tr_b16 v[44:45], v5 offset:57344
  ds_read_b64_tr_b16 v[46:47], v5 offset:58368
  s_waitcnt lgkmcnt(0)
  s_waitcnt vmcnt(13)
  s_barrier
  ds_write_b128 v8, v[32:35] offset:49152
  ds_write_b128 v8, v[36:39] offset:50176
  ds_write_b128 v8, v[40:43] offset:51200
  ds_write_b128 v8, v[44:47] offset:52224
  ds_read_b64_tr_b16 v[16:17], v6 offset:0
  ds_read_b64_tr_b16 v[18:19], v6 offset:1024
  ds_read_b64_tr_b16 v[20:21], v6 offset:8192
  ds_read_b64_tr_b16 v[22:23], v6 offset:9216
  ds_read_b64_tr_b16 v[24:25], v7 offset:0
  ds_read_b64_tr_b16 v[26:27], v7 offset:1024
  ds_read_b64_tr_b16 v[28:29], v7 offset:8192
  ds_read_b64_tr_b16 v[30:31], v7 offset:9216
  v_lshlrev_b32 v119, 1, v65
  s_lshl_b32 s34, s3, 11
  s_add_u32 s35, s34, 204800
  buffer_load_dword v114, v119, s[8:11], s35 offen sc1
  s_andn2_b32 s35, s46, 0x2000
  s_lshl_b32 s34, s34, 1
  s_add_u32 s35, s35, s34
  v_lshlrev_b32 v119, 1, v119
  buffer_load_dword v119, v119, s[8:11], s35 offen sc1
  s_waitcnt lgkmcnt(0)
  s_waitcnt vmcnt(10)
  s_barrier
  ds_write_b128 v9, v[16:19] offset:0
  ds_write_b128 v9, v[20:23] offset:1024
  ds_write_b128 v9, v[24:27] offset:2048
  ds_write_b128 v9, v[28:31] offset:3072
  ds_read_b64_tr_b16 v[32:33], v6 offset:16384
  ds_read_b64_tr_b16 v[34:35], v6 offset:17408
  ds_read_b64_tr_b16 v[36:37], v6 offset:24576
  ds_read_b64_tr_b16 v[38:39], v6 offset:25600
  ds_read_b64_tr_b16 v[40:41], v7 offset:16384
  ds_read_b64_tr_b16 v[42:43], v7 offset:17408
  ds_read_b64_tr_b16 v[44:45], v7 offset:24576
  ds_read_b64_tr_b16 v[46:47], v7 offset:25600
  buffer_load_dword v117, off, s[8:11], s49 sc1
  buffer_load_dword v118, off, s[8:11], s49 offset:16 sc1
  s_waitcnt lgkmcnt(0)
  s_waitcnt vmcnt(8)
  s_barrier
  ds_write_b128 v9, v[32:35] offset:16384
  ds_write_b128 v9, v[36:39] offset:17408
  ds_write_b128 v9, v[40:43] offset:18432
  ds_write_b128 v9, v[44:47] offset:19456
  ds_read_b64_tr_b16 v[16:17], v6 offset:32768
  ds_read_b64_tr_b16 v[18:19], v6 offset:33792
  ds_read_b64_tr_b16 v[20:21], v6 offset:40960
  ds_read_b64_tr_b16 v[22:23], v6 offset:41984
  ds_read_b64_tr_b16 v[24:25], v7 offset:32768
  ds_read_b64_tr_b16 v[26:27], v7 offset:33792
  ds_read_b64_tr_b16 v[28:29], v7 offset:40960
  ds_read_b64_tr_b16 v[30:31], v7 offset:41984
  s_waitcnt lgkmcnt(0)
  s_waitcnt vmcnt(4)
  s_barrier
  ds_write_b128 v9, v[16:19] offset:32768
  ds_write_b128 v9, v[20:23] offset:33792
  ds_write_b128 v9, v[24:27] offset:34816
  ds_write_b128 v9, v[28:31] offset:35840
  ds_read_b64_tr_b16 v[32:33], v6 offset:49152
  ds_read_b64_tr_b16 v[34:35], v6 offset:50176
  ds_read_b64_tr_b16 v[36:37], v6 offset:57344
  ds_read_b64_tr_b16 v[38:39], v6 offset:58368
  ds_read_b64_tr_b16 v[40:41], v7 offset:49152
  ds_read_b64_tr_b16 v[42:43], v7 offset:50176
  ds_read_b64_tr_b16 v[44:45], v7 offset:57344
  ds_read_b64_tr_b16 v[46:47], v7 offset:58368
  s_mov_b32 s57, 0
  s_waitcnt vmcnt(0)
  v_readlane_b32 s33, v116, s4
  v_and_b32 v116, 63, v116
  v_cmp_ne_u32 s[58:59], 32, v116
  v_min_u32 v117, v117, v118
  v_cmp_eq_u32 vcc, 0, v117
  s_nop 3
  s_or_b64 vcc, vcc, s[58:59]
  s_cbranch_vccnz JD_7
  s_bfe_u32 s34, s33, 0x80006
  s_mul_i32 s34, s34, s34
  s_lshr_b32 s33, s33, 14
  s_lshl_b32 s33, s33, 5
  s_cmp_lg_u32 s33, s34
  s_cselect_b32 s7, 1, 0
  buffer_load_dwordx4 v[120:123], v57, s[8:11], s50 offen offset:0 sc1
  buffer_load_dwordx4 v[124:127], v57, s[8:11], s50 offen offset:1024 sc1
  buffer_load_dwordx4 v[48:51], v57, s[8:11], s42 offen offset:0 sc1
  buffer_load_dwordx4 v[48:51], v57, s[8:11], s42 offen offset:0 sc1
  buffer_load_dwordx4 v[52:55], v57, s[8:11], s42 offen offset:1024 sc1
  buffer_load_dwordx4 v[52:55], v57, s[8:11], s42 offen offset:1024 sc1
  s_mov_b32 s57, 1
JD_7:
  s_waitcnt lgkmcnt(0)
  s_barrier
  ds_write_b128 v9, v[32:35] offset:49152
  ds_write_b128 v9, v[36:39] offset:50176
  ds_write_b128 v9, v[40:43] offset:51200
  ds_write_b128 v9, v[44:47] offset:52224
  s_waitcnt lgkmcnt(0)
  s_branch LOADED_1
LDW1_3:
  s_add_u32 s33, s36, 0
  buffer_load_dwordx2 v[16:17], v1, s[16:19], s33 offen offset:0
  buffer_load_dwordx2 v[18:19], v1, s[16:19], s33 offen offset:1024
  buffer_load_dwordx2 v[24:25], v1, s[16:19], s33 offen offset:2048
  buffer_load_dwordx2 v[26:27], v1, s[16:19], s33 offen offset:3072
  s_add_u32 s33, s36, 32768
  buffer_load_dwordx2 v[20:21], v1, s[16:19], s33 offen offset:0
  buffer_load_dwordx2 v[22:23], v1, s[16:19], s33 offen offset:1024
  buffer_load_dwordx2 v[28:29], v1, s[16:19], s33 offen offset:2048
  buffer_load_dwordx2 v[30:31], v1, s[16:19], s33 offen offset:3072
  s_add_u32 s33, s36, 8192
  buffer_load_dwordx2 v[32:33], v1, s[16:19], s33 offen offset:0
  buffer_load_dwordx2 v[34:35], v1, s[16:19], s33 offen offset:1024
  buffer_load_dwordx2 v[40:41], v1, s[16:19], s33 offen offset:2048
  buffer_load_dwordx2 v[42:43], v1, s[16:19], s33 offen offset:3072
  s_add_u32 s33, s36, 40960
  buffer_load_dwordx2 v[36:37], v1, s[16:19], s33 offen offset:0
  buffer_load_dwordx2 v[38:39], v1, s[16:19], s33 offen offset:1024
  buffer_load_dwordx2 v[44:45], v1, s[16:19], s33 offen offset:2048
  buffer_load_dwordx2 v[46:47], v1, s[16:19], s33 offen offset:3072
  s_add_u32 s33, s36, 0
  buffer_load_dwordx2 v[48:49], v1, s[16:19], s33 offen offset:128
  buffer_load_dwordx2 v[50:51], v1, s[16:19], s33 offen offset:1152
  buffer_load_dwordx2 v[56:57], v1, s[16:19], s33 offen offset:2176
  buffer_load_dwordx2 v[58:59], v1, s[16:19], s33 offen offset:3200
  s_add_u32 s33, s36, 32768
  buffer_load_dwordx2 v[52:53], v1, s[16:19], s33 offen offset:128
  buffer_load_dwordx2 v[54:55], v1, s[16:19], s33 offen offset:1152
  buffer_load_dwordx2 v[60:61], v1, s[16:19], s33 offen offset:2176
  buffer_load_dwordx2 v[62:63], v1, s[16:19], s33 offen offset:3200
  s_add_u32 s33, s36, 8192
  buffer_load_dwordx2 v[64:65], v1, s[16:19], s33 offen offset:128
  buffer_load_dwordx2 v[66:67], v1, s[16:19], s33 offen offset:1152
  buffer_load_dwordx2 v[72:73], v1, s[16:19], s33 offen offset:2176
  buffer_load_dwordx2 v[74:75], v1, s[16:19], s33 offen offset:3200
  s_add_u32 s33, s36, 40960
  buffer_load_dwordx2 v[68:69], v1, s[16:19], s33 offen offset:128
  buffer_load_dwordx2 v[70:71], v1, s[16:19], s33 offen offset:1152
  buffer_load_dwordx2 v[76:77], v1, s[16:19], s33 offen offset:2176
  buffer_load_dwordx2 v[78:79], v1, s[16:19], s33 offen offset:3200
  s_add_u32 s33, s36, 65536
  buffer_load_dwordx2 v[80:81], v1, s[16:19], s33 offen offset:0
  buffer_load_dwordx2 v[82:83], v1, s[16:19], s33 offen offset:1024
  buffer_load_dwordx2 v[88:89], v1, s[16:19], s33 offen offset:2048
  buffer_load_dwordx2 v[90:91], v1, s[16:19], s33 offen offset:3072
  s_add_u32 s33, s36, 98304
  buffer_load_dwordx2 v[84:85], v1, s[16:19], s33 offen offset:0
  buffer_load_dwordx2 v[86:87], v1, s[16:19], s33 offen offset:1024
  buffer_load_dwordx2 v[92:93], v1, s[16:19], s33 offen offset:2048
  buffer_load_dwordx2 v[94:95], v1, s[16:19], s33 offen offset:3072
  s_add_u32 s33, s36, 73728
  buffer_load_dwordx2 v[96:97], v1, s[16:19], s33 offen offset:0
  buffer_load_dwordx2 v[98:99], v1, s[16:19], s33 offen offset:1024
  buffer_load_dwordx2 v[104:105], v1, s[16:19], s33 offen offset:2048
  buffer_load_dwordx2 v[106:107], v1, s[16:19], s33 offen offset:3072
  s_add_u32 s33, s36, 106496
  buffer_load_dwordx2 v[100:101], v1, s[16:19], s33 offen offset:0
  buffer_load_dwordx2 v[102:103], v1, s[16:19], s33 offen offset:1024
  buffer_load_dwordx2 v[108:109], v1, s[16:19], s33 offen offset:2048
  buffer_load_dwordx2 v[110:111], v1, s[16:19], s33 offen offset:3072
  s_waitcnt vmcnt(40)
  s_barrier
  s_cmp_lg_u32 s3, 0
  s_cbranch_scc1 SIG_8
  s_lshl_b32 s33, s4, 2
  v_mov_b32 v10, s32
  s_mov_b64 exec, 1
  buffer_atomic_add v10, off, s[12:15], s33 offset:160 sc1
  s_mov_b64 exec, -1
SIG_8:
  v_perm_b32 v128, v18, v16, s39
  v_perm_b32 v129, v22, v20, s39
  v_perm_b32 v130, v26, v24, s39
  v_perm_b32 v131, v30, v28, s39
  v_perm_b32 v144, v18, v16, s40
  v_perm_b32 v145, v22, v20, s40
  v_perm_b32 v146, v26, v24, s40
  v_perm_b32 v147, v30, v28, s40
  v_perm_b32 v160, v19, v17, s39
  v_perm_b32 v161, v23, v21, s39
  v_perm_b32 v162, v27, v25, s39
  v_perm_b32 v163, v31, v29, s39
  v_perm_b32 v176, v19, v17, s40
  v_perm_b32 v177, v23, v21, s40
  v_perm_b32 v178, v27, v25, s40
  v_perm_b32 v179, v31, v29, s40
  s_add_u32 s33, s36, 65536
  buffer_load_dwordx2 v[16:17], v1, s[16:19], s33 offen offset:128
  buffer_load_dwordx2 v[18:19], v1, s[16:19], s33 offen offset:1152
  buffer_load_dwordx2 v[24:25], v1, s[16:19], s33 offen offset:2176
  buffer_load_dwordx2 v[26:27], v1, s[16:19], s33 offen offset:3200
  s_add_u32 s33, s36, 98304
  buffer_load_dwordx2 v[20:21], v1, s[16:19], s33 offen offset:128
  buffer_load_dwordx2 v[22:23], v1, s[16:19], s33 offen offset:1152
  buffer_load_dwordx2 v[28:29], v1, s[16:19], s33 offen offset:2176
  buffer_load_dwordx2 v[30:31], v1, s[16:19], s33 offen offset:3200
  s_waitcnt vmcnt(40)
  v_perm_b32 v132, v34, v32, s39
  v_perm_b32 v133, v38, v36, s39
  v_perm_b32 v134, v42, v40, s39
  v_perm_b32 v135, v46, v44, s39
  v_perm_b32 v148, v34, v32, s40
  v_perm_b32 v149, v38, v36, s40
  v_perm_b32 v150, v42, v40, s40
  v_perm_b32 v151, v46, v44, s40
  v_perm_b32 v164, v35, v33, s39
  v_perm_b32 v165, v39, v37, s39
  v_perm_b32 v166, v43, v41, s39
  v_perm_b32 v167, v47, v45, s39
  v_perm_b32 v180, v35, v33, s40
  v_perm_b32 v181, v39, v37, s40
  v_perm_b32 v182, v43, v41, s40
  v_perm_b32 v183, v47, v45, s40
  s_add_u32 s33, s36, 73728
  buffer_load_dwordx2 v[32:33], v1, s[16:19], s33 offen offset:128
  buffer_load_dwordx2 v[34:35], v1, s[16:19], s33 offen offset:1152
  buffer_load_dwordx2 v[40:41], v1, s[16:19], s33 offen offset:2176
  buffer_load_dwordx2 v[42:43], v1, s[16:19], s33 offen offset:3200
  s_add_u32 s33, s36, 106496
  buffer_load_dwordx2 v[36:37], v1, s[16:19], s33 offen offset:128
  buffer_load_dwordx2 v[38:39], v1, s[16:19], s33 offen offset:1152
  buffer_load_dwordx2 v[44:45], v1, s[16:19], s33 offen offset:2176
  buffer_load_dwordx2 v[46:47], v1, s[16:19], s33 offen offset:3200
  s_waitcnt vmcnt(40)
  v_perm_b32 v192, v50, v48, s39
  v_perm_b32 v193, v54, v52, s39
  v_perm_b32 v194, v58, v56, s39
  v_perm_b32 v195, v62, v60, s39
  v_perm_b32 v208, v50, v48, s40
  v_perm_b32 v209, v54, v52, s40
  v_perm_b32 v210, v58, v56, s40
  v_perm_b32 v211, v62, v60, s40
  v_perm_b32 v224, v51, v49, s39
  v_perm_b32 v225, v55, v53, s39
  v_perm_b32 v226, v59, v57, s39
  v_perm_b32 v227, v63, v61, s39
  v_perm_b32 v240, v51, v49, s40
  v_perm_b32 v241, v55, v53, s40
  v_perm_b32 v242, v59, v57, s40
  v_perm_b32 v243, v63, v61, s40
  s_add_u32 s33, s37, 0
  s_add_u32 m0, s38, 0
  s_nop 0
  buffer_load_dwordx4 v2, s[20:23], s33 offen lds
  s_add_u32 s33, s37, 32768
  s_add_u32 m0, s38, 1024
  s_nop 0
  buffer_load_dwordx4 v2, s[20:23], s33 offen lds
  s_add_u32 s33, s37, 65536
  s_add_u32 m0, s38, 2048
  s_nop 0
  buffer_load_dwordx4 v3, s[20:23], s33 offen lds
  s_add_u32 s33, s37, 98304
  s_add_u32 m0, s38, 3072
  s_nop 0
  buffer_load_dwordx4 v3, s[20:23], s33 offen lds
  s_waitcnt vmcnt(36)
  v_perm_b32 v196, v66, v64, s39
  v_perm_b32 v197, v70, v68, s39
  v_perm_b32 v198, v74, v72, s39
  v_perm_b32 v199, v78, v76, s39
  v_perm_b32 v212, v66, v64, s40
  v_perm_b32 v213, v70, v68, s40
  v_perm_b32 v214, v74, v72, s40
  v_perm_b32 v215, v78, v76, s40
  v_perm_b32 v228, v67, v65, s39
  v_perm_b32 v229, v71, v69, s39
  v_perm_b32 v230, v75, v73, s39
  v_perm_b32 v231, v79, v77, s39
  v_perm_b32 v244, v67, v65, s40
  v_perm_b32 v245, v71, v69, s40
  v_perm_b32 v246, v75, v73, s40
  v_perm_b32 v247, v79, v77, s40
  s_add_u32 s33, s37, 524288
  s_add_u32 m0, s38, 16384
  s_nop 0
  buffer_load_dwordx4 v2, s[20:23], s33 offen lds
  s_add_u32 s33, s37, 557056
  s_add_u32 m0, s38, 17408
  s_nop 0
  buffer_load_dwordx4 v2, s[20:23], s33 offen lds
  s_add_u32 s33, s37, 589824
  s_add_u32 m0, s38, 18432
  s_nop 0
  buffer_load_dwordx4 v3, s[20:23], s33 offen lds
  s_add_u32 s33, s37, 622592
  s_add_u32 m0, s38, 19456
  s_nop 0
  buffer_load_dwordx4 v3, s[20:23], s33 offen lds
  s_waitcnt vmcnt(32)
  v_perm_b32 v136, v82, v80, s39
  v_perm_b32 v137, v86, v84, s39
  v_perm_b32 v138, v90, v88, s39
  v_perm_b32 v139, v94, v92, s39
  v_perm_b32 v152, v82, v80, s40
  v_perm_b32 v153, v86, v84, s40
  v_perm_b32 v154, v90, v88, s40
  v_perm_b32 v155, v94, v92, s40
  v_perm_b32 v168, v83, v81, s39
  v_perm_b32 v169, v87, v85, s39
  v_perm_b32 v170, v91, v89, s39
  v_perm_b32 v171, v95, v93, s39
  v_perm_b32 v184, v83, v81, s40
  v_perm_b32 v185, v87, v85, s40
  v_perm_b32 v186, v91, v89, s40
  v_perm_b32 v187, v95, v93, s40
  s_add_u32 s33, s37, 1048576
  s_add_u32 m0, s38, 32768
  s_nop 0
  buffer_load_dwordx4 v2, s[20:23], s33 offen lds
  s_add_u32 s33, s37, 1081344
  s_add_u32 m0, s38, 33792
  s_nop 0
  buffer_load_dwordx4 v2, s[20:23], s33 offen lds
  s_add_u32 s33, s37, 1114112
  s_add_u32 m0, s38, 34816
  s_nop 0
  buffer_load_dwordx4 v3, s[20:23], s33 offen lds
  s_add_u32 s33, s37, 1146880
  s_add_u32 m0, s38, 35840
  s_nop 0
  buffer_load_dwordx4 v3, s[20:23], s33 offen lds
  s_waitcnt vmcnt(28)
  v_perm_b32 v140, v98, v96, s39
  v_perm_b32 v141, v102, v100, s39
  v_perm_b32 v142, v106, v104, s39
  v_perm_b32 v143, v110, v108, s39
  v_perm_b32 v156, v98, v96, s40
  v_perm_b32 v157, v102, v100, s40
  v_perm_b32 v158, v106, v104, s40
  v_perm_b32 v159, v110, v108, s40
  v_perm_b32 v172, v99, v97, s39
  v_perm_b32 v173, v103, v101, s39
  v_perm_b32 v174, v107, v105, s39
  v_perm_b32 v175, v111, v109, s39
  v_perm_b32 v188, v99, v97, s40
  v_perm_b32 v189, v103, v101, s40
  v_perm_b32 v190, v107, v105, s40
  v_perm_b32 v191, v111, v109, s40
  s_add_u32 s33, s37, 1572864
  s_add_u32 m0, s38, 49152
  s_nop 0
  buffer_load_dwordx4 v2, s[20:23], s33 offen lds
  s_add_u32 s33, s37, 1605632
  s_add_u32 m0, s38, 50176
  s_nop 0
  buffer_load_dwordx4 v2, s[20:23], s33 offen lds
  s_add_u32 s33, s37, 1638400
  s_add_u32 m0, s38, 51200
  s_nop 0
  buffer_load_dwordx4 v3, s[20:23], s33 offen lds
  s_add_u32 s33, s37, 1671168
  s_add_u32 m0, s38, 52224
  s_nop 0
  buffer_load_dwordx4 v3, s[20:23], s33 offen lds
  s_waitcnt vmcnt(24)
  v_perm_b32 v200, v18, v16, s39
  v_perm_b32 v201, v22, v20, s39
  v_perm_b32 v202, v26, v24, s39
  v_perm_b32 v203, v30, v28, s39
  v_perm_b32 v216, v18, v16, s40
  v_perm_b32 v217, v22, v20, s40
  v_perm_b32 v218, v26, v24, s40
  v_perm_b32 v219, v30, v28, s40
  v_perm_b32 v232, v19, v17, s39
  v_perm_b32 v233, v23, v21, s39
  v_perm_b32 v234, v27, v25, s39
  v_perm_b32 v235, v31, v29, s39
  v_perm_b32 v248, v19, v17, s40
  v_perm_b32 v249, v23, v21, s40
  v_perm_b32 v250, v27, v25, s40
  v_perm_b32 v251, v31, v29, s40
  s_add_u32 s33, s37, 2097152
  s_add_u32 m0, s38, 65536
  s_nop 0
  buffer_load_dwordx4 v2, s[20:23], s33 offen lds
  s_add_u32 s33, s37, 2129920
  s_add_u32 m0, s38, 66560
  s_nop 0
  buffer_load_dwordx4 v2, s[20:23], s33 offen lds
  s_add_u32 s33, s37, 2162688
  s_add_u32 m0, s38, 67584
  s_nop 0
  buffer_load_dwordx4 v3, s[20:23], s33 offen lds
  s_add_u32 s33, s37, 2195456
  s_add_u32 m0, s38, 68608
  s_nop 0
  buffer_load_dwordx4 v3, s[20:23], s33 offen lds
  s_waitcnt vmcnt(20)
  v_perm_b32 v204, v34, v32, s39
  v_perm_b32 v205, v38, v36, s39
  v_perm_b32 v206, v42, v40, s39
  v_perm_b32 v207, v46, v44, s39
  v_perm_b32 v220, v34, v32, s40
  v_perm_b32 v221, v38, v36, s40
  v_perm_b32 v222, v42, v40, s40
  v_perm_b32 v223, v46, v44, s40
  v_perm_b32 v236, v35, v33, s39
  v_perm_b32 v237, v39, v37, s39
  v_perm_b32 v238, v43, v41, s39
  v_perm_b32 v239, v47, v45, s39
  v_perm_b32 v252, v35, v33, s40
  v_perm_b32 v253, v39, v37, s40
  v_perm_b32 v254, v43, v41, s40
  v_perm_b32 v255, v47, v45, s40
  s_add_u32 s33, s37, 2621440
  s_add_u32 m0, s38, 81920
  s_nop 0
  buffer_load_dwordx4 v2, s[20:23], s33 offen lds
  s_add_u32 s33, s37, 2654208
  s_add_u32 m0, s38, 82944
  s_nop 0
  buffer_load_dwordx4 v2, s[20:23], s33 offen lds
  s_add_u32 s33, s37, 2686976
  s_add_u32 m0, s38, 83968
  s_nop 0
  buffer_load_dwordx4 v3, s[20:23], s33 offen lds
  s_add_u32 s33, s37, 2719744
  s_add_u32 m0, s38, 84992
  s_nop 0
  buffer_load_dwordx4 v3, s[20:23], s33 offen lds
  s_waitcnt vmcnt(20)
  s_barrier
  ds_read_b64_tr_b16 a[96:97], v4 offset:0
  ds_read_b64_tr_b16 a[98:99], v4 offset:1024
  ds_read_b64_tr_b16 a[100:101], v4 offset:8192
  ds_read_b64_tr_b16 a[102:103], v4 offset:9216
  ds_read_b64_tr_b16 a[104:105], v5 offset:0
  ds_read_b64_tr_b16 a[106:107], v5 offset:1024
  ds_read_b64_tr_b16 a[108:109], v5 offset:8192
  ds_read_b64_tr_b16 a[110:111], v5 offset:9216
  s_waitcnt lgkmcnt(0)
  s_add_u32 s33, s37, 3145728
  s_add_u32 m0, s38, 98304
  s_nop 0
  buffer_load_dwordx4 v2, s[20:23], s33 offen lds
  s_add_u32 s33, s37, 3178496
  s_add_u32 m0, s38, 99328
  s_nop 0
  buffer_load_dwordx4 v2, s[20:23], s33 offen lds
  s_add_u32 s33, s37, 3211264
  s_add_u32 m0, s38, 100352
  s_nop 0
  buffer_load_dwordx4 v3, s[20:23], s33 offen lds
  s_add_u32 s33, s37, 3244032
  s_add_u32 m0, s38, 101376
  s_nop 0
  buffer_load_dwordx4 v3, s[20:23], s33 offen lds
  s_waitcnt vmcnt(20)
  s_barrier
  ds_read_b64_tr_b16 a[112:113], v4 offset:16384
  ds_read_b64_tr_b16 a[114:115], v4 offset:17408
  ds_read_b64_tr_b16 a[116:117], v4 offset:24576
  ds_read_b64_tr_b16 a[118:119], v4 offset:25600
  ds_read_b64_tr_b16 a[120:121], v5 offset:16384
  ds_read_b64_tr_b16 a[122:123], v5 offset:17408
  ds_read_b64_tr_b16 a[124:125], v5 offset:24576
  ds_read_b64_tr_b16 a[126:127], v5 offset:25600
  v_mov_b32 v20, v0
  v_and_b32 v115, 7, v0
  v_lshlrev_b32 v115, 2, v115
  v_lshlrev_b32 v65, 4, v20
  s_lshl_b32 s33, s3, 11
  v_add_u32 v57, s33, v65
  s_add_u32 s33, s3, 0
  s_and_b32 s33, s33, 3
  s_lshl_b32 s33, s33, 15
  s_lshl_b32 s34, s3, 12
  s_add_u32 s33, s33, s34
  s_add_u32 s33, s33, 32768
  v_add_u32 v58, s33, v65
  s_add_u32 s33, s3, 1
  s_and_b32 s33, s33, 3
  s_lshl_b32 s34, s33, 11
  v_add_u32 v62, s34, v65
  s_lshl_b32 s33, s33, 15
  s_lshl_b32 s34, s3, 12
  s_add_u32 s33, s33, s34
  s_add_u32 s33, s33, 32768
  v_add_u32 v59, s33, v65
  s_add_u32 s33, s3, 2
  s_and_b32 s33, s33, 3
  s_lshl_b32 s34, s33, 11
  v_add_u32 v63, s34, v65
  s_lshl_b32 s33, s33, 15
  s_lshl_b32 s34, s3, 12
  s_add_u32 s33, s33, s34
  s_add_u32 s33, s33, 32768
  v_add_u32 v60, s33, v65
  s_add_u32 s33, s3, 3
  s_and_b32 s33, s33, 3
  s_lshl_b32 s34, s33, 11
  v_add_u32 v64, s34, v65
  s_lshl_b32 s33, s33, 15
  s_lshl_b32 s34, s3, 12
  s_add_u32 s33, s33, s34
  s_add_u32 s33, s33, 32768
  v_add_u32 v61, s33, v65
  v_and_b32 v21, 15, v20
  v_lshrrev_b32 v22, 4, v20
  v_lshrrev_b32 v23, 2, v21
  v_xor_b32 v24, v22, v23
  v_lshlrev_b32 v24, 3, v24
  v_lshlrev_b32 v25, 5, v21
  s_lshl_b32 s33, s3, 10
  s_add_u32 s33, s33, 16384
  v_add3_u32 v66, v24, v25, s33
  v_lshlrev_b32 v24, 2, v22
  v_add_u32 v24, v24, v23
  v_lshlrev_b32 v24, 5, v24
  v_and_b32 v25, 3, v21
  v_xor_b32 v26, v25, v22
  v_lshlrev_b32 v26, 3, v26
  s_mov_b32 s33, 16384
  v_add3_u32 v67, v24, v26, s33
  v_lshlrev_b32 v24, 6, v23
  v_and_b32 v26, 1, v21
  v_lshlrev_b32 v26, 4, v26
  v_lshlrev_b32 v27, 8, v22
  v_add3_u32 v24, v24, v26, v27
  s_lshr_b32 s33, s3, 1
  s_lshl_b32 s33, s33, 10
  s_and_b32 s34, s3, 1
  s_lshl_b32 s34, s34, 5
  s_add_u32 s33, s33, s34
  s_add_u32 s33, s33, 20480
  v_add_u32 v24, s33, v24
  v_xor_b32 v26, 32, v24
  v_add_u32 v26, 0x800, v26
  v_cmp_lt_u32 vcc, 1, v25
  s_nop 1
  v_cndmask_b32 v68, v26, v24, vcc
  v_and_b32 v26, 1, v22
  v_lshlrev_b32 v26, 11, v26
  v_and_b32 v27, 2, v22
  v_lshl_add_u32 v26, v27, 14, v26
  v_lshlrev_b32 v24, 13, v23
  v_lshlrev_b32 v27, 4, v25
  v_add3_u32 v24, v24, v26, v27
  s_lshl_b32 s33, s3, 16
  v_add_u32 v69, s33, v24
  v_mov_b32 v24, 0x44444444
  v_mov_b32 v26, 0xeeeeeeee
  v_cndmask_b32 v71, v24, v26, vcc
  v_bfe_u32 v24, v21, 2, 1
  v_lshlrev_b32 v24, 9, v24
  v_bfe_u32 v26, v21, 3, 1
  v_lshlrev_b32 v26, 7, v26
  v_and_b32 v27, 1, v21
  v_lshlrev_b32 v27, 5, v27
  v_add3_u32 v24, v24, v26, v27
  v_lshlrev_b32 v26, 3, v22
  v_and_b32 v27, 2, v21
  v_lshlrev_b32 v27, 1, v27
  v_add3_u32 v24, v24, v26, v27
  s_lshr_b32 s33, s3, 1
  s_lshl_b32 s33, s33, 10
  s_and_b32 s34, s3, 1
  s_lshl_b32 s34, s34, 8
  s_add_u32 s33, s33, s34
  s_add_u32 s33, s33, 0
  v_add_u32 v72, s33, v24
  v_mov_b32 v24, 0
  ds_write_b32 v66, v24
  ds_write_b32 v66, v24 offset:512
  s_mov_b32 s53, 0x3f80
  s_mov_b32 s64, 0x550055
  s_mov_b32 s65, 0x550055
  s_mov_b32 s66, 0x55005500
  s_mov_b32 s67, 0x55005500
  s_mov_b32 s68, 0x550055
  s_mov_b32 s69, 0x550055
  s_mov_b32 s70, 0x55005500
  s_mov_b32 s71, 0x55005500
  s_mov_b32 s54, 0x3f803f80
  s_mov_b32 s55, 0x3f803f80
  s_mov_b32 s52, 0x3e0293ee
  s_mov_b32 s41, 0
  s_mov_b32 s42, 196608
  s_lshl_b32 s33, s58, 8
  s_add_u32 s43, s33, 204800
  s_add_u32 s44, s33, 524288
  s_lshl_b32 s33, s5, 13
  s_add_u32 s45, s33, 1048576
  s_add_u32 s46, s33, 1310720
  s_add_u32 s50, s33, 16777216
  s_add_u32 s51, s33, 33554432
  s_lshl_b32 s33, s5, 6
  s_add_u32 s47, s33, 1048576
  s_add_u32 s48, s33, 1052672
  s_lshl_b32 s33, s5, 10
  s_lshl_b32 s34, s3, 2
  s_add_u32 s33, s33, s34
  s_add_u32 s49, s33, 0
  s_add_u32 s56, s49, 1008
  s_waitcnt lgkmcnt(0)
  s_add_u32 s33, s37, 3670016
  s_add_u32 m0, s38, 114688
  s_nop 0
  buffer_load_dwordx4 v2, s[20:23], s33 offen lds
  s_add_u32 s33, s37, 3702784
  s_add_u32 m0, s38, 115712
  s_nop 0
  buffer_load_dwordx4 v2, s[20:23], s33 offen lds
  s_add_u32 s33, s37, 3735552
  s_add_u32 m0, s38, 116736
  s_nop 0
  buffer_load_dwordx4 v3, s[20:23], s33 offen lds
  s_add_u32 s33, s37, 3768320
  s_add_u32 m0, s38, 117760
  s_nop 0
  buffer_load_dwordx4 v3, s[20:23], s33 offen lds
  s_waitcnt vmcnt(20)
  s_barrier
  ds_read_b64_tr_b16 a[0:1], v4 offset:32768
  ds_read_b64_tr_b16 a[2:3], v4 offset:33792
  ds_read_b64_tr_b16 a[4:5], v4 offset:40960
  ds_read_b64_tr_b16 a[6:7], v4 offset:41984
  ds_read_b64_tr_b16 a[8:9], v5 offset:32768
  ds_read_b64_tr_b16 a[10:11], v5 offset:33792
  ds_read_b64_tr_b16 a[12:13], v5 offset:40960
  ds_read_b64_tr_b16 a[14:15], v5 offset:41984
  s_waitcnt lgkmcnt(0)
  s_add_u32 s33, s37, 0
  s_add_u32 m0, s38, 0
  s_nop 0
  buffer_load_dwordx4 v2, s[24:27], s33 offen lds
  s_add_u32 s33, s37, 32768
  s_add_u32 m0, s38, 1024
  s_nop 0
  buffer_load_dwordx4 v2, s[24:27], s33 offen lds
  s_add_u32 s33, s37, 65536
  s_add_u32 m0, s38, 2048
  s_nop 0
  buffer_load_dwordx4 v3, s[24:27], s33 offen lds
  s_add_u32 s33, s37, 98304
  s_add_u32 m0, s38, 3072
  s_nop 0
  buffer_load_dwordx4 v3, s[24:27], s33 offen lds
  s_waitcnt vmcnt(20)
  s_barrier
  ds_read_b64_tr_b16 a[16:17], v4 offset:49152
  ds_read_b64_tr_b16 a[18:19], v4 offset:50176
  ds_read_b64_tr_b16 a[20:21], v4 offset:57344
  ds_read_b64_tr_b16 a[22:23], v4 offset:58368
  ds_read_b64_tr_b16 a[24:25], v5 offset:49152
  ds_read_b64_tr_b16 a[26:27], v5 offset:50176
  ds_read_b64_tr_b16 a[28:29], v5 offset:57344
  ds_read_b64_tr_b16 a[30:31], v5 offset:58368
  s_waitcnt lgkmcnt(0)
  s_add_u32 s33, s37, 524288
  s_add_u32 m0, s38, 16384
  s_nop 0
  buffer_load_dwordx4 v2, s[24:27], s33 offen lds
  s_add_u32 s33, s37, 557056
  s_add_u32 m0, s38, 17408
  s_nop 0
  buffer_load_dwordx4 v2, s[24:27], s33 offen lds
  s_add_u32 s33, s37, 589824
  s_add_u32 m0, s38, 18432
  s_nop 0
  buffer_load_dwordx4 v3, s[24:27], s33 offen lds
  s_add_u32 s33, s37, 622592
  s_add_u32 m0, s38, 19456
  s_nop 0
  buffer_load_dwordx4 v3, s[24:27], s33 offen lds
  s_waitcnt vmcnt(20)
  s_barrier
  ds_read_b64_tr_b16 a[32:33], v6 offset:0
  ds_read_b64_tr_b16 a[34:35], v6 offset:1024
  ds_read_b64_tr_b16 a[36:37], v6 offset:8192
  ds_read_b64_tr_b16 a[38:39], v6 offset:9216
  ds_read_b64_tr_b16 a[40:41], v7 offset:0
  ds_read_b64_tr_b16 a[42:43], v7 offset:1024
  ds_read_b64_tr_b16 a[44:45], v7 offset:8192
  ds_read_b64_tr_b16 a[46:47], v7 offset:9216
  s_waitcnt lgkmcnt(0)
  s_add_u32 s33, s37, 1048576
  s_add_u32 m0, s38, 32768
  s_nop 0
  buffer_load_dwordx4 v2, s[24:27], s33 offen lds
  s_add_u32 s33, s37, 1081344
  s_add_u32 m0, s38, 33792
  s_nop 0
  buffer_load_dwordx4 v2, s[24:27], s33 offen lds
  s_add_u32 s33, s37, 1114112
  s_add_u32 m0, s38, 34816
  s_nop 0
  buffer_load_dwordx4 v3, s[24:27], s33 offen lds
  s_add_u32 s33, s37, 1146880
  s_add_u32 m0, s38, 35840
  s_nop 0
  buffer_load_dwordx4 v3, s[24:27], s33 offen lds
  s_waitcnt vmcnt(20)
  s_barrier
  ds_read_b64_tr_b16 a[48:49], v6 offset:16384
  ds_read_b64_tr_b16 a[50:51], v6 offset:17408
  ds_read_b64_tr_b16 a[52:53], v6 offset:24576
  ds_read_b64_tr_b16 a[54:55], v6 offset:25600
  ds_read_b64_tr_b16 a[56:57], v7 offset:16384
  ds_read_b64_tr_b16 a[58:59], v7 offset:17408
  ds_read_b64_tr_b16 a[60:61], v7 offset:24576
  ds_read_b64_tr_b16 a[62:63], v7 offset:25600
  s_waitcnt lgkmcnt(0)
  s_add_u32 s33, s37, 1572864
  s_add_u32 m0, s38, 49152
  s_nop 0
  buffer_load_dwordx4 v2, s[24:27], s33 offen lds
  s_add_u32 s33, s37, 1605632
  s_add_u32 m0, s38, 50176
  s_nop 0
  buffer_load_dwordx4 v2, s[24:27], s33 offen lds
  s_add_u32 s33, s37, 1638400
  s_add_u32 m0, s38, 51200
  s_nop 0
  buffer_load_dwordx4 v3, s[24:27], s33 offen lds
  s_add_u32 s33, s37, 1671168
  s_add_u32 m0, s38, 52224
  s_nop 0
  buffer_load_dwordx4 v3, s[24:27], s33 offen lds
  s_waitcnt vmcnt(20)
  s_barrier
  ds_read_b64_tr_b16 a[64:65], v6 offset:32768
  ds_read_b64_tr_b16 a[66:67], v6 offset:33792
  ds_read_b64_tr_b16 a[68:69], v6 offset:40960
  ds_read_b64_tr_b16 a[70:71], v6 offset:41984
  ds_read_b64_tr_b16 a[72:73], v7 offset:32768
  ds_read_b64_tr_b16 a[74:75], v7 offset:33792
  ds_read_b64_tr_b16 a[76:77], v7 offset:40960
  ds_read_b64_tr_b16 a[78:79], v7 offset:41984
  s_waitcnt lgkmcnt(0)
  s_add_u32 s33, s37, 2097152
  s_add_u32 m0, s38, 65536
  s_nop 0
  buffer_load_dwordx4 v2, s[24:27], s33 offen lds
  s_add_u32 s33, s37, 2129920
  s_add_u32 m0, s38, 66560
  s_nop 0
  buffer_load_dwordx4 v2, s[24:27], s33 offen lds
  s_add_u32 s33, s37, 2162688
  s_add_u32 m0, s38, 67584
  s_nop 0
  buffer_load_dwordx4 v3, s[24:27], s33 offen lds
  s_add_u32 s33, s37, 2195456
  s_add_u32 m0, s38, 68608
  s_nop 0
  buffer_load_dwordx4 v3, s[24:27], s33 offen lds
  s_waitcnt vmcnt(20)
  s_barrier
  ds_read_b64_tr_b16 a[80:81], v6 offset:49152
  ds_read_b64_tr_b16 a[82:83], v6 offset:50176
  ds_read_b64_tr_b16 a[84:85], v6 offset:57344
  ds_read_b64_tr_b16 a[86:87], v6 offset:58368
  ds_read_b64_tr_b16 a[88:89], v7 offset:49152
  ds_read_b64_tr_b16 a[90:91], v7 offset:50176
  ds_read_b64_tr_b16 a[92:93], v7 offset:57344
  ds_read_b64_tr_b16 a[94:95], v7 offset:58368
  s_waitcnt lgkmcnt(0)
  s_add_u32 s33, s37, 2621440
  s_add_u32 m0, s38, 81920
  s_nop 0
  buffer_load_dwordx4 v2, s[24:27], s33 offen lds
  s_add_u32 s33, s37, 2654208
  s_add_u32 m0, s38, 82944
  s_nop 0
  buffer_load_dwordx4 v2, s[24:27], s33 offen lds
  s_add_u32 s33, s37, 2686976
  s_add_u32 m0, s38, 83968
  s_nop 0
  buffer_load_dwordx4 v3, s[24:27], s33 offen lds
  s_add_u32 s33, s37, 2719744
  s_add_u32 m0, s38, 84992
  s_nop 0
  buffer_load_dwordx4 v3, s[24:27], s33 offen lds
  s_waitcnt vmcnt(20)
  s_barrier
  ds_read_b64_tr_b16 a[224:225], v4 offset:0
  ds_read_b64_tr_b16 a[226:227], v4 offset:1024
  ds_read_b64_tr_b16 a[228:229], v4 offset:8192
  ds_read_b64_tr_b16 a[230:231], v4 offset:9216
  ds_read_b64_tr_b16 a[232:233], v5 offset:0
  ds_read_b64_tr_b16 a[234:235], v5 offset:1024
  ds_read_b64_tr_b16 a[236:237], v5 offset:8192
  ds_read_b64_tr_b16 a[238:239], v5 offset:9216
  s_waitcnt lgkmcnt(0)
  s_add_u32 s33, s37, 3145728
  s_add_u32 m0, s38, 98304
  s_nop 0
  buffer_load_dwordx4 v2, s[24:27], s33 offen lds
  s_add_u32 s33, s37, 3178496
  s_add_u32 m0, s38, 99328
  s_nop 0
  buffer_load_dwordx4 v2, s[24:27], s33 offen lds
  s_add_u32 s33, s37, 3211264
  s_add_u32 m0, s38, 100352
  s_nop 0
  buffer_load_dwordx4 v3, s[24:27], s33 offen lds
  s_add_u32 s33, s37, 3244032
  s_add_u32 m0, s38, 101376
  s_nop 0
  buffer_load_dwordx4 v3, s[24:27], s33 offen lds
  s_waitcnt vmcnt(20)
  s_barrier
  ds_read_b64_tr_b16 a[240:241], v4 offset:16384
  ds_read_b64_tr_b16 a[242:243], v4 offset:17408
  ds_read_b64_tr_b16 a[244:245], v4 offset:24576
  ds_read_b64_tr_b16 a[246:247], v4 offset:25600
  ds_read_b64_tr_b16 a[248:249], v5 offset:16384
  ds_read_b64_tr_b16 a[250:251], v5 offset:17408
  ds_read_b64_tr_b16 a[252:253], v5 offset:24576
  ds_read_b64_tr_b16 a[254:255], v5 offset:25600
  s_waitcnt lgkmcnt(0)
  s_add_u32 s33, s37, 3670016
  s_add_u32 m0, s38, 114688
  s_nop 0
  buffer_load_dwordx4 v2, s[24:27], s33 offen lds
  s_add_u32 s33, s37, 3702784
  s_add_u32 m0, s38, 115712
  s_nop 0
  buffer_load_dwordx4 v2, s[24:27], s33 offen lds
  s_add_u32 s33, s37, 3735552
  s_add_u32 m0, s38, 116736
  s_nop 0
  buffer_load_dwordx4 v3, s[24:27], s33 offen lds
  s_add_u32 s33, s37, 3768320
  s_add_u32 m0, s38, 117760
  s_nop 0
  buffer_load_dwordx4 v3, s[24:27], s33 offen lds
  s_waitcnt vmcnt(20)
  s_barrier
  ds_read_b64_tr_b16 a[128:129], v4 offset:32768
  ds_read_b64_tr_b16 a[130:131], v4 offset:33792
  ds_read_b64_tr_b16 a[132:133], v4 offset:40960
  ds_read_b64_tr_b16 a[134:135], v4 offset:41984
  ds_read_b64_tr_b16 a[136:137], v5 offset:32768
  ds_read_b64_tr_b16 a[138:139], v5 offset:33792
  ds_read_b64_tr_b16 a[140:141], v5 offset:40960
  ds_read_b64_tr_b16 a[142:143], v5 offset:41984
  s_waitcnt lgkmcnt(0)
  s_add_u32 s33, s37, 0
  s_add_u32 m0, s38, 0
  s_nop 0
  buffer_load_dwordx4 v2, s[28:31], s33 offen lds
  s_add_u32 s33, s37, 32768
  s_add_u32 m0, s38, 1024
  s_nop 0
  buffer_load_dwordx4 v2, s[28:31], s33 offen lds
  s_add_u32 s33, s37, 65536
  s_add_u32 m0, s38, 2048
  s_nop 0
  buffer_load_dwordx4 v3, s[28:31], s33 offen lds
  s_add_u32 s33, s37, 98304
  s_add_u32 m0, s38, 3072
  s_nop 0
  buffer_load_dwordx4 v3, s[28:31], s33 offen lds
  s_waitcnt vmcnt(20)
  s_barrier
  ds_read_b64_tr_b16 a[144:145], v4 offset:49152
  ds_read_b64_tr_b16 a[146:147], v4 offset:50176
  ds_read_b64_tr_b16 a[148:149], v4 offset:57344
  ds_read_b64_tr_b16 a[150:151], v4 offset:58368
  ds_read_b64_tr_b16 a[152:153], v5 offset:49152
  ds_read_b64_tr_b16 a[154:155], v5 offset:50176
  ds_read_b64_tr_b16 a[156:157], v5 offset:57344
  ds_read_b64_tr_b16 a[158:159], v5 offset:58368
  s_waitcnt lgkmcnt(0)
  s_add_u32 s33, s37, 524288
  s_add_u32 m0, s38, 16384
  s_nop 0
  buffer_load_dwordx4 v2, s[28:31], s33 offen lds
  s_add_u32 s33, s37, 557056
  s_add_u32 m0, s38, 17408
  s_nop 0
  buffer_load_dwordx4 v2, s[28:31], s33 offen lds
  s_add_u32 s33, s37, 589824
  s_add_u32 m0, s38, 18432
  s_nop 0
  buffer_load_dwordx4 v3, s[28:31], s33 offen lds
  s_add_u32 s33, s37, 622592
  s_add_u32 m0, s38, 19456
  s_nop 0
  buffer_load_dwordx4 v3, s[28:31], s33 offen lds
  s_waitcnt vmcnt(20)
  s_barrier
  ds_read_b64_tr_b16 a[160:161], v6 offset:0
  ds_read_b64_tr_b16 a[162:163], v6 offset:1024
  ds_read_b64_tr_b16 a[164:165], v6 offset:8192
  ds_read_b64_tr_b16 a[166:167], v6 offset:9216
  ds_read_b64_tr_b16 a[168:169], v7 offset:0
  ds_read_b64_tr_b16 a[170:171], v7 offset:1024
  ds_read_b64_tr_b16 a[172:173], v7 offset:8192
  ds_read_b64_tr_b16 a[174:175], v7 offset:9216
  s_waitcnt lgkmcnt(0)
  s_add_u32 s33, s37, 1048576
  s_add_u32 m0, s38, 32768
  s_nop 0
  buffer_load_dwordx4 v2, s[28:31], s33 offen lds
  s_add_u32 s33, s37, 1081344
  s_add_u32 m0, s38, 33792
  s_nop 0
  buffer_load_dwordx4 v2, s[28:31], s33 offen lds
  s_add_u32 s33, s37, 1114112
  s_add_u32 m0, s38, 34816
  s_nop 0
  buffer_load_dwordx4 v3, s[28:31], s33 offen lds
  s_add_u32 s33, s37, 1146880
  s_add_u32 m0, s38, 35840
  s_nop 0
  buffer_load_dwordx4 v3, s[28:31], s33 offen lds
  s_waitcnt vmcnt(20)
  s_barrier
  ds_read_b64_tr_b16 a[176:177], v6 offset:16384
  ds_read_b64_tr_b16 a[178:179], v6 offset:17408
  ds_read_b64_tr_b16 a[180:181], v6 offset:24576
  ds_read_b64_tr_b16 a[182:183], v6 offset:25600
  ds_read_b64_tr_b16 a[184:185], v7 offset:16384
  ds_read_b64_tr_b16 a[186:187], v7 offset:17408
  ds_read_b64_tr_b16 a[188:189], v7 offset:24576
  ds_read_b64_tr_b16 a[190:191], v7 offset:25600
  s_waitcnt lgkmcnt(0)
  s_add_u32 s33, s37, 1572864
  s_add_u32 m0, s38, 49152
  s_nop 0
  buffer_load_dwordx4 v2, s[28:31], s33 offen lds
  s_add_u32 s33, s37, 1605632
  s_add_u32 m0, s38, 50176
  s_nop 0
  buffer_load_dwordx4 v2, s[28:31], s33 offen lds
  s_add_u32 s33, s37, 1638400
  s_add_u32 m0, s38, 51200
  s_nop 0
  buffer_load_dwordx4 v3, s[28:31], s33 offen lds
  s_add_u32 s33, s37, 1671168
  s_add_u32 m0, s38, 52224
  s_nop 0
  buffer_load_dwordx4 v3, s[28:31], s33 offen lds
  s_waitcnt vmcnt(20)
  s_barrier
  ds_read_b64_tr_b16 a[192:193], v6 offset:32768
  ds_read_b64_tr_b16 a[194:195], v6 offset:33792
  ds_read_b64_tr_b16 a[196:197], v6 offset:40960
  ds_read_b64_tr_b16 a[198:199], v6 offset:41984
  ds_read_b64_tr_b16 a[200:201], v7 offset:32768
  ds_read_b64_tr_b16 a[202:203], v7 offset:33792
  ds_read_b64_tr_b16 a[204:205], v7 offset:40960
  ds_read_b64_tr_b16 a[206:207], v7 offset:41984
  s_waitcnt lgkmcnt(0)
  s_add_u32 s33, s37, 2097152
  s_add_u32 m0, s38, 65536
  s_nop 0
  buffer_load_dwordx4 v2, s[28:31], s33 offen lds
  s_add_u32 s33, s37, 2129920
  s_add_u32 m0, s38, 66560
  s_nop 0
  buffer_load_dwordx4 v2, s[28:31], s33 offen lds
  s_add_u32 s33, s37, 2162688
  s_add_u32 m0, s38, 67584
  s_nop 0
  buffer_load_dwordx4 v3, s[28:31], s33 offen lds
  s_add_u32 s33, s37, 2195456
  s_add_u32 m0, s38, 68608
  s_nop 0
  buffer_load_dwordx4 v3, s[28:31], s33 offen lds
  s_waitcnt vmcnt(20)
  s_barrier
  ds_read_b64_tr_b16 a[208:209], v6 offset:49152
  ds_read_b64_tr_b16 a[210:211], v6 offset:50176
  ds_read_b64_tr_b16 a[212:213], v6 offset:57344
  ds_read_b64_tr_b16 a[214:215], v6 offset:58368
  ds_read_b64_tr_b16 a[216:217], v7 offset:49152
  ds_read_b64_tr_b16 a[218:219], v7 offset:50176
  ds_read_b64_tr_b16 a[220:221], v7 offset:57344
  ds_read_b64_tr_b16 a[222:223], v7 offset:58368
  buffer_load_dword v116, v115, s[12:15], 0 offen offset:160 sc1
  s_waitcnt lgkmcnt(0)
  s_add_u32 s33, s37, 2621440
  s_add_u32 m0, s38, 81920
  s_nop 0
  buffer_load_dwordx4 v2, s[28:31], s33 offen lds
  s_add_u32 s33, s37, 2654208
  s_add_u32 m0, s38, 82944
  s_nop 0
  buffer_load_dwordx4 v2, s[28:31], s33 offen lds
  s_add_u32 s33, s37, 2686976
  s_add_u32 m0, s38, 83968
  s_nop 0
  buffer_load_dwordx4 v3, s[28:31], s33 offen lds
  s_add_u32 s33, s37, 2719744
  s_add_u32 m0, s38, 84992
  s_nop 0
  buffer_load_dwordx4 v3, s[28:31], s33 offen lds
  s_waitcnt vmcnt(21)
  s_barrier
  ds_read_b64_tr_b16 v[16:17], v4 offset:0
  ds_read_b64_tr_b16 v[18:19], v4 offset:1024
  ds_read_b64_tr_b16 v[20:21], v4 offset:8192
  ds_read_b64_tr_b16 v[22:23], v4 offset:9216
  ds_read_b64_tr_b16 v[24:25], v5 offset:0
  ds_read_b64_tr_b16 v[26:27], v5 offset:1024
  ds_read_b64_tr_b16 v[28:29], v5 offset:8192
  ds_read_b64_tr_b16 v[30:31], v5 offset:9216
  s_waitcnt lgkmcnt(0)
  s_add_u32 s33, s37, 3145728
  s_add_u32 m0, s38, 98304
  s_nop 0
  buffer_load_dwordx4 v2, s[28:31], s33 offen lds
  s_add_u32 s33, s37, 3178496
  s_add_u32 m0, s38, 99328
  s_nop 0
  buffer_load_dwordx4 v2, s[28:31], s33 offen lds
  s_add_u32 s33, s37, 3211264
  s_add_u32 m0, s38, 100352
  s_nop 0
  buffer_load_dwordx4 v3, s[28:31], s33 offen lds
  s_add_u32 s33, s37, 3244032
  s_add_u32 m0, s38, 101376
  s_nop 0
  buffer_load_dwordx4 v3, s[28:31], s33 offen lds
  s_waitcnt vmcnt(21)
  s_barrier
  ds_write_b128 v8, v[16:19] offset:0
  ds_write_b128 v8, v[20:23] offset:1024
  ds_write_b128 v8, v[24:27] offset:2048
  ds_write_b128 v8, v[28:31] offset:3072
  ds_read_b64_tr_b16 v[32:33], v4 offset:16384
  ds_read_b64_tr_b16 v[34:35], v4 offset:17408
  ds_read_b64_tr_b16 v[36:37], v4 offset:24576
  ds_read_b64_tr_b16 v[38:39], v4 offset:25600
  ds_read_b64_tr_b16 v[40:41], v5 offset:16384
  ds_read_b64_tr_b16 v[42:43], v5 offset:17408
  ds_read_b64_tr_b16 v[44:45], v5 offset:24576
  ds_read_b64_tr_b16 v[46:47], v5 offset:25600
  s_waitcnt lgkmcnt(0)
  s_add_u32 s33, s37, 3670016
  s_add_u32 m0, s38, 114688
  s_nop 0
  buffer_load_dwordx4 v2, s[28:31], s33 offen lds
  s_add_u32 s33, s37, 3702784
  s_add_u32 m0, s38, 115712
  s_nop 0
  buffer_load_dwordx4 v2, s[28:31], s33 offen lds
  s_add_u32 s33, s37, 3735552
  s_add_u32 m0, s38, 116736
  s_nop 0
  buffer_load_dwordx4 v3, s[28:31], s33 offen lds
  s_add_u32 s33, s37, 3768320
  s_add_u32 m0, s38, 117760
  s_nop 0
  buffer_load_dwordx4 v3, s[28:31], s33 offen lds
  s_waitcnt vmcnt(21)
  s_barrier
  ds_write_b128 v8, v[32:35] offset:16384
  ds_write_b128 v8, v[36:39] offset:17408
  ds_write_b128 v8, v[40:43] offset:18432
  ds_write_b128 v8, v[44:47] offset:19456
  ds_read_b64_tr_b16 v[16:17], v4 offset:32768
  ds_read_b64_tr_b16 v[18:19], v4 offset:33792
  ds_read_b64_tr_b16 v[20:21], v4 offset:40960
  ds_read_b64_tr_b16 v[22:23], v4 offset:41984
  ds_read_b64_tr_b16 v[24:25], v5 offset:32768
  ds_read_b64_tr_b16 v[26:27], v5 offset:33792
  ds_read_b64_tr_b16 v[28:29], v5 offset:40960
  ds_read_b64_tr_b16 v[30:31], v5 offset:41984
  s_waitcnt lgkmcnt(0)
  s_waitcnt vmcnt(17)
  s_barrier
  ds_write_b128 v8, v[16:19] offset:32768
  ds_write_b128 v8, v[20:23] offset:33792
  ds_write_b128 v8, v[24:27] offset:34816
  ds_write_b128 v8, v[28:31] offset:35840
  ds_read_b64_tr_b16 v[32:33], v4 offset:49152
  ds_read_b64_tr_b16 v[34:35], v4 offset:50176
  ds_read_b64_tr_b16 v[36:37], v4 offset:57344
  ds_read_b64_tr_b16 v[38:39], v4 offset:58368
  ds_read_b64_tr_b16 v[40:41], v5 offset:49152
  ds_read_b64_tr_b16 v[42:43], v5 offset:50176
  ds_read_b64_tr_b16 v[44:45], v5 offset:57344
  ds_read_b64_tr_b16 v[46:47], v5 offset:58368
  s_waitcnt lgkmcnt(0)
  s_waitcnt vmcnt(13)
  s_barrier
  ds_write_b128 v8, v[32:35] offset:49152
  ds_write_b128 v8, v[36:39] offset:50176
  ds_write_b128 v8, v[40:43] offset:51200
  ds_write_b128 v8, v[44:47] offset:52224
  ds_read_b64_tr_b16 v[16:17], v6 offset:0
  ds_read_b64_tr_b16 v[18:19], v6 offset:1024
  ds_read_b64_tr_b16 v[20:21], v6 offset:8192
  ds_read_b64_tr_b16 v[22:23], v6 offset:9216
  ds_read_b64_tr_b16 v[24:25], v7 offset:0
  ds_read_b64_tr_b16 v[26:27], v7 offset:1024
  ds_read_b64_tr_b16 v[28:29], v7 offset:8192
  ds_read_b64_tr_b16 v[30:31], v7 offset:9216
  v_lshlrev_b32 v119, 1, v65
  s_lshl_b32 s34, s3, 11
  s_add_u32 s35, s34, 204800
  buffer_load_dword v114, v119, s[8:11], s35 offen sc1
  s_andn2_b32 s35, s46, 0x2000
  s_lshl_b32 s34, s34, 1
  s_add_u32 s35, s35, s34
  v_lshlrev_b32 v119, 1, v119
  buffer_load_dword v119, v119, s[8:11], s35 offen sc1
  s_waitcnt lgkmcnt(0)
  s_waitcnt vmcnt(10)
  s_barrier
  ds_write_b128 v9, v[16:19] offset:0
  ds_write_b128 v9, v[20:23] offset:1024
  ds_write_b128 v9, v[24:27] offset:2048
  ds_write_b128 v9, v[28:31] offset:3072
  ds_read_b64_tr_b16 v[32:33], v6 offset:16384
  ds_read_b64_tr_b16 v[34:35], v6 offset:17408
  ds_read_b64_tr_b16 v[36:37], v6 offset:24576
  ds_read_b64_tr_b16 v[38:39], v6 offset:25600
  ds_read_b64_tr_b16 v[40:41], v7 offset:16384
  ds_read_b64_tr_b16 v[42:43], v7 offset:17408
  ds_read_b64_tr_b16 v[44:45], v7 offset:24576
  ds_read_b64_tr_b16 v[46:47], v7 offset:25600
  buffer_load_dword v117, off, s[8:11], s49 sc1
  buffer_load_dword v118, off, s[8:11], s49 offset:16 sc1
  s_waitcnt lgkmcnt(0)
  s_waitcnt vmcnt(8)
  s_barrier
  ds_write_b128 v9, v[32:35] offset:16384
  ds_write_b128 v9, v[36:39] offset:17408
  ds_write_b128 v9, v[40:43] offset:18432
  ds_write_b128 v9, v[44:47] offset:19456
  ds_read_b64_tr_b16 v[16:17], v6 offset:32768
  ds_read_b64_tr_b16 v[18:19], v6 offset:33792
  ds_read_b64_tr_b16 v[20:21], v6 offset:40960
  ds_read_b64_tr_b16 v[22:23], v6 offset:41984
  ds_read_b64_tr_b16 v[24:25], v7 offset:32768
  ds_read_b64_tr_b16 v[26:27], v7 offset:33792
  ds_read_b64_tr_b16 v[28:29], v7 offset:40960
  ds_read_b64_tr_b16 v[30:31], v7 offset:41984
  s_waitcnt lgkmcnt(0)
  s_waitcnt vmcnt(4)
  s_barrier
  ds_write_b128 v9, v[16:19] offset:32768
  ds_write_b128 v9, v[20:23] offset:33792
  ds_write_b128 v9, v[24:27] offset:34816
  ds_write_b128 v9, v[28:31] offset:35840
  ds_read_b64_tr_b16 v[32:33], v6 offset:49152
  ds_read_b64_tr_b16 v[34:35], v6 offset:50176
  ds_read_b64_tr_b16 v[36:37], v6 offset:57344
  ds_read_b64_tr_b16 v[38:39], v6 offset:58368
  ds_read_b64_tr_b16 v[40:41], v7 offset:49152
  ds_read_b64_tr_b16 v[42:43], v7 offset:50176
  ds_read_b64_tr_b16 v[44:45], v7 offset:57344
  ds_read_b64_tr_b16 v[46:47], v7 offset:58368
  s_mov_b32 s57, 0
  s_waitcnt vmcnt(0)
  v_readlane_b32 s33, v116, s4
  v_and_b32 v116, 63, v116
  v_cmp_ne_u32 s[58:59], 32, v116
  v_min_u32 v117, v117, v118
  v_cmp_eq_u32 vcc, 0, v117
  s_nop 3
  s_or_b64 vcc, vcc, s[58:59]
  s_cbranch_vccnz JD_9
  s_bfe_u32 s34, s33, 0x80006
  s_mul_i32 s34, s34, s34
  s_lshr_b32 s33, s33, 14
  s_lshl_b32 s33, s33, 5
  s_cmp_lg_u32 s33, s34
  s_cselect_b32 s7, 1, 0
  buffer_load_dwordx4 v[120:123], v57, s[8:11], s50 offen offset:0 sc1
  buffer_load_dwordx4 v[124:127], v57, s[8:11], s50 offen offset:1024 sc1
  buffer_load_dwordx4 v[48:51], v57, s[8:11], s42 offen offset:0 sc1
  buffer_load_dwordx4 v[48:51], v57, s[8:11], s42 offen offset:0 sc1
  buffer_load_dwordx4 v[52:55], v57, s[8:11], s42 offen offset:1024 sc1
  buffer_load_dwordx4 v[52:55], v57, s[8:11], s42 offen offset:1024 sc1
  s_mov_b32 s57, 1
JD_9:
  s_waitcnt lgkmcnt(0)
  s_barrier
  ds_write_b128 v9, v[32:35] offset:49152
  ds_write_b128 v9, v[36:39] offset:50176
  ds_write_b128 v9, v[40:43] offset:51200
  ds_write_b128 v9, v[44:47] offset:52224
  s_waitcnt lgkmcnt(0)
  s_branch LOADED_1
LDW2_4:
  s_add_u32 s33, s36, 0
  buffer_load_dwordx2 v[16:17], v1, s[16:19], s33 offen offset:0
  buffer_load_dwordx2 v[18:19], v1, s[16:19], s33 offen offset:1024
  buffer_load_dwordx2 v[24:25], v1, s[16:19], s33 offen offset:2048
  buffer_load_dwordx2 v[26:27], v1, s[16:19], s33 offen offset:3072
  s_add_u32 s33, s36, 32768
  buffer_load_dwordx2 v[20:21], v1, s[16:19], s33 offen offset:0
  buffer_load_dwordx2 v[22:23], v1, s[16:19], s33 offen offset:1024
  buffer_load_dwordx2 v[28:29], v1, s[16:19], s33 offen offset:2048
  buffer_load_dwordx2 v[30:31], v1, s[16:19], s33 offen offset:3072
  s_add_u32 s33, s36, 8192
  buffer_load_dwordx2 v[32:33], v1, s[16:19], s33 offen offset:0
  buffer_load_dwordx2 v[34:35], v1, s[16:19], s33 offen offset:1024
  buffer_load_dwordx2 v[40:41], v1, s[16:19], s33 offen offset:2048
  buffer_load_dwordx2 v[42:43], v1, s[16:19], s33 offen offset:3072
  s_add_u32 s33, s36, 40960
  buffer_load_dwordx2 v[36:37], v1, s[16:19], s33 offen offset:0
  buffer_load_dwordx2 v[38:39], v1, s[16:19], s33 offen offset:1024
  buffer_load_dwordx2 v[44:45], v1, s[16:19], s33 offen offset:2048
  buffer_load_dwordx2 v[46:47], v1, s[16:19], s33 offen offset:3072
  s_add_u32 s33, s36, 0
  buffer_load_dwordx2 v[48:49], v1, s[16:19], s33 offen offset:128
  buffer_load_dwordx2 v[50:51], v1, s[16:19], s33 offen offset:1152
  buffer_load_dwordx2 v[56:57], v1, s[16:19], s33 offen offset:2176
  buffer_load_dwordx2 v[58:59], v1, s[16:19], s33 offen offset:3200
  s_add_u32 s33, s36, 32768
  buffer_load_dwordx2 v[52:53], v1, s[16:19], s33 offen offset:128
  buffer_load_dwordx2 v[54:55], v1, s[16:19], s33 offen offset:1152
  buffer_load_dwordx2 v[60:61], v1, s[16:19], s33 offen offset:2176
  buffer_load_dwordx2 v[62:63], v1, s[16:19], s33 offen offset:3200
  s_add_u32 s33, s36, 8192
  buffer_load_dwordx2 v[64:65], v1, s[16:19], s33 offen offset:128
  buffer_load_dwordx2 v[66:67], v1, s[16:19], s33 offen offset:1152
  buffer_load_dwordx2 v[72:73], v1, s[16:19], s33 offen offset:2176
  buffer_load_dwordx2 v[74:75], v1, s[16:19], s33 offen offset:3200
  s_add_u32 s33, s36, 40960
  buffer_load_dwordx2 v[68:69], v1, s[16:19], s33 offen offset:128
  buffer_load_dwordx2 v[70:71], v1, s[16:19], s33 offen offset:1152
  buffer_load_dwordx2 v[76:77], v1, s[16:19], s33 offen offset:2176
  buffer_load_dwordx2 v[78:79], v1, s[16:19], s33 offen offset:3200
  s_add_u32 s33, s36, 65536
  buffer_load_dwordx2 v[80:81], v1, s[16:19], s33 offen offset:0
  buffer_load_dwordx2 v[82:83], v1, s[16:19], s33 offen offset:1024
  buffer_load_dwordx2 v[88:89], v1, s[16:19], s33 offen offset:2048
  buffer_load_dwordx2 v[90:91], v1, s[16:19], s33 offen offset:3072
  s_add_u32 s33, s36, 98304
  buffer_load_dwordx2 v[84:85], v1, s[16:19], s33 offen offset:0
  buffer_load_dwordx2 v[86:87], v1, s[16:19], s33 offen offset:1024
  buffer_load_dwordx2 v[92:93], v1, s[16:19], s33 offen offset:2048
  buffer_load_dwordx2 v[94:95], v1, s[16:19], s33 offen offset:3072
  s_add_u32 s33, s36, 73728
  buffer_load_dwordx2 v[96:97], v1, s[16:19], s33 offen offset:0
  buffer_load_dwordx2 v[98:99], v1, s[16:19], s33 offen offset:1024
  buffer_load_dwordx2 v[104:105], v1, s[16:19], s33 offen offset:2048
  buffer_load_dwordx2 v[106:107], v1, s[16:19], s33 offen offset:3072
  s_add_u32 s33, s36, 106496
  buffer_load_dwordx2 v[100:101], v1, s[16:19], s33 offen offset:0
  buffer_load_dwordx2 v[102:103], v1, s[16:19], s33 offen offset:1024
  buffer_load_dwordx2 v[108:109], v1, s[16:19], s33 offen offset:2048
  buffer_load_dwordx2 v[110:111], v1, s[16:19], s33 offen offset:3072
  s_waitcnt vmcnt(40)
  s_barrier
  s_cmp_lg_u32 s3, 0
  s_cbranch_scc1 SIG_10
  s_lshl_b32 s33, s4, 2
  v_mov_b32 v10, s32
  s_mov_b64 exec, 1
  buffer_atomic_add v10, off, s[12:15], s33 offset:160 sc1
  s_mov_b64 exec, -1
SIG_10:
  v_perm_b32 v128, v18, v16, s39
  v_perm_b32 v129, v22, v20, s39
  v_perm_b32 v130, v26, v24, s39
  v_perm_b32 v131, v30, v28, s39
  v_perm_b32 v144, v18, v16, s40
  v_perm_b32 v145, v22, v20, s40
  v_perm_b32 v146, v26, v24, s40
  v_perm_b32 v147, v30, v28, s40
  v_perm_b32 v160, v19, v17, s39
  v_perm_b32 v161, v23, v21, s39
  v_perm_b32 v162, v27, v25, s39
  v_perm_b32 v163, v31, v29, s39
  v_perm_b32 v176, v19, v17, s40
  v_perm_b32 v177, v23, v21, s40
  v_perm_b32 v178, v27, v25, s40
  v_perm_b32 v179, v31, v29, s40
  s_add_u32 s33, s36, 65536
  buffer_load_dwordx2 v[16:17], v1, s[16:19], s33 offen offset:128
  buffer_load_dwordx2 v[18:19], v1, s[16:19], s33 offen offset:1152
  buffer_load_dwordx2 v[24:25], v1, s[16:19], s33 offen offset:2176
  buffer_load_dwordx2 v[26:27], v1, s[16:19], s33 offen offset:3200
  s_add_u32 s33, s36, 98304
  buffer_load_dwordx2 v[20:21], v1, s[16:19], s33 offen offset:128
  buffer_load_dwordx2 v[22:23], v1, s[16:19], s33 offen offset:1152
  buffer_load_dwordx2 v[28:29], v1, s[16:19], s33 offen offset:2176
  buffer_load_dwordx2 v[30:31], v1, s[16:19], s33 offen offset:3200
  s_waitcnt vmcnt(40)
  v_perm_b32 v132, v34, v32, s39
  v_perm_b32 v133, v38, v36, s39
  v_perm_b32 v134, v42, v40, s39
  v_perm_b32 v135, v46, v44, s39
  v_perm_b32 v148, v34, v32, s40
  v_perm_b32 v149, v38, v36, s40
  v_perm_b32 v150, v42, v40, s40
  v_perm_b32 v151, v46, v44, s40
  v_perm_b32 v164, v35, v33, s39
  v_perm_b32 v165, v39, v37, s39
  v_perm_b32 v166, v43, v41, s39
  v_perm_b32 v167, v47, v45, s39
  v_perm_b32 v180, v35, v33, s40
  v_perm_b32 v181, v39, v37, s40
  v_perm_b32 v182, v43, v41, s40
  v_perm_b32 v183, v47, v45, s40
  s_add_u32 s33, s36, 73728
  buffer_load_dwordx2 v[32:33], v1, s[16:19], s33 offen offset:128
  buffer_load_dwordx2 v[34:35], v1, s[16:19], s33 offen offset:1152
  buffer_load_dwordx2 v[40:41], v1, s[16:19], s33 offen offset:2176
  buffer_load_dwordx2 v[42:43], v1, s[16:19], s33 offen offset:3200
  s_add_u32 s33, s36, 106496
  buffer_load_dwordx2 v[36:37], v1, s[16:19], s33 offen offset:128
  buffer_load_dwordx2 v[38:39], v1, s[16:19], s33 offen offset:1152
  buffer_load_dwordx2 v[44:45], v1, s[16:19], s33 offen offset:2176
  buffer_load_dwordx2 v[46:47], v1, s[16:19], s33 offen offset:3200
  s_waitcnt vmcnt(40)
  v_perm_b32 v192, v50, v48, s39
  v_perm_b32 v193, v54, v52, s39
  v_perm_b32 v194, v58, v56, s39
  v_perm_b32 v195, v62, v60, s39
  v_perm_b32 v208, v50, v48, s40
  v_perm_b32 v209, v54, v52, s40
  v_perm_b32 v210, v58, v56, s40
  v_perm_b32 v211, v62, v60, s40
  v_perm_b32 v224, v51, v49, s39
  v_perm_b32 v225, v55, v53, s39
  v_perm_b32 v226, v59, v57, s39
  v_perm_b32 v227, v63, v61, s39
  v_perm_b32 v240, v51, v49, s40
  v_perm_b32 v241, v55, v53, s40
  v_perm_b32 v242, v59, v57, s40
  v_perm_b32 v243, v63, v61, s40
  s_add_u32 s33, s37, 0
  s_add_u32 m0, s38, 0
  s_nop 0
  buffer_load_dwordx4 v2, s[20:23], s33 offen lds
  s_add_u32 s33, s37, 32768
  s_add_u32 m0, s38, 1024
  s_nop 0
  buffer_load_dwordx4 v2, s[20:23], s33 offen lds
  s_add_u32 s33, s37, 65536
  s_add_u32 m0, s38, 2048
  s_nop 0
  buffer_load_dwordx4 v3, s[20:23], s33 offen lds
  s_add_u32 s33, s37, 98304
  s_add_u32 m0, s38, 3072
  s_nop 0
  buffer_load_dwordx4 v3, s[20:23], s33 offen lds
  s_waitcnt vmcnt(36)
  v_perm_b32 v196, v66, v64, s39
  v_perm_b32 v197, v70, v68, s39
  v_perm_b32 v198, v74, v72, s39
  v_perm_b32 v199, v78, v76, s39
  v_perm_b32 v212, v66, v64, s40
  v_perm_b32 v213, v70, v68, s40
  v_perm_b32 v214, v74, v72, s40
  v_perm_b32 v215, v78, v76, s40
  v_perm_b32 v228, v67, v65, s39
  v_perm_b32 v229, v71, v69, s39
  v_perm_b32 v230, v75, v73, s39
  v_perm_b32 v231, v79, v77, s39
  v_perm_b32 v244, v67, v65, s40
  v_perm_b32 v245, v71, v69, s40
  v_perm_b32 v246, v75, v73, s40
  v_perm_b32 v247, v79, v77, s40
  s_add_u32 s33, s37, 524288
  s_add_u32 m0, s38, 16384
  s_nop 0
  buffer_load_dwordx4 v2, s[20:23], s33 offen lds
  s_add_u32 s33, s37, 557056
  s_add_u32 m0, s38, 17408
  s_nop 0
  buffer_load_dwordx4 v2, s[20:23], s33 offen lds
  s_add_u32 s33, s37, 589824
  s_add_u32 m0, s38, 18432
  s_nop 0
  buffer_load_dwordx4 v3, s[20:23], s33 offen lds
  s_add_u32 s33, s37, 622592
  s_add_u32 m0, s38, 19456
  s_nop 0
  buffer_load_dwordx4 v3, s[20:23], s33 offen lds
  s_waitcnt vmcnt(32)
  v_perm_b32 v136, v82, v80, s39
  v_perm_b32 v137, v86, v84, s39
  v_perm_b32 v138, v90, v88, s39
  v_perm_b32 v139, v94, v92, s39
  v_perm_b32 v152, v82, v80, s40
  v_perm_b32 v153, v86, v84, s40
  v_perm_b32 v154, v90, v88, s40
  v_perm_b32 v155, v94, v92, s40
  v_perm_b32 v168, v83, v81, s39
  v_perm_b32 v169, v87, v85, s39
  v_perm_b32 v170, v91, v89, s39
  v_perm_b32 v171, v95, v93, s39
  v_perm_b32 v184, v83, v81, s40
  v_perm_b32 v185, v87, v85, s40
  v_perm_b32 v186, v91, v89, s40
  v_perm_b32 v187, v95, v93, s40
  s_add_u32 s33, s37, 1048576
  s_add_u32 m0, s38, 32768
  s_nop 0
  buffer_load_dwordx4 v2, s[20:23], s33 offen lds
  s_add_u32 s33, s37, 1081344
  s_add_u32 m0, s38, 33792
  s_nop 0
  buffer_load_dwordx4 v2, s[20:23], s33 offen lds
  s_add_u32 s33, s37, 1114112
  s_add_u32 m0, s38, 34816
  s_nop 0
  buffer_load_dwordx4 v3, s[20:23], s33 offen lds
  s_add_u32 s33, s37, 1146880
  s_add_u32 m0, s38, 35840
  s_nop 0
  buffer_load_dwordx4 v3, s[20:23], s33 offen lds
  s_waitcnt vmcnt(28)
  v_perm_b32 v140, v98, v96, s39
  v_perm_b32 v141, v102, v100, s39
  v_perm_b32 v142, v106, v104, s39
  v_perm_b32 v143, v110, v108, s39
  v_perm_b32 v156, v98, v96, s40
  v_perm_b32 v157, v102, v100, s40
  v_perm_b32 v158, v106, v104, s40
  v_perm_b32 v159, v110, v108, s40
  v_perm_b32 v172, v99, v97, s39
  v_perm_b32 v173, v103, v101, s39
  v_perm_b32 v174, v107, v105, s39
  v_perm_b32 v175, v111, v109, s39
  v_perm_b32 v188, v99, v97, s40
  v_perm_b32 v189, v103, v101, s40
  v_perm_b32 v190, v107, v105, s40
  v_perm_b32 v191, v111, v109, s40
  s_add_u32 s33, s37, 1572864
  s_add_u32 m0, s38, 49152
  s_nop 0
  buffer_load_dwordx4 v2, s[20:23], s33 offen lds
  s_add_u32 s33, s37, 1605632
  s_add_u32 m0, s38, 50176
  s_nop 0
  buffer_load_dwordx4 v2, s[20:23], s33 offen lds
  s_add_u32 s33, s37, 1638400
  s_add_u32 m0, s38, 51200
  s_nop 0
  buffer_load_dwordx4 v3, s[20:23], s33 offen lds
  s_add_u32 s33, s37, 1671168
  s_add_u32 m0, s38, 52224
  s_nop 0
  buffer_load_dwordx4 v3, s[20:23], s33 offen lds
  s_waitcnt vmcnt(24)
  v_perm_b32 v200, v18, v16, s39
  v_perm_b32 v201, v22, v20, s39
  v_perm_b32 v202, v26, v24, s39
  v_perm_b32 v203, v30, v28, s39
  v_perm_b32 v216, v18, v16, s40
  v_perm_b32 v217, v22, v20, s40
  v_perm_b32 v218, v26, v24, s40
  v_perm_b32 v219, v30, v28, s40
  v_perm_b32 v232, v19, v17, s39
  v_perm_b32 v233, v23, v21, s39
  v_perm_b32 v234, v27, v25, s39
  v_perm_b32 v235, v31, v29, s39
  v_perm_b32 v248, v19, v17, s40
  v_perm_b32 v249, v23, v21, s40
  v_perm_b32 v250, v27, v25, s40
  v_perm_b32 v251, v31, v29, s40
  s_add_u32 s33, s37, 2097152
  s_add_u32 m0, s38, 65536
  s_nop 0
  buffer_load_dwordx4 v2, s[20:23], s33 offen lds
  s_add_u32 s33, s37, 2129920
  s_add_u32 m0, s38, 66560
  s_nop 0
  buffer_load_dwordx4 v2, s[20:23], s33 offen lds
  s_add_u32 s33, s37, 2162688
  s_add_u32 m0, s38, 67584
  s_nop 0
  buffer_load_dwordx4 v3, s[20:23], s33 offen lds
  s_add_u32 s33, s37, 2195456
  s_add_u32 m0, s38, 68608
  s_nop 0
  buffer_load_dwordx4 v3, s[20:23], s33 offen lds
  s_waitcnt vmcnt(20)
  v_perm_b32 v204, v34, v32, s39
  v_perm_b32 v205, v38, v36, s39
  v_perm_b32 v206, v42, v40, s39
  v_perm_b32 v207, v46, v44, s39
  v_perm_b32 v220, v34, v32, s40
  v_perm_b32 v221, v38, v36, s40
  v_perm_b32 v222, v42, v40, s40
  v_perm_b32 v223, v46, v44, s40
  v_perm_b32 v236, v35, v33, s39
  v_perm_b32 v237, v39, v37, s39
  v_perm_b32 v238, v43, v41, s39
  v_perm_b32 v239, v47, v45, s39
  v_perm_b32 v252, v35, v33, s40
  v_perm_b32 v253, v39, v37, s40
  v_perm_b32 v254, v43, v41, s40
  v_perm_b32 v255, v47, v45, s40
  s_add_u32 s33, s37, 2621440
  s_add_u32 m0, s38, 81920
  s_nop 0
  buffer_load_dwordx4 v2, s[20:23], s33 offen lds
  s_add_u32 s33, s37, 2654208
  s_add_u32 m0, s38, 82944
  s_nop 0
  buffer_load_dwordx4 v2, s[20:23], s33 offen lds
  s_add_u32 s33, s37, 2686976
  s_add_u32 m0, s38, 83968
  s_nop 0
  buffer_load_dwordx4 v3, s[20:23], s33 offen lds
  s_add_u32 s33, s37, 2719744
  s_add_u32 m0, s38, 84992
  s_nop 0
  buffer_load_dwordx4 v3, s[20:23], s33 offen lds
  s_waitcnt vmcnt(20)
  s_barrier
  ds_read_b64_tr_b16 a[64:65], v4 offset:0
  ds_read_b64_tr_b16 a[66:67], v4 offset:1024
  ds_read_b64_tr_b16 a[68:69], v4 offset:8192
  ds_read_b64_tr_b16 a[70:71], v4 offset:9216
  ds_read_b64_tr_b16 a[72:73], v5 offset:0
  ds_read_b64_tr_b16 a[74:75], v5 offset:1024
  ds_read_b64_tr_b16 a[76:77], v5 offset:8192
  ds_read_b64_tr_b16 a[78:79], v5 offset:9216
  s_waitcnt lgkmcnt(0)
  s_add_u32 s33, s37, 3145728
  s_add_u32 m0, s38, 98304
  s_nop 0
  buffer_load_dwordx4 v2, s[20:23], s33 offen lds
  s_add_u32 s33, s37, 3178496
  s_add_u32 m0, s38, 99328
  s_nop 0
  buffer_load_dwordx4 v2, s[20:23], s33 offen lds
  s_add_u32 s33, s37, 3211264
  s_add_u32 m0, s38, 100352
  s_nop 0
  buffer_load_dwordx4 v3, s[20:23], s33 offen lds
  s_add_u32 s33, s37, 3244032
  s_add_u32 m0, s38, 101376
  s_nop 0
  buffer_load_dwordx4 v3, s[20:23], s33 offen lds
  s_waitcnt vmcnt(20)
  s_barrier
  ds_read_b64_tr_b16 a[80:81], v4 offset:16384
  ds_read_b64_tr_b16 a[82:83], v4 offset:17408
  ds_read_b64_tr_b16 a[84:85], v4 offset:24576
  ds_read_b64_tr_b16 a[86:87], v4 offset:25600
  ds_read_b64_tr_b16 a[88:89], v5 offset:16384
  ds_read_b64_tr_b16 a[90:91], v5 offset:17408
  ds_read_b64_tr_b16 a[92:93], v5 offset:24576
  ds_read_b64_tr_b16 a[94:95], v5 offset:25600
  v_mov_b32 v20, v0
  v_and_b32 v115, 7, v0
  v_lshlrev_b32 v115, 2, v115
  v_lshlrev_b32 v65, 4, v20
  s_lshl_b32 s33, s3, 11
  v_add_u32 v57, s33, v65
  s_add_u32 s33, s3, 0
  s_and_b32 s33, s33, 3
  s_lshl_b32 s33, s33, 15
  s_lshl_b32 s34, s3, 12
  s_add_u32 s33, s33, s34
  s_add_u32 s33, s33, 32768
  v_add_u32 v58, s33, v65
  s_add_u32 s33, s3, 1
  s_and_b32 s33, s33, 3
  s_lshl_b32 s34, s33, 11
  v_add_u32 v62, s34, v65
  s_lshl_b32 s33, s33, 15
  s_lshl_b32 s34, s3, 12
  s_add_u32 s33, s33, s34
  s_add_u32 s33, s33, 32768
  v_add_u32 v59, s33, v65
  s_add_u32 s33, s3, 2
  s_and_b32 s33, s33, 3
  s_lshl_b32 s34, s33, 11
  v_add_u32 v63, s34, v65
  s_lshl_b32 s33, s33, 15
  s_lshl_b32 s34, s3, 12
  s_add_u32 s33, s33, s34
  s_add_u32 s33, s33, 32768
  v_add_u32 v60, s33, v65
  s_add_u32 s33, s3, 3
  s_and_b32 s33, s33, 3
  s_lshl_b32 s34, s33, 11
  v_add_u32 v64, s34, v65
  s_lshl_b32 s33, s33, 15
  s_lshl_b32 s34, s3, 12
  s_add_u32 s33, s33, s34
  s_add_u32 s33, s33, 32768
  v_add_u32 v61, s33, v65
  v_and_b32 v21, 15, v20
  v_lshrrev_b32 v22, 4, v20
  v_lshrrev_b32 v23, 2, v21
  v_xor_b32 v24, v22, v23
  v_lshlrev_b32 v24, 3, v24
  v_lshlrev_b32 v25, 5, v21
  s_lshl_b32 s33, s3, 10
  s_add_u32 s33, s33, 16384
  v_add3_u32 v66, v24, v25, s33
  v_lshlrev_b32 v24, 2, v22
  v_add_u32 v24, v24, v23
  v_lshlrev_b32 v24, 5, v24
  v_and_b32 v25, 3, v21
  v_xor_b32 v26, v25, v22
  v_lshlrev_b32 v26, 3, v26
  s_mov_b32 s33, 16384
  v_add3_u32 v67, v24, v26, s33
  v_lshlrev_b32 v24, 6, v23
  v_and_b32 v26, 1, v21
  v_lshlrev_b32 v26, 4, v26
  v_lshlrev_b32 v27, 8, v22
  v_add3_u32 v24, v24, v26, v27
  s_lshr_b32 s33, s3, 1
  s_lshl_b32 s33, s33, 10
  s_and_b32 s34, s3, 1
  s_lshl_b32 s34, s34, 5
  s_add_u32 s33, s33, s34
  s_add_u32 s33, s33, 20480
  v_add_u32 v24, s33, v24
  v_xor_b32 v26, 32, v24
  v_add_u32 v26, 0x800, v26
  v_cmp_lt_u32 vcc, 1, v25
  s_nop 1
  v_cndmask_b32 v68, v26, v24, vcc
  v_and_b32 v26, 1, v22
  v_lshlrev_b32 v26, 11, v26
  v_and_b32 v27, 2, v22
  v_lshl_add_u32 v26, v27, 14, v26
  v_lshlrev_b32 v24, 13, v23
  v_lshlrev_b32 v27, 4, v25
  v_add3_u32 v24, v24, v26, v27
  s_lshl_b32 s33, s3, 16
  v_add_u32 v69, s33, v24
  v_mov_b32 v24, 0x44444444
  v_mov_b32 v26, 0xeeeeeeee
  v_cndmask_b32 v71, v24, v26, vcc
  v_bfe_u32 v24, v21, 2, 1
  v_lshlrev_b32 v24, 9, v24
  v_bfe_u32 v26, v21, 3, 1
  v_lshlrev_b32 v26, 7, v26
  v_and_b32 v27, 1, v21
  v_lshlrev_b32 v27, 5, v27
  v_add3_u32 v24, v24, v26, v27
  v_lshlrev_b32 v26, 3, v22
  v_and_b32 v27, 2, v21
  v_lshlrev_b32 v27, 1, v27
  v_add3_u32 v24, v24, v26, v27
  s_lshr_b32 s33, s3, 1
  s_lshl_b32 s33, s33, 10
  s_and_b32 s34, s3, 1
  s_lshl_b32 s34, s34, 8
  s_add_u32 s33, s33, s34
  s_add_u32 s33, s33, 0
  v_add_u32 v72, s33, v24
  v_mov_b32 v24, 0
  ds_write_b32 v66, v24
  ds_write_b32 v66, v24 offset:512
  s_mov_b32 s53, 0x3f80
  s_mov_b32 s64, 0x550055
  s_mov_b32 s65, 0x550055
  s_mov_b32 s66, 0x55005500
  s_mov_b32 s67, 0x55005500
  s_mov_b32 s68, 0x550055
  s_mov_b32 s69, 0x550055
  s_mov_b32 s70, 0x55005500
  s_mov_b32 s71, 0x55005500
  s_mov_b32 s54, 0x3f803f80
  s_mov_b32 s55, 0x3f803f80
  s_mov_b32 s52, 0x3e0293ee
  s_mov_b32 s41, 0
  s_mov_b32 s42, 196608
  s_lshl_b32 s33, s58, 8
  s_add_u32 s43, s33, 204800
  s_add_u32 s44, s33, 524288
  s_lshl_b32 s33, s5, 13
  s_add_u32 s45, s33, 1048576
  s_add_u32 s46, s33, 1310720
  s_add_u32 s50, s33, 16777216
  s_add_u32 s51, s33, 33554432
  s_lshl_b32 s33, s5, 6
  s_add_u32 s47, s33, 1048576
  s_add_u32 s48, s33, 1052672
  s_lshl_b32 s33, s5, 10
  s_lshl_b32 s34, s3, 2
  s_add_u32 s33, s33, s34
  s_add_u32 s49, s33, 0
  s_add_u32 s56, s49, 1008
  s_waitcnt lgkmcnt(0)
  s_add_u32 s33, s37, 3670016
  s_add_u32 m0, s38, 114688
  s_nop 0
  buffer_load_dwordx4 v2, s[20:23], s33 offen lds
  s_add_u32 s33, s37, 3702784
  s_add_u32 m0, s38, 115712
  s_nop 0
  buffer_load_dwordx4 v2, s[20:23], s33 offen lds
  s_add_u32 s33, s37, 3735552
  s_add_u32 m0, s38, 116736
  s_nop 0
  buffer_load_dwordx4 v3, s[20:23], s33 offen lds
  s_add_u32 s33, s37, 3768320
  s_add_u32 m0, s38, 117760
  s_nop 0
  buffer_load_dwordx4 v3, s[20:23], s33 offen lds
  s_waitcnt vmcnt(20)
  s_barrier
  ds_read_b64_tr_b16 a[96:97], v4 offset:32768
  ds_read_b64_tr_b16 a[98:99], v4 offset:33792
  ds_read_b64_tr_b16 a[100:101], v4 offset:40960
  ds_read_b64_tr_b16 a[102:103], v4 offset:41984
  ds_read_b64_tr_b16 a[104:105], v5 offset:32768
  ds_read_b64_tr_b16 a[106:107], v5 offset:33792
  ds_read_b64_tr_b16 a[108:109], v5 offset:40960
  ds_read_b64_tr_b16 a[110:111], v5 offset:41984
  s_waitcnt lgkmcnt(0)
  s_add_u32 s33, s37, 0
  s_add_u32 m0, s38, 0
  s_nop 0
  buffer_load_dwordx4 v2, s[24:27], s33 offen lds
  s_add_u32 s33, s37, 32768
  s_add_u32 m0, s38, 1024
  s_nop 0
  buffer_load_dwordx4 v2, s[24:27], s33 offen lds
  s_add_u32 s33, s37, 65536
  s_add_u32 m0, s38, 2048
  s_nop 0
  buffer_load_dwordx4 v3, s[24:27], s33 offen lds
  s_add_u32 s33, s37, 98304
  s_add_u32 m0, s38, 3072
  s_nop 0
  buffer_load_dwordx4 v3, s[24:27], s33 offen lds
  s_waitcnt vmcnt(20)
  s_barrier
  ds_read_b64_tr_b16 a[112:113], v4 offset:49152
  ds_read_b64_tr_b16 a[114:115], v4 offset:50176
  ds_read_b64_tr_b16 a[116:117], v4 offset:57344
  ds_read_b64_tr_b16 a[118:119], v4 offset:58368
  ds_read_b64_tr_b16 a[120:121], v5 offset:49152
  ds_read_b64_tr_b16 a[122:123], v5 offset:50176
  ds_read_b64_tr_b16 a[124:125], v5 offset:57344
  ds_read_b64_tr_b16 a[126:127], v5 offset:58368
  s_waitcnt lgkmcnt(0)
  s_add_u32 s33, s37, 524288
  s_add_u32 m0, s38, 16384
  s_nop 0
  buffer_load_dwordx4 v2, s[24:27], s33 offen lds
  s_add_u32 s33, s37, 557056
  s_add_u32 m0, s38, 17408
  s_nop 0
  buffer_load_dwordx4 v2, s[24:27], s33 offen lds
  s_add_u32 s33, s37, 589824
  s_add_u32 m0, s38, 18432
  s_nop 0
  buffer_load_dwordx4 v3, s[24:27], s33 offen lds
  s_add_u32 s33, s37, 622592
  s_add_u32 m0, s38, 19456
  s_nop 0
  buffer_load_dwordx4 v3, s[24:27], s33 offen lds
  s_waitcnt vmcnt(20)
  s_barrier
  ds_read_b64_tr_b16 a[0:1], v6 offset:0
  ds_read_b64_tr_b16 a[2:3], v6 offset:1024
  ds_read_b64_tr_b16 a[4:5], v6 offset:8192
  ds_read_b64_tr_b16 a[6:7], v6 offset:9216
  ds_read_b64_tr_b16 a[8:9], v7 offset:0
  ds_read_b64_tr_b16 a[10:11], v7 offset:1024
  ds_read_b64_tr_b16 a[12:13], v7 offset:8192
  ds_read_b64_tr_b16 a[14:15], v7 offset:9216
  s_waitcnt lgkmcnt(0)
  s_add_u32 s33, s37, 1048576
  s_add_u32 m0, s38, 32768
  s_nop 0
  buffer_load_dwordx4 v2, s[24:27], s33 offen lds
  s_add_u32 s33, s37, 1081344
  s_add_u32 m0, s38, 33792
  s_nop 0
  buffer_load_dwordx4 v2, s[24:27], s33 offen lds
  s_add_u32 s33, s37, 1114112
  s_add_u32 m0, s38, 34816
  s_nop 0
  buffer_load_dwordx4 v3, s[24:27], s33 offen lds
  s_add_u32 s33, s37, 1146880
  s_add_u32 m0, s38, 35840
  s_nop 0
  buffer_load_dwordx4 v3, s[24:27], s33 offen lds
  s_waitcnt vmcnt(20)
  s_barrier
  ds_read_b64_tr_b16 a[16:17], v6 offset:16384
  ds_read_b64_tr_b16 a[18:19], v6 offset:17408
  ds_read_b64_tr_b16 a[20:21], v6 offset:24576
  ds_read_b64_tr_b16 a[22:23], v6 offset:25600
  ds_read_b64_tr_b16 a[24:25], v7 offset:16384
  ds_read_b64_tr_b16 a[26:27], v7 offset:17408
  ds_read_b64_tr_b16 a[28:29], v7 offset:24576
  ds_read_b64_tr_b16 a[30:31], v7 offset:25600
  s_waitcnt lgkmcnt(0)
  s_add_u32 s33, s37, 1572864
  s_add_u32 m0, s38, 49152
  s_nop 0
  buffer_load_dwordx4 v2, s[24:27], s33 offen lds
  s_add_u32 s33, s37, 1605632
  s_add_u32 m0, s38, 50176
  s_nop 0
  buffer_load_dwordx4 v2, s[24:27], s33 offen lds
  s_add_u32 s33, s37, 1638400
  s_add_u32 m0, s38, 51200
  s_nop 0
  buffer_load_dwordx4 v3, s[24:27], s33 offen lds
  s_add_u32 s33, s37, 1671168
  s_add_u32 m0, s38, 52224
  s_nop 0
  buffer_load_dwordx4 v3, s[24:27], s33 offen lds
  s_waitcnt vmcnt(20)
  s_barrier
  ds_read_b64_tr_b16 a[32:33], v6 offset:32768
  ds_read_b64_tr_b16 a[34:35], v6 offset:33792
  ds_read_b64_tr_b16 a[36:37], v6 offset:40960
  ds_read_b64_tr_b16 a[38:39], v6 offset:41984
  ds_read_b64_tr_b16 a[40:41], v7 offset:32768
  ds_read_b64_tr_b16 a[42:43], v7 offset:33792
  ds_read_b64_tr_b16 a[44:45], v7 offset:40960
  ds_read_b64_tr_b16 a[46:47], v7 offset:41984
  s_waitcnt lgkmcnt(0)
  s_add_u32 s33, s37, 2097152
  s_add_u32 m0, s38, 65536
  s_nop 0
  buffer_load_dwordx4 v2, s[24:27], s33 offen lds
  s_add_u32 s33, s37, 2129920
  s_add_u32 m0, s38, 66560
  s_nop 0
  buffer_load_dwordx4 v2, s[24:27], s33 offen lds
  s_add_u32 s33, s37, 2162688
  s_add_u32 m0, s38, 67584
  s_nop 0
  buffer_load_dwordx4 v3, s[24:27], s33 offen lds
  s_add_u32 s33, s37, 2195456
  s_add_u32 m0, s38, 68608
  s_nop 0
  buffer_load_dwordx4 v3, s[24:27], s33 offen lds
  s_waitcnt vmcnt(20)
  s_barrier
  ds_read_b64_tr_b16 a[48:49], v6 offset:49152
  ds_read_b64_tr_b16 a[50:51], v6 offset:50176
  ds_read_b64_tr_b16 a[52:53], v6 offset:57344
  ds_read_b64_tr_b16 a[54:55], v6 offset:58368
  ds_read_b64_tr_b16 a[56:57], v7 offset:49152
  ds_read_b64_tr_b16 a[58:59], v7 offset:50176
  ds_read_b64_tr_b16 a[60:61], v7 offset:57344
  ds_read_b64_tr_b16 a[62:63], v7 offset:58368
  s_waitcnt lgkmcnt(0)
  s_add_u32 s33, s37, 2621440
  s_add_u32 m0, s38, 81920
  s_nop 0
  buffer_load_dwordx4 v2, s[24:27], s33 offen lds
  s_add_u32 s33, s37, 2654208
  s_add_u32 m0, s38, 82944
  s_nop 0
  buffer_load_dwordx4 v2, s[24:27], s33 offen lds
  s_add_u32 s33, s37, 2686976
  s_add_u32 m0, s38, 83968
  s_nop 0
  buffer_load_dwordx4 v3, s[24:27], s33 offen lds
  s_add_u32 s33, s37, 2719744
  s_add_u32 m0, s38, 84992
  s_nop 0
  buffer_load_dwordx4 v3, s[24:27], s33 offen lds
  s_waitcnt vmcnt(20)
  s_barrier
  ds_read_b64_tr_b16 a[192:193], v4 offset:0
  ds_read_b64_tr_b16 a[194:195], v4 offset:1024
  ds_read_b64_tr_b16 a[196:197], v4 offset:8192
  ds_read_b64_tr_b16 a[198:199], v4 offset:9216
  ds_read_b64_tr_b16 a[200:201], v5 offset:0
  ds_read_b64_tr_b16 a[202:203], v5 offset:1024
  ds_read_b64_tr_b16 a[204:205], v5 offset:8192
  ds_read_b64_tr_b16 a[206:207], v5 offset:9216
  s_waitcnt lgkmcnt(0)
  s_add_u32 s33, s37, 3145728
  s_add_u32 m0, s38, 98304
  s_nop 0
  buffer_load_dwordx4 v2, s[24:27], s33 offen lds
  s_add_u32 s33, s37, 3178496
  s_add_u32 m0, s38, 99328
  s_nop 0
  buffer_load_dwordx4 v2, s[24:27], s33 offen lds
  s_add_u32 s33, s37, 3211264
  s_add_u32 m0, s38, 100352
  s_nop 0
  buffer_load_dwordx4 v3, s[24:27], s33 offen lds
  s_add_u32 s33, s37, 3244032
  s_add_u32 m0, s38, 101376
  s_nop 0
  buffer_load_dwordx4 v3, s[24:27], s33 offen lds
  s_waitcnt vmcnt(20)
  s_barrier
  ds_read_b64_tr_b16 a[208:209], v4 offset:16384
  ds_read_b64_tr_b16 a[210:211], v4 offset:17408
  ds_read_b64_tr_b16 a[212:213], v4 offset:24576
  ds_read_b64_tr_b16 a[214:215], v4 offset:25600
  ds_read_b64_tr_b16 a[216:217], v5 offset:16384
  ds_read_b64_tr_b16 a[218:219], v5 offset:17408
  ds_read_b64_tr_b16 a[220:221], v5 offset:24576
  ds_read_b64_tr_b16 a[222:223], v5 offset:25600
  s_waitcnt lgkmcnt(0)
  s_add_u32 s33, s37, 3670016
  s_add_u32 m0, s38, 114688
  s_nop 0
  buffer_load_dwordx4 v2, s[24:27], s33 offen lds
  s_add_u32 s33, s37, 3702784
  s_add_u32 m0, s38, 115712
  s_nop 0
  buffer_load_dwordx4 v2, s[24:27], s33 offen lds
  s_add_u32 s33, s37, 3735552
  s_add_u32 m0, s38, 116736
  s_nop 0
  buffer_load_dwordx4 v3, s[24:27], s33 offen lds
  s_add_u32 s33, s37, 3768320
  s_add_u32 m0, s38, 117760
  s_nop 0
  buffer_load_dwordx4 v3, s[24:27], s33 offen lds
  s_waitcnt vmcnt(20)
  s_barrier
  ds_read_b64_tr_b16 a[224:225], v4 offset:32768
  ds_read_b64_tr_b16 a[226:227], v4 offset:33792
  ds_read_b64_tr_b16 a[228:229], v4 offset:40960
  ds_read_b64_tr_b16 a[230:231], v4 offset:41984
  ds_read_b64_tr_b16 a[232:233], v5 offset:32768
  ds_read_b64_tr_b16 a[234:235], v5 offset:33792
  ds_read_b64_tr_b16 a[236:237], v5 offset:40960
  ds_read_b64_tr_b16 a[238:239], v5 offset:41984
  s_waitcnt lgkmcnt(0)
  s_add_u32 s33, s37, 0
  s_add_u32 m0, s38, 0
  s_nop 0
  buffer_load_dwordx4 v2, s[28:31], s33 offen lds
  s_add_u32 s33, s37, 32768
  s_add_u32 m0, s38, 1024
  s_nop 0
  buffer_load_dwordx4 v2, s[28:31], s33 offen lds
  s_add_u32 s33, s37, 65536
  s_add_u32 m0, s38, 2048
  s_nop 0
  buffer_load_dwordx4 v3, s[28:31], s33 offen lds
  s_add_u32 s33, s37, 98304
  s_add_u32 m0, s38, 3072
  s_nop 0
  buffer_load_dwordx4 v3, s[28:31], s33 offen lds
  s_waitcnt vmcnt(20)
  s_barrier
  ds_read_b64_tr_b16 a[240:241], v4 offset:49152
  ds_read_b64_tr_b16 a[242:243], v4 offset:50176
  ds_read_b64_tr_b16 a[244:245], v4 offset:57344
  ds_read_b64_tr_b16 a[246:247], v4 offset:58368
  ds_read_b64_tr_b16 a[248:249], v5 offset:49152
  ds_read_b64_tr_b16 a[250:251], v5 offset:50176
  ds_read_b64_tr_b16 a[252:253], v5 offset:57344
  ds_read_b64_tr_b16 a[254:255], v5 offset:58368
  s_waitcnt lgkmcnt(0)
  s_add_u32 s33, s37, 524288
  s_add_u32 m0, s38, 16384
  s_nop 0
  buffer_load_dwordx4 v2, s[28:31], s33 offen lds
  s_add_u32 s33, s37, 557056
  s_add_u32 m0, s38, 17408
  s_nop 0
  buffer_load_dwordx4 v2, s[28:31], s33 offen lds
  s_add_u32 s33, s37, 589824
  s_add_u32 m0, s38, 18432
  s_nop 0
  buffer_load_dwordx4 v3, s[28:31], s33 offen lds
  s_add_u32 s33, s37, 622592
  s_add_u32 m0, s38, 19456
  s_nop 0
  buffer_load_dwordx4 v3, s[28:31], s33 offen lds
  s_waitcnt vmcnt(20)
  s_barrier
  ds_read_b64_tr_b16 a[128:129], v6 offset:0
  ds_read_b64_tr_b16 a[130:131], v6 offset:1024
  ds_read_b64_tr_b16 a[132:133], v6 offset:8192
  ds_read_b64_tr_b16 a[134:135], v6 offset:9216
  ds_read_b64_tr_b16 a[136:137], v7 offset:0
  ds_read_b64_tr_b16 a[138:139], v7 offset:1024
  ds_read_b64_tr_b16 a[140:141], v7 offset:8192
  ds_read_b64_tr_b16 a[142:143], v7 offset:9216
  s_waitcnt lgkmcnt(0)
  s_add_u32 s33, s37, 1048576
  s_add_u32 m0, s38, 32768
  s_nop 0
  buffer_load_dwordx4 v2, s[28:31], s33 offen lds
  s_add_u32 s33, s37, 1081344
  s_add_u32 m0, s38, 33792
  s_nop 0
  buffer_load_dwordx4 v2, s[28:31], s33 offen lds
  s_add_u32 s33, s37, 1114112
  s_add_u32 m0, s38, 34816
  s_nop 0
  buffer_load_dwordx4 v3, s[28:31], s33 offen lds
  s_add_u32 s33, s37, 1146880
  s_add_u32 m0, s38, 35840
  s_nop 0
  buffer_load_dwordx4 v3, s[28:31], s33 offen lds
  s_waitcnt vmcnt(20)
  s_barrier
  ds_read_b64_tr_b16 a[144:145], v6 offset:16384
  ds_read_b64_tr_b16 a[146:147], v6 offset:17408
  ds_read_b64_tr_b16 a[148:149], v6 offset:24576
  ds_read_b64_tr_b16 a[150:151], v6 offset:25600
  ds_read_b64_tr_b16 a[152:153], v7 offset:16384
  ds_read_b64_tr_b16 a[154:155], v7 offset:17408
  ds_read_b64_tr_b16 a[156:157], v7 offset:24576
  ds_read_b64_tr_b16 a[158:159], v7 offset:25600
  s_waitcnt lgkmcnt(0)
  s_add_u32 s33, s37, 1572864
  s_add_u32 m0, s38, 49152
  s_nop 0
  buffer_load_dwordx4 v2, s[28:31], s33 offen lds
  s_add_u32 s33, s37, 1605632
  s_add_u32 m0, s38, 50176
  s_nop 0
  buffer_load_dwordx4 v2, s[28:31], s33 offen lds
  s_add_u32 s33, s37, 1638400
  s_add_u32 m0, s38, 51200
  s_nop 0
  buffer_load_dwordx4 v3, s[28:31], s33 offen lds
  s_add_u32 s33, s37, 1671168
  s_add_u32 m0, s38, 52224
  s_nop 0
  buffer_load_dwordx4 v3, s[28:31], s33 offen lds
  s_waitcnt vmcnt(20)
  s_barrier
  ds_read_b64_tr_b16 a[160:161], v6 offset:32768
  ds_read_b64_tr_b16 a[162:163], v6 offset:33792
  ds_read_b64_tr_b16 a[164:165], v6 offset:40960
  ds_read_b64_tr_b16 a[166:167], v6 offset:41984
  ds_read_b64_tr_b16 a[168:169], v7 offset:32768
  ds_read_b64_tr_b16 a[170:171], v7 offset:33792
  ds_read_b64_tr_b16 a[172:173], v7 offset:40960
  ds_read_b64_tr_b16 a[174:175], v7 offset:41984
  s_waitcnt lgkmcnt(0)
  s_add_u32 s33, s37, 2097152
  s_add_u32 m0, s38, 65536
  s_nop 0
  buffer_load_dwordx4 v2, s[28:31], s33 offen lds
  s_add_u32 s33, s37, 2129920
  s_add_u32 m0, s38, 66560
  s_nop 0
  buffer_load_dwordx4 v2, s[28:31], s33 offen lds
  s_add_u32 s33, s37, 2162688
  s_add_u32 m0, s38, 67584
  s_nop 0
  buffer_load_dwordx4 v3, s[28:31], s33 offen lds
  s_add_u32 s33, s37, 2195456
  s_add_u32 m0, s38, 68608
  s_nop 0
  buffer_load_dwordx4 v3, s[28:31], s33 offen lds
  s_waitcnt vmcnt(20)
  s_barrier
  ds_read_b64_tr_b16 a[176:177], v6 offset:49152
  ds_read_b64_tr_b16 a[178:179], v6 offset:50176
  ds_read_b64_tr_b16 a[180:181], v6 offset:57344
  ds_read_b64_tr_b16 a[182:183], v6 offset:58368
  ds_read_b64_tr_b16 a[184:185], v7 offset:49152
  ds_read_b64_tr_b16 a[186:187], v7 offset:50176
  ds_read_b64_tr_b16 a[188:189], v7 offset:57344
  ds_read_b64_tr_b16 a[190:191], v7 offset:58368
  buffer_load_dword v116, v115, s[12:15], 0 offen offset:160 sc1
  s_waitcnt lgkmcnt(0)
  s_add_u32 s33, s37, 2621440
  s_add_u32 m0, s38, 81920
  s_nop 0
  buffer_load_dwordx4 v2, s[28:31], s33 offen lds
  s_add_u32 s33, s37, 2654208
  s_add_u32 m0, s38, 82944
  s_nop 0
  buffer_load_dwordx4 v2, s[28:31], s33 offen lds
  s_add_u32 s33, s37, 2686976
  s_add_u32 m0, s38, 83968
  s_nop 0
  buffer_load_dwordx4 v3, s[28:31], s33 offen lds
  s_add_u32 s33, s37, 2719744
  s_add_u32 m0, s38, 84992
  s_nop 0
  buffer_load_dwordx4 v3, s[28:31], s33 offen lds
  s_waitcnt vmcnt(21)
  s_barrier
  ds_read_b64_tr_b16 v[16:17], v4 offset:0
  ds_read_b64_tr_b16 v[18:19], v4 offset:1024
  ds_read_b64_tr_b16 v[20:21], v4 offset:8192
  ds_read_b64_tr_b16 v[22:23], v4 offset:9216
  ds_read_b64_tr_b16 v[24:25], v5 offset:0
  ds_read_b64_tr_b16 v[26:27], v5 offset:1024
  ds_read_b64_tr_b16 v[28:29], v5 offset:8192
  ds_read_b64_tr_b16 v[30:31], v5 offset:9216
  s_waitcnt lgkmcnt(0)
  s_add_u32 s33, s37, 3145728
  s_add_u32 m0, s38, 98304
  s_nop 0
  buffer_load_dwordx4 v2, s[28:31], s33 offen lds
  s_add_u32 s33, s37, 3178496
  s_add_u32 m0, s38, 99328
  s_nop 0
  buffer_load_dwordx4 v2, s[28:31], s33 offen lds
  s_add_u32 s33, s37, 3211264
  s_add_u32 m0, s38, 100352
  s_nop 0
  buffer_load_dwordx4 v3, s[28:31], s33 offen lds
  s_add_u32 s33, s37, 3244032
  s_add_u32 m0, s38, 101376
  s_nop 0
  buffer_load_dwordx4 v3, s[28:31], s33 offen lds
  s_waitcnt vmcnt(21)
  s_barrier
  ds_write_b128 v8, v[16:19] offset:0
  ds_write_b128 v8, v[20:23] offset:1024
  ds_write_b128 v8, v[24:27] offset:2048
  ds_write_b128 v8, v[28:31] offset:3072
  ds_read_b64_tr_b16 v[32:33], v4 offset:16384
  ds_read_b64_tr_b16 v[34:35], v4 offset:17408
  ds_read_b64_tr_b16 v[36:37], v4 offset:24576
  ds_read_b64_tr_b16 v[38:39], v4 offset:25600
  ds_read_b64_tr_b16 v[40:41], v5 offset:16384
  ds_read_b64_tr_b16 v[42:43], v5 offset:17408
  ds_read_b64_tr_b16 v[44:45], v5 offset:24576
  ds_read_b64_tr_b16 v[46:47], v5 offset:25600
  s_waitcnt lgkmcnt(0)
  s_add_u32 s33, s37, 3670016
  s_add_u32 m0, s38, 114688
  s_nop 0
  buffer_load_dwordx4 v2, s[28:31], s33 offen lds
  s_add_u32 s33, s37, 3702784
  s_add_u32 m0, s38, 115712
  s_nop 0
  buffer_load_dwordx4 v2, s[28:31], s33 offen lds
  s_add_u32 s33, s37, 3735552
  s_add_u32 m0, s38, 116736
  s_nop 0
  buffer_load_dwordx4 v3, s[28:31], s33 offen lds
  s_add_u32 s33, s37, 3768320
  s_add_u32 m0, s38, 117760
  s_nop 0
  buffer_load_dwordx4 v3, s[28:31], s33 offen lds
  s_waitcnt vmcnt(21)
  s_barrier
  ds_write_b128 v8, v[32:35] offset:16384
  ds_write_b128 v8, v[36:39] offset:17408
  ds_write_b128 v8, v[40:43] offset:18432
  ds_write_b128 v8, v[44:47] offset:19456
  ds_read_b64_tr_b16 v[16:17], v4 offset:32768
  ds_read_b64_tr_b16 v[18:19], v4 offset:33792
  ds_read_b64_tr_b16 v[20:21], v4 offset:40960
  ds_read_b64_tr_b16 v[22:23], v4 offset:41984
  ds_read_b64_tr_b16 v[24:25], v5 offset:32768
  ds_read_b64_tr_b16 v[26:27], v5 offset:33792
  ds_read_b64_tr_b16 v[28:29], v5 offset:40960
  ds_read_b64_tr_b16 v[30:31], v5 offset:41984
  s_waitcnt lgkmcnt(0)
  s_waitcnt vmcnt(17)
  s_barrier
  ds_write_b128 v8, v[16:19] offset:32768
  ds_write_b128 v8, v[20:23] offset:33792
  ds_write_b128 v8, v[24:27] offset:34816
  ds_write_b128 v8, v[28:31] offset:35840
  ds_read_b64_tr_b16 v[32:33], v4 offset:49152
  ds_read_b64_tr_b16 v[34:35], v4 offset:50176
  ds_read_b64_tr_b16 v[36:37], v4 offset:57344
  ds_read_b64_tr_b16 v[38:39], v4 offset:58368
  ds_read_b64_tr_b16 v[40:41], v5 offset:49152
  ds_read_b64_tr_b16 v[42:43], v5 offset:50176
  ds_read_b64_tr_b16 v[44:45], v5 offset:57344
  ds_read_b64_tr_b16 v[46:47], v5 offset:58368
  s_waitcnt lgkmcnt(0)
  s_waitcnt vmcnt(13)
  s_barrier
  ds_write_b128 v8, v[32:35] offset:49152
  ds_write_b128 v8, v[36:39] offset:50176
  ds_write_b128 v8, v[40:43] offset:51200
  ds_write_b128 v8, v[44:47] offset:52224
  ds_read_b64_tr_b16 v[16:17], v6 offset:0
  ds_read_b64_tr_b16 v[18:19], v6 offset:1024
  ds_read_b64_tr_b16 v[20:21], v6 offset:8192
  ds_read_b64_tr_b16 v[22:23], v6 offset:9216
  ds_read_b64_tr_b16 v[24:25], v7 offset:0
  ds_read_b64_tr_b16 v[26:27], v7 offset:1024
  ds_read_b64_tr_b16 v[28:29], v7 offset:8192
  ds_read_b64_tr_b16 v[30:31], v7 offset:9216
  v_lshlrev_b32 v119, 1, v65
  s_lshl_b32 s34, s3, 11
  s_add_u32 s35, s34, 204800
  buffer_load_dword v114, v119, s[8:11], s35 offen sc1
  s_andn2_b32 s35, s46, 0x2000
  s_lshl_b32 s34, s34, 1
  s_add_u32 s35, s35, s34
  v_lshlrev_b32 v119, 1, v119
  buffer_load_dword v119, v119, s[8:11], s35 offen sc1
  s_waitcnt lgkmcnt(0)
  s_waitcnt vmcnt(10)
  s_barrier
  ds_write_b128 v9, v[16:19] offset:0
  ds_write_b128 v9, v[20:23] offset:1024
  ds_write_b128 v9, v[24:27] offset:2048
  ds_write_b128 v9, v[28:31] offset:3072
  ds_read_b64_tr_b16 v[32:33], v6 offset:16384
  ds_read_b64_tr_b16 v[34:35], v6 offset:17408
  ds_read_b64_tr_b16 v[36:37], v6 offset:24576
  ds_read_b64_tr_b16 v[38:39], v6 offset:25600
  ds_read_b64_tr_b16 v[40:41], v7 offset:16384
  ds_read_b64_tr_b16 v[42:43], v7 offset:17408
  ds_read_b64_tr_b16 v[44:45], v7 offset:24576
  ds_read_b64_tr_b16 v[46:47], v7 offset:25600
  buffer_load_dword v117, off, s[8:11], s49 sc1
  buffer_load_dword v118, off, s[8:11], s49 offset:16 sc1
  s_waitcnt lgkmcnt(0)
  s_waitcnt vmcnt(8)
  s_barrier
  ds_write_b128 v9, v[32:35] offset:16384
  ds_write_b128 v9, v[36:39] offset:17408
  ds_write_b128 v9, v[40:43] offset:18432
  ds_write_b128 v9, v[44:47] offset:19456
  ds_read_b64_tr_b16 v[16:17], v6 offset:32768
  ds_read_b64_tr_b16 v[18:19], v6 offset:33792
  ds_read_b64_tr_b16 v[20:21], v6 offset:40960
  ds_read_b64_tr_b16 v[22:23], v6 offset:41984
  ds_read_b64_tr_b16 v[24:25], v7 offset:32768
  ds_read_b64_tr_b16 v[26:27], v7 offset:33792
  ds_read_b64_tr_b16 v[28:29], v7 offset:40960
  ds_read_b64_tr_b16 v[30:31], v7 offset:41984
  s_waitcnt lgkmcnt(0)
  s_waitcnt vmcnt(4)
  s_barrier
  ds_write_b128 v9, v[16:19] offset:32768
  ds_write_b128 v9, v[20:23] offset:33792
  ds_write_b128 v9, v[24:27] offset:34816
  ds_write_b128 v9, v[28:31] offset:35840
  ds_read_b64_tr_b16 v[32:33], v6 offset:49152
  ds_read_b64_tr_b16 v[34:35], v6 offset:50176
  ds_read_b64_tr_b16 v[36:37], v6 offset:57344
  ds_read_b64_tr_b16 v[38:39], v6 offset:58368
  ds_read_b64_tr_b16 v[40:41], v7 offset:49152
  ds_read_b64_tr_b16 v[42:43], v7 offset:50176
  ds_read_b64_tr_b16 v[44:45], v7 offset:57344
  ds_read_b64_tr_b16 v[46:47], v7 offset:58368
  s_mov_b32 s57, 0
  s_waitcnt vmcnt(0)
  v_readlane_b32 s33, v116, s4
  v_and_b32 v116, 63, v116
  v_cmp_ne_u32 s[58:59], 32, v116
  v_min_u32 v117, v117, v118
  v_cmp_eq_u32 vcc, 0, v117
  s_nop 3
  s_or_b64 vcc, vcc, s[58:59]
  s_cbranch_vccnz JD_11
  s_bfe_u32 s34, s33, 0x80006
  s_mul_i32 s34, s34, s34
  s_lshr_b32 s33, s33, 14
  s_lshl_b32 s33, s33, 5
  s_cmp_lg_u32 s33, s34
  s_cselect_b32 s7, 1, 0
  buffer_load_dwordx4 v[120:123], v57, s[8:11], s50 offen offset:0 sc1
  buffer_load_dwordx4 v[124:127], v57, s[8:11], s50 offen offset:1024 sc1
  buffer_load_dwordx4 v[48:51], v57, s[8:11], s42 offen offset:0 sc1
  buffer_load_dwordx4 v[48:51], v57, s[8:11], s42 offen offset:0 sc1
  buffer_load_dwordx4 v[52:55], v57, s[8:11], s42 offen offset:1024 sc1
  buffer_load_dwordx4 v[52:55], v57, s[8:11], s42 offen offset:1024 sc1
  s_mov_b32 s57, 1
JD_11:
  s_waitcnt lgkmcnt(0)
  s_barrier
  ds_write_b128 v9, v[32:35] offset:49152
  ds_write_b128 v9, v[36:39] offset:50176
  ds_write_b128 v9, v[40:43] offset:51200
  ds_write_b128 v9, v[44:47] offset:52224
  s_waitcnt lgkmcnt(0)
  s_branch LOADED_1
LDW3_5:
  s_add_u32 s33, s36, 0
  buffer_load_dwordx2 v[16:17], v1, s[16:19], s33 offen offset:0
  buffer_load_dwordx2 v[18:19], v1, s[16:19], s33 offen offset:1024
  buffer_load_dwordx2 v[24:25], v1, s[16:19], s33 offen offset:2048
  buffer_load_dwordx2 v[26:27], v1, s[16:19], s33 offen offset:3072
  s_add_u32 s33, s36, 32768
  buffer_load_dwordx2 v[20:21], v1, s[16:19], s33 offen offset:0
  buffer_load_dwordx2 v[22:23], v1, s[16:19], s33 offen offset:1024
  buffer_load_dwordx2 v[28:29], v1, s[16:19], s33 offen offset:2048
  buffer_load_dwordx2 v[30:31], v1, s[16:19], s33 offen offset:3072
  s_add_u32 s33, s36, 8192
  buffer_load_dwordx2 v[32:33], v1, s[16:19], s33 offen offset:0
  buffer_load_dwordx2 v[34:35], v1, s[16:19], s33 offen offset:1024
  buffer_load_dwordx2 v[40:41], v1, s[16:19], s33 offen offset:2048
  buffer_load_dwordx2 v[42:43], v1, s[16:19], s33 offen offset:3072
  s_add_u32 s33, s36, 40960
  buffer_load_dwordx2 v[36:37], v1, s[16:19], s33 offen offset:0
  buffer_load_dwordx2 v[38:39], v1, s[16:19], s33 offen offset:1024
  buffer_load_dwordx2 v[44:45], v1, s[16:19], s33 offen offset:2048
  buffer_load_dwordx2 v[46:47], v1, s[16:19], s33 offen offset:3072
  s_add_u32 s33, s36, 0
  buffer_load_dwordx2 v[48:49], v1, s[16:19], s33 offen offset:128
  buffer_load_dwordx2 v[50:51], v1, s[16:19], s33 offen offset:1152
  buffer_load_dwordx2 v[56:57], v1, s[16:19], s33 offen offset:2176
  buffer_load_dwordx2 v[58:59], v1, s[16:19], s33 offen offset:3200
  s_add_u32 s33, s36, 32768
  buffer_load_dwordx2 v[52:53], v1, s[16:19], s33 offen offset:128
  buffer_load_dwordx2 v[54:55], v1, s[16:19], s33 offen offset:1152
  buffer_load_dwordx2 v[60:61], v1, s[16:19], s33 offen offset:2176
  buffer_load_dwordx2 v[62:63], v1, s[16:19], s33 offen offset:3200
  s_add_u32 s33, s36, 8192
  buffer_load_dwordx2 v[64:65], v1, s[16:19], s33 offen offset:128
  buffer_load_dwordx2 v[66:67], v1, s[16:19], s33 offen offset:1152
  buffer_load_dwordx2 v[72:73], v1, s[16:19], s33 offen offset:2176
  buffer_load_dwordx2 v[74:75], v1, s[16:19], s33 offen offset:3200
  s_add_u32 s33, s36, 40960
  buffer_load_dwordx2 v[68:69], v1, s[16:19], s33 offen offset:128
  buffer_load_dwordx2 v[70:71], v1, s[16:19], s33 offen offset:1152
  buffer_load_dwordx2 v[76:77], v1, s[16:19], s33 offen offset:2176
  buffer_load_dwordx2 v[78:79], v1, s[16:19], s33 offen offset:3200
  s_add_u32 s33, s36, 65536
  buffer_load_dwordx2 v[80:81], v1, s[16:19], s33 offen offset:0
  buffer_load_dwordx2 v[82:83], v1, s[16:19], s33 offen offset:1024
  buffer_load_dwordx2 v[88:89], v1, s[16:19], s33 offen offset:2048
  buffer_load_dwordx2 v[90:91], v1, s[16:19], s33 offen offset:3072
  s_add_u32 s33, s36, 98304
  buffer_load_dwordx2 v[84:85], v1, s[16:19], s33 offen offset:0
  buffer_load_dwordx2 v[86:87], v1, s[16:19], s33 offen offset:1024
  buffer_load_dwordx2 v[92:93], v1, s[16:19], s33 offen offset:2048
  buffer_load_dwordx2 v[94:95], v1, s[16:19], s33 offen offset:3072
  s_add_u32 s33, s36, 73728
  buffer_load_dwordx2 v[96:97], v1, s[16:19], s33 offen offset:0
  buffer_load_dwordx2 v[98:99], v1, s[16:19], s33 offen offset:1024
  buffer_load_dwordx2 v[104:105], v1, s[16:19], s33 offen offset:2048
  buffer_load_dwordx2 v[106:107], v1, s[16:19], s33 offen offset:3072
  s_add_u32 s33, s36, 106496
  buffer_load_dwordx2 v[100:101], v1, s[16:19], s33 offen offset:0
  buffer_load_dwordx2 v[102:103], v1, s[16:19], s33 offen offset:1024
  buffer_load_dwordx2 v[108:109], v1, s[16:19], s33 offen offset:2048
  buffer_load_dwordx2 v[110:111], v1, s[16:19], s33 offen offset:3072
  s_waitcnt vmcnt(40)
  s_barrier
  s_cmp_lg_u32 s3, 0
  s_cbranch_scc1 SIG_12
  s_lshl_b32 s33, s4, 2
  v_mov_b32 v10, s32
  s_mov_b64 exec, 1
  buffer_atomic_add v10, off, s[12:15], s33 offset:160 sc1
  s_mov_b64 exec, -1
SIG_12:
  v_perm_b32 v128, v18, v16, s39
  v_perm_b32 v129, v22, v20, s39
  v_perm_b32 v130, v26, v24, s39
  v_perm_b32 v131, v30, v28, s39
  v_perm_b32 v144, v18, v16, s40
  v_perm_b32 v145, v22, v20, s40
  v_perm_b32 v146, v26, v24, s40
  v_perm_b32 v147, v30, v28, s40
  v_perm_b32 v160, v19, v17, s39
  v_perm_b32 v161, v23, v21, s39
  v_perm_b32 v162, v27, v25, s39
  v_perm_b32 v163, v31, v29, s39
  v_perm_b32 v176, v19, v17, s40
  v_perm_b32 v177, v23, v21, s40
  v_perm_b32 v178, v27, v25, s40
  v_perm_b32 v179, v31, v29, s40
  s_add_u32 s33, s36, 65536
  buffer_load_dwordx2 v[16:17], v1, s[16:19], s33 offen offset:128
  buffer_load_dwordx2 v[18:19], v1, s[16:19], s33 offen offset:1152
  buffer_load_dwordx2 v[24:25], v1, s[16:19], s33 offen offset:2176
  buffer_load_dwordx2 v[26:27], v1, s[16:19], s33 offen offset:3200
  s_add_u32 s33, s36, 98304
  buffer_load_dwordx2 v[20:21], v1, s[16:19], s33 offen offset:128
  buffer_load_dwordx2 v[22:23], v1, s[16:19], s33 offen offset:1152
  buffer_load_dwordx2 v[28:29], v1, s[16:19], s33 offen offset:2176
  buffer_load_dwordx2 v[30:31], v1, s[16:19], s33 offen offset:3200
  s_waitcnt vmcnt(40)
  v_perm_b32 v132, v34, v32, s39
  v_perm_b32 v133, v38, v36, s39
  v_perm_b32 v134, v42, v40, s39
  v_perm_b32 v135, v46, v44, s39
  v_perm_b32 v148, v34, v32, s40
  v_perm_b32 v149, v38, v36, s40
  v_perm_b32 v150, v42, v40, s40
  v_perm_b32 v151, v46, v44, s40
  v_perm_b32 v164, v35, v33, s39
  v_perm_b32 v165, v39, v37, s39
  v_perm_b32 v166, v43, v41, s39
  v_perm_b32 v167, v47, v45, s39
  v_perm_b32 v180, v35, v33, s40
  v_perm_b32 v181, v39, v37, s40
  v_perm_b32 v182, v43, v41, s40
  v_perm_b32 v183, v47, v45, s40
  s_add_u32 s33, s36, 73728
  buffer_load_dwordx2 v[32:33], v1, s[16:19], s33 offen offset:128
  buffer_load_dwordx2 v[34:35], v1, s[16:19], s33 offen offset:1152
  buffer_load_dwordx2 v[40:41], v1, s[16:19], s33 offen offset:2176
  buffer_load_dwordx2 v[42:43], v1, s[16:19], s33 offen offset:3200
  s_add_u32 s33, s36, 106496
  buffer_load_dwordx2 v[36:37], v1, s[16:19], s33 offen offset:128
  buffer_load_dwordx2 v[38:39], v1, s[16:19], s33 offen offset:1152
  buffer_load_dwordx2 v[44:45], v1, s[16:19], s33 offen offset:2176
  buffer_load_dwordx2 v[46:47], v1, s[16:19], s33 offen offset:3200
  s_waitcnt vmcnt(40)
  v_perm_b32 v192, v50, v48, s39
  v_perm_b32 v193, v54, v52, s39
  v_perm_b32 v194, v58, v56, s39
  v_perm_b32 v195, v62, v60, s39
  v_perm_b32 v208, v50, v48, s40
  v_perm_b32 v209, v54, v52, s40
  v_perm_b32 v210, v58, v56, s40
  v_perm_b32 v211, v62, v60, s40
  v_perm_b32 v224, v51, v49, s39
  v_perm_b32 v225, v55, v53, s39
  v_perm_b32 v226, v59, v57, s39
  v_perm_b32 v227, v63, v61, s39
  v_perm_b32 v240, v51, v49, s40
  v_perm_b32 v241, v55, v53, s40
  v_perm_b32 v242, v59, v57, s40
  v_perm_b32 v243, v63, v61, s40
  s_add_u32 s33, s37, 0
  s_add_u32 m0, s38, 0
  s_nop 0
  buffer_load_dwordx4 v2, s[20:23], s33 offen lds
  s_add_u32 s33, s37, 32768
  s_add_u32 m0, s38, 1024
  s_nop 0
  buffer_load_dwordx4 v2, s[20:23], s33 offen lds
  s_add_u32 s33, s37, 65536
  s_add_u32 m0, s38, 2048
  s_nop 0
  buffer_load_dwordx4 v3, s[20:23], s33 offen lds
  s_add_u32 s33, s37, 98304
  s_add_u32 m0, s38, 3072
  s_nop 0
  buffer_load_dwordx4 v3, s[20:23], s33 offen lds
  s_waitcnt vmcnt(36)
  v_perm_b32 v196, v66, v64, s39
  v_perm_b32 v197, v70, v68, s39
  v_perm_b32 v198, v74, v72, s39
  v_perm_b32 v199, v78, v76, s39
  v_perm_b32 v212, v66, v64, s40
  v_perm_b32 v213, v70, v68, s40
  v_perm_b32 v214, v74, v72, s40
  v_perm_b32 v215, v78, v76, s40
  v_perm_b32 v228, v67, v65, s39
  v_perm_b32 v229, v71, v69, s39
  v_perm_b32 v230, v75, v73, s39
  v_perm_b32 v231, v79, v77, s39
  v_perm_b32 v244, v67, v65, s40
  v_perm_b32 v245, v71, v69, s40
  v_perm_b32 v246, v75, v73, s40
  v_perm_b32 v247, v79, v77, s40
  s_add_u32 s33, s37, 524288
  s_add_u32 m0, s38, 16384
  s_nop 0
  buffer_load_dwordx4 v2, s[20:23], s33 offen lds
  s_add_u32 s33, s37, 557056
  s_add_u32 m0, s38, 17408
  s_nop 0
  buffer_load_dwordx4 v2, s[20:23], s33 offen lds
  s_add_u32 s33, s37, 589824
  s_add_u32 m0, s38, 18432
  s_nop 0
  buffer_load_dwordx4 v3, s[20:23], s33 offen lds
  s_add_u32 s33, s37, 622592
  s_add_u32 m0, s38, 19456
  s_nop 0
  buffer_load_dwordx4 v3, s[20:23], s33 offen lds
  s_waitcnt vmcnt(32)
  v_perm_b32 v136, v82, v80, s39
  v_perm_b32 v137, v86, v84, s39
  v_perm_b32 v138, v90, v88, s39
  v_perm_b32 v139, v94, v92, s39
  v_perm_b32 v152, v82, v80, s40
  v_perm_b32 v153, v86, v84, s40
  v_perm_b32 v154, v90, v88, s40
  v_perm_b32 v155, v94, v92, s40
  v_perm_b32 v168, v83, v81, s39
  v_perm_b32 v169, v87, v85, s39
  v_perm_b32 v170, v91, v89, s39
  v_perm_b32 v171, v95, v93, s39
  v_perm_b32 v184, v83, v81, s40
  v_perm_b32 v185, v87, v85, s40
  v_perm_b32 v186, v91, v89, s40
  v_perm_b32 v187, v95, v93, s40
  s_add_u32 s33, s37, 1048576
  s_add_u32 m0, s38, 32768
  s_nop 0
  buffer_load_dwordx4 v2, s[20:23], s33 offen lds
  s_add_u32 s33, s37, 1081344
  s_add_u32 m0, s38, 33792
  s_nop 0
  buffer_load_dwordx4 v2, s[20:23], s33 offen lds
  s_add_u32 s33, s37, 1114112
  s_add_u32 m0, s38, 34816
  s_nop 0
  buffer_load_dwordx4 v3, s[20:23], s33 offen lds
  s_add_u32 s33, s37, 1146880
  s_add_u32 m0, s38, 35840
  s_nop 0
  buffer_load_dwordx4 v3, s[20:23], s33 offen lds
  s_waitcnt vmcnt(28)
  v_perm_b32 v140, v98, v96, s39
  v_perm_b32 v141, v102, v100, s39
  v_perm_b32 v142, v106, v104, s39
  v_perm_b32 v143, v110, v108, s39
  v_perm_b32 v156, v98, v96, s40
  v_perm_b32 v157, v102, v100, s40
  v_perm_b32 v158, v106, v104, s40
  v_perm_b32 v159, v110, v108, s40
  v_perm_b32 v172, v99, v97, s39
  v_perm_b32 v173, v103, v101, s39
  v_perm_b32 v174, v107, v105, s39
  v_perm_b32 v175, v111, v109, s39
  v_perm_b32 v188, v99, v97, s40
  v_perm_b32 v189, v103, v101, s40
  v_perm_b32 v190, v107, v105, s40
  v_perm_b32 v191, v111, v109, s40
  s_add_u32 s33, s37, 1572864
  s_add_u32 m0, s38, 49152
  s_nop 0
  buffer_load_dwordx4 v2, s[20:23], s33 offen lds
  s_add_u32 s33, s37, 1605632
  s_add_u32 m0, s38, 50176
  s_nop 0
  buffer_load_dwordx4 v2, s[20:23], s33 offen lds
  s_add_u32 s33, s37, 1638400
  s_add_u32 m0, s38, 51200
  s_nop 0
  buffer_load_dwordx4 v3, s[20:23], s33 offen lds
  s_add_u32 s33, s37, 1671168
  s_add_u32 m0, s38, 52224
  s_nop 0
  buffer_load_dwordx4 v3, s[20:23], s33 offen lds
  s_waitcnt vmcnt(24)
  v_perm_b32 v200, v18, v16, s39
  v_perm_b32 v201, v22, v20, s39
  v_perm_b32 v202, v26, v24, s39
  v_perm_b32 v203, v30, v28, s39
  v_perm_b32 v216, v18, v16, s40
  v_perm_b32 v217, v22, v20, s40
  v_perm_b32 v218, v26, v24, s40
  v_perm_b32 v219, v30, v28, s40
  v_perm_b32 v232, v19, v17, s39
  v_perm_b32 v233, v23, v21, s39
  v_perm_b32 v234, v27, v25, s39
  v_perm_b32 v235, v31, v29, s39
  v_perm_b32 v248, v19, v17, s40
  v_perm_b32 v249, v23, v21, s40
  v_perm_b32 v250, v27, v25, s40
  v_perm_b32 v251, v31, v29, s40
  s_add_u32 s33, s37, 2097152
  s_add_u32 m0, s38, 65536
  s_nop 0
  buffer_load_dwordx4 v2, s[20:23], s33 offen lds
  s_add_u32 s33, s37, 2129920
  s_add_u32 m0, s38, 66560
  s_nop 0
  buffer_load_dwordx4 v2, s[20:23], s33 offen lds
  s_add_u32 s33, s37, 2162688
  s_add_u32 m0, s38, 67584
  s_nop 0
  buffer_load_dwordx4 v3, s[20:23], s33 offen lds
  s_add_u32 s33, s37, 2195456
  s_add_u32 m0, s38, 68608
  s_nop 0
  buffer_load_dwordx4 v3, s[20:23], s33 offen lds
  s_waitcnt vmcnt(20)
  v_perm_b32 v204, v34, v32, s39
  v_perm_b32 v205, v38, v36, s39
  v_perm_b32 v206, v42, v40, s39
  v_perm_b32 v207, v46, v44, s39
  v_perm_b32 v220, v34, v32, s40
  v_perm_b32 v221, v38, v36, s40
  v_perm_b32 v222, v42, v40, s40
  v_perm_b32 v223, v46, v44, s40
  v_perm_b32 v236, v35, v33, s39
  v_perm_b32 v237, v39, v37, s39
  v_perm_b32 v238, v43, v41, s39
  v_perm_b32 v239, v47, v45, s39
  v_perm_b32 v252, v35, v33, s40
  v_perm_b32 v253, v39, v37, s40
  v_perm_b32 v254, v43, v41, s40
  v_perm_b32 v255, v47, v45, s40
  s_add_u32 s33, s37, 2621440
  s_add_u32 m0, s38, 81920
  s_nop 0
  buffer_load_dwordx4 v2, s[20:23], s33 offen lds
  s_add_u32 s33, s37, 2654208
  s_add_u32 m0, s38, 82944
  s_nop 0
  buffer_load_dwordx4 v2, s[20:23], s33 offen lds
  s_add_u32 s33, s37, 2686976
  s_add_u32 m0, s38, 83968
  s_nop 0
  buffer_load_dwordx4 v3, s[20:23], s33 offen lds
  s_add_u32 s33, s37, 2719744
  s_add_u32 m0, s38, 84992
  s_nop 0
  buffer_load_dwordx4 v3, s[20:23], s33 offen lds
  s_waitcnt vmcnt(20)
  s_barrier
  ds_read_b64_tr_b16 a[32:33], v4 offset:0
  ds_read_b64_tr_b16 a[34:35], v4 offset:1024
  ds_read_b64_tr_b16 a[36:37], v4 offset:8192
  ds_read_b64_tr_b16 a[38:39], v4 offset:9216
  ds_read_b64_tr_b16 a[40:41], v5 offset:0
  ds_read_b64_tr_b16 a[42:43], v5 offset:1024
  ds_read_b64_tr_b16 a[44:45], v5 offset:8192
  ds_read_b64_tr_b16 a[46:47], v5 offset:9216
  s_waitcnt lgkmcnt(0)
  s_add_u32 s33, s37, 3145728
  s_add_u32 m0, s38, 98304
  s_nop 0
  buffer_load_dwordx4 v2, s[20:23], s33 offen lds
  s_add_u32 s33, s37, 3178496
  s_add_u32 m0, s38, 99328
  s_nop 0
  buffer_load_dwordx4 v2, s[20:23], s33 offen lds
  s_add_u32 s33, s37, 3211264
  s_add_u32 m0, s38, 100352
  s_nop 0
  buffer_load_dwordx4 v3, s[20:23], s33 offen lds
  s_add_u32 s33, s37, 3244032
  s_add_u32 m0, s38, 101376
  s_nop 0
  buffer_load_dwordx4 v3, s[20:23], s33 offen lds
  s_waitcnt vmcnt(20)
  s_barrier
  ds_read_b64_tr_b16 a[48:49], v4 offset:16384
  ds_read_b64_tr_b16 a[50:51], v4 offset:17408
  ds_read_b64_tr_b16 a[52:53], v4 offset:24576
  ds_read_b64_tr_b16 a[54:55], v4 offset:25600
  ds_read_b64_tr_b16 a[56:57], v5 offset:16384
  ds_read_b64_tr_b16 a[58:59], v5 offset:17408
  ds_read_b64_tr_b16 a[60:61], v5 offset:24576
  ds_read_b64_tr_b16 a[62:63], v5 offset:25600
  v_mov_b32 v20, v0
  v_and_b32 v115, 7, v0
  v_lshlrev_b32 v115, 2, v115
  v_lshlrev_b32 v65, 4, v20
  s_lshl_b32 s33, s3, 11
  v_add_u32 v57, s33, v65
  s_add_u32 s33, s3, 0
  s_and_b32 s33, s33, 3
  s_lshl_b32 s33, s33, 15
  s_lshl_b32 s34, s3, 12
  s_add_u32 s33, s33, s34
  s_add_u32 s33, s33, 32768
  v_add_u32 v58, s33, v65
  s_add_u32 s33, s3, 1
  s_and_b32 s33, s33, 3
  s_lshl_b32 s34, s33, 11
  v_add_u32 v62, s34, v65
  s_lshl_b32 s33, s33, 15
  s_lshl_b32 s34, s3, 12
  s_add_u32 s33, s33, s34
  s_add_u32 s33, s33, 32768
  v_add_u32 v59, s33, v65
  s_add_u32 s33, s3, 2
  s_and_b32 s33, s33, 3
  s_lshl_b32 s34, s33, 11
  v_add_u32 v63, s34, v65
  s_lshl_b32 s33, s33, 15
  s_lshl_b32 s34, s3, 12
  s_add_u32 s33, s33, s34
  s_add_u32 s33, s33, 32768
  v_add_u32 v60, s33, v65
  s_add_u32 s33, s3, 3
  s_and_b32 s33, s33, 3
  s_lshl_b32 s34, s33, 11
  v_add_u32 v64, s34, v65
  s_lshl_b32 s33, s33, 15
  s_lshl_b32 s34, s3, 12
  s_add_u32 s33, s33, s34
  s_add_u32 s33, s33, 32768
  v_add_u32 v61, s33, v65
  v_and_b32 v21, 15, v20
  v_lshrrev_b32 v22, 4, v20
  v_lshrrev_b32 v23, 2, v21
  v_xor_b32 v24, v22, v23
  v_lshlrev_b32 v24, 3, v24
  v_lshlrev_b32 v25, 5, v21
  s_lshl_b32 s33, s3, 10
  s_add_u32 s33, s33, 16384
  v_add3_u32 v66, v24, v25, s33
  v_lshlrev_b32 v24, 2, v22
  v_add_u32 v24, v24, v23
  v_lshlrev_b32 v24, 5, v24
  v_and_b32 v25, 3, v21
  v_xor_b32 v26, v25, v22
  v_lshlrev_b32 v26, 3, v26
  s_mov_b32 s33, 16384
  v_add3_u32 v67, v24, v26, s33
  v_lshlrev_b32 v24, 6, v23
  v_and_b32 v26, 1, v21
  v_lshlrev_b32 v26, 4, v26
  v_lshlrev_b32 v27, 8, v22
  v_add3_u32 v24, v24, v26, v27
  s_lshr_b32 s33, s3, 1
  s_lshl_b32 s33, s33, 10
  s_and_b32 s34, s3, 1
  s_lshl_b32 s34, s34, 5
  s_add_u32 s33, s33, s34
  s_add_u32 s33, s33, 20480
  v_add_u32 v24, s33, v24
  v_xor_b32 v26, 32, v24
  v_add_u32 v26, 0x800, v26
  v_cmp_lt_u32 vcc, 1, v25
  s_nop 1
  v_cndmask_b32 v68, v26, v24, vcc
  v_and_b32 v26, 1, v22
  v_lshlrev_b32 v26, 11, v26
  v_and_b32 v27, 2, v22
  v_lshl_add_u32 v26, v27, 14, v26
  v_lshlrev_b32 v24, 13, v23
  v_lshlrev_b32 v27, 4, v25
  v_add3_u32 v24, v24, v26, v27
  s_lshl_b32 s33, s3, 16
  v_add_u32 v69, s33, v24
  v_mov_b32 v24, 0x44444444
  v_mov_b32 v26, 0xeeeeeeee
  v_cndmask_b32 v71, v24, v26, vcc
  v_bfe_u32 v24, v21, 2, 1
  v_lshlrev_b32 v24, 9, v24
  v_bfe_u32 v26, v21, 3, 1
  v_lshlrev_b32 v26, 7, v26
  v_and_b32 v27, 1, v21
  v_lshlrev_b32 v27, 5, v27
  v_add3_u32 v24, v24, v26, v27
  v_lshlrev_b32 v26, 3, v22
  v_and_b32 v27, 2, v21
  v_lshlrev_b32 v27, 1, v27
  v_add3_u32 v24, v24, v26, v27
  s_lshr_b32 s33, s3, 1
  s_lshl_b32 s33, s33, 10
  s_and_b32 s34, s3, 1
  s_lshl_b32 s34, s34, 8
  s_add_u32 s33, s33, s34
  s_add_u32 s33, s33, 0
  v_add_u32 v72, s33, v24
  v_mov_b32 v24, 0
  ds_write_b32 v66, v24
  ds_write_b32 v66, v24 offset:512
  s_mov_b32 s53, 0x3f80
  s_mov_b32 s64, 0x550055
  s_mov_b32 s65, 0x550055
  s_mov_b32 s66, 0x55005500
  s_mov_b32 s67, 0x55005500
  s_mov_b32 s68, 0x550055
  s_mov_b32 s69, 0x550055
  s_mov_b32 s70, 0x55005500
  s_mov_b32 s71, 0x55005500
  s_mov_b32 s54, 0x3f803f80
  s_mov_b32 s55, 0x3f803f80
  s_mov_b32 s52, 0x3e0293ee
  s_mov_b32 s41, 0
  s_mov_b32 s42, 196608
  s_lshl_b32 s33, s58, 8
  s_add_u32 s43, s33, 204800
  s_add_u32 s44, s33, 524288
  s_lshl_b32 s33, s5, 13
  s_add_u32 s45, s33, 1048576
  s_add_u32 s46, s33, 1310720
  s_add_u32 s50, s33, 16777216
  s_add_u32 s51, s33, 33554432
  s_lshl_b32 s33, s5, 6
  s_add_u32 s47, s33, 1048576
  s_add_u32 s48, s33, 1052672
  s_lshl_b32 s33, s5, 10
  s_lshl_b32 s34, s3, 2
  s_add_u32 s33, s33, s34
  s_add_u32 s49, s33, 0
  s_add_u32 s56, s49, 1008
  s_waitcnt lgkmcnt(0)
  s_add_u32 s33, s37, 3670016
  s_add_u32 m0, s38, 114688
  s_nop 0
  buffer_load_dwordx4 v2, s[20:23], s33 offen lds
  s_add_u32 s33, s37, 3702784
  s_add_u32 m0, s38, 115712
  s_nop 0
  buffer_load_dwordx4 v2, s[20:23], s33 offen lds
  s_add_u32 s33, s37, 3735552
  s_add_u32 m0, s38, 116736
  s_nop 0
  buffer_load_dwordx4 v3, s[20:23], s33 offen lds
  s_add_u32 s33, s37, 3768320
  s_add_u32 m0, s38, 117760
  s_nop 0
  buffer_load_dwordx4 v3, s[20:23], s33 offen lds
  s_waitcnt vmcnt(20)
  s_barrier
  ds_read_b64_tr_b16 a[64:65], v4 offset:32768
  ds_read_b64_tr_b16 a[66:67], v4 offset:33792
  ds_read_b64_tr_b16 a[68:69], v4 offset:40960
  ds_read_b64_tr_b16 a[70:71], v4 offset:41984
  ds_read_b64_tr_b16 a[72:73], v5 offset:32768
  ds_read_b64_tr_b16 a[74:75], v5 offset:33792
  ds_read_b64_tr_b16 a[76:77], v5 offset:40960
  ds_read_b64_tr_b16 a[78:79], v5 offset:41984
  s_waitcnt lgkmcnt(0)
  s_add_u32 s33, s37, 0
  s_add_u32 m0, s38, 0
  s_nop 0
  buffer_load_dwordx4 v2, s[24:27], s33 offen lds
  s_add_u32 s33, s37, 32768
  s_add_u32 m0, s38, 1024
  s_nop 0
  buffer_load_dwordx4 v2, s[24:27], s33 offen lds
  s_add_u32 s33, s37, 65536
  s_add_u32 m0, s38, 2048
  s_nop 0
  buffer_load_dwordx4 v3, s[24:27], s33 offen lds
  s_add_u32 s33, s37, 98304
  s_add_u32 m0, s38, 3072
  s_nop 0
  buffer_load_dwordx4 v3, s[24:27], s33 offen lds
  s_waitcnt vmcnt(20)
  s_barrier
  ds_read_b64_tr_b16 a[80:81], v4 offset:49152
  ds_read_b64_tr_b16 a[82:83], v4 offset:50176
  ds_read_b64_tr_b16 a[84:85], v4 offset:57344
  ds_read_b64_tr_b16 a[86:87], v4 offset:58368
  ds_read_b64_tr_b16 a[88:89], v5 offset:49152
  ds_read_b64_tr_b16 a[90:91], v5 offset:50176
  ds_read_b64_tr_b16 a[92:93], v5 offset:57344
  ds_read_b64_tr_b16 a[94:95], v5 offset:58368
  s_waitcnt lgkmcnt(0)
  s_add_u32 s33, s37, 524288
  s_add_u32 m0, s38, 16384
  s_nop 0
  buffer_load_dwordx4 v2, s[24:27], s33 offen lds
  s_add_u32 s33, s37, 557056
  s_add_u32 m0, s38, 17408
  s_nop 0
  buffer_load_dwordx4 v2, s[24:27], s33 offen lds
  s_add_u32 s33, s37, 589824
  s_add_u32 m0, s38, 18432
  s_nop 0
  buffer_load_dwordx4 v3, s[24:27], s33 offen lds
  s_add_u32 s33, s37, 622592
  s_add_u32 m0, s38, 19456
  s_nop 0
  buffer_load_dwordx4 v3, s[24:27], s33 offen lds
  s_waitcnt vmcnt(20)
  s_barrier
  ds_read_b64_tr_b16 a[96:97], v6 offset:0
  ds_read_b64_tr_b16 a[98:99], v6 offset:1024
  ds_read_b64_tr_b16 a[100:101], v6 offset:8192
  ds_read_b64_tr_b16 a[102:103], v6 offset:9216
  ds_read_b64_tr_b16 a[104:105], v7 offset:0
  ds_read_b64_tr_b16 a[106:107], v7 offset:1024
  ds_read_b64_tr_b16 a[108:109], v7 offset:8192
  ds_read_b64_tr_b16 a[110:111], v7 offset:9216
  s_waitcnt lgkmcnt(0)
  s_add_u32 s33, s37, 1048576
  s_add_u32 m0, s38, 32768
  s_nop 0
  buffer_load_dwordx4 v2, s[24:27], s33 offen lds
  s_add_u32 s33, s37, 1081344
  s_add_u32 m0, s38, 33792
  s_nop 0
  buffer_load_dwordx4 v2, s[24:27], s33 offen lds
  s_add_u32 s33, s37, 1114112
  s_add_u32 m0, s38, 34816
  s_nop 0
  buffer_load_dwordx4 v3, s[24:27], s33 offen lds
  s_add_u32 s33, s37, 1146880
  s_add_u32 m0, s38, 35840
  s_nop 0
  buffer_load_dwordx4 v3, s[24:27], s33 offen lds
  s_waitcnt vmcnt(20)
  s_barrier
  ds_read_b64_tr_b16 a[112:113], v6 offset:16384
  ds_read_b64_tr_b16 a[114:115], v6 offset:17408
  ds_read_b64_tr_b16 a[116:117], v6 offset:24576
  ds_read_b64_tr_b16 a[118:119], v6 offset:25600
  ds_read_b64_tr_b16 a[120:121], v7 offset:16384
  ds_read_b64_tr_b16 a[122:123], v7 offset:17408
  ds_read_b64_tr_b16 a[124:125], v7 offset:24576
  ds_read_b64_tr_b16 a[126:127], v7 offset:25600
  s_waitcnt lgkmcnt(0)
  s_add_u32 s33, s37, 1572864
  s_add_u32 m0, s38, 49152
  s_nop 0
  buffer_load_dwordx4 v2, s[24:27], s33 offen lds
  s_add_u32 s33, s37, 1605632
  s_add_u32 m0, s38, 50176
  s_nop 0
  buffer_load_dwordx4 v2, s[24:27], s33 offen lds
  s_add_u32 s33, s37, 1638400
  s_add_u32 m0, s38, 51200
  s_nop 0
  buffer_load_dwordx4 v3, s[24:27], s33 offen lds
  s_add_u32 s33, s37, 1671168
  s_add_u32 m0, s38, 52224
  s_nop 0
  buffer_load_dwordx4 v3, s[24:27], s33 offen lds
  s_waitcnt vmcnt(20)
  s_barrier
  ds_read_b64_tr_b16 a[0:1], v6 offset:32768
  ds_read_b64_tr_b16 a[2:3], v6 offset:33792
  ds_read_b64_tr_b16 a[4:5], v6 offset:40960
  ds_read_b64_tr_b16 a[6:7], v6 offset:41984
  ds_read_b64_tr_b16 a[8:9], v7 offset:32768
  ds_read_b64_tr_b16 a[10:11], v7 offset:33792
  ds_read_b64_tr_b16 a[12:13], v7 offset:40960
  ds_read_b64_tr_b16 a[14:15], v7 offset:41984
  s_waitcnt lgkmcnt(0)
  s_add_u32 s33, s37, 2097152
  s_add_u32 m0, s38, 65536
  s_nop 0
  buffer_load_dwordx4 v2, s[24:27], s33 offen lds
  s_add_u32 s33, s37, 2129920
  s_add_u32 m0, s38, 66560
  s_nop 0
  buffer_load_dwordx4 v2, s[24:27], s33 offen lds
  s_add_u32 s33, s37, 2162688
  s_add_u32 m0, s38, 67584
  s_nop 0
  buffer_load_dwordx4 v3, s[24:27], s33 offen lds
  s_add_u32 s33, s37, 2195456
  s_add_u32 m0, s38, 68608
  s_nop 0
  buffer_load_dwordx4 v3, s[24:27], s33 offen lds
  s_waitcnt vmcnt(20)
  s_barrier
  ds_read_b64_tr_b16 a[16:17], v6 offset:49152
  ds_read_b64_tr_b16 a[18:19], v6 offset:50176
  ds_read_b64_tr_b16 a[20:21], v6 offset:57344
  ds_read_b64_tr_b16 a[22:23], v6 offset:58368
  ds_read_b64_tr_b16 a[24:25], v7 offset:49152
  ds_read_b64_tr_b16 a[26:27], v7 offset:50176
  ds_read_b64_tr_b16 a[28:29], v7 offset:57344
  ds_read_b64_tr_b16 a[30:31], v7 offset:58368
  s_waitcnt lgkmcnt(0)
  s_add_u32 s33, s37, 2621440
  s_add_u32 m0, s38, 81920
  s_nop 0
  buffer_load_dwordx4 v2, s[24:27], s33 offen lds
  s_add_u32 s33, s37, 2654208
  s_add_u32 m0, s38, 82944
  s_nop 0
  buffer_load_dwordx4 v2, s[24:27], s33 offen lds
  s_add_u32 s33, s37, 2686976
  s_add_u32 m0, s38, 83968
  s_nop 0
  buffer_load_dwordx4 v3, s[24:27], s33 offen lds
  s_add_u32 s33, s37, 2719744
  s_add_u32 m0, s38, 84992
  s_nop 0
  buffer_load_dwordx4 v3, s[24:27], s33 offen lds
  s_waitcnt vmcnt(20)
  s_barrier
  ds_read_b64_tr_b16 a[160:161], v4 offset:0
  ds_read_b64_tr_b16 a[162:163], v4 offset:1024
  ds_read_b64_tr_b16 a[164:165], v4 offset:8192
  ds_read_b64_tr_b16 a[166:167], v4 offset:9216
  ds_read_b64_tr_b16 a[168:169], v5 offset:0
  ds_read_b64_tr_b16 a[170:171], v5 offset:1024
  ds_read_b64_tr_b16 a[172:173], v5 offset:8192
  ds_read_b64_tr_b16 a[174:175], v5 offset:9216
  s_waitcnt lgkmcnt(0)
  s_add_u32 s33, s37, 3145728
  s_add_u32 m0, s38, 98304
  s_nop 0
  buffer_load_dwordx4 v2, s[24:27], s33 offen lds
  s_add_u32 s33, s37, 3178496
  s_add_u32 m0, s38, 99328
  s_nop 0
  buffer_load_dwordx4 v2, s[24:27], s33 offen lds
  s_add_u32 s33, s37, 3211264
  s_add_u32 m0, s38, 100352
  s_nop 0
  buffer_load_dwordx4 v3, s[24:27], s33 offen lds
  s_add_u32 s33, s37, 3244032
  s_add_u32 m0, s38, 101376
  s_nop 0
  buffer_load_dwordx4 v3, s[24:27], s33 offen lds
  s_waitcnt vmcnt(20)
  s_barrier
  ds_read_b64_tr_b16 a[176:177], v4 offset:16384
  ds_read_b64_tr_b16 a[178:179], v4 offset:17408
  ds_read_b64_tr_b16 a[180:181], v4 offset:24576
  ds_read_b64_tr_b16 a[182:183], v4 offset:25600
  ds_read_b64_tr_b16 a[184:185], v5 offset:16384
  ds_read_b64_tr_b16 a[186:187], v5 offset:17408
  ds_read_b64_tr_b16 a[188:189], v5 offset:24576
  ds_read_b64_tr_b16 a[190:191], v5 offset:25600
  s_waitcnt lgkmcnt(0)
  s_add_u32 s33, s37, 3670016
  s_add_u32 m0, s38, 114688
  s_nop 0
  buffer_load_dwordx4 v2, s[24:27], s33 offen lds
  s_add_u32 s33, s37, 3702784
  s_add_u32 m0, s38, 115712
  s_nop 0
  buffer_load_dwordx4 v2, s[24:27], s33 offen lds
  s_add_u32 s33, s37, 3735552
  s_add_u32 m0, s38, 116736
  s_nop 0
  buffer_load_dwordx4 v3, s[24:27], s33 offen lds
  s_add_u32 s33, s37, 3768320
  s_add_u32 m0, s38, 117760
  s_nop 0
  buffer_load_dwordx4 v3, s[24:27], s33 offen lds
  s_waitcnt vmcnt(20)
  s_barrier
  ds_read_b64_tr_b16 a[192:193], v4 offset:32768
  ds_read_b64_tr_b16 a[194:195], v4 offset:33792
  ds_read_b64_tr_b16 a[196:197], v4 offset:40960
  ds_read_b64_tr_b16 a[198:199], v4 offset:41984
  ds_read_b64_tr_b16 a[200:201], v5 offset:32768
  ds_read_b64_tr_b16 a[202:203], v5 offset:33792
  ds_read_b64_tr_b16 a[204:205], v5 offset:40960
  ds_read_b64_tr_b16 a[206:207], v5 offset:41984
  s_waitcnt lgkmcnt(0)
  s_add_u32 s33, s37, 0
  s_add_u32 m0, s38, 0
  s_nop 0
  buffer_load_dwordx4 v2, s[28:31], s33 offen lds
  s_add_u32 s33, s37, 32768
  s_add_u32 m0, s38, 1024
  s_nop 0
  buffer_load_dwordx4 v2, s[28:31], s33 offen lds
  s_add_u32 s33, s37, 65536
  s_add_u32 m0, s38, 2048
  s_nop 0
  buffer_load_dwordx4 v3, s[28:31], s33 offen lds
  s_add_u32 s33, s37, 98304
  s_add_u32 m0, s38, 3072
  s_nop 0
  buffer_load_dwordx4 v3, s[28:31], s33 offen lds
  s_waitcnt vmcnt(20)
  s_barrier
  ds_read_b64_tr_b16 a[208:209], v4 offset:49152
  ds_read_b64_tr_b16 a[210:211], v4 offset:50176
  ds_read_b64_tr_b16 a[212:213], v4 offset:57344
  ds_read_b64_tr_b16 a[214:215], v4 offset:58368
  ds_read_b64_tr_b16 a[216:217], v5 offset:49152
  ds_read_b64_tr_b16 a[218:219], v5 offset:50176
  ds_read_b64_tr_b16 a[220:221], v5 offset:57344
  ds_read_b64_tr_b16 a[222:223], v5 offset:58368
  s_waitcnt lgkmcnt(0)
  s_add_u32 s33, s37, 524288
  s_add_u32 m0, s38, 16384
  s_nop 0
  buffer_load_dwordx4 v2, s[28:31], s33 offen lds
  s_add_u32 s33, s37, 557056
  s_add_u32 m0, s38, 17408
  s_nop 0
  buffer_load_dwordx4 v2, s[28:31], s33 offen lds
  s_add_u32 s33, s37, 589824
  s_add_u32 m0, s38, 18432
  s_nop 0
  buffer_load_dwordx4 v3, s[28:31], s33 offen lds
  s_add_u32 s33, s37, 622592
  s_add_u32 m0, s38, 19456
  s_nop 0
  buffer_load_dwordx4 v3, s[28:31], s33 offen lds
  s_waitcnt vmcnt(20)
  s_barrier
  ds_read_b64_tr_b16 a[224:225], v6 offset:0
  ds_read_b64_tr_b16 a[226:227], v6 offset:1024
  ds_read_b64_tr_b16 a[228:229], v6 offset:8192
  ds_read_b64_tr_b16 a[230:231], v6 offset:9216
  ds_read_b64_tr_b16 a[232:233], v7 offset:0
  ds_read_b64_tr_b16 a[234:235], v7 offset:1024
  ds_read_b64_tr_b16 a[236:237], v7 offset:8192
  ds_read_b64_tr_b16 a[238:239], v7 offset:9216
  s_waitcnt lgkmcnt(0)
  s_add_u32 s33, s37, 1048576
  s_add_u32 m0, s38, 32768
  s_nop 0
  buffer_load_dwordx4 v2, s[28:31], s33 offen lds
  s_add_u32 s33, s37, 1081344
  s_add_u32 m0, s38, 33792
  s_nop 0
  buffer_load_dwordx4 v2, s[28:31], s33 offen lds
  s_add_u32 s33, s37, 1114112
  s_add_u32 m0, s38, 34816
  s_nop 0
  buffer_load_dwordx4 v3, s[28:31], s33 offen lds
  s_add_u32 s33, s37, 1146880
  s_add_u32 m0, s38, 35840
  s_nop 0
  buffer_load_dwordx4 v3, s[28:31], s33 offen lds
  s_waitcnt vmcnt(20)
  s_barrier
  ds_read_b64_tr_b16 a[240:241], v6 offset:16384
  ds_read_b64_tr_b16 a[242:243], v6 offset:17408
  ds_read_b64_tr_b16 a[244:245], v6 offset:24576
  ds_read_b64_tr_b16 a[246:247], v6 offset:25600
  ds_read_b64_tr_b16 a[248:249], v7 offset:16384
  ds_read_b64_tr_b16 a[250:251], v7 offset:17408
  ds_read_b64_tr_b16 a[252:253], v7 offset:24576
  ds_read_b64_tr_b16 a[254:255], v7 offset:25600
  s_waitcnt lgkmcnt(0)
  s_add_u32 s33, s37, 1572864
  s_add_u32 m0, s38, 49152
  s_nop 0
  buffer_load_dwordx4 v2, s[28:31], s33 offen lds
  s_add_u32 s33, s37, 1605632
  s_add_u32 m0, s38, 50176
  s_nop 0
  buffer_load_dwordx4 v2, s[28:31], s33 offen lds
  s_add_u32 s33, s37, 1638400
  s_add_u32 m0, s38, 51200
  s_nop 0
  buffer_load_dwordx4 v3, s[28:31], s33 offen lds
  s_add_u32 s33, s37, 1671168
  s_add_u32 m0, s38, 52224
  s_nop 0
  buffer_load_dwordx4 v3, s[28:31], s33 offen lds
  s_waitcnt vmcnt(20)
  s_barrier
  ds_read_b64_tr_b16 a[128:129], v6 offset:32768
  ds_read_b64_tr_b16 a[130:131], v6 offset:33792
  ds_read_b64_tr_b16 a[132:133], v6 offset:40960
  ds_read_b64_tr_b16 a[134:135], v6 offset:41984
  ds_read_b64_tr_b16 a[136:137], v7 offset:32768
  ds_read_b64_tr_b16 a[138:139], v7 offset:33792
  ds_read_b64_tr_b16 a[140:141], v7 offset:40960
  ds_read_b64_tr_b16 a[142:143], v7 offset:41984
  s_waitcnt lgkmcnt(0)
  s_add_u32 s33, s37, 2097152
  s_add_u32 m0, s38, 65536
  s_nop 0
  buffer_load_dwordx4 v2, s[28:31], s33 offen lds
  s_add_u32 s33, s37, 2129920
  s_add_u32 m0, s38, 66560
  s_nop 0
  buffer_load_dwordx4 v2, s[28:31], s33 offen lds
  s_add_u32 s33, s37, 2162688
  s_add_u32 m0, s38, 67584
  s_nop 0
  buffer_load_dwordx4 v3, s[28:31], s33 offen lds
  s_add_u32 s33, s37, 2195456
  s_add_u32 m0, s38, 68608
  s_nop 0
  buffer_load_dwordx4 v3, s[28:31], s33 offen lds
  s_waitcnt vmcnt(20)
  s_barrier
  ds_read_b64_tr_b16 a[144:145], v6 offset:49152
  ds_read_b64_tr_b16 a[146:147], v6 offset:50176
  ds_read_b64_tr_b16 a[148:149], v6 offset:57344
  ds_read_b64_tr_b16 a[150:151], v6 offset:58368
  ds_read_b64_tr_b16 a[152:153], v7 offset:49152
  ds_read_b64_tr_b16 a[154:155], v7 offset:50176
  ds_read_b64_tr_b16 a[156:157], v7 offset:57344
  ds_read_b64_tr_b16 a[158:159], v7 offset:58368
  buffer_load_dword v116, v115, s[12:15], 0 offen offset:160 sc1
  s_waitcnt lgkmcnt(0)
  s_add_u32 s33, s37, 2621440
  s_add_u32 m0, s38, 81920
  s_nop 0
  buffer_load_dwordx4 v2, s[28:31], s33 offen lds
  s_add_u32 s33, s37, 2654208
  s_add_u32 m0, s38, 82944
  s_nop 0
  buffer_load_dwordx4 v2, s[28:31], s33 offen lds
  s_add_u32 s33, s37, 2686976
  s_add_u32 m0, s38, 83968
  s_nop 0
  buffer_load_dwordx4 v3, s[28:31], s33 offen lds
  s_add_u32 s33, s37, 2719744
  s_add_u32 m0, s38, 84992
  s_nop 0
  buffer_load_dwordx4 v3, s[28:31], s33 offen lds
  s_waitcnt vmcnt(21)
  s_barrier
  ds_read_b64_tr_b16 v[16:17], v4 offset:0
  ds_read_b64_tr_b16 v[18:19], v4 offset:1024
  ds_read_b64_tr_b16 v[20:21], v4 offset:8192
  ds_read_b64_tr_b16 v[22:23], v4 offset:9216
  ds_read_b64_tr_b16 v[24:25], v5 offset:0
  ds_read_b64_tr_b16 v[26:27], v5 offset:1024
  ds_read_b64_tr_b16 v[28:29], v5 offset:8192
  ds_read_b64_tr_b16 v[30:31], v5 offset:9216
  s_waitcnt lgkmcnt(0)
  s_add_u32 s33, s37, 3145728
  s_add_u32 m0, s38, 98304
  s_nop 0
  buffer_load_dwordx4 v2, s[28:31], s33 offen lds
  s_add_u32 s33, s37, 3178496
  s_add_u32 m0, s38, 99328
  s_nop 0
  buffer_load_dwordx4 v2, s[28:31], s33 offen lds
  s_add_u32 s33, s37, 3211264
  s_add_u32 m0, s38, 100352
  s_nop 0
  buffer_load_dwordx4 v3, s[28:31], s33 offen lds
  s_add_u32 s33, s37, 3244032
  s_add_u32 m0, s38, 101376
  s_nop 0
  buffer_load_dwordx4 v3, s[28:31], s33 offen lds
  s_waitcnt vmcnt(21)
  s_barrier
  ds_write_b128 v8, v[16:19] offset:0
  ds_write_b128 v8, v[20:23] offset:1024
  ds_write_b128 v8, v[24:27] offset:2048
  ds_write_b128 v8, v[28:31] offset:3072
  ds_read_b64_tr_b16 v[32:33], v4 offset:16384
  ds_read_b64_tr_b16 v[34:35], v4 offset:17408
  ds_read_b64_tr_b16 v[36:37], v4 offset:24576
  ds_read_b64_tr_b16 v[38:39], v4 offset:25600
  ds_read_b64_tr_b16 v[40:41], v5 offset:16384
  ds_read_b64_tr_b16 v[42:43], v5 offset:17408
  ds_read_b64_tr_b16 v[44:45], v5 offset:24576
  ds_read_b64_tr_b16 v[46:47], v5 offset:25600
  s_waitcnt lgkmcnt(0)
  s_add_u32 s33, s37, 3670016
  s_add_u32 m0, s38, 114688
  s_nop 0
  buffer_load_dwordx4 v2, s[28:31], s33 offen lds
  s_add_u32 s33, s37, 3702784
  s_add_u32 m0, s38, 115712
  s_nop 0
  buffer_load_dwordx4 v2, s[28:31], s33 offen lds
  s_add_u32 s33, s37, 3735552
  s_add_u32 m0, s38, 116736
  s_nop 0
  buffer_load_dwordx4 v3, s[28:31], s33 offen lds
  s_add_u32 s33, s37, 3768320
  s_add_u32 m0, s38, 117760
  s_nop 0
  buffer_load_dwordx4 v3, s[28:31], s33 offen lds
  s_waitcnt vmcnt(21)
  s_barrier
  ds_write_b128 v8, v[32:35] offset:16384
  ds_write_b128 v8, v[36:39] offset:17408
  ds_write_b128 v8, v[40:43] offset:18432
  ds_write_b128 v8, v[44:47] offset:19456
  ds_read_b64_tr_b16 v[16:17], v4 offset:32768
  ds_read_b64_tr_b16 v[18:19], v4 offset:33792
  ds_read_b64_tr_b16 v[20:21], v4 offset:40960
  ds_read_b64_tr_b16 v[22:23], v4 offset:41984
  ds_read_b64_tr_b16 v[24:25], v5 offset:32768
  ds_read_b64_tr_b16 v[26:27], v5 offset:33792
  ds_read_b64_tr_b16 v[28:29], v5 offset:40960
  ds_read_b64_tr_b16 v[30:31], v5 offset:41984
  s_waitcnt lgkmcnt(0)
  s_waitcnt vmcnt(17)
  s_barrier
  ds_write_b128 v8, v[16:19] offset:32768
  ds_write_b128 v8, v[20:23] offset:33792
  ds_write_b128 v8, v[24:27] offset:34816
  ds_write_b128 v8, v[28:31] offset:35840
  ds_read_b64_tr_b16 v[32:33], v4 offset:49152
  ds_read_b64_tr_b16 v[34:35], v4 offset:50176
  ds_read_b64_tr_b16 v[36:37], v4 offset:57344
  ds_read_b64_tr_b16 v[38:39], v4 offset:58368
  ds_read_b64_tr_b16 v[40:41], v5 offset:49152
  ds_read_b64_tr_b16 v[42:43], v5 offset:50176
  ds_read_b64_tr_b16 v[44:45], v5 offset:57344
  ds_read_b64_tr_b16 v[46:47], v5 offset:58368
  s_waitcnt lgkmcnt(0)
  s_waitcnt vmcnt(13)
  s_barrier
  ds_write_b128 v8, v[32:35] offset:49152
  ds_write_b128 v8, v[36:39] offset:50176
  ds_write_b128 v8, v[40:43] offset:51200
  ds_write_b128 v8, v[44:47] offset:52224
  ds_read_b64_tr_b16 v[16:17], v6 offset:0
  ds_read_b64_tr_b16 v[18:19], v6 offset:1024
  ds_read_b64_tr_b16 v[20:21], v6 offset:8192
  ds_read_b64_tr_b16 v[22:23], v6 offset:9216
  ds_read_b64_tr_b16 v[24:25], v7 offset:0
  ds_read_b64_tr_b16 v[26:27], v7 offset:1024
  ds_read_b64_tr_b16 v[28:29], v7 offset:8192
  ds_read_b64_tr_b16 v[30:31], v7 offset:9216
  v_lshlrev_b32 v119, 1, v65
  s_lshl_b32 s34, s3, 11
  s_add_u32 s35, s34, 204800
  buffer_load_dword v114, v119, s[8:11], s35 offen sc1
  s_andn2_b32 s35, s46, 0x2000
  s_lshl_b32 s34, s34, 1
  s_add_u32 s35, s35, s34
  v_lshlrev_b32 v119, 1, v119
  buffer_load_dword v119, v119, s[8:11], s35 offen sc1
  s_waitcnt lgkmcnt(0)
  s_waitcnt vmcnt(10)
  s_barrier
  ds_write_b128 v9, v[16:19] offset:0
  ds_write_b128 v9, v[20:23] offset:1024
  ds_write_b128 v9, v[24:27] offset:2048
  ds_write_b128 v9, v[28:31] offset:3072
  ds_read_b64_tr_b16 v[32:33], v6 offset:16384
  ds_read_b64_tr_b16 v[34:35], v6 offset:17408
  ds_read_b64_tr_b16 v[36:37], v6 offset:24576
  ds_read_b64_tr_b16 v[38:39], v6 offset:25600
  ds_read_b64_tr_b16 v[40:41], v7 offset:16384
  ds_read_b64_tr_b16 v[42:43], v7 offset:17408
  ds_read_b64_tr_b16 v[44:45], v7 offset:24576
  ds_read_b64_tr_b16 v[46:47], v7 offset:25600
  buffer_load_dword v117, off, s[8:11], s49 sc1
  buffer_load_dword v118, off, s[8:11], s49 offset:16 sc1
  s_waitcnt lgkmcnt(0)
  s_waitcnt vmcnt(8)
  s_barrier
  ds_write_b128 v9, v[32:35] offset:16384
  ds_write_b128 v9, v[36:39] offset:17408
  ds_write_b128 v9, v[40:43] offset:18432
  ds_write_b128 v9, v[44:47] offset:19456
  ds_read_b64_tr_b16 v[16:17], v6 offset:32768
  ds_read_b64_tr_b16 v[18:19], v6 offset:33792
  ds_read_b64_tr_b16 v[20:21], v6 offset:40960
  ds_read_b64_tr_b16 v[22:23], v6 offset:41984
  ds_read_b64_tr_b16 v[24:25], v7 offset:32768
  ds_read_b64_tr_b16 v[26:27], v7 offset:33792
  ds_read_b64_tr_b16 v[28:29], v7 offset:40960
  ds_read_b64_tr_b16 v[30:31], v7 offset:41984
  s_waitcnt lgkmcnt(0)
  s_waitcnt vmcnt(4)
  s_barrier
  ds_write_b128 v9, v[16:19] offset:32768
  ds_write_b128 v9, v[20:23] offset:33792
  ds_write_b128 v9, v[24:27] offset:34816
  ds_write_b128 v9, v[28:31] offset:35840
  ds_read_b64_tr_b16 v[32:33], v6 offset:49152
  ds_read_b64_tr_b16 v[34:35], v6 offset:50176
  ds_read_b64_tr_b16 v[36:37], v6 offset:57344
  ds_read_b64_tr_b16 v[38:39], v6 offset:58368
  ds_read_b64_tr_b16 v[40:41], v7 offset:49152
  ds_read_b64_tr_b16 v[42:43], v7 offset:50176
  ds_read_b64_tr_b16 v[44:45], v7 offset:57344
  ds_read_b64_tr_b16 v[46:47], v7 offset:58368
  s_mov_b32 s57, 0
  s_waitcnt vmcnt(0)
  v_readlane_b32 s33, v116, s4
  v_and_b32 v116, 63, v116
  v_cmp_ne_u32 s[58:59], 32, v116
  v_min_u32 v117, v117, v118
  v_cmp_eq_u32 vcc, 0, v117
  s_nop 3
  s_or_b64 vcc, vcc, s[58:59]
  s_cbranch_vccnz JD_13
  s_bfe_u32 s34, s33, 0x80006
  s_mul_i32 s34, s34, s34
  s_lshr_b32 s33, s33, 14
  s_lshl_b32 s33, s33, 5
  s_cmp_lg_u32 s33, s34
  s_cselect_b32 s7, 1, 0
  buffer_load_dwordx4 v[120:123], v57, s[8:11], s50 offen offset:0 sc1
  buffer_load_dwordx4 v[124:127], v57, s[8:11], s50 offen offset:1024 sc1
  buffer_load_dwordx4 v[48:51], v57, s[8:11], s42 offen offset:0 sc1
  buffer_load_dwordx4 v[48:51], v57, s[8:11], s42 offen offset:0 sc1
  buffer_load_dwordx4 v[52:55], v57, s[8:11], s42 offen offset:1024 sc1
  buffer_load_dwordx4 v[52:55], v57, s[8:11], s42 offen offset:1024 sc1
  s_mov_b32 s57, 1
JD_13:
  s_waitcnt lgkmcnt(0)
  s_barrier
  ds_write_b128 v9, v[32:35] offset:49152
  ds_write_b128 v9, v[36:39] offset:50176
  ds_write_b128 v9, v[40:43] offset:51200
  ds_write_b128 v9, v[44:47] offset:52224
  s_waitcnt lgkmcnt(0)
LOADED_1:
  s_barrier
  v_mov_b64 v[0:1], v[56:57]
  v_mov_b64 v[2:3], v[58:59]
  v_mov_b64 v[4:5], v[60:61]
  v_mov_b64 v[6:7], v[62:63]
  v_mov_b64 v[8:9], v[64:65]
  v_mov_b64 v[10:11], v[66:67]
  v_mov_b64 v[12:13], v[68:69]
  v_mov_b64 v[14:15], v[70:71]
  v_mov_b64 v[16:17], v[72:73]
  v_mov_b32 v18, v112
  v_mov_b32 v14, v113
  s_cmp_lg_u32 s57, 0
  s_cbranch_scc1 T_GO
  v_lshrrev_b32 v20, 4, v9
  v_and_b32 v22, 7, v20
  v_lshlrev_b32 v22, 2, v22
RDY_14:
  buffer_load_dword v21, v22, s[12:15], 0 offen offset:160 sc1
  s_waitcnt vmcnt(0)
  v_readlane_b32 s33, v21, s4
  v_and_b32 v21, 63, v21
  v_cmp_ne_u32 vcc, 32, v21
  s_cbranch_vccz RDYOK_15
  s_sleep 4
  s_sub_u32 s6, s6, 1
  s_cbranch_scc1 GIVEUP
  s_branch RDY_14
RDYOK_15:
  s_bfe_u32 s34, s33, 0x80006
  s_mul_i32 s34, s34, s34
  s_lshr_b32 s33, s33, 14
  s_lshl_b32 s33, s33, 5
  s_cmp_lg_u32 s33, s34
  s_cselect_b32 s7, 1, 0
T_F0:
  buffer_load_dword v17, off, s[8:11], s49 offset:0 sc1
  s_waitcnt vmcnt(0)
  v_cmp_ne_u32 vcc, 0, v17
  s_cbranch_vccnz T_F0OK
  s_sleep 2
  s_sub_u32 s6, s6, 1
  s_cbranch_scc1 GIVEUP
  s_branch T_F0
T_F0OK:
T_F1:
  buffer_load_dword v17, off, s[8:11], s49 offset:16 sc1
  s_waitcnt vmcnt(0)
  v_cmp_ne_u32 vcc, 0, v17
  s_cbranch_vccnz T_F1OK
  s_sleep 2
  s_sub_u32 s6, s6, 1
  s_cbranch_scc1 GIVEUP
  s_branch T_F1
T_F1OK:
  buffer_load_dwordx4 v[120:123], v1, s[8:11], s50 offen offset:0 sc1
  buffer_load_dwordx4 v[124:127], v1, s[8:11], s50 offen offset:1024 sc1
  buffer_load_dwordx4 v[48:51], v1, s[8:11], s42 offen offset:0 sc1
  buffer_load_dwordx4 v[48:51], v1, s[8:11], s42 offen offset:0 sc1
  buffer_load_dwordx4 v[52:55], v1, s[8:11], s42 offen offset:1024 sc1
  buffer_load_dwordx4 v[52:55], v1, s[8:11], s42 offen offset:1024 sc1
T_GO:
TF_ENTRY:
  ds_read_b128 v[80:83], v2 offset:0
  ds_read_b128 v[84:87], v2 offset:1024
  ds_read_b128 v[88:91], v2 offset:2048
  ds_read_b128 v[92:95], v2 offset:3072
  ds_read_b128 v[96:99], v2 offset:16384
  ds_read_b128 v[100:103], v2 offset:17408
  ds_read_b128 v[104:107], v2 offset:18432
  ds_read_b128 v[108:111], v2 offset:19456
  ds_read_b128 v[112:115], v3 offset:0
  ds_read_b128 v[116:119], v3 offset:1024
  v_mov_b64 v[20:21], 0
  v_mov_b64 v[22:23], 0
  v_mov_b64 v[24:25], 0
  v_mov_b64 v[26:27], 0
  v_mov_b64 v[28:29], 0
  v_mov_b64 v[30:31], 0
  v_mov_b64 v[32:33], 0
  v_mov_b64 v[34:35], 0
  v_mov_b64 v[36:37], 0
  v_mov_b64 v[38:39], 0
  v_mov_b64 v[40:41], 0
  v_mov_b64 v[42:43], 0
  v_mov_b64 v[44:45], 0
  v_mov_b64 v[46:47], 0
  v_mov_b32 v17, -1
  s_add_u32 s50, s50, 0x40000
  s_add_u32 s49, s49, 32
  s_waitcnt vmcnt(4)
  ds_write_b128 v1, v[120:123] offset:8192
  ds_write_b128 v1, v[124:127] offset:9216
  s_cmp_lg_u32 s7, 0
  s_cbranch_scc1 TS_STEP
  s_cmp_eq_u32 s3, 1
  s_cbranch_scc1 TFE1_STEP
  s_cmp_eq_u32 s3, 2
  s_cbranch_scc1 TFL0_STEP
  s_cmp_eq_u32 s3, 3
  s_cbranch_scc1 TFL1_STEP
  .p2align 6
TFE0_STEP:
  s_waitcnt vmcnt(3)
  v_max3_u32 v0, v48, v49, v50
  v_max_u32 v0, v0, v51
  v_cmp_eq_u32 vcc, -1, v0
  s_cbranch_vccnz TFE0_ARETRY
TFE0_MOK:
  ds_write_b128 v1, v[48:51] offset:0
  v_smfmac_f32_16x16x64_bf16 v[24:27], v[48:51], a[0:7], v15
  v_smfmac_f32_16x16x64_bf16 v[28:31], v[48:51], a[8:15], v15
  v_smfmac_f32_16x16x64_bf16 v[32:35], v[48:51], a[128:135], v15
  v_smfmac_f32_16x16x64_bf16 v[36:39], v[48:51], a[136:143], v15
  s_waitcnt lgkmcnt(0)
  s_barrier
  ds_read_b128 v[56:59], v6 offset:0
  v_smfmac_f32_16x16x64_bf16 v[40:43], v[48:51], v[80:87], v15
  ds_read_b128 v[64:67], v7 offset:0
  s_waitcnt vmcnt(1)
  v_max3_u32 v0, v52, v53, v54
  v_max_u32 v0, v0, v55
  v_cmp_eq_u32 vcc, -1, v0
  v_smfmac_f32_16x16x64_bf16 v[44:47], v[48:51], v[88:95], v15
  ds_read_b128 v[72:75], v8 offset:0
  s_cbranch_vccnz TFE0_BRETRY
TFE0_BOK:
  ds_write_b128 v1, v[52:55] offset:1024
  v_smfmac_f32_16x16x64_bf16 v[24:27], v[52:55], a[16:23], v15
  buffer_load_dwordx4 v[120:123], v1, s[8:11], s51 offen offset:0 sc1
  v_smfmac_f32_16x16x64_bf16 v[28:31], v[52:55], a[24:31], v15
  v_smfmac_f32_16x16x64_bf16 v[32:35], v[52:55], a[144:151], v15
  buffer_store_dword v18, v14, s[8:11], s44 offen sc1
  v_smfmac_f32_16x16x64_bf16 v[36:39], v[52:55], a[152:159], v15
  s_waitcnt lgkmcnt(0)
  s_barrier
  ds_read_b128 v[60:63], v6 offset:1024
  v_smfmac_f32_16x16x64_bf16 v[40:43], v[52:55], v[96:103], v15
  ds_read_b128 v[68:71], v7 offset:1024
  buffer_store_dword v17, v14, s[8:11], s43 offen
  v_smfmac_f32_16x16x64_bf16 v[44:47], v[52:55], v[104:111], v15
  ds_read_b128 v[76:79], v8 offset:1024
  v_smfmac_f32_16x16x64_bf16 v[24:27], v[56:59], a[32:39], v15
  ds_read_b128 v[80:83], v3 offset:2048
  buffer_store_dword v17, v1, s[8:11], s46 offen
  v_smfmac_f32_16x16x64_bf16 v[28:31], v[56:59], a[40:47], v15
  ds_read_b128 v[84:87], v3 offset:3072
  v_smfmac_f32_16x16x64_bf16 v[24:27], v[64:67], a[64:71], v15
  ds_read_b128 v[88:91], v3 offset:16384
  buffer_store_dword v17, v1, s[8:11], s46 offen offset:1024
  v_smfmac_f32_16x16x64_bf16 v[28:31], v[64:67], a[72:79], v15
  ds_read_b128 v[92:95], v3 offset:17408
  v_smfmac_f32_16x16x64_bf16 v[24:27], v[72:75], a[96:103], v15
  ds_read_b128 v[96:99], v3 offset:18432
  buffer_load_dwordx4 v[124:127], v1, s[8:11], s51 offen offset:1024 sc1
  v_smfmac_f32_16x16x64_bf16 v[28:31], v[72:75], a[104:111], v15
  ds_read_b128 v[100:103], v3 offset:19456
  s_waitcnt lgkmcnt(5)
  v_smfmac_f32_16x16x64_bf16 v[24:27], v[60:63], a[48:55], v15
  ds_read_b128 v[104:107], v4 offset:0
  v_smfmac_f32_16x16x64_bf16 v[24:27], v[68:71], a[80:87], v15
  ds_read_b128 v[108:111], v4 offset:1024
  s_xor_b32 s42, s42, 0x2000
  s_add_u32 s41, s41, 1
  v_smfmac_f32_16x16x64_bf16 v[24:27], v[76:79], a[112:119], v15
  s_add_u32 s44, s44, 0x2000
  s_xor_b32 s46, s46, 0x40000
  v_smfmac_f32_16x16x64_bf16 v[28:31], v[60:63], a[56:63], v15
  v_smfmac_f32_16x16x64_bf16 v[28:31], v[68:71], a[88:95], v15
  v_mul_f32_e64 v26, s52, v26
  v_mul_f32 v27, s52, v27
  v_smfmac_f32_16x16x64_bf16 v[28:31], v[76:79], a[120:127], v15
  s_waitcnt lgkmcnt(1)
  v_fma_f32 v24, v24, s52, v26
  v_fma_f32 v25, v25, s52, v27
  v_smfmac_f32_16x16x64_bf16 v[44:47], v[56:59], v[80:87], v15
  ds_read_b128 v[80:83], v9 offset:8192
  v_cvt_pk_bf16_f32 v24, v24, v25
  v_smfmac_f32_16x16x64_bf16 v[40:43], v[60:63], v[88:95], v15
  ds_write_b32 v10, v24 offset:4
  v_mul_f32_e64 v30, s52, v30
  v_mul_f32 v31, s52, v31
  v_smfmac_f32_16x16x64_bf16 v[44:47], v[60:63], v[96:103], v15
  ds_read_b128 v[84:87], v9 offset:9216
  v_fma_f32 v28, v28, s52, v30
  v_fma_f32 v29, v29, s52, v31
  v_smfmac_f32_16x16x64_bf16 v[40:43], v[56:59], v[112:119], v15
  ds_read_b128 v[88:91], v9 offset:10240
  s_waitcnt lgkmcnt(4)
  v_cvt_pk_bf16_f32 v28, v28, v29
  v_smfmac_f32_16x16x64_bf16 v[40:43], v[64:67], v[104:111], v15
  ds_write_b32 v10, v28 offset:516
  v_smfmac_f32_16x16x64_bf16 v[32:35], v[56:59], a[160:167], v15
  ds_read_b128 v[92:95], v9 offset:11264
  v_lshrrev_b32 v19, 1, v9
  v_smfmac_f32_16x16x64_bf16 v[32:35], v[60:63], a[176:183], v15
  ds_read_b128 v[96:99], v9 offset:12288
  s_waitcnt vmcnt(6)
  v_smfmac_f32_16x16x64_bf16 v[32:35], v[64:67], a[192:199], v15
  s_waitcnt lgkmcnt(2)
  s_barrier
  v_smfmac_f32_16x16x64_bf16 v[36:39], v[56:59], a[168:175], v15
  ds_read_b64_tr_b16 v[108:109], v11 offset:1024
  v_smfmac_f32_16x16x64_bf16 v[32:35], v[68:71], a[208:215], v15
  ds_read_b64_tr_b16 v[48:49], v11 offset:2048
  ds_read_b128 v[100:103], v9 offset:13312
  v_smfmac_f32_16x16x64_bf16 v[32:35], v[72:75], a[224:231], v15
  ds_read_b64_tr_b16 v[50:51], v11 offset:2560
  v_mov_b64_e64 v[56:57], s[54:55]
  v_smfmac_f32_16x16x64_bf16 v[32:35], v[76:79], a[240:247], v15
  ds_read_b64_tr_b16 v[104:105], v11 offset:0
  ds_read_b64_tr_b16 v[110:111], v11 offset:1536
  v_smfmac_f32_16x16x64_bf16 v[36:39], v[60:63], a[184:191], v15
  ds_read_b64_tr_b16 v[106:107], v11 offset:512
  ds_read_b128 v[112:115], v9 offset:14336
  v_smfmac_f32_16x16x64_bf16 v[36:39], v[64:67], a[200:207], v15
  ds_read_b64_tr_b16 v[52:53], v11 offset:3072
  v_add_f32_e64 v32, v32, v34
  v_smfmac_f32_16x16x64_bf16 v[36:39], v[68:71], a[216:223], v15
  ds_read_b128 v[116:119], v9 offset:15360
  v_add_f32_e64 v33, v33, v35
  v_smfmac_f32_16x16x64_bf16 v[36:39], v[72:75], a[232:239], v15
  ds_read_b64_tr_b16 v[54:55], v11 offset:3584
  v_cvt_pk_bf16_f32 v32, v32, v33
  v_smfmac_f32_16x16x64_bf16 v[36:39], v[76:79], a[248:255], v15
  ds_write_b32 v16, v32 offset:0
  s_waitcnt lgkmcnt(5)
  v_mfma_f32_16x16x32_bf16 v[28:31], v[84:87], v[104:107], 0
  ds_read_b128 v[84:87], v4 offset:3072
  v_mov_b64 v[58:59], s[54:55]
  v_mfma_f32_16x16x32_bf16 v[24:27], v[80:83], v[104:107], 0
  ds_read_b128 v[80:83], v4 offset:2048
  v_add_f32_e64 v37, v37, v39
  v_mfma_f32_16x16x32_bf16 v[24:27], v[88:91], v[108:111], v[24:27]
  ds_read_b128 v[88:91], v4 offset:16384
  v_add_f32_e64 v36, v36, v38
  v_cvt_pk_bf16_f32 v36, v36, v37
  v_mfma_f32_16x16x32_bf16 v[28:31], v[92:95], v[108:111], v[28:31]
  ds_read_b128 v[92:95], v4 offset:17408
  ds_write_b32 v16, v36 offset:64
  v_mfma_f32_16x16x32_bf16 v[24:27], v[96:99], v[48:51], v[24:27]
  s_waitcnt lgkmcnt(5)
  v_mov_b32 v61, 0
  v_mfma_f32_16x16x32_bf16 v[24:27], v[112:115], v[52:55], v[24:27]
  ds_read_b128 v[112:115], v5 offset:0
  v_mfma_f32_16x16x32_bf16 v[28:31], v[100:103], v[48:51], v[28:31]
  ds_read_b128 v[96:99], v4 offset:18432
  ds_read_b128 v[100:103], v4 offset:19456
  v_mfma_f32_16x16x32_bf16 v[28:31], v[116:119], v[52:55], v[28:31]
  ds_read_b128 v[116:119], v5 offset:1024
  v_exp_f32 v27, v27
  v_exp_f32 v24, v24
  v_exp_f32 v26, v26
  v_exp_f32 v25, v25
  s_waitcnt lgkmcnt(4)
  v_smfmac_f32_16x16x64_bf16 v[40:43], v[68:71], v[88:95], v15
  s_barrier
  ds_read_b64_tr_b16 v[32:33], v19 offset:0
  ds_read_b64_tr_b16 v[36:37], v19 offset:1024
  v_smfmac_f32_16x16x64_bf16 v[44:47], v[64:67], v[80:87], v15
  ds_read_b64_tr_b16 v[38:39], v19 offset:1536
  ds_read_b128 v[92:95], v5 offset:17408
  ds_read_b64_tr_b16 v[34:35], v19 offset:512
  s_waitcnt lgkmcnt(5)
  v_exp_f32 v30, v30
  v_exp_f32 v31, v31
  v_exp_f32 v29, v29
  v_smfmac_f32_16x16x64_bf16 v[44:47], v[68:71], v[96:103], v15
  ds_read_b128 v[80:83], v5 offset:2048
  ds_read_b128 v[88:91], v5 offset:16384
  v_smfmac_f32_16x16x64_bf16 v[40:43], v[72:75], v[112:119], v15
  ds_read_b128 v[84:87], v5 offset:3072
  v_exp_f32 v28, v28
  v_cvt_pk_bf16_f32 v24, v24, v25
  s_waitcnt lgkmcnt(3)
  v_smfmac_f32_16x16x64_bf16 v[20:23], v[32:35], v[104:111], v15
  ds_read_b128 v[100:103], v5 offset:19456
  v_cvt_pk_bf16_f32 v25, v26, v27
  v_cvt_pk_bf16_f32 v27, v30, v31
  v_smfmac_f32_16x16x64_bf16 v[20:23], v[36:39], v[48:55], v15
  ds_read_b128 v[96:99], v5 offset:18432
  v_cvt_pk_bf16_f32 v26, v28, v29
  s_waitcnt lgkmcnt(3)
  v_smfmac_f32_16x16x64_bf16 v[40:43], v[76:79], v[88:95], v15
  buffer_load_dwordx4 v[32:35], v1, s[8:11], s50 offen offset:0 sc1
  v_mfma_f32_16x16x32_bf16 v[28:31], v[56:59], v[24:27], 0
  s_waitcnt lgkmcnt(2)
  v_add_f32 v20, v20, v22
  v_exp_f32 v22, v20
  v_add_f32 v21, v21, v23
  v_exp_f32 v23, v21
  v_smfmac_f32_16x16x64_bf16 v[44:47], v[72:75], v[80:87], v15
  s_waitcnt vmcnt(1)
  v_mfma_f32_16x16x32_bf16 v[104:107], v[120:123], v[24:27], 0
  s_waitcnt lgkmcnt(0)
  v_add_f32_e64 v41, v41, v43
  v_cvt_pk_bf16_f32 v60, v22, v23
  v_smfmac_f32_16x16x64_bf16 v[44:47], v[76:79], v[96:103], v15
  buffer_load_dword v17, off, s[8:11], s49 sc1
  v_mfma_f32_16x16x32_bf16 v[108:111], v[124:127], v[24:27], 0
  v_add_f32_e64 v40, v40, v42
  v_cvt_pk_bf16_f32 v52, v40, v41
  v_mfma_f32_16x16x16_bf16 v[28:31], v[56:57], v[60:61], v[28:31]
  v_add_f32 v45, v45, v47
  v_add_f32 v44, v44, v46
  v_cvt_pk_bf16_f32 v54, v44, v45
  v_mfma_f32_16x16x16_bf16 v[104:107], v[52:53], v[60:61], v[104:107]
  buffer_load_dwordx4 v[36:39], v1, s[8:11], s50 offen offset:1024 sc1
  v_mfma_f32_16x16x16_bf16 v[108:111], v[54:55], v[60:61], v[108:111]
  v_rcp_f32 v0, v28
  s_nop 2
  v_pk_mul_f32 v[104:105], v[104:105], v[0:1] op_sel_hi:[1,0]
  v_pk_mul_f32 v[106:107], v[106:107], v[0:1] op_sel_hi:[1,0]
  v_cvt_pk_bf16_f32 v104, v104, v105
  v_cvt_pk_bf16_f32 v105, v106, v107
  v_pk_mul_f32 v[108:109], v[108:109], v[0:1] op_sel_hi:[1,0]
  v_pk_mul_f32 v[110:111], v[110:111], v[0:1] op_sel_hi:[1,0]
  v_cvt_pk_bf16_f32 v106, v108, v109
  v_cvt_pk_bf16_f32 v107, v110, v111
  ds_write_b128 v12, v[104:107]
  v_subrev_u32 v18, 0x1f800000, v28
  v_cmp_lt_u32 vcc, 0x40000000, v18
  v_mov_b64 v[72:73], 0
  v_mov_b64 v[74:75], 0
  v_mov_b64 v[76:77], 0
  v_mov_b64 v[78:79], 0
  s_cbranch_vccnz TFE0_FAR
TFE0_NEAR:
  v_mov_b64 v[64:65], 0
  v_mov_b64 v[66:67], 0
  v_mov_b64 v[68:69], 0
  v_mov_b64 v[70:71], 0
  v_mov_b64 v[48:49], 0
  v_mov_b64 v[50:51], 0
  v_mov_b64 v[52:53], 0
  v_mov_b64 v[54:55], 0
  s_waitcnt vmcnt(4) lgkmcnt(0)
  s_barrier
  ds_read_b128 v[104:107], v9 offset:20480
  ds_read_b128 v[108:111], v9 offset:21504
  v_mov_b64 v[56:57], 0
  v_mov_b64 v[58:59], 0
  v_mov_b64 v[60:61], 0
  v_mov_b64 v[62:63], 0
  s_add_u32 s50, s50, 262144
  s_add_u32 s51, s51, 262144
  s_waitcnt lgkmcnt(1)
  v_smfmac_f32_16x16x64_bf16 v[48:51], v[104:107], v[128:135], v15
  v_smfmac_f32_16x16x64_bf16 v[52:55], v[104:107], v[144:151], v15
  s_waitcnt lgkmcnt(0)
  v_smfmac_f32_16x16x64_bf16 v[48:51], v[108:111], v[136:143], v15
  v_smfmac_f32_16x16x64_bf16 v[52:55], v[108:111], v[152:159], v15
  v_smfmac_f32_16x16x64_bf16 v[56:59], v[104:107], v[160:167], v15
  v_smfmac_f32_16x16x64_bf16 v[60:63], v[104:107], v[176:183], v15
  v_add_f32 v48, v48, v50
  v_add_f32 v49, v49, v51
  v_smfmac_f32_16x16x64_bf16 v[56:59], v[108:111], v[168:175], v15
  v_cvt_pk_bf16_f32 v20, v48, v49
  v_smfmac_f32_16x16x64_bf16 v[60:63], v[108:111], v[184:191], v15
  v_add_f32 v52, v52, v54
  v_add_f32 v53, v53, v55
  v_smfmac_f32_16x16x64_bf16 v[64:67], v[104:107], v[192:199], v15
  v_cvt_pk_bf16_f32 v21, v52, v53
  v_smfmac_f32_16x16x64_bf16 v[68:71], v[104:107], v[208:215], v15
  v_add_f32 v56, v56, v58
  v_add_f32 v57, v57, v59
  v_smfmac_f32_16x16x64_bf16 v[64:67], v[108:111], v[200:207], v15
  v_cvt_pk_bf16_f32 v22, v56, v57
  v_smfmac_f32_16x16x64_bf16 v[68:71], v[108:111], v[216:223], v15
  v_add_f32 v60, v60, v62
  v_add_f32 v61, v61, v63
  v_smfmac_f32_16x16x64_bf16 v[72:75], v[104:107], v[224:231], v15
  v_cvt_pk_bf16_f32 v23, v60, v61
  buffer_store_dwordx4 v[20:23], v13, s[8:11], s47 offen
  v_smfmac_f32_16x16x64_bf16 v[76:79], v[104:107], v[240:247], v15
  v_add_f32 v64, v64, v66
  v_add_f32 v65, v65, v67
  v_smfmac_f32_16x16x64_bf16 v[72:75], v[108:111], v[232:239], v15
  v_cvt_pk_bf16_f32 v24, v64, v65
  v_smfmac_f32_16x16x64_bf16 v[76:79], v[108:111], v[248:255], v15
  v_add_f32 v68, v68, v70
  v_add_f32 v69, v69, v71
  v_cvt_pk_bf16_f32 v25, v68, v69
  v_add_f32 v72, v72, v74
  v_add_f32 v73, v73, v75
  v_cvt_pk_bf16_f32 v26, v72, v73
  v_add_f32 v76, v76, v78
  v_add_f32 v77, v77, v79
  v_cvt_pk_bf16_f32 v27, v76, v77
  buffer_store_dwordx4 v[24:27], v13, s[8:11], s48 offen
  s_xor_b32 s47, s47, 0x40000
  s_xor_b32 s48, s48, 0x40000
  v_lshrrev_b32 v0, 2, v9
  v_and_b32 v0, 16, v0
  v_lshlrev_b32 v0, v0, s53
  v_cndmask_b32 v28, 0, v0, s[64:65]
  v_cndmask_b32 v29, 0, v0, s[66:67]
  v_cndmask_b32 v30, 0, v0, s[68:69]
  v_cndmask_b32 v31, 0, v0, s[70:71]
  v_mov_b32 v24, 0
  v_mov_b32 v26, 0
  v_mov_b64 v[40:41], 0
  v_mov_b64 v[42:43], 0
  v_mov_b64 v[44:45], 0
  v_mov_b64 v[46:47], 0
  v_mov_b64_e64 v[20:21], 0
  v_mov_b64 v[22:23], 0
  s_nop 15
  s_nop 15
  buffer_load_dwordx4 v[64:67], v1, s[8:11], s45 offen sc1
  buffer_load_dwordx4 v[68:71], v1, s[8:11], s45 offen offset:1024 sc1
  s_waitcnt vmcnt(4)
  ds_write_b128 v1, v[32:35] offset:8192
  ds_write_b128 v1, v[36:39] offset:9216
  s_nop 15
  s_nop 7
  buffer_load_dwordx4 v[64:67], v1, s[8:11], s45 offen sc1
  buffer_load_dwordx4 v[68:71], v1, s[8:11], s45 offen offset:1024 sc1
  v_cmp_eq_u32 vcc, 0, v17
  s_add_u32 s33, s49, 16
  s_cbranch_vccnz TFE0_FRETRY
TFE0_FOK:
  s_min_u32 s49, s33, s56
  v_mov_b32 v17, -1
  s_waitcnt vmcnt(2)
TFE0_ROK:
  v_max_u32_e64 v0, v64, v68
  v_smfmac_f32_16x16x64_bf16 v[24:27], v[28:31], v[64:71], v15
  v_cmp_eq_u32 vcc, -1, v0
  s_nop 2
  s_cbranch_vccnz TFE0_RRETRY
  s_xor_b32 s45, s45, 0x40000
  v_add_f32_dpp v24, v24, v24 row_ror:4 row_mask:0xf bank_mask:0xf
  v_add_f32_dpp v26, v26, v26 row_ror:4 row_mask:0xf bank_mask:0xf
  s_cmp_eq_u32 s41, 63
  v_add_f32_dpp v24, v24, v24 row_ror:8 row_mask:0xf bank_mask:0xf
  v_add_f32_dpp v26, v26, v26 row_ror:8 row_mask:0xf bank_mask:0xf
  v_cvt_pk_bf16_f32 v18, v24, v26
  buffer_store_dword v18, v14, s[8:11], s43 offen
TFE0_RDONE:
  s_cbranch_scc1 TFE0_LAST
  s_xor_b32 s43, s43, 0x2000
  v_mov_b64 v[24:25], 0
  v_mov_b64 v[26:27], 0
  v_mov_b64 v[28:29], 0
  v_mov_b64 v[30:31], 0
  v_mov_b64 v[32:33], 0
  v_mov_b64 v[34:35], 0
  v_mov_b64 v[36:37], 0
  v_mov_b64_e64 v[38:39], 0
  ds_read_b128 v[80:83], v2 offset:0
  ds_read_b128 v[84:87], v2 offset:1024
  ds_read_b128 v[104:107], v2 offset:18432
  ds_read_b128 v[108:111], v2 offset:19456
  s_barrier
  buffer_load_dwordx4 v[48:51], v1, s[8:11], s42 offen sc1
  ds_read_b128 v[112:115], v3 offset:0
  ds_read_b128 v[116:119], v3 offset:1024
  s_nop 15
  s_nop 3
  s_nop 3
  buffer_load_dwordx4 v[48:51], v1, s[8:11], s42 offen sc1
  ds_read_b128 v[88:91], v2 offset:2048
  ds_read_b128 v[92:95], v2 offset:3072
  ds_read_b128 v[96:99], v2 offset:16384
  ds_read_b128 v[100:103], v2 offset:17408
  buffer_load_dwordx4 v[52:55], v1, s[8:11], s42 offen offset:1024 sc1
  s_nop 7
  s_nop 7
  buffer_load_dwordx4 v[52:55], v1, s[8:11], s42 offen offset:1024 sc1
  s_branch TFE0_STEP
TFE0_LAST:
  buffer_store_dword v18, v14, s[8:11], s44 offen sc1
  s_waitcnt vmcnt(0)
  s_waitcnt vmcnt(0)
  s_endpgm
TFE0_FAR:
  s_nop 15
  ds_read_b64_tr_b16 v[80:81], v11 offset:0
  ds_read_b64_tr_b16 v[82:83], v11 offset:512
  ds_read_b64_tr_b16 v[84:85], v11 offset:1024
  ds_read_b64_tr_b16 v[86:87], v11 offset:1536
  ds_read_b64_tr_b16 v[88:89], v11 offset:2048
  ds_read_b64_tr_b16 v[90:91], v11 offset:2560
  ds_read_b64_tr_b16 v[92:93], v11 offset:3072
  ds_read_b64_tr_b16 v[94:95], v11 offset:3584
  s_waitcnt lgkmcnt(0)
  ds_read_b128 v[96:99], v9 offset:8192
  ds_read_b128 v[100:103], v9 offset:9216
  ds_read_b128 v[104:107], v9 offset:10240
  ds_read_b128 v[108:111], v9 offset:11264
  ds_read_b128 v[112:115], v9 offset:12288
  ds_read_b128 v[116:119], v9 offset:13312
  ds_read_b128 v[64:67], v9 offset:14336
  ds_read_b128 v[68:71], v9 offset:15360
  ds_read_b64_tr_b16 v[40:41], v19 offset:0
  ds_read_b64_tr_b16 v[42:43], v19 offset:512
  ds_read_b64_tr_b16 v[44:45], v19 offset:1024
  ds_read_b64_tr_b16 v[46:47], v19 offset:1536
  v_mov_b64 v[20:21], 0
  v_mov_b64 v[22:23], 0
  s_waitcnt lgkmcnt(0)
  v_mfma_f32_16x16x32_bf16 v[24:27], v[96:99], v[80:83], 0
  v_mfma_f32_16x16x32_bf16 v[28:31], v[100:103], v[80:83], 0
  v_mfma_f32_16x16x32_bf16 v[24:27], v[104:107], v[84:87], v[24:27]
  v_mfma_f32_16x16x32_bf16 v[28:31], v[108:111], v[84:87], v[28:31]
  v_mfma_f32_16x16x32_bf16 v[24:27], v[112:115], v[88:91], v[24:27]
  v_mfma_f32_16x16x32_bf16 v[28:31], v[116:119], v[88:91], v[28:31]
  v_mfma_f32_16x16x32_bf16 v[24:27], v[64:67], v[92:95], v[24:27]
  v_mfma_f32_16x16x32_bf16 v[28:31], v[68:71], v[92:95], v[28:31]
  v_smfmac_f32_16x16x64_bf16 v[20:23], v[40:43], v[80:87], v15
  v_smfmac_f32_16x16x64_bf16 v[20:23], v[44:47], v[88:95], v15
  s_nop 7
  v_add_f32 v20, v20, v22
  v_add_f32 v21, v21, v23
  v_max3_f32 v0, v24, v25, v26
  v_max3_f32 v0, v0, v27, v28
  v_max3_f32 v0, v0, v29, v30
  v_max3_f32 v0, v0, v31, v20
  v_max_f32 v0, v0, v21
  v_mov_b32 v18, v0
  s_nop 1
  v_permlane32_swap_b32 v0, v18
  v_max_f32 v0, v0, v18
  v_mov_b32 v18, v0
  s_nop 1
  v_permlane16_swap_b32 v0, v18
  v_max_f32 v0, v0, v18
  v_sub_f32 v24, v24, v0
  v_sub_f32 v25, v25, v0
  v_sub_f32 v26, v26, v0
  v_sub_f32 v27, v27, v0
  v_sub_f32 v28, v28, v0
  v_sub_f32 v29, v29, v0
  v_sub_f32 v30, v30, v0
  v_sub_f32 v31, v31, v0
  v_sub_f32 v20, v20, v0
  v_sub_f32 v21, v21, v0
  v_exp_f32 v24, v24
  v_exp_f32 v25, v25
  v_exp_f32 v26, v26
  v_exp_f32 v27, v27
  v_exp_f32 v28, v28
  v_exp_f32 v29, v29
  v_exp_f32 v30, v30
  v_exp_f32 v31, v31
  v_exp_f32 v22, v20
  v_exp_f32 v23, v21
  s_nop 0
  v_cvt_pk_bf16_f32 v60, v22, v23
  v_cvt_pk_bf16_f32 v24, v24, v25
  v_cvt_pk_bf16_f32 v25, v26, v27
  v_cvt_pk_bf16_f32 v26, v28, v29
  v_cvt_pk_bf16_f32 v27, v30, v31
  s_nop 1
  v_mfma_f32_16x16x32_bf16 v[28:31], v[56:59], v[24:27], 0
  v_mfma_f32_16x16x32_bf16 v[104:107], v[120:123], v[24:27], 0
  v_mfma_f32_16x16x32_bf16 v[108:111], v[124:127], v[24:27], 0
  v_mfma_f32_16x16x16_bf16 v[28:31], v[56:57], v[60:61], v[28:31]
  v_mfma_f32_16x16x16_bf16 v[104:107], v[52:53], v[60:61], v[104:107]
  v_mfma_f32_16x16x16_bf16 v[108:111], v[54:55], v[60:61], v[108:111]
  v_rcp_f32 v0, v28
  s_nop 2
  v_pk_mul_f32 v[104:105], v[104:105], v[0:1] op_sel_hi:[1,0]
  v_pk_mul_f32 v[106:107], v[106:107], v[0:1] op_sel_hi:[1,0]
  v_cvt_pk_bf16_f32 v104, v104, v105
  v_cvt_pk_bf16_f32 v105, v106, v107
  s_nop 2
  v_pk_mul_f32 v[108:109], v[108:109], v[0:1] op_sel_hi:[1,0]
  v_pk_mul_f32 v[110:111], v[110:111], v[0:1] op_sel_hi:[1,0]
  v_cvt_pk_bf16_f32 v106, v108, v109
  v_cvt_pk_bf16_f32 v107, v110, v111
  ds_write_b128 v12, v[104:107]
  s_branch TFE0_NEAR
TFE0_ARETRY:
  s_mov_b64 exec, vcc
  buffer_load_dwordx4 v[48:51], v1, s[8:11], s42 offen sc1
  s_mov_b64 exec, -1
  buffer_load_dwordx4 v[52:55], v1, s[8:11], s42 offen offset:1024 sc1
  s_waitcnt vmcnt(4)
  v_max3_u32 v0, v48, v49, v50
  v_max_u32 v0, v0, v51
  v_cmp_eq_u32 vcc, -1, v0
  s_cbranch_vccz TFE0_MOK
TFE0_ARETRY2:
  s_mov_b64 exec, vcc
  buffer_load_dwordx4 v[48:51], v1, s[8:11], s42 offen sc1
  s_mov_b64 exec, -1
  buffer_load_dwordx4 v[52:55], v1, s[8:11], s42 offen offset:1024 sc1
  s_sub_u32 s6, s6, 1
  s_cbranch_scc1 GIVEUP
  s_waitcnt vmcnt(3)
  v_max3_u32 v0, v48, v49, v50
  v_max_u32 v0, v0, v51
  v_cmp_eq_u32 vcc, -1, v0
  s_cbranch_vccnz TFE0_ARETRY2
  s_branch TFE0_MOK
TFE0_BRETRY:
TFE0_BRETRY2:
  s_mov_b64 exec, vcc
  buffer_load_dwordx4 v[52:55], v1, s[8:11], s42 offen offset:1024 sc1
  s_sub_u32 s6, s6, 1
  s_cbranch_scc1 GIVEUP
  s_waitcnt vmcnt(1)
  v_max3_u32 v0, v52, v53, v54
  v_max_u32 v0, v0, v55
  v_cmp_eq_u32 vcc, -1, v0
  s_cbranch_vccnz TFE0_BRETRY2
  s_mov_b64 exec, -1
  s_branch TFE0_BOK
TFE0_RRETRY:
  s_mov_b64 exec, vcc
  buffer_load_dwordx4 v[64:67], v1, s[8:11], s45 offen sc1
  buffer_load_dwordx4 v[68:71], v1, s[8:11], s45 offen offset:1024 sc1
  s_mov_b64 exec, -1
  v_mov_b32 v24, 0
  v_mov_b32 v26, 0
  s_sub_u32 s6, s6, 1
  s_cbranch_scc1 GIVEUP
  s_waitcnt vmcnt(2)
  v_max_u32 v0, v64, v68
  v_smfmac_f32_16x16x64_bf16 v[24:27], v[28:31], v[64:71], v15
  v_cmp_eq_u32 vcc, -1, v0
  s_nop 2
  s_cbranch_vccnz TFE0_RRETRY
  s_xor_b32 s45, s45, 0x40000
  v_add_f32_dpp v24, v24, v24 row_ror:4 row_mask:0xf bank_mask:0xf
  v_add_f32_dpp v26, v26, v26 row_ror:4 row_mask:0xf bank_mask:0xf
  s_cmp_eq_u32 s41, 63
  v_add_f32_dpp v24, v24, v24 row_ror:8 row_mask:0xf bank_mask:0xf
  v_add_f32_dpp v26, v26, v26 row_ror:8 row_mask:0xf bank_mask:0xf
  v_cvt_pk_bf16_f32 v18, v24, v26
  buffer_store_dword v18, v14, s[8:11], s43 offen
  s_branch TFE0_RDONE
TFE0_FRETRY:
  buffer_load_dword v17, off, s[8:11], s49 sc1
  s_waitcnt vmcnt(0)
  v_cmp_ne_u32 vcc, 0, v17
  s_cbranch_vccnz TFE0_FOK
  s_sleep 1
  s_sub_u32 s6, s6, 1
  s_cbranch_scc1 GIVEUP
  s_branch TFE0_FRETRY
  .p2align 6
TFE1_STEP:
  s_waitcnt vmcnt(3)
  v_max3_u32 v0, v48, v49, v50
  v_max_u32 v0, v0, v51
  v_cmp_eq_u32 vcc, -1, v0
  s_cbranch_vccnz TFE1_ARETRY
TFE1_MOK:
  ds_write_b128 v1, v[48:51] offset:0
  v_smfmac_f32_16x16x64_bf16 v[24:27], v[48:51], a[0:7], v15
  v_smfmac_f32_16x16x64_bf16 v[28:31], v[48:51], a[8:15], v15
  v_smfmac_f32_16x16x64_bf16 v[32:35], v[48:51], a[128:135], v15
  v_smfmac_f32_16x16x64_bf16 v[36:39], v[48:51], a[136:143], v15
  s_waitcnt lgkmcnt(0)
  s_barrier
  ds_read_b128 v[56:59], v6 offset:0
  v_smfmac_f32_16x16x64_bf16 v[40:43], v[48:51], v[80:87], v15
  ds_read_b128 v[64:67], v7 offset:0
  s_waitcnt vmcnt(1)
  v_max3_u32 v0, v52, v53, v54
  v_max_u32 v0, v0, v55
  v_cmp_eq_u32 vcc, -1, v0
  v_smfmac_f32_16x16x64_bf16 v[44:47], v[48:51], v[88:95], v15
  ds_read_b128 v[72:75], v8 offset:0
  s_cbranch_vccnz TFE1_BRETRY
TFE1_BOK:
  ds_write_b128 v1, v[52:55] offset:1024
  v_smfmac_f32_16x16x64_bf16 v[24:27], v[52:55], a[16:23], v15
  v_smfmac_f32_16x16x64_bf16 v[28:31], v[52:55], a[24:31], v15
  buffer_load_dwordx4 v[120:123], v1, s[8:11], s51 offen offset:0 sc1
  v_smfmac_f32_16x16x64_bf16 v[32:35], v[52:55], a[144:151], v15
  v_smfmac_f32_16x16x64_bf16 v[36:39], v[52:55], a[152:159], v15
  s_waitcnt lgkmcnt(0)
  s_barrier
  ds_read_b128 v[60:63], v6 offset:1024
  buffer_store_dword v18, v14, s[8:11], s44 offen sc1
  v_smfmac_f32_16x16x64_bf16 v[40:43], v[52:55], v[96:103], v15
  ds_read_b128 v[68:71], v7 offset:1024
  v_smfmac_f32_16x16x64_bf16 v[44:47], v[52:55], v[104:111], v15
  ds_read_b128 v[76:79], v8 offset:1024
  buffer_store_dword v17, v14, s[8:11], s43 offen
  v_smfmac_f32_16x16x64_bf16 v[24:27], v[56:59], a[32:39], v15
  ds_read_b128 v[80:83], v3 offset:2048
  v_smfmac_f32_16x16x64_bf16 v[28:31], v[56:59], a[40:47], v15
  ds_read_b128 v[84:87], v3 offset:3072
  buffer_store_dword v17, v1, s[8:11], s46 offen
  v_smfmac_f32_16x16x64_bf16 v[24:27], v[64:67], a[64:71], v15
  ds_read_b128 v[88:91], v3 offset:16384
  v_smfmac_f32_16x16x64_bf16 v[28:31], v[64:67], a[72:79], v15
  ds_read_b128 v[92:95], v3 offset:17408
  buffer_store_dword v17, v1, s[8:11], s46 offen offset:1024
  v_smfmac_f32_16x16x64_bf16 v[24:27], v[72:75], a[96:103], v15
  ds_read_b128 v[96:99], v3 offset:18432
  v_smfmac_f32_16x16x64_bf16 v[28:31], v[72:75], a[104:111], v15
  ds_read_b128 v[100:103], v3 offset:19456
  buffer_load_dwordx4 v[124:127], v1, s[8:11], s51 offen offset:1024 sc1
  s_waitcnt lgkmcnt(5)
  v_smfmac_f32_16x16x64_bf16 v[24:27], v[60:63], a[48:55], v15
  ds_read_b128 v[104:107], v4 offset:0
  v_smfmac_f32_16x16x64_bf16 v[24:27], v[68:71], a[80:87], v15
  ds_read_b128 v[108:111], v4 offset:1024
  s_xor_b32 s42, s42, 0x2000
  s_add_u32 s41, s41, 1
  v_smfmac_f32_16x16x64_bf16 v[24:27], v[76:79], a[112:119], v15
  s_add_u32 s44, s44, 0x2000
  s_xor_b32 s46, s46, 0x40000
  v_smfmac_f32_16x16x64_bf16 v[28:31], v[60:63], a[56:63], v15
  v_smfmac_f32_16x16x64_bf16 v[28:31], v[68:71], a[88:95], v15
  v_mul_f32_e64 v26, s52, v26
  v_mul_f32 v27, s52, v27
  v_smfmac_f32_16x16x64_bf16 v[28:31], v[76:79], a[120:127], v15
  s_waitcnt lgkmcnt(1)
  v_fma_f32 v24, v24, s52, v26
  v_fma_f32 v25, v25, s52, v27
  v_smfmac_f32_16x16x64_bf16 v[44:47], v[56:59], v[80:87], v15
  ds_read_b128 v[80:83], v9 offset:8192
  v_cvt_pk_bf16_f32 v24, v24, v25
  v_smfmac_f32_16x16x64_bf16 v[40:43], v[60:63], v[88:95], v15
  ds_write_b32 v10, v24 offset:4
  v_mul_f32_e64 v30, s52, v30
  v_mul_f32 v31, s52, v31
  v_smfmac_f32_16x16x64_bf16 v[44:47], v[60:63], v[96:103], v15
  ds_read_b128 v[84:87], v9 offset:9216
  v_fma_f32 v28, v28, s52, v30
  v_fma_f32 v29, v29, s52, v31
  v_smfmac_f32_16x16x64_bf16 v[40:43], v[56:59], v[112:119], v15
  ds_read_b128 v[88:91], v9 offset:10240
  s_waitcnt lgkmcnt(4)
  v_cvt_pk_bf16_f32 v28, v28, v29
  v_smfmac_f32_16x16x64_bf16 v[40:43], v[64:67], v[104:111], v15
  ds_write_b32 v10, v28 offset:516
  v_smfmac_f32_16x16x64_bf16 v[32:35], v[56:59], a[160:167], v15
  ds_read_b128 v[92:95], v9 offset:11264
  v_lshrrev_b32 v19, 1, v9
  v_smfmac_f32_16x16x64_bf16 v[32:35], v[60:63], a[176:183], v15
  ds_read_b128 v[96:99], v9 offset:12288
  s_waitcnt vmcnt(6)
  v_smfmac_f32_16x16x64_bf16 v[32:35], v[64:67], a[192:199], v15
  s_waitcnt lgkmcnt(2)
  s_barrier
  v_smfmac_f32_16x16x64_bf16 v[36:39], v[56:59], a[168:175], v15
  ds_read_b64_tr_b16 v[108:109], v11 offset:1024
  v_smfmac_f32_16x16x64_bf16 v[32:35], v[68:71], a[208:215], v15
  ds_read_b64_tr_b16 v[48:49], v11 offset:2048
  ds_read_b128 v[100:103], v9 offset:13312
  v_smfmac_f32_16x16x64_bf16 v[32:35], v[72:75], a[224:231], v15
  ds_read_b64_tr_b16 v[50:51], v11 offset:2560
  v_mov_b64_e64 v[56:57], s[54:55]
  v_smfmac_f32_16x16x64_bf16 v[32:35], v[76:79], a[240:247], v15
  ds_read_b64_tr_b16 v[104:105], v11 offset:0
  ds_read_b64_tr_b16 v[110:111], v11 offset:1536
  v_smfmac_f32_16x16x64_bf16 v[36:39], v[60:63], a[184:191], v15
  ds_read_b64_tr_b16 v[106:107], v11 offset:512
  ds_read_b128 v[112:115], v9 offset:14336
  v_smfmac_f32_16x16x64_bf16 v[36:39], v[64:67], a[200:207], v15
  ds_read_b64_tr_b16 v[52:53], v11 offset:3072
  v_add_f32_e64 v32, v32, v34
  v_smfmac_f32_16x16x64_bf16 v[36:39], v[68:71], a[216:223], v15
  ds_read_b128 v[116:119], v9 offset:15360
  v_add_f32_e64 v33, v33, v35
  v_smfmac_f32_16x16x64_bf16 v[36:39], v[72:75], a[232:239], v15
  ds_read_b64_tr_b16 v[54:55], v11 offset:3584
  v_cvt_pk_bf16_f32 v32, v32, v33
  v_smfmac_f32_16x16x64_bf16 v[36:39], v[76:79], a[248:255], v15
  ds_write_b32 v16, v32 offset:0
  s_waitcnt lgkmcnt(5)
  v_mfma_f32_16x16x32_bf16 v[28:31], v[84:87], v[104:107], 0
  ds_read_b128 v[84:87], v4 offset:3072
  v_mov_b64 v[58:59], s[54:55]
  v_mfma_f32_16x16x32_bf16 v[24:27], v[80:83], v[104:107], 0
  ds_read_b128 v[80:83], v4 offset:2048
  v_add_f32_e64 v37, v37, v39
  v_mfma_f32_16x16x32_bf16 v[24:27], v[88:91], v[108:111], v[24:27]
  ds_read_b128 v[88:91], v4 offset:16384
  v_add_f32_e64 v36, v36, v38
  v_cvt_pk_bf16_f32 v36, v36, v37
  v_mfma_f32_16x16x32_bf16 v[28:31], v[92:95], v[108:111], v[28:31]
  ds_read_b128 v[92:95], v4 offset:17408
  ds_write_b32 v16, v36 offset:64
  v_mfma_f32_16x16x32_bf16 v[24:27], v[96:99], v[48:51], v[24:27]
  s_waitcnt lgkmcnt(5)
  v_mov_b32 v61, 0
  v_mfma_f32_16x16x32_bf16 v[24:27], v[112:115], v[52:55], v[24:27]
  ds_read_b128 v[112:115], v5 offset:0
  v_mfma_f32_16x16x32_bf16 v[28:31], v[100:103], v[48:51], v[28:31]
  ds_read_b128 v[96:99], v4 offset:18432
  ds_read_b128 v[100:103], v4 offset:19456
  v_mfma_f32_16x16x32_bf16 v[28:31], v[116:119], v[52:55], v[28:31]
  ds_read_b128 v[116:119], v5 offset:1024
  v_exp_f32 v27, v27
  v_exp_f32 v24, v24
  v_exp_f32 v26, v26
  v_exp_f32 v25, v25
  s_waitcnt lgkmcnt(4)
  v_smfmac_f32_16x16x64_bf16 v[40:43], v[68:71], v[88:95], v15
  s_barrier
  ds_read_b64_tr_b16 v[32:33], v19 offset:0
  ds_read_b64_tr_b16 v[36:37], v19 offset:1024
  v_smfmac_f32_16x16x64_bf16 v[44:47], v[64:67], v[80:87], v15
  ds_read_b64_tr_b16 v[38:39], v19 offset:1536
  ds_read_b128 v[92:95], v5 offset:17408
  ds_read_b64_tr_b16 v[34:35], v19 offset:512
  s_waitcnt lgkmcnt(5)
  v_exp_f32 v30, v30
  v_exp_f32 v31, v31
  v_exp_f32 v29, v29
  v_smfmac_f32_16x16x64_bf16 v[44:47], v[68:71], v[96:103], v15
  ds_read_b128 v[80:83], v5 offset:2048
  ds_read_b128 v[88:91], v5 offset:16384
  v_smfmac_f32_16x16x64_bf16 v[40:43], v[72:75], v[112:119], v15
  ds_read_b128 v[84:87], v5 offset:3072
  v_exp_f32 v28, v28
  v_cvt_pk_bf16_f32 v24, v24, v25
  s_waitcnt lgkmcnt(3)
  v_smfmac_f32_16x16x64_bf16 v[20:23], v[32:35], v[104:111], v15
  ds_read_b128 v[100:103], v5 offset:19456
  v_cvt_pk_bf16_f32 v25, v26, v27
  v_cvt_pk_bf16_f32 v27, v30, v31
  v_smfmac_f32_16x16x64_bf16 v[20:23], v[36:39], v[48:55], v15
  ds_read_b128 v[96:99], v5 offset:18432
  v_cvt_pk_bf16_f32 v26, v28, v29
  s_waitcnt lgkmcnt(3)
  v_smfmac_f32_16x16x64_bf16 v[40:43], v[76:79], v[88:95], v15
  buffer_load_dwordx4 v[32:35], v1, s[8:11], s50 offen offset:0 sc1
  v_mfma_f32_16x16x32_bf16 v[28:31], v[56:59], v[24:27], 0
  s_waitcnt lgkmcnt(2)
  v_add_f32 v20, v20, v22
  v_exp_f32 v22, v20
  v_add_f32 v21, v21, v23
  v_exp_f32 v23, v21
  v_smfmac_f32_16x16x64_bf16 v[44:47], v[72:75], v[80:87], v15
  s_waitcnt vmcnt(1)
  v_mfma_f32_16x16x32_bf16 v[104:107], v[120:123], v[24:27], 0
  s_waitcnt lgkmcnt(0)
  v_add_f32_e64 v41, v41, v43
  v_cvt_pk_bf16_f32 v60, v22, v23
  v_smfmac_f32_16x16x64_bf16 v[44:47], v[76:79], v[96:103], v15
  buffer_load_dword v17, off, s[8:11], s49 sc1
  v_mfma_f32_16x16x32_bf16 v[108:111], v[124:127], v[24:27], 0
  v_add_f32_e64 v40, v40, v42
  v_cvt_pk_bf16_f32 v52, v40, v41
  v_mfma_f32_16x16x16_bf16 v[28:31], v[56:57], v[60:61], v[28:31]
  v_add_f32 v45, v45, v47
  v_add_f32 v44, v44, v46
  v_cvt_pk_bf16_f32 v54, v44, v45
  v_mfma_f32_16x16x16_bf16 v[104:107], v[52:53], v[60:61], v[104:107]
  buffer_load_dwordx4 v[36:39], v1, s[8:11], s50 offen offset:1024 sc1
  v_mfma_f32_16x16x16_bf16 v[108:111], v[54:55], v[60:61], v[108:111]
  v_rcp_f32 v0, v28
  s_nop 2
  v_pk_mul_f32 v[104:105], v[104:105], v[0:1] op_sel_hi:[1,0]
  v_pk_mul_f32 v[106:107], v[106:107], v[0:1] op_sel_hi:[1,0]
  v_cvt_pk_bf16_f32 v104, v104, v105
  v_cvt_pk_bf16_f32 v105, v106, v107
  v_pk_mul_f32 v[108:109], v[108:109], v[0:1] op_sel_hi:[1,0]
  v_pk_mul_f32 v[110:111], v[110:111], v[0:1] op_sel_hi:[1,0]
  v_cvt_pk_bf16_f32 v106, v108, v109
  v_cvt_pk_bf16_f32 v107, v110, v111
  ds_write_b128 v12, v[104:107]
  v_subrev_u32 v18, 0x1f800000, v28
  v_cmp_lt_u32 vcc, 0x40000000, v18
  v_mov_b64 v[72:73], 0
  v_mov_b64 v[74:75], 0
  v_mov_b64 v[76:77], 0
  v_mov_b64 v[78:79], 0
  s_cbranch_vccnz TFE1_FAR
TFE1_NEAR:
  v_mov_b64 v[64:65], 0
  v_mov_b64 v[66:67], 0
  v_mov_b64 v[68:69], 0
  v_mov_b64 v[70:71], 0
  v_mov_b64 v[48:49], 0
  v_mov_b64 v[50:51], 0
  v_mov_b64 v[52:53], 0
  v_mov_b64 v[54:55], 0
  s_waitcnt vmcnt(4) lgkmcnt(0)
  s_barrier
  ds_read_b128 v[104:107], v9 offset:20480
  ds_read_b128 v[108:111], v9 offset:21504
  v_mov_b64 v[56:57], 0
  v_mov_b64 v[58:59], 0
  v_mov_b64 v[60:61], 0
  v_mov_b64 v[62:63], 0
  s_add_u32 s50, s50, 262144
  s_add_u32 s51, s51, 262144
  s_waitcnt lgkmcnt(1)
  v_smfmac_f32_16x16x64_bf16 v[48:51], v[104:107], v[128:135], v15
  v_smfmac_f32_16x16x64_bf16 v[52:55], v[104:107], v[144:151], v15
  s_waitcnt lgkmcnt(0)
  v_smfmac_f32_16x16x64_bf16 v[48:51], v[108:111], v[136:143], v15
  v_smfmac_f32_16x16x64_bf16 v[52:55], v[108:111], v[152:159], v15
  v_smfmac_f32_16x16x64_bf16 v[56:59], v[104:107], v[160:167], v15
  v_smfmac_f32_16x16x64_bf16 v[60:63], v[104:107], v[176:183], v15
  v_add_f32 v48, v48, v50
  v_add_f32 v49, v49, v51
  v_smfmac_f32_16x16x64_bf16 v[56:59], v[108:111], v[168:175], v15
  v_cvt_pk_bf16_f32 v20, v48, v49
  v_smfmac_f32_16x16x64_bf16 v[60:63], v[108:111], v[184:191], v15
  v_add_f32 v52, v52, v54
  v_add_f32 v53, v53, v55
  v_smfmac_f32_16x16x64_bf16 v[64:67], v[104:107], v[192:199], v15
  v_cvt_pk_bf16_f32 v21, v52, v53
  v_smfmac_f32_16x16x64_bf16 v[68:71], v[104:107], v[208:215], v15
  v_add_f32 v56, v56, v58
  v_add_f32 v57, v57, v59
  v_smfmac_f32_16x16x64_bf16 v[64:67], v[108:111], v[200:207], v15
  v_cvt_pk_bf16_f32 v22, v56, v57
  v_smfmac_f32_16x16x64_bf16 v[68:71], v[108:111], v[216:223], v15
  v_add_f32 v60, v60, v62
  v_add_f32 v61, v61, v63
  v_smfmac_f32_16x16x64_bf16 v[72:75], v[104:107], v[224:231], v15
  v_cvt_pk_bf16_f32 v23, v60, v61
  buffer_store_dwordx4 v[20:23], v13, s[8:11], s47 offen
  v_smfmac_f32_16x16x64_bf16 v[76:79], v[104:107], v[240:247], v15
  v_add_f32 v64, v64, v66
  v_add_f32 v65, v65, v67
  v_smfmac_f32_16x16x64_bf16 v[72:75], v[108:111], v[232:239], v15
  v_cvt_pk_bf16_f32 v24, v64, v65
  v_smfmac_f32_16x16x64_bf16 v[76:79], v[108:111], v[248:255], v15
  v_add_f32 v68, v68, v70
  v_add_f32 v69, v69, v71
  v_cvt_pk_bf16_f32 v25, v68, v69
  v_add_f32 v72, v72, v74
  v_add_f32 v73, v73, v75
  v_cvt_pk_bf16_f32 v26, v72, v73
  v_add_f32 v76, v76, v78
  v_add_f32 v77, v77, v79
  v_cvt_pk_bf16_f32 v27, v76, v77
  buffer_store_dwordx4 v[24:27], v13, s[8:11], s48 offen
  s_xor_b32 s47, s47, 0x40000
  s_xor_b32 s48, s48, 0x40000
  v_lshrrev_b32 v0, 2, v9
  v_and_b32 v0, 16, v0
  v_lshlrev_b32 v0, v0, s53
  v_cndmask_b32 v28, 0, v0, s[64:65]
  v_cndmask_b32 v29, 0, v0, s[66:67]
  v_cndmask_b32 v30, 0, v0, s[68:69]
  v_cndmask_b32 v31, 0, v0, s[70:71]
  v_mov_b32 v24, 0
  v_mov_b32 v26, 0
  v_mov_b64 v[40:41], 0
  v_mov_b64 v[42:43], 0
  v_mov_b64 v[44:45], 0
  v_mov_b64 v[46:47], 0
  v_mov_b64_e64 v[20:21], 0
  v_mov_b64 v[22:23], 0
  s_nop 15
  s_nop 7
  buffer_load_dwordx4 v[64:67], v1, s[8:11], s45 offen sc1
  buffer_load_dwordx4 v[68:71], v1, s[8:11], s45 offen offset:1024 sc1
  s_waitcnt vmcnt(4)
  ds_write_b128 v1, v[32:35] offset:8192
  ds_write_b128 v1, v[36:39] offset:9216
  s_nop 15
  s_nop 7
  buffer_load_dwordx4 v[64:67], v1, s[8:11], s45 offen sc1
  buffer_load_dwordx4 v[68:71], v1, s[8:11], s45 offen offset:1024 sc1
  v_cmp_eq_u32 vcc, 0, v17
  s_add_u32 s33, s49, 16
  s_cbranch_vccnz TFE1_FRETRY
TFE1_FOK:
  s_min_u32 s49, s33, s56
  v_mov_b32 v17, -1
  s_waitcnt vmcnt(2)
TFE1_ROK:
  v_max_u32_e64 v0, v64, v68
  v_smfmac_f32_16x16x64_bf16 v[24:27], v[28:31], v[64:71], v15
  v_cmp_eq_u32 vcc, -1, v0
  s_nop 2
  s_cbranch_vccnz TFE1_RRETRY
  s_xor_b32 s45, s45, 0x40000
  v_add_f32_dpp v24, v24, v24 row_ror:4 row_mask:0xf bank_mask:0xf
  v_add_f32_dpp v26, v26, v26 row_ror:4 row_mask:0xf bank_mask:0xf
  s_cmp_eq_u32 s41, 63
  v_add_f32_dpp v24, v24, v24 row_ror:8 row_mask:0xf bank_mask:0xf
  v_add_f32_dpp v26, v26, v26 row_ror:8 row_mask:0xf bank_mask:0xf
  v_cvt_pk_bf16_f32 v18, v24, v26
  buffer_store_dword v18, v14, s[8:11], s43 offen
TFE1_RDONE:
  s_cbranch_scc1 TFE1_LAST
  s_xor_b32 s43, s43, 0x2000
  v_mov_b64 v[24:25], 0
  v_mov_b64 v[26:27], 0
  v_mov_b64 v[28:29], 0
  v_mov_b64 v[30:31], 0
  v_mov_b64 v[32:33], 0
  v_mov_b64 v[34:35], 0
  v_mov_b64 v[36:37], 0
  v_mov_b64_e64 v[38:39], 0
  ds_read_b128 v[80:83], v2 offset:0
  ds_read_b128 v[84:87], v2 offset:1024
  ds_read_b128 v[104:107], v2 offset:18432
  ds_read_b128 v[108:111], v2 offset:19456
  s_barrier
  buffer_load_dwordx4 v[48:51], v1, s[8:11], s42 offen sc1
  ds_read_b128 v[112:115], v3 offset:0
  ds_read_b128 v[116:119], v3 offset:1024
  s_nop 15
  s_nop 3
  s_nop 3
  buffer_load_dwordx4 v[48:51], v1, s[8:11], s42 offen sc1
  ds_read_b128 v[88:91], v2 offset:2048
  ds_read_b128 v[92:95], v2 offset:3072
  ds_read_b128 v[96:99], v2 offset:16384
  ds_read_b128 v[100:103], v2 offset:17408
  buffer_load_dwordx4 v[52:55], v1, s[8:11], s42 offen offset:1024 sc1
  s_nop 7
  s_nop 7
  buffer_load_dwordx4 v[52:55], v1, s[8:11], s42 offen offset:1024 sc1
  s_branch TFE1_STEP
TFE1_LAST:
  buffer_store_dword v18, v14, s[8:11], s44 offen sc1
  s_waitcnt vmcnt(0)
  s_waitcnt vmcnt(0)
  s_endpgm
TFE1_FAR:
  s_nop 15
  ds_read_b64_tr_b16 v[80:81], v11 offset:0
  ds_read_b64_tr_b16 v[82:83], v11 offset:512
  ds_read_b64_tr_b16 v[84:85], v11 offset:1024
  ds_read_b64_tr_b16 v[86:87], v11 offset:1536
  ds_read_b64_tr_b16 v[88:89], v11 offset:2048
  ds_read_b64_tr_b16 v[90:91], v11 offset:2560
  ds_read_b64_tr_b16 v[92:93], v11 offset:3072
  ds_read_b64_tr_b16 v[94:95], v11 offset:3584
  s_waitcnt lgkmcnt(0)
  ds_read_b128 v[96:99], v9 offset:8192
  ds_read_b128 v[100:103], v9 offset:9216
  ds_read_b128 v[104:107], v9 offset:10240
  ds_read_b128 v[108:111], v9 offset:11264
  ds_read_b128 v[112:115], v9 offset:12288
  ds_read_b128 v[116:119], v9 offset:13312
  ds_read_b128 v[64:67], v9 offset:14336
  ds_read_b128 v[68:71], v9 offset:15360
  ds_read_b64_tr_b16 v[40:41], v19 offset:0
  ds_read_b64_tr_b16 v[42:43], v19 offset:512
  ds_read_b64_tr_b16 v[44:45], v19 offset:1024
  ds_read_b64_tr_b16 v[46:47], v19 offset:1536
  v_mov_b64 v[20:21], 0
  v_mov_b64 v[22:23], 0
  s_waitcnt lgkmcnt(0)
  v_mfma_f32_16x16x32_bf16 v[24:27], v[96:99], v[80:83], 0
  v_mfma_f32_16x16x32_bf16 v[28:31], v[100:103], v[80:83], 0
  v_mfma_f32_16x16x32_bf16 v[24:27], v[104:107], v[84:87], v[24:27]
  v_mfma_f32_16x16x32_bf16 v[28:31], v[108:111], v[84:87], v[28:31]
  v_mfma_f32_16x16x32_bf16 v[24:27], v[112:115], v[88:91], v[24:27]
  v_mfma_f32_16x16x32_bf16 v[28:31], v[116:119], v[88:91], v[28:31]
  v_mfma_f32_16x16x32_bf16 v[24:27], v[64:67], v[92:95], v[24:27]
  v_mfma_f32_16x16x32_bf16 v[28:31], v[68:71], v[92:95], v[28:31]
  v_smfmac_f32_16x16x64_bf16 v[20:23], v[40:43], v[80:87], v15
  v_smfmac_f32_16x16x64_bf16 v[20:23], v[44:47], v[88:95], v15
  s_nop 7
  v_add_f32 v20, v20, v22
  v_add_f32 v21, v21, v23
  v_max3_f32 v0, v24, v25, v26
  v_max3_f32 v0, v0, v27, v28
  v_max3_f32 v0, v0, v29, v30
  v_max3_f32 v0, v0, v31, v20
  v_max_f32 v0, v0, v21
  v_mov_b32 v18, v0
  s_nop 1
  v_permlane32_swap_b32 v0, v18
  v_max_f32 v0, v0, v18
  v_mov_b32 v18, v0
  s_nop 1
  v_permlane16_swap_b32 v0, v18
  v_max_f32 v0, v0, v18
  v_sub_f32 v24, v24, v0
  v_sub_f32 v25, v25, v0
  v_sub_f32 v26, v26, v0
  v_sub_f32 v27, v27, v0
  v_sub_f32 v28, v28, v0
  v_sub_f32 v29, v29, v0
  v_sub_f32 v30, v30, v0
  v_sub_f32 v31, v31, v0
  v_sub_f32 v20, v20, v0
  v_sub_f32 v21, v21, v0
  v_exp_f32 v24, v24
  v_exp_f32 v25, v25
  v_exp_f32 v26, v26
  v_exp_f32 v27, v27
  v_exp_f32 v28, v28
  v_exp_f32 v29, v29
  v_exp_f32 v30, v30
  v_exp_f32 v31, v31
  v_exp_f32 v22, v20
  v_exp_f32 v23, v21
  s_nop 0
  v_cvt_pk_bf16_f32 v60, v22, v23
  v_cvt_pk_bf16_f32 v24, v24, v25
  v_cvt_pk_bf16_f32 v25, v26, v27
  v_cvt_pk_bf16_f32 v26, v28, v29
  v_cvt_pk_bf16_f32 v27, v30, v31
  s_nop 1
  v_mfma_f32_16x16x32_bf16 v[28:31], v[56:59], v[24:27], 0
  v_mfma_f32_16x16x32_bf16 v[104:107], v[120:123], v[24:27], 0
  v_mfma_f32_16x16x32_bf16 v[108:111], v[124:127], v[24:27], 0
  v_mfma_f32_16x16x16_bf16 v[28:31], v[56:57], v[60:61], v[28:31]
  v_mfma_f32_16x16x16_bf16 v[104:107], v[52:53], v[60:61], v[104:107]
  v_mfma_f32_16x16x16_bf16 v[108:111], v[54:55], v[60:61], v[108:111]
  v_rcp_f32 v0, v28
  s_nop 2
  v_pk_mul_f32 v[104:105], v[104:105], v[0:1] op_sel_hi:[1,0]
  v_pk_mul_f32 v[106:107], v[106:107], v[0:1] op_sel_hi:[1,0]
  v_cvt_pk_bf16_f32 v104, v104, v105
  v_cvt_pk_bf16_f32 v105, v106, v107
  s_nop 2
  v_pk_mul_f32 v[108:109], v[108:109], v[0:1] op_sel_hi:[1,0]
  v_pk_mul_f32 v[110:111], v[110:111], v[0:1] op_sel_hi:[1,0]
  v_cvt_pk_bf16_f32 v106, v108, v109
  v_cvt_pk_bf16_f32 v107, v110, v111
  ds_write_b128 v12, v[104:107]
  s_branch TFE1_NEAR
TFE1_ARETRY:
  s_mov_b64 exec, vcc
  buffer_load_dwordx4 v[48:51], v1, s[8:11], s42 offen sc1
  s_mov_b64 exec, -1
  buffer_load_dwordx4 v[52:55], v1, s[8:11], s42 offen offset:1024 sc1
  s_waitcnt vmcnt(4)
  v_max3_u32 v0, v48, v49, v50
  v_max_u32 v0, v0, v51
  v_cmp_eq_u32 vcc, -1, v0
  s_cbranch_vccz TFE1_MOK
TFE1_ARETRY2:
  s_mov_b64 exec, vcc
  buffer_load_dwordx4 v[48:51], v1, s[8:11], s42 offen sc1
  s_mov_b64 exec, -1
  buffer_load_dwordx4 v[52:55], v1, s[8:11], s42 offen offset:1024 sc1
  s_sub_u32 s6, s6, 1
  s_cbranch_scc1 GIVEUP
  s_waitcnt vmcnt(3)
  v_max3_u32 v0, v48, v49, v50
  v_max_u32 v0, v0, v51
  v_cmp_eq_u32 vcc, -1, v0
  s_cbranch_vccnz TFE1_ARETRY2
  s_branch TFE1_MOK
TFE1_BRETRY:
TFE1_BRETRY2:
  s_mov_b64 exec, vcc
  buffer_load_dwordx4 v[52:55], v1, s[8:11], s42 offen offset:1024 sc1
  s_sub_u32 s6, s6, 1
  s_cbranch_scc1 GIVEUP
  s_waitcnt vmcnt(1)
  v_max3_u32 v0, v52, v53, v54
  v_max_u32 v0, v0, v55
  v_cmp_eq_u32 vcc, -1, v0
  s_cbranch_vccnz TFE1_BRETRY2
  s_mov_b64 exec, -1
  s_branch TFE1_BOK
TFE1_RRETRY:
  s_mov_b64 exec, vcc
  buffer_load_dwordx4 v[64:67], v1, s[8:11], s45 offen sc1
  buffer_load_dwordx4 v[68:71], v1, s[8:11], s45 offen offset:1024 sc1
  s_mov_b64 exec, -1
  v_mov_b32 v24, 0
  v_mov_b32 v26, 0
  s_sub_u32 s6, s6, 1
  s_cbranch_scc1 GIVEUP
  s_waitcnt vmcnt(2)
  v_max_u32 v0, v64, v68
  v_smfmac_f32_16x16x64_bf16 v[24:27], v[28:31], v[64:71], v15
  v_cmp_eq_u32 vcc, -1, v0
  s_nop 2
  s_cbranch_vccnz TFE1_RRETRY
  s_xor_b32 s45, s45, 0x40000
  v_add_f32_dpp v24, v24, v24 row_ror:4 row_mask:0xf bank_mask:0xf
  v_add_f32_dpp v26, v26, v26 row_ror:4 row_mask:0xf bank_mask:0xf
  s_cmp_eq_u32 s41, 63
  v_add_f32_dpp v24, v24, v24 row_ror:8 row_mask:0xf bank_mask:0xf
  v_add_f32_dpp v26, v26, v26 row_ror:8 row_mask:0xf bank_mask:0xf
  v_cvt_pk_bf16_f32 v18, v24, v26
  buffer_store_dword v18, v14, s[8:11], s43 offen
  s_branch TFE1_RDONE
TFE1_FRETRY:
  buffer_load_dword v17, off, s[8:11], s49 sc1
  s_waitcnt vmcnt(0)
  v_cmp_ne_u32 vcc, 0, v17
  s_cbranch_vccnz TFE1_FOK
  s_sleep 1
  s_sub_u32 s6, s6, 1
  s_cbranch_scc1 GIVEUP
  s_branch TFE1_FRETRY
  .p2align 6
TFL0_STEP:
  s_waitcnt vmcnt(3)
  v_max3_u32 v0, v48, v49, v50
  v_max_u32 v0, v0, v51
  v_cmp_eq_u32 vcc, -1, v0
  s_cbranch_vccnz TFL0_ARETRY
TFL0_MOK:
  ds_write_b128 v1, v[48:51] offset:0
  v_smfmac_f32_16x16x64_bf16 v[24:27], v[48:51], a[0:7], v15
  v_smfmac_f32_16x16x64_bf16 v[28:31], v[48:51], a[8:15], v15
  v_smfmac_f32_16x16x64_bf16 v[32:35], v[48:51], a[128:135], v15
  v_smfmac_f32_16x16x64_bf16 v[36:39], v[48:51], a[136:143], v15
  s_waitcnt lgkmcnt(0)
  s_barrier
  ds_read_b128 v[56:59], v6 offset:0
  v_smfmac_f32_16x16x64_bf16 v[40:43], v[48:51], v[80:87], v15
  ds_read_b128 v[64:67], v7 offset:0
  s_waitcnt vmcnt(1)
  v_max3_u32 v0, v52, v53, v54
  v_max_u32 v0, v0, v55
  v_cmp_eq_u32 vcc, -1, v0
  v_smfmac_f32_16x16x64_bf16 v[44:47], v[48:51], v[88:95], v15
  ds_read_b128 v[72:75], v8 offset:0
  s_cbranch_vccnz TFL0_BRETRY
TFL0_BOK:
  ds_write_b128 v1, v[52:55] offset:1024
  v_smfmac_f32_16x16x64_bf16 v[24:27], v[52:55], a[16:23], v15
  v_smfmac_f32_16x16x64_bf16 v[28:31], v[52:55], a[24:31], v15
  v_smfmac_f32_16x16x64_bf16 v[32:35], v[52:55], a[144:151], v15
  buffer_load_dwordx4 v[120:123], v1, s[8:11], s51 offen offset:0 sc1
  v_smfmac_f32_16x16x64_bf16 v[36:39], v[52:55], a[152:159], v15
  s_waitcnt lgkmcnt(0)
  s_barrier
  ds_read_b128 v[60:63], v6 offset:1024
  v_smfmac_f32_16x16x64_bf16 v[40:43], v[52:55], v[96:103], v15
  ds_read_b128 v[68:71], v7 offset:1024
  buffer_store_dword v18, v14, s[8:11], s44 offen sc1
  v_smfmac_f32_16x16x64_bf16 v[44:47], v[52:55], v[104:111], v15
  ds_read_b128 v[76:79], v8 offset:1024
  v_smfmac_f32_16x16x64_bf16 v[24:27], v[56:59], a[32:39], v15
  ds_read_b128 v[80:83], v3 offset:2048
  buffer_store_dword v17, v14, s[8:11], s43 offen
  v_smfmac_f32_16x16x64_bf16 v[28:31], v[56:59], a[40:47], v15
  ds_read_b128 v[84:87], v3 offset:3072
  v_smfmac_f32_16x16x64_bf16 v[24:27], v[64:67], a[64:71], v15
  ds_read_b128 v[88:91], v3 offset:16384
  buffer_store_dword v17, v1, s[8:11], s46 offen
  v_smfmac_f32_16x16x64_bf16 v[28:31], v[64:67], a[72:79], v15
  ds_read_b128 v[92:95], v3 offset:17408
  v_smfmac_f32_16x16x64_bf16 v[24:27], v[72:75], a[96:103], v15
  ds_read_b128 v[96:99], v3 offset:18432
  buffer_store_dword v17, v1, s[8:11], s46 offen offset:1024
  v_smfmac_f32_16x16x64_bf16 v[28:31], v[72:75], a[104:111], v15
  ds_read_b128 v[100:103], v3 offset:19456
  s_waitcnt lgkmcnt(5)
  v_smfmac_f32_16x16x64_bf16 v[24:27], v[60:63], a[48:55], v15
  ds_read_b128 v[104:107], v4 offset:0
  buffer_load_dwordx4 v[124:127], v1, s[8:11], s51 offen offset:1024 sc1
  v_smfmac_f32_16x16x64_bf16 v[24:27], v[68:71], a[80:87], v15
  ds_read_b128 v[108:111], v4 offset:1024
  s_xor_b32 s42, s42, 0x2000
  s_add_u32 s41, s41, 1
  v_smfmac_f32_16x16x64_bf16 v[24:27], v[76:79], a[112:119], v15
  s_add_u32 s44, s44, 0x2000
  s_xor_b32 s46, s46, 0x40000
  v_smfmac_f32_16x16x64_bf16 v[28:31], v[60:63], a[56:63], v15
  v_smfmac_f32_16x16x64_bf16 v[28:31], v[68:71], a[88:95], v15
  v_mul_f32_e64 v26, s52, v26
  v_mul_f32 v27, s52, v27
  v_smfmac_f32_16x16x64_bf16 v[28:31], v[76:79], a[120:127], v15
  s_waitcnt lgkmcnt(1)
  v_fma_f32 v24, v24, s52, v26
  v_fma_f32 v25, v25, s52, v27
  v_smfmac_f32_16x16x64_bf16 v[44:47], v[56:59], v[80:87], v15
  ds_read_b128 v[80:83], v9 offset:8192
  v_cvt_pk_bf16_f32 v24, v24, v25
  v_smfmac_f32_16x16x64_bf16 v[40:43], v[60:63], v[88:95], v15
  ds_write_b32 v10, v24 offset:4
  v_mul_f32_e64 v30, s52, v30
  v_mul_f32 v31, s52, v31
  v_smfmac_f32_16x16x64_bf16 v[44:47], v[60:63], v[96:103], v15
  ds_read_b128 v[84:87], v9 offset:9216
  v_fma_f32 v28, v28, s52, v30
  v_fma_f32 v29, v29, s52, v31
  v_smfmac_f32_16x16x64_bf16 v[40:43], v[56:59], v[112:119], v15
  ds_read_b128 v[88:91], v9 offset:10240
  s_waitcnt lgkmcnt(4)
  v_cvt_pk_bf16_f32 v28, v28, v29
  v_smfmac_f32_16x16x64_bf16 v[40:43], v[64:67], v[104:111], v15
  ds_write_b32 v10, v28 offset:516
  v_smfmac_f32_16x16x64_bf16 v[32:35], v[56:59], a[160:167], v15
  ds_read_b128 v[92:95], v9 offset:11264
  v_lshrrev_b32 v19, 1, v9
  v_smfmac_f32_16x16x64_bf16 v[32:35], v[60:63], a[176:183], v15
  ds_read_b128 v[96:99], v9 offset:12288
  s_waitcnt vmcnt(6)
  v_smfmac_f32_16x16x64_bf16 v[32:35], v[64:67], a[192:199], v15
  s_waitcnt lgkmcnt(2)
  s_barrier
  v_smfmac_f32_16x16x64_bf16 v[36:39], v[56:59], a[168:175], v15
  ds_read_b64_tr_b16 v[108:109], v11 offset:1024
  v_smfmac_f32_16x16x64_bf16 v[32:35], v[68:71], a[208:215], v15
  ds_read_b64_tr_b16 v[48:49], v11 offset:2048
  ds_read_b128 v[100:103], v9 offset:13312
  v_smfmac_f32_16x16x64_bf16 v[32:35], v[72:75], a[224:231], v15
  ds_read_b64_tr_b16 v[50:51], v11 offset:2560
  v_mov_b64_e64 v[56:57], s[54:55]
  v_smfmac_f32_16x16x64_bf16 v[32:35], v[76:79], a[240:247], v15
  ds_read_b64_tr_b16 v[104:105], v11 offset:0
  ds_read_b64_tr_b16 v[110:111], v11 offset:1536
  v_smfmac_f32_16x16x64_bf16 v[36:39], v[60:63], a[184:191], v15
  ds_read_b64_tr_b16 v[106:107], v11 offset:512
  ds_read_b128 v[112:115], v9 offset:14336
  v_smfmac_f32_16x16x64_bf16 v[36:39], v[64:67], a[200:207], v15
  ds_read_b64_tr_b16 v[52:53], v11 offset:3072
  v_add_f32_e64 v32, v32, v34
  v_smfmac_f32_16x16x64_bf16 v[36:39], v[68:71], a[216:223], v15
  ds_read_b128 v[116:119], v9 offset:15360
  v_add_f32_e64 v33, v33, v35
  v_smfmac_f32_16x16x64_bf16 v[36:39], v[72:75], a[232:239], v15
  ds_read_b64_tr_b16 v[54:55], v11 offset:3584
  v_cvt_pk_bf16_f32 v32, v32, v33
  v_smfmac_f32_16x16x64_bf16 v[36:39], v[76:79], a[248:255], v15
  ds_write_b32 v16, v32 offset:0
  s_waitcnt lgkmcnt(5)
  v_mfma_f32_16x16x32_bf16 v[28:31], v[84:87], v[104:107], 0
  ds_read_b128 v[84:87], v4 offset:3072
  v_mov_b64 v[58:59], s[54:55]
  v_mfma_f32_16x16x32_bf16 v[24:27], v[80:83], v[104:107], 0
  ds_read_b128 v[80:83], v4 offset:2048
  v_add_f32_e64 v37, v37, v39
  v_mfma_f32_16x16x32_bf16 v[24:27], v[88:91], v[108:111], v[24:27]
  ds_read_b128 v[88:91], v4 offset:16384
  v_add_f32_e64 v36, v36, v38
  v_cvt_pk_bf16_f32 v36, v36, v37
  v_mfma_f32_16x16x32_bf16 v[28:31], v[92:95], v[108:111], v[28:31]
  ds_read_b128 v[92:95], v4 offset:17408
  ds_write_b32 v16, v36 offset:64
  v_mfma_f32_16x16x32_bf16 v[24:27], v[96:99], v[48:51], v[24:27]
  s_waitcnt lgkmcnt(5)
  v_mov_b32 v61, 0
  v_mfma_f32_16x16x32_bf16 v[24:27], v[112:115], v[52:55], v[24:27]
  ds_read_b128 v[112:115], v5 offset:0
  v_mfma_f32_16x16x32_bf16 v[28:31], v[100:103], v[48:51], v[28:31]
  ds_read_b128 v[96:99], v4 offset:18432
  ds_read_b128 v[100:103], v4 offset:19456
  v_mfma_f32_16x16x32_bf16 v[28:31], v[116:119], v[52:55], v[28:31]
  ds_read_b128 v[116:119], v5 offset:1024
  v_exp_f32 v27, v27
  v_exp_f32 v24, v24
  v_exp_f32 v26, v26
  v_exp_f32 v25, v25
  s_waitcnt lgkmcnt(4)
  v_smfmac_f32_16x16x64_bf16 v[40:43], v[68:71], v[88:95], v15
  s_barrier
  ds_read_b64_tr_b16 v[32:33], v19 offset:0
  ds_read_b64_tr_b16 v[36:37], v19 offset:1024
  v_smfmac_f32_16x16x64_bf16 v[44:47], v[64:67], v[80:87], v15
  ds_read_b64_tr_b16 v[38:39], v19 offset:1536
  ds_read_b128 v[92:95], v5 offset:17408
  ds_read_b64_tr_b16 v[34:35], v19 offset:512
  s_waitcnt lgkmcnt(5)
  v_exp_f32 v30, v30
  v_exp_f32 v31, v31
  v_exp_f32 v29, v29
  v_smfmac_f32_16x16x64_bf16 v[44:47], v[68:71], v[96:103], v15
  ds_read_b128 v[80:83], v5 offset:2048
  ds_read_b128 v[88:91], v5 offset:16384
  v_smfmac_f32_16x16x64_bf16 v[40:43], v[72:75], v[112:119], v15
  ds_read_b128 v[84:87], v5 offset:3072
  v_exp_f32 v28, v28
  v_cvt_pk_bf16_f32 v24, v24, v25
  s_waitcnt lgkmcnt(3)
  v_smfmac_f32_16x16x64_bf16 v[20:23], v[32:35], v[104:111], v15
  ds_read_b128 v[100:103], v5 offset:19456
  v_cvt_pk_bf16_f32 v25, v26, v27
  v_cvt_pk_bf16_f32 v27, v30, v31
  v_smfmac_f32_16x16x64_bf16 v[20:23], v[36:39], v[48:55], v15
  ds_read_b128 v[96:99], v5 offset:18432
  v_cvt_pk_bf16_f32 v26, v28, v29
  s_waitcnt lgkmcnt(3)
  v_smfmac_f32_16x16x64_bf16 v[40:43], v[76:79], v[88:95], v15
  buffer_load_dwordx4 v[32:35], v1, s[8:11], s50 offen offset:0 sc1
  v_mfma_f32_16x16x32_bf16 v[28:31], v[56:59], v[24:27], 0
  s_waitcnt lgkmcnt(2)
  v_add_f32 v20, v20, v22
  v_exp_f32 v22, v20
  v_add_f32 v21, v21, v23
  v_exp_f32 v23, v21
  v_smfmac_f32_16x16x64_bf16 v[44:47], v[72:75], v[80:87], v15
  s_waitcnt vmcnt(1)
  v_mfma_f32_16x16x32_bf16 v[104:107], v[120:123], v[24:27], 0
  s_waitcnt lgkmcnt(0)
  v_add_f32_e64 v41, v41, v43
  v_cvt_pk_bf16_f32 v60, v22, v23
  v_smfmac_f32_16x16x64_bf16 v[44:47], v[76:79], v[96:103], v15
  buffer_load_dword v17, off, s[8:11], s49 sc1
  v_mfma_f32_16x16x32_bf16 v[108:111], v[124:127], v[24:27], 0
  v_add_f32_e64 v40, v40, v42
  v_cvt_pk_bf16_f32 v52, v40, v41
  v_mfma_f32_16x16x16_bf16 v[28:31], v[56:57], v[60:61], v[28:31]
  v_add_f32 v45, v45, v47
  v_add_f32 v44, v44, v46
  v_cvt_pk_bf16_f32 v54, v44, v45
  v_mfma_f32_16x16x16_bf16 v[104:107], v[52:53], v[60:61], v[104:107]
  buffer_load_dwordx4 v[36:39], v1, s[8:11], s50 offen offset:1024 sc1
  v_mfma_f32_16x16x16_bf16 v[108:111], v[54:55], v[60:61], v[108:111]
  v_rcp_f32 v0, v28
  s_nop 2
  v_pk_mul_f32 v[104:105], v[104:105], v[0:1] op_sel_hi:[1,0]
  v_pk_mul_f32 v[106:107], v[106:107], v[0:1] op_sel_hi:[1,0]
  v_cvt_pk_bf16_f32 v104, v104, v105
  v_cvt_pk_bf16_f32 v105, v106, v107
  v_pk_mul_f32 v[108:109], v[108:109], v[0:1] op_sel_hi:[1,0]
  v_pk_mul_f32 v[110:111], v[110:111], v[0:1] op_sel_hi:[1,0]
  v_cvt_pk_bf16_f32 v106, v108, v109
  v_cvt_pk_bf16_f32 v107, v110, v111
  ds_write_b128 v12, v[104:107]
  v_subrev_u32 v18, 0x1f800000, v28
  v_cmp_lt_u32 vcc, 0x40000000, v18
  v_mov_b64 v[72:73], 0
  v_mov_b64 v[74:75], 0
  v_mov_b64 v[76:77], 0
  v_mov_b64 v[78:79], 0
  s_cbranch_vccnz TFL0_FAR
TFL0_NEAR:
  v_mov_b64 v[64:65], 0
  v_mov_b64 v[66:67], 0
  v_mov_b64 v[68:69], 0
  v_mov_b64 v[70:71], 0
  v_mov_b64 v[48:49], 0
  v_mov_b64 v[50:51], 0
  v_mov_b64 v[52:53], 0
  v_mov_b64 v[54:55], 0
  s_waitcnt vmcnt(4) lgkmcnt(0)
  s_barrier
  ds_read_b128 v[104:107], v9 offset:20480
  ds_read_b128 v[108:111], v9 offset:21504
  v_mov_b64 v[56:57], 0
  v_mov_b64 v[58:59], 0
  v_mov_b64 v[60:61], 0
  v_mov_b64 v[62:63], 0
  s_add_u32 s50, s50, 262144
  s_add_u32 s51, s51, 262144
  s_waitcnt lgkmcnt(1)
  v_smfmac_f32_16x16x64_bf16 v[48:51], v[104:107], v[128:135], v15
  v_smfmac_f32_16x16x64_bf16 v[52:55], v[104:107], v[144:151], v15
  s_waitcnt lgkmcnt(0)
  v_smfmac_f32_16x16x64_bf16 v[48:51], v[108:111], v[136:143], v15
  v_smfmac_f32_16x16x64_bf16 v[52:55], v[108:111], v[152:159], v15
  v_smfmac_f32_16x16x64_bf16 v[56:59], v[104:107], v[160:167], v15
  v_smfmac_f32_16x16x64_bf16 v[60:63], v[104:107], v[176:183], v15
  v_add_f32 v48, v48, v50
  v_add_f32 v49, v49, v51
  v_smfmac_f32_16x16x64_bf16 v[56:59], v[108:111], v[168:175], v15
  v_cvt_pk_bf16_f32 v20, v48, v49
  v_smfmac_f32_16x16x64_bf16 v[60:63], v[108:111], v[184:191], v15
  v_add_f32 v52, v52, v54
  v_add_f32 v53, v53, v55
  v_smfmac_f32_16x16x64_bf16 v[64:67], v[104:107], v[192:199], v15
  v_cvt_pk_bf16_f32 v21, v52, v53
  v_smfmac_f32_16x16x64_bf16 v[68:71], v[104:107], v[208:215], v15
  v_add_f32 v56, v56, v58
  v_add_f32 v57, v57, v59
  v_smfmac_f32_16x16x64_bf16 v[64:67], v[108:111], v[200:207], v15
  v_cvt_pk_bf16_f32 v22, v56, v57
  v_smfmac_f32_16x16x64_bf16 v[68:71], v[108:111], v[216:223], v15
  v_add_f32 v60, v60, v62
  v_add_f32 v61, v61, v63
  v_smfmac_f32_16x16x64_bf16 v[72:75], v[104:107], v[224:231], v15
  v_cvt_pk_bf16_f32 v23, v60, v61
  v_smfmac_f32_16x16x64_bf16 v[76:79], v[104:107], v[240:247], v15
  buffer_store_dwordx4 v[20:23], v13, s[8:11], s47 offen
  v_add_f32 v64, v64, v66
  v_add_f32 v65, v65, v67
  v_smfmac_f32_16x16x64_bf16 v[72:75], v[108:111], v[232:239], v15
  v_cvt_pk_bf16_f32 v24, v64, v65
  v_smfmac_f32_16x16x64_bf16 v[76:79], v[108:111], v[248:255], v15
  v_add_f32 v68, v68, v70
  v_add_f32 v69, v69, v71
  v_cvt_pk_bf16_f32 v25, v68, v69
  v_add_f32 v72, v72, v74
  v_add_f32 v73, v73, v75
  v_cvt_pk_bf16_f32 v26, v72, v73
  v_add_f32 v76, v76, v78
  v_add_f32 v77, v77, v79
  v_cvt_pk_bf16_f32 v27, v76, v77
  buffer_store_dwordx4 v[24:27], v13, s[8:11], s48 offen
  s_xor_b32 s47, s47, 0x40000
  s_xor_b32 s48, s48, 0x40000
  v_lshrrev_b32 v0, 2, v9
  v_and_b32 v0, 16, v0
  v_lshlrev_b32 v0, v0, s53
  v_cndmask_b32 v28, 0, v0, s[64:65]
  v_cndmask_b32 v29, 0, v0, s[66:67]
  v_cndmask_b32 v30, 0, v0, s[68:69]
  v_cndmask_b32 v31, 0, v0, s[70:71]
  v_mov_b32 v24, 0
  v_mov_b32 v26, 0
  v_mov_b64 v[40:41], 0
  v_mov_b64 v[42:43], 0
  v_mov_b64 v[44:45], 0
  v_mov_b64 v[46:47], 0
  v_mov_b64_e64 v[20:21], 0
  v_mov_b64 v[22:23], 0
  s_nop 15
  s_nop 15
  s_nop 15
  s_nop 11
  buffer_load_dwordx4 v[64:67], v1, s[8:11], s45 offen sc1
  buffer_load_dwordx4 v[68:71], v1, s[8:11], s45 offen offset:1024 sc1
  s_waitcnt vmcnt(4)
  ds_write_b128 v1, v[32:35] offset:8192
  ds_write_b128 v1, v[36:39] offset:9216
  s_nop 15
  s_nop 11
  buffer_load_dwordx4 v[64:67], v1, s[8:11], s45 offen sc1
  buffer_load_dwordx4 v[68:71], v1, s[8:11], s45 offen offset:1024 sc1
  v_cmp_eq_u32 vcc, 0, v17
  s_add_u32 s33, s49, 16
  s_cbranch_vccnz TFL0_FRETRY
TFL0_FOK:
  s_min_u32 s49, s33, s56
  v_mov_b32 v17, -1
  s_waitcnt vmcnt(2)
TFL0_ROK:
  v_max_u32_e64 v0, v64, v68
  v_smfmac_f32_16x16x64_bf16 v[24:27], v[28:31], v[64:71], v15
  v_cmp_eq_u32 vcc, -1, v0
  s_nop 2
  s_cbranch_vccnz TFL0_RRETRY
  s_xor_b32 s45, s45, 0x40000
  v_add_f32_dpp v24, v24, v24 row_ror:4 row_mask:0xf bank_mask:0xf
  v_add_f32_dpp v26, v26, v26 row_ror:4 row_mask:0xf bank_mask:0xf
  s_cmp_eq_u32 s41, 63
  v_add_f32_dpp v24, v24, v24 row_ror:8 row_mask:0xf bank_mask:0xf
  v_add_f32_dpp v26, v26, v26 row_ror:8 row_mask:0xf bank_mask:0xf
  v_cvt_pk_bf16_f32 v18, v24, v26
  buffer_store_dword v18, v14, s[8:11], s43 offen
TFL0_RDONE:
  s_cbranch_scc1 TFL0_LAST
  s_xor_b32 s43, s43, 0x2000
  s_barrier
  v_mov_b64 v[24:25], 0
  v_mov_b64 v[26:27], 0
  v_mov_b64_e64 v[28:29], 0
  v_mov_b64 v[30:31], 0
  s_nop 7
  buffer_load_dwordx4 v[48:51], v1, s[8:11], s42 offen sc1
  v_mov_b64 v[32:33], 0
  v_mov_b64 v[34:35], 0
  v_mov_b64 v[36:37], 0
  v_mov_b64 v[38:39], 0
  ds_read_b128 v[80:83], v2 offset:0
  ds_read_b128 v[84:87], v2 offset:1024
  ds_read_b128 v[104:107], v2 offset:18432
  ds_read_b128 v[108:111], v2 offset:19456
  s_nop 7
  s_nop 7
  buffer_load_dwordx4 v[48:51], v1, s[8:11], s42 offen sc1
  ds_read_b128 v[112:115], v3 offset:0
  ds_read_b128 v[116:119], v3 offset:1024
  buffer_load_dwordx4 v[52:55], v1, s[8:11], s42 offen offset:1024 sc1
  ds_read_b128 v[88:91], v2 offset:2048
  ds_read_b128 v[92:95], v2 offset:3072
  ds_read_b128 v[96:99], v2 offset:16384
  ds_read_b128 v[100:103], v2 offset:17408
  buffer_load_dwordx4 v[52:55], v1, s[8:11], s42 offen offset:1024 sc1
  s_branch TFL0_STEP
TFL0_LAST:
  buffer_store_dword v18, v14, s[8:11], s44 offen sc1
  s_waitcnt vmcnt(0)
  s_waitcnt vmcnt(0)
  s_endpgm
TFL0_FAR:
  s_nop 15
  ds_read_b64_tr_b16 v[80:81], v11 offset:0
  ds_read_b64_tr_b16 v[82:83], v11 offset:512
  ds_read_b64_tr_b16 v[84:85], v11 offset:1024
  ds_read_b64_tr_b16 v[86:87], v11 offset:1536
  ds_read_b64_tr_b16 v[88:89], v11 offset:2048
  ds_read_b64_tr_b16 v[90:91], v11 offset:2560
  ds_read_b64_tr_b16 v[92:93], v11 offset:3072
  ds_read_b64_tr_b16 v[94:95], v11 offset:3584
  s_waitcnt lgkmcnt(0)
  ds_read_b128 v[96:99], v9 offset:8192
  ds_read_b128 v[100:103], v9 offset:9216
  ds_read_b128 v[104:107], v9 offset:10240
  ds_read_b128 v[108:111], v9 offset:11264
  ds_read_b128 v[112:115], v9 offset:12288
  ds_read_b128 v[116:119], v9 offset:13312
  ds_read_b128 v[64:67], v9 offset:14336
  ds_read_b128 v[68:71], v9 offset:15360
  ds_read_b64_tr_b16 v[40:41], v19 offset:0
  ds_read_b64_tr_b16 v[42:43], v19 offset:512
  ds_read_b64_tr_b16 v[44:45], v19 offset:1024
  ds_read_b64_tr_b16 v[46:47], v19 offset:1536
  v_mov_b64 v[20:21], 0
  v_mov_b64 v[22:23], 0
  s_waitcnt lgkmcnt(0)
  v_mfma_f32_16x16x32_bf16 v[24:27], v[96:99], v[80:83], 0
  v_mfma_f32_16x16x32_bf16 v[28:31], v[100:103], v[80:83], 0
  v_mfma_f32_16x16x32_bf16 v[24:27], v[104:107], v[84:87], v[24:27]
  v_mfma_f32_16x16x32_bf16 v[28:31], v[108:111], v[84:87], v[28:31]
  v_mfma_f32_16x16x32_bf16 v[24:27], v[112:115], v[88:91], v[24:27]
  v_mfma_f32_16x16x32_bf16 v[28:31], v[116:119], v[88:91], v[28:31]
  v_mfma_f32_16x16x32_bf16 v[24:27], v[64:67], v[92:95], v[24:27]
  v_mfma_f32_16x16x32_bf16 v[28:31], v[68:71], v[92:95], v[28:31]
  v_smfmac_f32_16x16x64_bf16 v[20:23], v[40:43], v[80:87], v15
  v_smfmac_f32_16x16x64_bf16 v[20:23], v[44:47], v[88:95], v15
  s_nop 7
  v_add_f32 v20, v20, v22
  v_add_f32 v21, v21, v23
  v_max3_f32 v0, v24, v25, v26
  v_max3_f32 v0, v0, v27, v28
  v_max3_f32 v0, v0, v29, v30
  v_max3_f32 v0, v0, v31, v20
  v_max_f32 v0, v0, v21
  v_mov_b32 v18, v0
  s_nop 1
  v_permlane32_swap_b32 v0, v18
  v_max_f32 v0, v0, v18
  v_mov_b32 v18, v0
  s_nop 1
  v_permlane16_swap_b32 v0, v18
  v_max_f32 v0, v0, v18
  v_sub_f32 v24, v24, v0
  v_sub_f32 v25, v25, v0
  v_sub_f32 v26, v26, v0
  v_sub_f32 v27, v27, v0
  v_sub_f32 v28, v28, v0
  v_sub_f32 v29, v29, v0
  v_sub_f32 v30, v30, v0
  v_sub_f32 v31, v31, v0
  v_sub_f32 v20, v20, v0
  v_sub_f32 v21, v21, v0
  v_exp_f32 v24, v24
  v_exp_f32 v25, v25
  v_exp_f32 v26, v26
  v_exp_f32 v27, v27
  v_exp_f32 v28, v28
  v_exp_f32 v29, v29
  v_exp_f32 v30, v30
  v_exp_f32 v31, v31
  v_exp_f32 v22, v20
  v_exp_f32 v23, v21
  s_nop 0
  v_cvt_pk_bf16_f32 v60, v22, v23
  v_cvt_pk_bf16_f32 v24, v24, v25
  v_cvt_pk_bf16_f32 v25, v26, v27
  v_cvt_pk_bf16_f32 v26, v28, v29
  v_cvt_pk_bf16_f32 v27, v30, v31
  s_nop 1
  v_mfma_f32_16x16x32_bf16 v[28:31], v[56:59], v[24:27], 0
  v_mfma_f32_16x16x32_bf16 v[104:107], v[120:123], v[24:27], 0
  v_mfma_f32_16x16x32_bf16 v[108:111], v[124:127], v[24:27], 0
  v_mfma_f32_16x16x16_bf16 v[28:31], v[56:57], v[60:61], v[28:31]
  v_mfma_f32_16x16x16_bf16 v[104:107], v[52:53], v[60:61], v[104:107]
  v_mfma_f32_16x16x16_bf16 v[108:111], v[54:55], v[60:61], v[108:111]
  v_rcp_f32 v0, v28
  s_nop 2
  v_pk_mul_f32 v[104:105], v[104:105], v[0:1] op_sel_hi:[1,0]
  v_pk_mul_f32 v[106:107], v[106:107], v[0:1] op_sel_hi:[1,0]
  v_cvt_pk_bf16_f32 v104, v104, v105
  v_cvt_pk_bf16_f32 v105, v106, v107
  s_nop 2
  v_pk_mul_f32 v[108:109], v[108:109], v[0:1] op_sel_hi:[1,0]
  v_pk_mul_f32 v[110:111], v[110:111], v[0:1] op_sel_hi:[1,0]
  v_cvt_pk_bf16_f32 v106, v108, v109
  v_cvt_pk_bf16_f32 v107, v110, v111
  ds_write_b128 v12, v[104:107]
  s_branch TFL0_NEAR
TFL0_ARETRY:
  s_mov_b64 exec, vcc
  buffer_load_dwordx4 v[48:51], v1, s[8:11], s42 offen sc1
  s_mov_b64 exec, -1
  buffer_load_dwordx4 v[52:55], v1, s[8:11], s42 offen offset:1024 sc1
  s_waitcnt vmcnt(4)
  v_max3_u32 v0, v48, v49, v50
  v_max_u32 v0, v0, v51
  v_cmp_eq_u32 vcc, -1, v0
  s_cbranch_vccz TFL0_MOK
TFL0_ARETRY2:
  s_mov_b64 exec, vcc
  buffer_load_dwordx4 v[48:51], v1, s[8:11], s42 offen sc1
  s_mov_b64 exec, -1
  buffer_load_dwordx4 v[52:55], v1, s[8:11], s42 offen offset:1024 sc1
  s_sub_u32 s6, s6, 1
  s_cbranch_scc1 GIVEUP
  s_waitcnt vmcnt(3)
  v_max3_u32 v0, v48, v49, v50
  v_max_u32 v0, v0, v51
  v_cmp_eq_u32 vcc, -1, v0
  s_cbranch_vccnz TFL0_ARETRY2
  s_branch TFL0_MOK
TFL0_BRETRY:
TFL0_BRETRY2:
  s_mov_b64 exec, vcc
  buffer_load_dwordx4 v[52:55], v1, s[8:11], s42 offen offset:1024 sc1
  s_sub_u32 s6, s6, 1
  s_cbranch_scc1 GIVEUP
  s_waitcnt vmcnt(1)
  v_max3_u32 v0, v52, v53, v54
  v_max_u32 v0, v0, v55
  v_cmp_eq_u32 vcc, -1, v0
  s_cbranch_vccnz TFL0_BRETRY2
  s_mov_b64 exec, -1
  s_branch TFL0_BOK
TFL0_RRETRY:
  s_mov_b64 exec, vcc
  buffer_load_dwordx4 v[64:67], v1, s[8:11], s45 offen sc1
  buffer_load_dwordx4 v[68:71], v1, s[8:11], s45 offen offset:1024 sc1
  s_mov_b64 exec, -1
  v_mov_b32 v24, 0
  v_mov_b32 v26, 0
  s_sub_u32 s6, s6, 1
  s_cbranch_scc1 GIVEUP
  s_waitcnt vmcnt(2)
  v_max_u32 v0, v64, v68
  v_smfmac_f32_16x16x64_bf16 v[24:27], v[28:31], v[64:71], v15
  v_cmp_eq_u32 vcc, -1, v0
  s_nop 2
  s_cbranch_vccnz TFL0_RRETRY
  s_xor_b32 s45, s45, 0x40000
  v_add_f32_dpp v24, v24, v24 row_ror:4 row_mask:0xf bank_mask:0xf
  v_add_f32_dpp v26, v26, v26 row_ror:4 row_mask:0xf bank_mask:0xf
  s_cmp_eq_u32 s41, 63
  v_add_f32_dpp v24, v24, v24 row_ror:8 row_mask:0xf bank_mask:0xf
  v_add_f32_dpp v26, v26, v26 row_ror:8 row_mask:0xf bank_mask:0xf
  v_cvt_pk_bf16_f32 v18, v24, v26
  buffer_store_dword v18, v14, s[8:11], s43 offen
  s_branch TFL0_RDONE
TFL0_FRETRY:
  buffer_load_dword v17, off, s[8:11], s49 sc1
  s_waitcnt vmcnt(0)
  v_cmp_ne_u32 vcc, 0, v17
  s_cbranch_vccnz TFL0_FOK
  s_sleep 1
  s_sub_u32 s6, s6, 1
  s_cbranch_scc1 GIVEUP
  s_branch TFL0_FRETRY
  .p2align 6
TFL1_STEP:
  s_waitcnt vmcnt(3)
  v_max3_u32 v0, v48, v49, v50
  v_max_u32 v0, v0, v51
  v_cmp_eq_u32 vcc, -1, v0
  s_cbranch_vccnz TFL1_ARETRY
TFL1_MOK:
  ds_write_b128 v1, v[48:51] offset:0
  v_smfmac_f32_16x16x64_bf16 v[24:27], v[48:51], a[0:7], v15
  v_smfmac_f32_16x16x64_bf16 v[28:31], v[48:51], a[8:15], v15
  v_smfmac_f32_16x16x64_bf16 v[32:35], v[48:51], a[128:135], v15
  v_smfmac_f32_16x16x64_bf16 v[36:39], v[48:51], a[136:143], v15
  s_waitcnt lgkmcnt(0)
  s_barrier
  ds_read_b128 v[56:59], v6 offset:0
  v_smfmac_f32_16x16x64_bf16 v[40:43], v[48:51], v[80:87], v15
  ds_read_b128 v[64:67], v7 offset:0
  s_waitcnt vmcnt(1)
  v_max3_u32 v0, v52, v53, v54
  v_max_u32 v0, v0, v55
  v_cmp_eq_u32 vcc, -1, v0
  v_smfmac_f32_16x16x64_bf16 v[44:47], v[48:51], v[88:95], v15
  ds_read_b128 v[72:75], v8 offset:0
  s_cbranch_vccnz TFL1_BRETRY
TFL1_BOK:
  ds_write_b128 v1, v[52:55] offset:1024
  v_smfmac_f32_16x16x64_bf16 v[24:27], v[52:55], a[16:23], v15
  v_smfmac_f32_16x16x64_bf16 v[28:31], v[52:55], a[24:31], v15
  v_smfmac_f32_16x16x64_bf16 v[32:35], v[52:55], a[144:151], v15
  v_smfmac_f32_16x16x64_bf16 v[36:39], v[52:55], a[152:159], v15
  s_waitcnt lgkmcnt(0)
  s_barrier
  ds_read_b128 v[60:63], v6 offset:1024
  buffer_load_dwordx4 v[120:123], v1, s[8:11], s51 offen offset:0 sc1
  v_smfmac_f32_16x16x64_bf16 v[40:43], v[52:55], v[96:103], v15
  ds_read_b128 v[68:71], v7 offset:1024
  v_smfmac_f32_16x16x64_bf16 v[44:47], v[52:55], v[104:111], v15
  ds_read_b128 v[76:79], v8 offset:1024
  buffer_store_dword v18, v14, s[8:11], s44 offen sc1
  v_smfmac_f32_16x16x64_bf16 v[24:27], v[56:59], a[32:39], v15
  ds_read_b128 v[80:83], v3 offset:2048
  v_smfmac_f32_16x16x64_bf16 v[28:31], v[56:59], a[40:47], v15
  ds_read_b128 v[84:87], v3 offset:3072
  buffer_store_dword v17, v14, s[8:11], s43 offen
  v_smfmac_f32_16x16x64_bf16 v[24:27], v[64:67], a[64:71], v15
  ds_read_b128 v[88:91], v3 offset:16384
  v_smfmac_f32_16x16x64_bf16 v[28:31], v[64:67], a[72:79], v15
  ds_read_b128 v[92:95], v3 offset:17408
  buffer_store_dword v17, v1, s[8:11], s46 offen
  v_smfmac_f32_16x16x64_bf16 v[24:27], v[72:75], a[96:103], v15
  ds_read_b128 v[96:99], v3 offset:18432
  v_smfmac_f32_16x16x64_bf16 v[28:31], v[72:75], a[104:111], v15
  ds_read_b128 v[100:103], v3 offset:19456
  buffer_store_dword v17, v1, s[8:11], s46 offen offset:1024
  s_waitcnt lgkmcnt(5)
  v_smfmac_f32_16x16x64_bf16 v[24:27], v[60:63], a[48:55], v15
  ds_read_b128 v[104:107], v4 offset:0
  v_smfmac_f32_16x16x64_bf16 v[24:27], v[68:71], a[80:87], v15
  ds_read_b128 v[108:111], v4 offset:1024
  buffer_load_dwordx4 v[124:127], v1, s[8:11], s51 offen offset:1024 sc1
  s_xor_b32 s42, s42, 0x2000
  s_add_u32 s41, s41, 1
  v_smfmac_f32_16x16x64_bf16 v[24:27], v[76:79], a[112:119], v15
  s_add_u32 s44, s44, 0x2000
  s_xor_b32 s46, s46, 0x40000
  v_smfmac_f32_16x16x64_bf16 v[28:31], v[60:63], a[56:63], v15
  v_smfmac_f32_16x16x64_bf16 v[28:31], v[68:71], a[88:95], v15
  v_mul_f32_e64 v26, s52, v26
  v_mul_f32 v27, s52, v27
  v_smfmac_f32_16x16x64_bf16 v[28:31], v[76:79], a[120:127], v15
  s_waitcnt lgkmcnt(1)
  v_fma_f32 v24, v24, s52, v26
  v_fma_f32 v25, v25, s52, v27
  v_smfmac_f32_16x16x64_bf16 v[44:47], v[56:59], v[80:87], v15
  ds_read_b128 v[80:83], v9 offset:8192
  v_cvt_pk_bf16_f32 v24, v24, v25
  v_smfmac_f32_16x16x64_bf16 v[40:43], v[60:63], v[88:95], v15
  ds_write_b32 v10, v24 offset:4
  v_mul_f32_e64 v30, s52, v30
  v_mul_f32 v31, s52, v31
  v_smfmac_f32_16x16x64_bf16 v[44:47], v[60:63], v[96:103], v15
  ds_read_b128 v[84:87], v9 offset:9216
  v_fma_f32 v28, v28, s52, v30
  v_fma_f32 v29, v29, s52, v31
  v_smfmac_f32_16x16x64_bf16 v[40:43], v[56:59], v[112:119], v15
  ds_read_b128 v[88:91], v9 offset:10240
  s_waitcnt lgkmcnt(4)
  v_cvt_pk_bf16_f32 v28, v28, v29
  v_smfmac_f32_16x16x64_bf16 v[40:43], v[64:67], v[104:111], v15
  ds_write_b32 v10, v28 offset:516
  v_smfmac_f32_16x16x64_bf16 v[32:35], v[56:59], a[160:167], v15
  ds_read_b128 v[92:95], v9 offset:11264
  v_lshrrev_b32 v19, 1, v9
  v_smfmac_f32_16x16x64_bf16 v[32:35], v[60:63], a[176:183], v15
  ds_read_b128 v[96:99], v9 offset:12288
  s_waitcnt vmcnt(6)
  v_smfmac_f32_16x16x64_bf16 v[32:35], v[64:67], a[192:199], v15
  s_waitcnt lgkmcnt(2)
  s_barrier
  v_smfmac_f32_16x16x64_bf16 v[36:39], v[56:59], a[168:175], v15
  ds_read_b64_tr_b16 v[108:109], v11 offset:1024
  v_smfmac_f32_16x16x64_bf16 v[32:35], v[68:71], a[208:215], v15
  ds_read_b64_tr_b16 v[48:49], v11 offset:2048
  ds_read_b128 v[100:103], v9 offset:13312
  v_smfmac_f32_16x16x64_bf16 v[32:35], v[72:75], a[224:231], v15
  ds_read_b64_tr_b16 v[50:51], v11 offset:2560
  v_mov_b64_e64 v[56:57], s[54:55]
  v_smfmac_f32_16x16x64_bf16 v[32:35], v[76:79], a[240:247], v15
  ds_read_b64_tr_b16 v[104:105], v11 offset:0
  ds_read_b64_tr_b16 v[110:111], v11 offset:1536
  v_smfmac_f32_16x16x64_bf16 v[36:39], v[60:63], a[184:191], v15
  ds_read_b64_tr_b16 v[106:107], v11 offset:512
  ds_read_b128 v[112:115], v9 offset:14336
  v_smfmac_f32_16x16x64_bf16 v[36:39], v[64:67], a[200:207], v15
  ds_read_b64_tr_b16 v[52:53], v11 offset:3072
  v_add_f32_e64 v32, v32, v34
  v_smfmac_f32_16x16x64_bf16 v[36:39], v[68:71], a[216:223], v15
  ds_read_b128 v[116:119], v9 offset:15360
  v_add_f32_e64 v33, v33, v35
  v_smfmac_f32_16x16x64_bf16 v[36:39], v[72:75], a[232:239], v15
  ds_read_b64_tr_b16 v[54:55], v11 offset:3584
  v_cvt_pk_bf16_f32 v32, v32, v33
  v_smfmac_f32_16x16x64_bf16 v[36:39], v[76:79], a[248:255], v15
  ds_write_b32 v16, v32 offset:0
  s_waitcnt lgkmcnt(5)
  v_mfma_f32_16x16x32_bf16 v[28:31], v[84:87], v[104:107], 0
  ds_read_b128 v[84:87], v4 offset:3072
  v_mov_b64 v[58:59], s[54:55]
  v_mfma_f32_16x16x32_bf16 v[24:27], v[80:83], v[104:107], 0
  ds_read_b128 v[80:83], v4 offset:2048
  v_add_f32_e64 v37, v37, v39
  v_mfma_f32_16x16x32_bf16 v[24:27], v[88:91], v[108:111], v[24:27]
  ds_read_b128 v[88:91], v4 offset:16384
  v_add_f32_e64 v36, v36, v38
  v_cvt_pk_bf16_f32 v36, v36, v37
  v_mfma_f32_16x16x32_bf16 v[28:31], v[92:95], v[108:111], v[28:31]
  ds_read_b128 v[92:95], v4 offset:17408
  ds_write_b32 v16, v36 offset:64
  v_mfma_f32_16x16x32_bf16 v[24:27], v[96:99], v[48:51], v[24:27]
  s_waitcnt lgkmcnt(5)
  v_mov_b32 v61, 0
  v_mfma_f32_16x16x32_bf16 v[24:27], v[112:115], v[52:55], v[24:27]
  ds_read_b128 v[112:115], v5 offset:0
  v_mfma_f32_16x16x32_bf16 v[28:31], v[100:103], v[48:51], v[28:31]
  ds_read_b128 v[96:99], v4 offset:18432
  ds_read_b128 v[100:103], v4 offset:19456
  v_mfma_f32_16x16x32_bf16 v[28:31], v[116:119], v[52:55], v[28:31]
  ds_read_b128 v[116:119], v5 offset:1024
  v_exp_f32 v27, v27
  v_exp_f32 v24, v24
  v_exp_f32 v26, v26
  v_exp_f32 v25, v25
  s_waitcnt lgkmcnt(4)
  v_smfmac_f32_16x16x64_bf16 v[40:43], v[68:71], v[88:95], v15
  s_barrier
  ds_read_b64_tr_b16 v[32:33], v19 offset:0
  ds_read_b64_tr_b16 v[36:37], v19 offset:1024
  v_smfmac_f32_16x16x64_bf16 v[44:47], v[64:67], v[80:87], v15
  ds_read_b64_tr_b16 v[38:39], v19 offset:1536
  ds_read_b128 v[92:95], v5 offset:17408
  ds_read_b64_tr_b16 v[34:35], v19 offset:512
  s_waitcnt lgkmcnt(5)
  v_exp_f32 v30, v30
  v_exp_f32 v31, v31
  v_exp_f32 v29, v29
  v_smfmac_f32_16x16x64_bf16 v[44:47], v[68:71], v[96:103], v15
  ds_read_b128 v[80:83], v5 offset:2048
  ds_read_b128 v[88:91], v5 offset:16384
  v_smfmac_f32_16x16x64_bf16 v[40:43], v[72:75], v[112:119], v15
  ds_read_b128 v[84:87], v5 offset:3072
  v_exp_f32 v28, v28
  v_cvt_pk_bf16_f32 v24, v24, v25
  s_waitcnt lgkmcnt(3)
  v_smfmac_f32_16x16x64_bf16 v[20:23], v[32:35], v[104:111], v15
  ds_read_b128 v[100:103], v5 offset:19456
  v_cvt_pk_bf16_f32 v25, v26, v27
  v_cvt_pk_bf16_f32 v27, v30, v31
  v_smfmac_f32_16x16x64_bf16 v[20:23], v[36:39], v[48:55], v15
  ds_read_b128 v[96:99], v5 offset:18432
  v_cvt_pk_bf16_f32 v26, v28, v29
  s_waitcnt lgkmcnt(3)
  v_smfmac_f32_16x16x64_bf16 v[40:43], v[76:79], v[88:95], v15
  buffer_load_dwordx4 v[32:35], v1, s[8:11], s50 offen offset:0 sc1
  v_mfma_f32_16x16x32_bf16 v[28:31], v[56:59], v[24:27], 0
  s_waitcnt lgkmcnt(2)
  v_add_f32 v20, v20, v22
  v_exp_f32 v22, v20
  v_add_f32 v21, v21, v23
  v_exp_f32 v23, v21
  v_smfmac_f32_16x16x64_bf16 v[44:47], v[72:75], v[80:87], v15
  s_waitcnt vmcnt(1)
  v_mfma_f32_16x16x32_bf16 v[104:107], v[120:123], v[24:27], 0
  s_waitcnt lgkmcnt(0)
  v_add_f32_e64 v41, v41, v43
  v_cvt_pk_bf16_f32 v60, v22, v23
  v_smfmac_f32_16x16x64_bf16 v[44:47], v[76:79], v[96:103], v15
  buffer_load_dword v17, off, s[8:11], s49 sc1
  v_mfma_f32_16x16x32_bf16 v[108:111], v[124:127], v[24:27], 0
  v_add_f32_e64 v40, v40, v42
  v_cvt_pk_bf16_f32 v52, v40, v41
  v_mfma_f32_16x16x16_bf16 v[28:31], v[56:57], v[60:61], v[28:31]
  v_add_f32 v45, v45, v47
  v_add_f32 v44, v44, v46
  v_cvt_pk_bf16_f32 v54, v44, v45
  v_mfma_f32_16x16x16_bf16 v[104:107], v[52:53], v[60:61], v[104:107]
  buffer_load_dwordx4 v[36:39], v1, s[8:11], s50 offen offset:1024 sc1
  v_mfma_f32_16x16x16_bf16 v[108:111], v[54:55], v[60:61], v[108:111]
  v_rcp_f32 v0, v28
  s_nop 2
  v_pk_mul_f32 v[104:105], v[104:105], v[0:1] op_sel_hi:[1,0]
  v_pk_mul_f32 v[106:107], v[106:107], v[0:1] op_sel_hi:[1,0]
  v_cvt_pk_bf16_f32 v104, v104, v105
  v_cvt_pk_bf16_f32 v105, v106, v107
  v_pk_mul_f32 v[108:109], v[108:109], v[0:1] op_sel_hi:[1,0]
  v_pk_mul_f32 v[110:111], v[110:111], v[0:1] op_sel_hi:[1,0]
  v_cvt_pk_bf16_f32 v106, v108, v109
  v_cvt_pk_bf16_f32 v107, v110, v111
  ds_write_b128 v12, v[104:107]
  v_subrev_u32 v18, 0x1f800000, v28
  v_cmp_lt_u32 vcc, 0x40000000, v18
  v_mov_b64 v[72:73], 0
  v_mov_b64 v[74:75], 0
  v_mov_b64 v[76:77], 0
  v_mov_b64 v[78:79], 0
  s_cbranch_vccnz TFL1_FAR
TFL1_NEAR:
  v_mov_b64 v[64:65], 0
  v_mov_b64 v[66:67], 0
  v_mov_b64 v[68:69], 0
  v_mov_b64 v[70:71], 0
  v_mov_b64 v[48:49], 0
  v_mov_b64 v[50:51], 0
  v_mov_b64 v[52:53], 0
  v_mov_b64 v[54:55], 0
  s_waitcnt vmcnt(4) lgkmcnt(0)
  s_barrier
  ds_read_b128 v[104:107], v9 offset:20480
  ds_read_b128 v[108:111], v9 offset:21504
  v_mov_b64 v[56:57], 0
  v_mov_b64 v[58:59], 0
  v_mov_b64 v[60:61], 0
  v_mov_b64 v[62:63], 0
  s_add_u32 s50, s50, 262144
  s_add_u32 s51, s51, 262144
  s_waitcnt lgkmcnt(1)
  v_smfmac_f32_16x16x64_bf16 v[48:51], v[104:107], v[128:135], v15
  v_smfmac_f32_16x16x64_bf16 v[52:55], v[104:107], v[144:151], v15
  s_waitcnt lgkmcnt(0)
  v_smfmac_f32_16x16x64_bf16 v[48:51], v[108:111], v[136:143], v15
  v_smfmac_f32_16x16x64_bf16 v[52:55], v[108:111], v[152:159], v15
  v_smfmac_f32_16x16x64_bf16 v[56:59], v[104:107], v[160:167], v15
  v_smfmac_f32_16x16x64_bf16 v[60:63], v[104:107], v[176:183], v15
  v_add_f32 v48, v48, v50
  v_add_f32 v49, v49, v51
  v_smfmac_f32_16x16x64_bf16 v[56:59], v[108:111], v[168:175], v15
  v_cvt_pk_bf16_f32 v20, v48, v49
  v_smfmac_f32_16x16x64_bf16 v[60:63], v[108:111], v[184:191], v15
  v_add_f32 v52, v52, v54
  v_add_f32 v53, v53, v55
  v_smfmac_f32_16x16x64_bf16 v[64:67], v[104:107], v[192:199], v15
  v_cvt_pk_bf16_f32 v21, v52, v53
  v_smfmac_f32_16x16x64_bf16 v[68:71], v[104:107], v[208:215], v15
  v_add_f32 v56, v56, v58
  v_add_f32 v57, v57, v59
  v_smfmac_f32_16x16x64_bf16 v[64:67], v[108:111], v[200:207], v15
  v_cvt_pk_bf16_f32 v22, v56, v57
  v_smfmac_f32_16x16x64_bf16 v[68:71], v[108:111], v[216:223], v15
  v_add_f32 v60, v60, v62
  v_add_f32 v61, v61, v63
  v_smfmac_f32_16x16x64_bf16 v[72:75], v[104:107], v[224:231], v15
  v_cvt_pk_bf16_f32 v23, v60, v61
  v_smfmac_f32_16x16x64_bf16 v[76:79], v[104:107], v[240:247], v15
  v_add_f32 v64, v64, v66
  v_add_f32 v65, v65, v67
  v_smfmac_f32_16x16x64_bf16 v[72:75], v[108:111], v[232:239], v15
  v_cvt_pk_bf16_f32 v24, v64, v65
  buffer_store_dwordx4 v[20:23], v13, s[8:11], s47 offen
  v_smfmac_f32_16x16x64_bf16 v[76:79], v[108:111], v[248:255], v15
  v_add_f32 v68, v68, v70
  v_add_f32 v69, v69, v71
  v_cvt_pk_bf16_f32 v25, v68, v69
  v_add_f32 v72, v72, v74
  v_add_f32 v73, v73, v75
  v_cvt_pk_bf16_f32 v26, v72, v73
  v_add_f32 v76, v76, v78
  v_add_f32 v77, v77, v79
  v_cvt_pk_bf16_f32 v27, v76, v77
  buffer_store_dwordx4 v[24:27], v13, s[8:11], s48 offen
  s_xor_b32 s47, s47, 0x40000
  s_xor_b32 s48, s48, 0x40000
  v_lshrrev_b32 v0, 2, v9
  v_and_b32 v0, 16, v0
  v_lshlrev_b32 v0, v0, s53
  v_cndmask_b32 v28, 0, v0, s[64:65]
  v_cndmask_b32 v29, 0, v0, s[66:67]
  v_cndmask_b32 v30, 0, v0, s[68:69]
  v_cndmask_b32 v31, 0, v0, s[70:71]
  v_mov_b32 v24, 0
  v_mov_b32 v26, 0
  v_mov_b64 v[40:41], 0
  v_mov_b64 v[42:43], 0
  v_mov_b64 v[44:45], 0
  v_mov_b64 v[46:47], 0
  v_mov_b64_e64 v[20:21], 0
  v_mov_b64 v[22:23], 0
  s_nop 15
  s_nop 15
  s_nop 15
  s_nop 15
  buffer_load_dwordx4 v[64:67], v1, s[8:11], s45 offen sc1
  buffer_load_dwordx4 v[68:71], v1, s[8:11], s45 offen offset:1024 sc1
  s_waitcnt vmcnt(4)
  ds_write_b128 v1, v[32:35] offset:8192
  ds_write_b128 v1, v[36:39] offset:9216
  s_nop 15
  s_nop 11
  buffer_load_dwordx4 v[64:67], v1, s[8:11], s45 offen sc1
  buffer_load_dwordx4 v[68:71], v1, s[8:11], s45 offen offset:1024 sc1
  v_cmp_eq_u32 vcc, 0, v17
  s_add_u32 s33, s49, 16
  s_cbranch_vccnz TFL1_FRETRY
TFL1_FOK:
  s_min_u32 s49, s33, s56
  v_mov_b32 v17, -1
  s_waitcnt vmcnt(2)
TFL1_ROK:
  v_max_u32_e64 v0, v64, v68
  v_smfmac_f32_16x16x64_bf16 v[24:27], v[28:31], v[64:71], v15
  v_cmp_eq_u32 vcc, -1, v0
  s_nop 2
  s_cbranch_vccnz TFL1_RRETRY
  s_xor_b32 s45, s45, 0x40000
  v_add_f32_dpp v24, v24, v24 row_ror:4 row_mask:0xf bank_mask:0xf
  v_add_f32_dpp v26, v26, v26 row_ror:4 row_mask:0xf bank_mask:0xf
  s_cmp_eq_u32 s41, 63
  v_add_f32_dpp v24, v24, v24 row_ror:8 row_mask:0xf bank_mask:0xf
  v_add_f32_dpp v26, v26, v26 row_ror:8 row_mask:0xf bank_mask:0xf
  v_cvt_pk_bf16_f32 v18, v24, v26
  buffer_store_dword v18, v14, s[8:11], s43 offen
TFL1_RDONE:
  s_cbranch_scc1 TFL1_LAST
  s_xor_b32 s43, s43, 0x2000
  s_barrier
  v_mov_b64 v[24:25], 0
  v_mov_b64 v[26:27], 0
  v_mov_b64_e64 v[28:29], 0
  v_mov_b64 v[30:31], 0
  s_nop 7
  buffer_load_dwordx4 v[48:51], v1, s[8:11], s42 offen sc1
  v_mov_b64 v[32:33], 0
  v_mov_b64 v[34:35], 0
  v_mov_b64 v[36:37], 0
  v_mov_b64 v[38:39], 0
  ds_read_b128 v[80:83], v2 offset:0
  ds_read_b128 v[84:87], v2 offset:1024
  ds_read_b128 v[104:107], v2 offset:18432
  ds_read_b128 v[108:111], v2 offset:19456
  s_nop 7
  s_nop 7
  buffer_load_dwordx4 v[48:51], v1, s[8:11], s42 offen sc1
  ds_read_b128 v[112:115], v3 offset:0
  ds_read_b128 v[116:119], v3 offset:1024
  buffer_load_dwordx4 v[52:55], v1, s[8:11], s42 offen offset:1024 sc1
  ds_read_b128 v[88:91], v2 offset:2048
  ds_read_b128 v[92:95], v2 offset:3072
  ds_read_b128 v[96:99], v2 offset:16384
  ds_read_b128 v[100:103], v2 offset:17408
  buffer_load_dwordx4 v[52:55], v1, s[8:11], s42 offen offset:1024 sc1
  s_branch TFL1_STEP
TFL1_LAST:
  buffer_store_dword v18, v14, s[8:11], s44 offen sc1
  s_waitcnt vmcnt(0)
  s_waitcnt vmcnt(0)
  s_endpgm
TFL1_FAR:
  s_nop 15
  ds_read_b64_tr_b16 v[80:81], v11 offset:0
  ds_read_b64_tr_b16 v[82:83], v11 offset:512
  ds_read_b64_tr_b16 v[84:85], v11 offset:1024
  ds_read_b64_tr_b16 v[86:87], v11 offset:1536
  ds_read_b64_tr_b16 v[88:89], v11 offset:2048
  ds_read_b64_tr_b16 v[90:91], v11 offset:2560
  ds_read_b64_tr_b16 v[92:93], v11 offset:3072
  ds_read_b64_tr_b16 v[94:95], v11 offset:3584
  s_waitcnt lgkmcnt(0)
  ds_read_b128 v[96:99], v9 offset:8192
  ds_read_b128 v[100:103], v9 offset:9216
  ds_read_b128 v[104:107], v9 offset:10240
  ds_read_b128 v[108:111], v9 offset:11264
  ds_read_b128 v[112:115], v9 offset:12288
  ds_read_b128 v[116:119], v9 offset:13312
  ds_read_b128 v[64:67], v9 offset:14336
  ds_read_b128 v[68:71], v9 offset:15360
  ds_read_b64_tr_b16 v[40:41], v19 offset:0
  ds_read_b64_tr_b16 v[42:43], v19 offset:512
  ds_read_b64_tr_b16 v[44:45], v19 offset:1024
  ds_read_b64_tr_b16 v[46:47], v19 offset:1536
  v_mov_b64 v[20:21], 0
  v_mov_b64 v[22:23], 0
  s_waitcnt lgkmcnt(0)
  v_mfma_f32_16x16x32_bf16 v[24:27], v[96:99], v[80:83], 0
  v_mfma_f32_16x16x32_bf16 v[28:31], v[100:103], v[80:83], 0
  v_mfma_f32_16x16x32_bf16 v[24:27], v[104:107], v[84:87], v[24:27]
  v_mfma_f32_16x16x32_bf16 v[28:31], v[108:111], v[84:87], v[28:31]
  v_mfma_f32_16x16x32_bf16 v[24:27], v[112:115], v[88:91], v[24:27]
  v_mfma_f32_16x16x32_bf16 v[28:31], v[116:119], v[88:91], v[28:31]
  v_mfma_f32_16x16x32_bf16 v[24:27], v[64:67], v[92:95], v[24:27]
  v_mfma_f32_16x16x32_bf16 v[28:31], v[68:71], v[92:95], v[28:31]
  v_smfmac_f32_16x16x64_bf16 v[20:23], v[40:43], v[80:87], v15
  v_smfmac_f32_16x16x64_bf16 v[20:23], v[44:47], v[88:95], v15
  s_nop 7
  v_add_f32 v20, v20, v22
  v_add_f32 v21, v21, v23
  v_max3_f32 v0, v24, v25, v26
  v_max3_f32 v0, v0, v27, v28
  v_max3_f32 v0, v0, v29, v30
  v_max3_f32 v0, v0, v31, v20
  v_max_f32 v0, v0, v21
  v_mov_b32 v18, v0
  s_nop 1
  v_permlane32_swap_b32 v0, v18
  v_max_f32 v0, v0, v18
  v_mov_b32 v18, v0
  s_nop 1
  v_permlane16_swap_b32 v0, v18
  v_max_f32 v0, v0, v18
  v_sub_f32 v24, v24, v0
  v_sub_f32 v25, v25, v0
  v_sub_f32 v26, v26, v0
  v_sub_f32 v27, v27, v0
  v_sub_f32 v28, v28, v0
  v_sub_f32 v29, v29, v0
  v_sub_f32 v30, v30, v0
  v_sub_f32 v31, v31, v0
  v_sub_f32 v20, v20, v0
  v_sub_f32 v21, v21, v0
  v_exp_f32 v24, v24
  v_exp_f32 v25, v25
  v_exp_f32 v26, v26
  v_exp_f32 v27, v27
  v_exp_f32 v28, v28
  v_exp_f32 v29, v29
  v_exp_f32 v30, v30
  v_exp_f32 v31, v31
  v_exp_f32 v22, v20
  v_exp_f32 v23, v21
  s_nop 0
  v_cvt_pk_bf16_f32 v60, v22, v23
  v_cvt_pk_bf16_f32 v24, v24, v25
  v_cvt_pk_bf16_f32 v25, v26, v27
  v_cvt_pk_bf16_f32 v26, v28, v29
  v_cvt_pk_bf16_f32 v27, v30, v31
  s_nop 1
  v_mfma_f32_16x16x32_bf16 v[28:31], v[56:59], v[24:27], 0
  v_mfma_f32_16x16x32_bf16 v[104:107], v[120:123], v[24:27], 0
  v_mfma_f32_16x16x32_bf16 v[108:111], v[124:127], v[24:27], 0
  v_mfma_f32_16x16x16_bf16 v[28:31], v[56:57], v[60:61], v[28:31]
  v_mfma_f32_16x16x16_bf16 v[104:107], v[52:53], v[60:61], v[104:107]
  v_mfma_f32_16x16x16_bf16 v[108:111], v[54:55], v[60:61], v[108:111]
  v_rcp_f32 v0, v28
  s_nop 2
  v_pk_mul_f32 v[104:105], v[104:105], v[0:1] op_sel_hi:[1,0]
  v_pk_mul_f32 v[106:107], v[106:107], v[0:1] op_sel_hi:[1,0]
  v_cvt_pk_bf16_f32 v104, v104, v105
  v_cvt_pk_bf16_f32 v105, v106, v107
  s_nop 2
  v_pk_mul_f32 v[108:109], v[108:109], v[0:1] op_sel_hi:[1,0]
  v_pk_mul_f32 v[110:111], v[110:111], v[0:1] op_sel_hi:[1,0]
  v_cvt_pk_bf16_f32 v106, v108, v109
  v_cvt_pk_bf16_f32 v107, v110, v111
  ds_write_b128 v12, v[104:107]
  s_branch TFL1_NEAR
TFL1_ARETRY:
  s_mov_b64 exec, vcc
  buffer_load_dwordx4 v[48:51], v1, s[8:11], s42 offen sc1
  s_mov_b64 exec, -1
  buffer_load_dwordx4 v[52:55], v1, s[8:11], s42 offen offset:1024 sc1
  s_waitcnt vmcnt(4)
  v_max3_u32 v0, v48, v49, v50
  v_max_u32 v0, v0, v51
  v_cmp_eq_u32 vcc, -1, v0
  s_cbranch_vccz TFL1_MOK
TFL1_ARETRY2:
  s_mov_b64 exec, vcc
  buffer_load_dwordx4 v[48:51], v1, s[8:11], s42 offen sc1
  s_mov_b64 exec, -1
  buffer_load_dwordx4 v[52:55], v1, s[8:11], s42 offen offset:1024 sc1
  s_sub_u32 s6, s6, 1
  s_cbranch_scc1 GIVEUP
  s_waitcnt vmcnt(3)
  v_max3_u32 v0, v48, v49, v50
  v_max_u32 v0, v0, v51
  v_cmp_eq_u32 vcc, -1, v0
  s_cbranch_vccnz TFL1_ARETRY2
  s_branch TFL1_MOK
TFL1_BRETRY:
TFL1_BRETRY2:
  s_mov_b64 exec, vcc
  buffer_load_dwordx4 v[52:55], v1, s[8:11], s42 offen offset:1024 sc1
  s_sub_u32 s6, s6, 1
  s_cbranch_scc1 GIVEUP
  s_waitcnt vmcnt(1)
  v_max3_u32 v0, v52, v53, v54
  v_max_u32 v0, v0, v55
  v_cmp_eq_u32 vcc, -1, v0
  s_cbranch_vccnz TFL1_BRETRY2
  s_mov_b64 exec, -1
  s_branch TFL1_BOK
TFL1_RRETRY:
  s_mov_b64 exec, vcc
  buffer_load_dwordx4 v[64:67], v1, s[8:11], s45 offen sc1
  buffer_load_dwordx4 v[68:71], v1, s[8:11], s45 offen offset:1024 sc1
  s_mov_b64 exec, -1
  v_mov_b32 v24, 0
  v_mov_b32 v26, 0
  s_sub_u32 s6, s6, 1
  s_cbranch_scc1 GIVEUP
  s_waitcnt vmcnt(2)
  v_max_u32 v0, v64, v68
  v_smfmac_f32_16x16x64_bf16 v[24:27], v[28:31], v[64:71], v15
  v_cmp_eq_u32 vcc, -1, v0
  s_nop 2
  s_cbranch_vccnz TFL1_RRETRY
  s_xor_b32 s45, s45, 0x40000
  v_add_f32_dpp v24, v24, v24 row_ror:4 row_mask:0xf bank_mask:0xf
  v_add_f32_dpp v26, v26, v26 row_ror:4 row_mask:0xf bank_mask:0xf
  s_cmp_eq_u32 s41, 63
  v_add_f32_dpp v24, v24, v24 row_ror:8 row_mask:0xf bank_mask:0xf
  v_add_f32_dpp v26, v26, v26 row_ror:8 row_mask:0xf bank_mask:0xf
  v_cvt_pk_bf16_f32 v18, v24, v26
  buffer_store_dword v18, v14, s[8:11], s43 offen
  s_branch TFL1_RDONE
TFL1_FRETRY:
  buffer_load_dword v17, off, s[8:11], s49 sc1
  s_waitcnt vmcnt(0)
  v_cmp_ne_u32 vcc, 0, v17
  s_cbranch_vccnz TFL1_FOK
  s_sleep 1
  s_sub_u32 s6, s6, 1
  s_cbranch_scc1 GIVEUP
  s_branch TFL1_FRETRY
TS_STEP:
  s_waitcnt vmcnt(3)
  v_max3_u32 v0, v48, v49, v50
  v_max_u32 v0, v0, v51
  v_cmp_eq_u32 vcc, -1, v0
  s_cbranch_vccnz TS_ARETRY
TS_MOK:
  ds_write_b128 v1, v[48:51] offset:0
  v_smfmac_f32_16x16x64_bf16 v[24:27], v[48:51], a[0:7], v15
  v_smfmac_f32_16x16x64_bf16 v[28:31], v[48:51], a[8:15], v15
  v_smfmac_f32_16x16x64_bf16 v[32:35], v[48:51], a[128:135], v15
  v_smfmac_f32_16x16x64_bf16 v[36:39], v[48:51], a[136:143], v15
  s_waitcnt lgkmcnt(0)
  s_barrier
  ds_read_b128 v[56:59], v6 offset:0
  v_smfmac_f32_16x16x64_bf16 v[40:43], v[48:51], v[80:87], v15
  ds_read_b128 v[64:67], v7 offset:0
  s_waitcnt vmcnt(1)
  v_max3_u32 v0, v52, v53, v54
  v_max_u32 v0, v0, v55
  v_cmp_eq_u32 vcc, -1, v0
  v_smfmac_f32_16x16x64_bf16 v[44:47], v[48:51], v[88:95], v15
  ds_read_b128 v[72:75], v8 offset:0
  s_cbranch_vccnz TS_BRETRY
TS_BOK:
  ds_write_b128 v1, v[52:55] offset:1024
  v_smfmac_f32_16x16x64_bf16 v[24:27], v[52:55], a[16:23], v15
  buffer_store_dword v18, v14, s[8:11], s44 offen sc1
  v_smfmac_f32_16x16x64_bf16 v[28:31], v[52:55], a[24:31], v15
  buffer_store_dword v17, v14, s[8:11], s43 offen sc1
  v_smfmac_f32_16x16x64_bf16 v[32:35], v[52:55], a[144:151], v15
  buffer_store_dword v17, v1, s[8:11], s46 offen sc1
  v_smfmac_f32_16x16x64_bf16 v[36:39], v[52:55], a[152:159], v15
  s_waitcnt lgkmcnt(0)
  s_barrier
  ds_read_b128 v[60:63], v6 offset:1024
  buffer_store_dword v17, v1, s[8:11], s46 offen offset:1024 sc1
  v_smfmac_f32_16x16x64_bf16 v[40:43], v[52:55], v[96:103], v15
  ds_read_b128 v[68:71], v7 offset:1024
  v_smfmac_f32_16x16x64_bf16 v[44:47], v[52:55], v[104:111], v15
  ds_read_b128 v[76:79], v8 offset:1024
  v_smfmac_f32_16x16x64_bf16 v[24:27], v[56:59], a[32:39], v15
  ds_read_b128 v[80:83], v3 offset:2048
  buffer_load_dwordx4 v[120:123], v1, s[8:11], s51 offen offset:0 sc1
  v_smfmac_f32_16x16x64_bf16 v[28:31], v[56:59], a[40:47], v15
  ds_read_b128 v[84:87], v3 offset:3072
  v_smfmac_f32_16x16x64_bf16 v[24:27], v[64:67], a[64:71], v15
  ds_read_b128 v[88:91], v3 offset:16384
  v_smfmac_f32_16x16x64_bf16 v[28:31], v[64:67], a[72:79], v15
  ds_read_b128 v[92:95], v3 offset:17408
  v_smfmac_f32_16x16x64_bf16 v[24:27], v[72:75], a[96:103], v15
  ds_read_b128 v[96:99], v3 offset:18432
  v_smfmac_f32_16x16x64_bf16 v[28:31], v[72:75], a[104:111], v15
  ds_read_b128 v[100:103], v3 offset:19456
  s_waitcnt lgkmcnt(5)
  v_smfmac_f32_16x16x64_bf16 v[24:27], v[60:63], a[48:55], v15
  ds_read_b128 v[104:107], v4 offset:0
  buffer_load_dwordx4 v[124:127], v1, s[8:11], s51 offen offset:1024 sc1
  v_smfmac_f32_16x16x64_bf16 v[24:27], v[68:71], a[80:87], v15
  ds_read_b128 v[108:111], v4 offset:1024
  s_xor_b32 s42, s42, 0x2000
  s_add_u32 s41, s41, 1
  v_smfmac_f32_16x16x64_bf16 v[24:27], v[76:79], a[112:119], v15
  s_add_u32 s44, s44, 0x2000
  s_xor_b32 s46, s46, 0x40000
  v_smfmac_f32_16x16x64_bf16 v[28:31], v[60:63], a[56:63], v15
  v_smfmac_f32_16x16x64_bf16 v[28:31], v[68:71], a[88:95], v15
  v_mul_f32 v26, s52, v26
  v_mul_f32 v27, s52, v27
  v_smfmac_f32_16x16x64_bf16 v[28:31], v[76:79], a[120:127], v15
  s_waitcnt lgkmcnt(1)
  v_fma_f32 v24, v24, s52, v26
  v_fma_f32 v25, v25, s52, v27
  v_smfmac_f32_16x16x64_bf16 v[44:47], v[56:59], v[80:87], v15
  ds_read_b128 v[80:83], v9 offset:8192
  v_cvt_pk_bf16_f32 v24, v24, v25
  v_smfmac_f32_16x16x64_bf16 v[40:43], v[60:63], v[88:95], v15
  ds_write_b32 v10, v24 offset:4
  v_mul_f32 v30, s52, v30
  v_mul_f32 v31, s52, v31
  v_smfmac_f32_16x16x64_bf16 v[44:47], v[60:63], v[96:103], v15
  ds_read_b128 v[84:87], v9 offset:9216
  v_fma_f32 v28, v28, s52, v30
  v_fma_f32 v29, v29, s52, v31
  v_smfmac_f32_16x16x64_bf16 v[40:43], v[56:59], v[112:119], v15
  ds_read_b128 v[88:91], v9 offset:10240
  s_waitcnt lgkmcnt(4)
  v_cvt_pk_bf16_f32 v28, v28, v29
  v_smfmac_f32_16x16x64_bf16 v[40:43], v[64:67], v[104:111], v15
  ds_write_b32 v10, v28 offset:516
  v_smfmac_f32_16x16x64_bf16 v[32:35], v[56:59], a[160:167], v15
  ds_read_b128 v[92:95], v9 offset:11264
  v_lshrrev_b32 v19, 1, v9
  v_smfmac_f32_16x16x64_bf16 v[32:35], v[60:63], a[176:183], v15
  ds_read_b128 v[96:99], v9 offset:12288
  s_waitcnt vmcnt(6)
  v_smfmac_f32_16x16x64_bf16 v[32:35], v[64:67], a[192:199], v15
  s_waitcnt lgkmcnt(2)
  s_barrier
  v_smfmac_f32_16x16x64_bf16 v[36:39], v[56:59], a[168:175], v15
  ds_read_b64_tr_b16 v[108:109], v11 offset:1024
  v_smfmac_f32_16x16x64_bf16 v[32:35], v[68:71], a[208:215], v15
  ds_read_b64_tr_b16 v[48:49], v11 offset:2048
  ds_read_b128 v[100:103], v9 offset:13312
  v_smfmac_f32_16x16x64_bf16 v[32:35], v[72:75], a[224:231], v15
  ds_read_b64_tr_b16 v[50:51], v11 offset:2560
  v_mov_b64 v[56:57], s[54:55]
  v_smfmac_f32_16x16x64_bf16 v[32:35], v[76:79], a[240:247], v15
  ds_read_b64_tr_b16 v[104:105], v11 offset:0
  ds_read_b64_tr_b16 v[110:111], v11 offset:1536
  v_smfmac_f32_16x16x64_bf16 v[36:39], v[60:63], a[184:191], v15
  ds_read_b64_tr_b16 v[106:107], v11 offset:512
  ds_read_b128 v[112:115], v9 offset:14336
  v_smfmac_f32_16x16x64_bf16 v[36:39], v[64:67], a[200:207], v15
  ds_read_b64_tr_b16 v[52:53], v11 offset:3072
  v_add_f32 v32, v32, v34
  v_smfmac_f32_16x16x64_bf16 v[36:39], v[68:71], a[216:223], v15
  ds_read_b128 v[116:119], v9 offset:15360
  v_add_f32 v33, v33, v35
  v_smfmac_f32_16x16x64_bf16 v[36:39], v[72:75], a[232:239], v15
  ds_read_b64_tr_b16 v[54:55], v11 offset:3584
  v_cvt_pk_bf16_f32 v32, v32, v33
  v_smfmac_f32_16x16x64_bf16 v[36:39], v[76:79], a[248:255], v15
  ds_write_b32 v16, v32 offset:0
  s_waitcnt lgkmcnt(5)
  v_mfma_f32_16x16x32_bf16 v[28:31], v[84:87], v[104:107], 0
  ds_read_b128 v[84:87], v4 offset:3072
  v_mov_b64 v[58:59], s[54:55]
  v_mfma_f32_16x16x32_bf16 v[24:27], v[80:83], v[104:107], 0
  ds_read_b128 v[80:83], v4 offset:2048
  v_add_f32 v37, v37, v39
  v_mfma_f32_16x16x32_bf16 v[24:27], v[88:91], v[108:111], v[24:27]
  ds_read_b128 v[88:91], v4 offset:16384
  v_add_f32 v36, v36, v38
  v_cvt_pk_bf16_f32 v36, v36, v37
  v_mfma_f32_16x16x32_bf16 v[28:31], v[92:95], v[108:111], v[28:31]
  ds_read_b128 v[92:95], v4 offset:17408
  ds_write_b32 v16, v36 offset:64
  v_mfma_f32_16x16x32_bf16 v[24:27], v[96:99], v[48:51], v[24:27]
  s_waitcnt lgkmcnt(5)
  v_mov_b32 v61, 0
  v_mfma_f32_16x16x32_bf16 v[24:27], v[112:115], v[52:55], v[24:27]
  ds_read_b128 v[112:115], v5 offset:0
  v_mfma_f32_16x16x32_bf16 v[28:31], v[100:103], v[48:51], v[28:31]
  ds_read_b128 v[96:99], v4 offset:18432
  ds_read_b128 v[100:103], v4 offset:19456
  v_mfma_f32_16x16x32_bf16 v[28:31], v[116:119], v[52:55], v[28:31]
  ds_read_b128 v[116:119], v5 offset:1024
  v_exp_f32 v27, v27
  v_exp_f32 v24, v24
  v_exp_f32 v26, v26
  v_exp_f32 v25, v25
  s_waitcnt lgkmcnt(4)
  v_smfmac_f32_16x16x64_bf16 v[40:43], v[68:71], v[88:95], v15
  s_barrier
  ds_read_b64_tr_b16 v[32:33], v19 offset:0
  ds_read_b64_tr_b16 v[36:37], v19 offset:1024
  v_smfmac_f32_16x16x64_bf16 v[44:47], v[64:67], v[80:87], v15
  ds_read_b64_tr_b16 v[38:39], v19 offset:1536
  ds_read_b128 v[92:95], v5 offset:17408
  ds_read_b64_tr_b16 v[34:35], v19 offset:512
  s_waitcnt lgkmcnt(5)
  v_exp_f32 v30, v30
  v_exp_f32 v31, v31
  v_exp_f32 v29, v29
  v_smfmac_f32_16x16x64_bf16 v[44:47], v[68:71], v[96:103], v15
  ds_read_b128 v[80:83], v5 offset:2048
  ds_read_b128 v[88:91], v5 offset:16384
  v_smfmac_f32_16x16x64_bf16 v[40:43], v[72:75], v[112:119], v15
  ds_read_b128 v[84:87], v5 offset:3072
  v_exp_f32 v28, v28
  v_cvt_pk_bf16_f32 v24, v24, v25
  s_waitcnt lgkmcnt(3)
  v_smfmac_f32_16x16x64_bf16 v[20:23], v[32:35], v[104:111], v15
  ds_read_b128 v[100:103], v5 offset:19456
  v_cvt_pk_bf16_f32 v25, v26, v27
  v_cvt_pk_bf16_f32 v27, v30, v31
  v_smfmac_f32_16x16x64_bf16 v[20:23], v[36:39], v[48:55], v15
  ds_read_b128 v[96:99], v5 offset:18432
  v_cvt_pk_bf16_f32 v26, v28, v29
  s_waitcnt lgkmcnt(3)
  v_smfmac_f32_16x16x64_bf16 v[40:43], v[76:79], v[88:95], v15
  buffer_load_dwordx4 v[32:35], v1, s[8:11], s50 offen offset:0 sc1
  v_mfma_f32_16x16x32_bf16 v[28:31], v[56:59], v[24:27], 0
  s_waitcnt lgkmcnt(2)
  v_add_f32 v20, v20, v22
  v_exp_f32 v22, v20
  v_add_f32 v21, v21, v23
  v_exp_f32 v23, v21
  v_smfmac_f32_16x16x64_bf16 v[44:47], v[72:75], v[80:87], v15
  s_waitcnt vmcnt(1)
  v_mfma_f32_16x16x32_bf16 v[104:107], v[120:123], v[24:27], 0
  s_waitcnt lgkmcnt(0)
  v_add_f32 v41, v41, v43
  v_cvt_pk_bf16_f32 v60, v22, v23
  v_smfmac_f32_16x16x64_bf16 v[44:47], v[76:79], v[96:103], v15
  buffer_load_dword v17, off, s[8:11], s49 sc1
  v_mfma_f32_16x16x32_bf16 v[108:111], v[124:127], v[24:27], 0
  v_add_f32 v40, v40, v42
  v_cvt_pk_bf16_f32 v52, v40, v41
  v_mfma_f32_16x16x16_bf16 v[28:31], v[56:57], v[60:61], v[28:31]
  v_add_f32 v45, v45, v47
  v_add_f32 v44, v44, v46
  v_cvt_pk_bf16_f32 v54, v44, v45
  v_mfma_f32_16x16x16_bf16 v[104:107], v[52:53], v[60:61], v[104:107]
  buffer_load_dwordx4 v[36:39], v1, s[8:11], s50 offen offset:1024 sc1
  v_mfma_f32_16x16x16_bf16 v[108:111], v[54:55], v[60:61], v[108:111]
  v_rcp_f32 v0, v28
  s_nop 2
  v_pk_mul_f32 v[104:105], v[104:105], v[0:1] op_sel_hi:[1,0]
  v_pk_mul_f32 v[106:107], v[106:107], v[0:1] op_sel_hi:[1,0]
  v_cvt_pk_bf16_f32 v104, v104, v105
  v_cvt_pk_bf16_f32 v105, v106, v107
  v_pk_mul_f32 v[108:109], v[108:109], v[0:1] op_sel_hi:[1,0]
  v_pk_mul_f32 v[110:111], v[110:111], v[0:1] op_sel_hi:[1,0]
  v_cvt_pk_bf16_f32 v106, v108, v109
  v_cvt_pk_bf16_f32 v107, v110, v111
  ds_write_b128 v12, v[104:107]
  v_subrev_u32 v18, 0x1f800000, v28
  v_cmp_lt_u32 vcc, 0x40000000, v18
  v_mov_b64 v[72:73], 0
  v_mov_b64 v[74:75], 0
  v_mov_b64 v[76:77], 0
  v_mov_b64 v[78:79], 0
  s_cbranch_vccnz TS_FAR
TS_NEAR:
  v_mov_b64 v[64:65], 0
  v_mov_b64 v[66:67], 0
  v_mov_b64 v[68:69], 0
  v_mov_b64 v[70:71], 0
  v_mov_b64 v[48:49], 0
  v_mov_b64 v[50:51], 0
  v_mov_b64 v[52:53], 0
  v_mov_b64 v[54:55], 0
  s_waitcnt vmcnt(5) lgkmcnt(0)
  s_barrier
  ds_read_b128 v[104:107], v9 offset:20480
  ds_read_b128 v[108:111], v9 offset:21504
  v_mov_b64 v[56:57], 0
  v_mov_b64 v[58:59], 0
  v_mov_b64 v[60:61], 0
  v_mov_b64 v[62:63], 0
  s_add_u32 s50, s50, 262144
  s_add_u32 s51, s51, 262144
  s_waitcnt lgkmcnt(1)
  v_smfmac_f32_16x16x64_bf16 v[48:51], v[104:107], v[128:135], v15
  v_smfmac_f32_16x16x64_bf16 v[52:55], v[104:107], v[144:151], v15
  s_waitcnt lgkmcnt(0)
  v_smfmac_f32_16x16x64_bf16 v[48:51], v[108:111], v[136:143], v15
  v_smfmac_f32_16x16x64_bf16 v[52:55], v[108:111], v[152:159], v15
  v_smfmac_f32_16x16x64_bf16 v[56:59], v[104:107], v[160:167], v15
  v_smfmac_f32_16x16x64_bf16 v[60:63], v[104:107], v[176:183], v15
  v_add_f32 v48, v48, v50
  v_add_f32 v49, v49, v51
  v_smfmac_f32_16x16x64_bf16 v[56:59], v[108:111], v[168:175], v15
  v_cvt_pk_bf16_f32 v20, v48, v49
  v_smfmac_f32_16x16x64_bf16 v[60:63], v[108:111], v[184:191], v15
  v_add_f32 v52, v52, v54
  v_add_f32 v53, v53, v55
  v_smfmac_f32_16x16x64_bf16 v[64:67], v[104:107], v[192:199], v15
  v_cvt_pk_bf16_f32 v21, v52, v53
  v_smfmac_f32_16x16x64_bf16 v[68:71], v[104:107], v[208:215], v15
  v_add_f32 v56, v56, v58
  v_add_f32 v57, v57, v59
  v_smfmac_f32_16x16x64_bf16 v[64:67], v[108:111], v[200:207], v15
  v_cvt_pk_bf16_f32 v22, v56, v57
  v_smfmac_f32_16x16x64_bf16 v[68:71], v[108:111], v[216:223], v15
  v_add_f32 v60, v60, v62
  v_add_f32 v61, v61, v63
  v_smfmac_f32_16x16x64_bf16 v[72:75], v[104:107], v[224:231], v15
  v_cvt_pk_bf16_f32 v23, v60, v61
  buffer_store_dwordx4 v[20:23], v13, s[8:11], s47 offen sc1
  v_smfmac_f32_16x16x64_bf16 v[76:79], v[104:107], v[240:247], v15
  v_add_f32 v64, v64, v66
  v_add_f32 v65, v65, v67
  v_smfmac_f32_16x16x64_bf16 v[72:75], v[108:111], v[232:239], v15
  v_cvt_pk_bf16_f32 v24, v64, v65
  v_smfmac_f32_16x16x64_bf16 v[76:79], v[108:111], v[248:255], v15
  v_add_f32 v68, v68, v70
  v_add_f32 v69, v69, v71
  v_cvt_pk_bf16_f32 v25, v68, v69
  v_add_f32 v72, v72, v74
  v_add_f32 v73, v73, v75
  v_cvt_pk_bf16_f32 v26, v72, v73
  v_add_f32 v76, v76, v78
  v_add_f32 v77, v77, v79
  v_cvt_pk_bf16_f32 v27, v76, v77
  buffer_store_dwordx4 v[24:27], v13, s[8:11], s48 offen sc1
  s_xor_b32 s47, s47, 0x40000
  s_xor_b32 s48, s48, 0x40000
  v_lshrrev_b32 v0, 2, v9
  v_and_b32 v0, 16, v0
  v_lshlrev_b32 v0, v0, s53
  v_cndmask_b32 v28, 0, v0, s[64:65]
  v_cndmask_b32 v29, 0, v0, s[66:67]
  v_cndmask_b32 v30, 0, v0, s[68:69]
  v_cndmask_b32 v31, 0, v0, s[70:71]
  v_mov_b32 v24, 0
  v_mov_b32 v26, 0
  v_mov_b64 v[40:41], 0
  v_mov_b64 v[42:43], 0
  v_mov_b64 v[44:45], 0
  v_mov_b64 v[46:47], 0
  v_mov_b64 v[20:21], 0
  v_mov_b64 v[22:23], 0
  s_waitcnt vmcnt(2)
  ds_write_b128 v1, v[32:35] offset:8192
  ds_write_b128 v1, v[36:39] offset:9216
  s_nop 15
  s_nop 15
  s_nop 15
  s_nop 11
  buffer_load_dwordx4 v[64:67], v1, s[8:11], s45 offen sc1
  buffer_load_dwordx4 v[68:71], v1, s[8:11], s45 offen offset:1024 sc1
  s_nop 15
  s_nop 11
  buffer_load_dwordx4 v[64:67], v1, s[8:11], s45 offen sc1
  buffer_load_dwordx4 v[68:71], v1, s[8:11], s45 offen offset:1024 sc1
  v_cmp_eq_u32 vcc, 0, v17
  s_add_u32 s33, s49, 16
  s_cbranch_vccnz TS_FRETRY
TS_FOK:
  s_min_u32 s49, s33, s56
  v_mov_b32 v17, -1
  s_waitcnt vmcnt(2)
TS_ROK:
  v_max_u32 v0, v64, v68
  v_smfmac_f32_16x16x64_bf16 v[24:27], v[28:31], v[64:71], v15
  v_cmp_eq_u32 vcc, -1, v0
  s_nop 2
  s_cbranch_vccnz TS_RRETRY
  s_xor_b32 s45, s45, 0x40000
  v_add_f32_dpp v24, v24, v24 row_ror:4 row_mask:0xf bank_mask:0xf
  v_add_f32_dpp v26, v26, v26 row_ror:4 row_mask:0xf bank_mask:0xf
  s_cmp_eq_u32 s41, 63
  v_add_f32_dpp v24, v24, v24 row_ror:8 row_mask:0xf bank_mask:0xf
  v_add_f32_dpp v26, v26, v26 row_ror:8 row_mask:0xf bank_mask:0xf
  v_cvt_pk_bf16_f32 v18, v24, v26
  buffer_store_dword v18, v14, s[8:11], s43 offen sc1
TS_RDONE:
  s_cbranch_scc1 TS_LAST
  s_xor_b32 s43, s43, 0x2000
  s_barrier
  v_mov_b64 v[24:25], 0
  v_mov_b64 v[26:27], 0
  v_mov_b64 v[28:29], 0
  v_mov_b64 v[30:31], 0
  s_nop 7
  buffer_load_dwordx4 v[48:51], v1, s[8:11], s42 offen sc1
  v_mov_b64 v[32:33], 0
  v_mov_b64 v[34:35], 0
  v_mov_b64 v[36:37], 0
  v_mov_b64 v[38:39], 0
  ds_read_b128 v[80:83], v2 offset:0
  ds_read_b128 v[84:87], v2 offset:1024
  ds_read_b128 v[104:107], v2 offset:18432
  ds_read_b128 v[108:111], v2 offset:19456
  s_nop 15
  buffer_load_dwordx4 v[48:51], v1, s[8:11], s42 offen sc1
  ds_read_b128 v[112:115], v3 offset:0
  ds_read_b128 v[116:119], v3 offset:1024
  buffer_load_dwordx4 v[52:55], v1, s[8:11], s42 offen offset:1024 sc1
  ds_read_b128 v[88:91], v2 offset:2048
  ds_read_b128 v[92:95], v2 offset:3072
  ds_read_b128 v[96:99], v2 offset:16384
  ds_read_b128 v[100:103], v2 offset:17408
  buffer_load_dwordx4 v[52:55], v1, s[8:11], s42 offen offset:1024 sc1
  s_branch TS_STEP
TS_LAST:
  buffer_store_dword v18, v14, s[8:11], s44 offen sc1
  s_waitcnt vmcnt(0)
  s_waitcnt vmcnt(0)
  s_endpgm
TS_FAR:
  s_nop 15
  ds_read_b64_tr_b16 v[80:81], v11 offset:0
  ds_read_b64_tr_b16 v[82:83], v11 offset:512
  ds_read_b64_tr_b16 v[84:85], v11 offset:1024
  ds_read_b64_tr_b16 v[86:87], v11 offset:1536
  ds_read_b64_tr_b16 v[88:89], v11 offset:2048
  ds_read_b64_tr_b16 v[90:91], v11 offset:2560
  ds_read_b64_tr_b16 v[92:93], v11 offset:3072
  ds_read_b64_tr_b16 v[94:95], v11 offset:3584
  s_waitcnt lgkmcnt(0)
  ds_read_b128 v[96:99], v9 offset:8192
  ds_read_b128 v[100:103], v9 offset:9216
  ds_read_b128 v[104:107], v9 offset:10240
  ds_read_b128 v[108:111], v9 offset:11264
  ds_read_b128 v[112:115], v9 offset:12288
  ds_read_b128 v[116:119], v9 offset:13312
  ds_read_b128 v[64:67], v9 offset:14336
  ds_read_b128 v[68:71], v9 offset:15360
  ds_read_b64_tr_b16 v[40:41], v19 offset:0
  ds_read_b64_tr_b16 v[42:43], v19 offset:512
  ds_read_b64_tr_b16 v[44:45], v19 offset:1024
  ds_read_b64_tr_b16 v[46:47], v19 offset:1536
  v_mov_b64 v[20:21], 0
  v_mov_b64 v[22:23], 0
  s_waitcnt lgkmcnt(0)
  v_mfma_f32_16x16x32_bf16 v[24:27], v[96:99], v[80:83], 0
  v_mfma_f32_16x16x32_bf16 v[28:31], v[100:103], v[80:83], 0
  v_mfma_f32_16x16x32_bf16 v[24:27], v[104:107], v[84:87], v[24:27]
  v_mfma_f32_16x16x32_bf16 v[28:31], v[108:111], v[84:87], v[28:31]
  v_mfma_f32_16x16x32_bf16 v[24:27], v[112:115], v[88:91], v[24:27]
  v_mfma_f32_16x16x32_bf16 v[28:31], v[116:119], v[88:91], v[28:31]
  v_mfma_f32_16x16x32_bf16 v[24:27], v[64:67], v[92:95], v[24:27]
  v_mfma_f32_16x16x32_bf16 v[28:31], v[68:71], v[92:95], v[28:31]
  v_smfmac_f32_16x16x64_bf16 v[20:23], v[40:43], v[80:87], v15
  v_smfmac_f32_16x16x64_bf16 v[20:23], v[44:47], v[88:95], v15
  s_nop 7
  v_add_f32 v20, v20, v22
  v_add_f32 v21, v21, v23
  v_max3_f32 v0, v24, v25, v26
  v_max3_f32 v0, v0, v27, v28
  v_max3_f32 v0, v0, v29, v30
  v_max3_f32 v0, v0, v31, v20
  v_max_f32 v0, v0, v21
  v_mov_b32 v18, v0
  s_nop 1
  v_permlane32_swap_b32 v0, v18
  v_max_f32 v0, v0, v18
  v_mov_b32 v18, v0
  s_nop 1
  v_permlane16_swap_b32 v0, v18
  v_max_f32 v0, v0, v18
  v_sub_f32 v24, v24, v0
  v_sub_f32 v25, v25, v0
  v_sub_f32 v26, v26, v0
  v_sub_f32 v27, v27, v0
  v_sub_f32 v28, v28, v0
  v_sub_f32 v29, v29, v0
  v_sub_f32 v30, v30, v0
  v_sub_f32 v31, v31, v0
  v_sub_f32 v20, v20, v0
  v_sub_f32 v21, v21, v0
  v_exp_f32 v24, v24
  v_exp_f32 v25, v25
  v_exp_f32 v26, v26
  v_exp_f32 v27, v27
  v_exp_f32 v28, v28
  v_exp_f32 v29, v29
  v_exp_f32 v30, v30
  v_exp_f32 v31, v31
  v_exp_f32 v22, v20
  v_exp_f32 v23, v21
  s_nop 0
  v_cvt_pk_bf16_f32 v60, v22, v23
  v_cvt_pk_bf16_f32 v24, v24, v25
  v_cvt_pk_bf16_f32 v25, v26, v27
  v_cvt_pk_bf16_f32 v26, v28, v29
  v_cvt_pk_bf16_f32 v27, v30, v31
  s_nop 1
  v_mfma_f32_16x16x32_bf16 v[28:31], v[56:59], v[24:27], 0
  v_mfma_f32_16x16x32_bf16 v[104:107], v[120:123], v[24:27], 0
  v_mfma_f32_16x16x32_bf16 v[108:111], v[124:127], v[24:27], 0
  v_mfma_f32_16x16x16_bf16 v[28:31], v[56:57], v[60:61], v[28:31]
  v_mfma_f32_16x16x16_bf16 v[104:107], v[52:53], v[60:61], v[104:107]
  v_mfma_f32_16x16x16_bf16 v[108:111], v[54:55], v[60:61], v[108:111]
  v_rcp_f32 v0, v28
  s_nop 2
  v_pk_mul_f32 v[104:105], v[104:105], v[0:1] op_sel_hi:[1,0]
  v_pk_mul_f32 v[106:107], v[106:107], v[0:1] op_sel_hi:[1,0]
  v_cvt_pk_bf16_f32 v104, v104, v105
  v_cvt_pk_bf16_f32 v105, v106, v107
  s_nop 2
  v_pk_mul_f32 v[108:109], v[108:109], v[0:1] op_sel_hi:[1,0]
  v_pk_mul_f32 v[110:111], v[110:111], v[0:1] op_sel_hi:[1,0]
  v_cvt_pk_bf16_f32 v106, v108, v109
  v_cvt_pk_bf16_f32 v107, v110, v111
  ds_write_b128 v12, v[104:107]
  s_branch TS_NEAR
TS_ARETRY:
  s_mov_b64 exec, vcc
  buffer_load_dwordx4 v[48:51], v1, s[8:11], s42 offen sc1
  s_mov_b64 exec, -1
  buffer_load_dwordx4 v[52:55], v1, s[8:11], s42 offen offset:1024 sc1
  s_waitcnt vmcnt(4)
  v_max3_u32 v0, v48, v49, v50
  v_max_u32 v0, v0, v51
  v_cmp_eq_u32 vcc, -1, v0
  s_cbranch_vccz TS_MOK
TS_ARETRY2:
  s_mov_b64 exec, vcc
  buffer_load_dwordx4 v[48:51], v1, s[8:11], s42 offen sc1
  s_mov_b64 exec, -1
  buffer_load_dwordx4 v[52:55], v1, s[8:11], s42 offen offset:1024 sc1
  s_sub_u32 s6, s6, 1
  s_cbranch_scc1 GIVEUP
  s_waitcnt vmcnt(3)
  v_max3_u32 v0, v48, v49, v50
  v_max_u32 v0, v0, v51
  v_cmp_eq_u32 vcc, -1, v0
  s_cbranch_vccnz TS_ARETRY2
  s_branch TS_MOK
TS_BRETRY:
TS_BRETRY2:
  s_mov_b64 exec, vcc
  buffer_load_dwordx4 v[52:55], v1, s[8:11], s42 offen offset:1024 sc1
  s_sub_u32 s6, s6, 1
  s_cbranch_scc1 GIVEUP
  s_waitcnt vmcnt(1)
  v_max3_u32 v0, v52, v53, v54
  v_max_u32 v0, v0, v55
  v_cmp_eq_u32 vcc, -1, v0
  s_cbranch_vccnz TS_BRETRY2
  s_mov_b64 exec, -1
  s_branch TS_BOK
TS_RRETRY:
  s_mov_b64 exec, vcc
  buffer_load_dwordx4 v[64:67], v1, s[8:11], s45 offen sc1
  buffer_load_dwordx4 v[68:71], v1, s[8:11], s45 offen offset:1024 sc1
  s_mov_b64 exec, -1
  v_mov_b32 v24, 0
  v_mov_b32 v26, 0
  s_sub_u32 s6, s6, 1
  s_cbranch_scc1 GIVEUP
  s_waitcnt vmcnt(2)
  v_max_u32 v0, v64, v68
  v_smfmac_f32_16x16x64_bf16 v[24:27], v[28:31], v[64:71], v15
  v_cmp_eq_u32 vcc, -1, v0
  s_nop 2
  s_cbranch_vccnz TS_RRETRY
  s_xor_b32 s45, s45, 0x40000
  v_add_f32_dpp v24, v24, v24 row_ror:4 row_mask:0xf bank_mask:0xf
  v_add_f32_dpp v26, v26, v26 row_ror:4 row_mask:0xf bank_mask:0xf
  s_cmp_eq_u32 s41, 63
  v_add_f32_dpp v24, v24, v24 row_ror:8 row_mask:0xf bank_mask:0xf
  v_add_f32_dpp v26, v26, v26 row_ror:8 row_mask:0xf bank_mask:0xf
  v_cvt_pk_bf16_f32 v18, v24, v26
  buffer_store_dword v18, v14, s[8:11], s43 offen sc1
  s_branch TS_RDONE
TS_FRETRY:
  buffer_load_dword v17, off, s[8:11], s49 sc1
  s_waitcnt vmcnt(0)
  v_cmp_ne_u32 vcc, 0, v17
  s_cbranch_vccnz TS_FOK
  s_sleep 1
  s_sub_u32 s6, s6, 1
  s_cbranch_scc1 GIVEUP
  s_branch TS_FRETRY
ATT_ROLE:
  s_mov_b32 s20, s70
  s_mov_b32 s21, s71
  s_mov_b32 s22, 4194304
  s_mov_b32 s23, 0x00020000
  s_mov_b32 s24, s72
  s_mov_b32 s25, s73
  s_mov_b32 s26, 4194304
  s_mov_b32 s27, 0x00020000
  v_bfe_u32 v10, v0, 4, 1
  v_lshlrev_b32 v10, 14, v10
  v_lshrrev_b32 v11, 5, v0
  v_lshlrev_b32 v11, 12, v11
  v_and_b32 v12, 15, v0
  v_lshlrev_b32 v13, 3, v12
  s_lshl_b32 s33, s3, 8
  v_add3_u32 v10, v10, v11, v13
  v_add_u32 v1, s33, v10
  v_lshrrev_b32 v10, 4, v0
  v_lshrrev_b32 v11, 1, v12
  v_xor_b32 v11, v11, v10
  v_lshlrev_b32 v11, 5, v11
  v_and_b32 v13, 1, v0
  v_lshlrev_b32 v13, 4, v13
  v_lshlrev_b32 v10, 13, v10
  v_add3_u32 v10, v10, v11, v13
  s_lshl_b32 s33, s3, 17
  v_add_u32 v2, s33, v10
  v_xor_b32 v3, 0x80, v2
  v_bfe_u32 v10, v0, 2, 2
  v_lshrrev_b32 v11, 4, v0
  v_lshlrev_b32 v13, 3, v11
  v_add_u32 v13, v13, v10
  v_lshlrev_b32 v13, 8, v13
  v_and_b32 v11, 1, v11
  v_lshlrev_b32 v11, 2, v11
  v_add_u32 v10, v10, v11
  s_lshl_b32 s33, s3, 1
  v_xor_b32 v10, s33, v10
  v_lshlrev_b32 v10, 5, v10
  v_and_b32 v11, 3, v0
  v_lshlrev_b32 v11, 3, v11
  v_add3_u32 v10, v10, v11, v13
  v_add_u32 v4, 32768, v10
  v_xor_b32 v5, 32, v4
  v_add_u32 v6, 0x10000, v4
  v_add_u32 v7, 0x10000, v5
  s_lshl_b32 s33, s3, 12
  s_add_u32 s33, s33, 32768
  v_lshlrev_b32 v10, 4, v0
  v_add_u32 v8, s33, v10
  v_add_u32 v9, 0x10000, v8
  s_lshl_b32 s36, s5, 17
  s_lshl_b32 s37, s5, 8
  s_lshl_b32 s38, s3, 12
  s_add_u32 s38, s38, 32768
  s_mov_b32 s39, 0x05040100
  s_mov_b32 s40, 0x07060302
  s_cmp_eq_u32 s3, 1
  s_cbranch_scc1 LDW1_18
  s_cmp_eq_u32 s3, 2
  s_cbranch_scc1 LDW2_19
  s_cmp_eq_u32 s3, 3
  s_cbranch_scc1 LDW3_20
LDW0_17:
  s_add_u32 s33, s37, 0
  s_add_u32 m0, s38, 0
  s_nop 0
  buffer_load_dwordx4 v2, s[20:23], s33 offen lds
  s_add_u32 s33, s37, 32768
  s_add_u32 m0, s38, 1024
  s_nop 0
  buffer_load_dwordx4 v2, s[20:23], s33 offen lds
  s_add_u32 s33, s37, 65536
  s_add_u32 m0, s38, 2048
  s_nop 0
  buffer_load_dwordx4 v3, s[20:23], s33 offen lds
  s_add_u32 s33, s37, 98304
  s_add_u32 m0, s38, 3072
  s_nop 0
  buffer_load_dwordx4 v3, s[20:23], s33 offen lds
  s_add_u32 s33, s37, 524288
  s_add_u32 m0, s38, 16384
  s_nop 0
  buffer_load_dwordx4 v2, s[20:23], s33 offen lds
  s_add_u32 s33, s37, 557056
  s_add_u32 m0, s38, 17408
  s_nop 0
  buffer_load_dwordx4 v2, s[20:23], s33 offen lds
  s_add_u32 s33, s37, 589824
  s_add_u32 m0, s38, 18432
  s_nop 0
  buffer_load_dwordx4 v3, s[20:23], s33 offen lds
  s_add_u32 s33, s37, 622592
  s_add_u32 m0, s38, 19456
  s_nop 0
  buffer_load_dwordx4 v3, s[20:23], s33 offen lds
  s_add_u32 s33, s37, 1048576
  s_add_u32 m0, s38, 32768
  s_nop 0
  buffer_load_dwordx4 v2, s[20:23], s33 offen lds
  s_add_u32 s33, s37, 1081344
  s_add_u32 m0, s38, 33792
  s_nop 0
  buffer_load_dwordx4 v2, s[20:23], s33 offen lds
  s_add_u32 s33, s37, 1114112
  s_add_u32 m0, s38, 34816
  s_nop 0
  buffer_load_dwordx4 v3, s[20:23], s33 offen lds
  s_add_u32 s33, s37, 1146880
  s_add_u32 m0, s38, 35840
  s_nop 0
  buffer_load_dwordx4 v3, s[20:23], s33 offen lds
  s_add_u32 s33, s37, 1572864
  s_add_u32 m0, s38, 49152
  s_nop 0
  buffer_load_dwordx4 v2, s[20:23], s33 offen lds
  s_add_u32 s33, s37, 1605632
  s_add_u32 m0, s38, 50176
  s_nop 0
  buffer_load_dwordx4 v2, s[20:23], s33 offen lds
  s_add_u32 s33, s37, 1638400
  s_add_u32 m0, s38, 51200
  s_nop 0
  buffer_load_dwordx4 v3, s[20:23], s33 offen lds
  s_add_u32 s33, s37, 1671168
  s_add_u32 m0, s38, 52224
  s_nop 0
  buffer_load_dwordx4 v3, s[20:23], s33 offen lds
  s_add_u32 s33, s37, 2097152
  s_add_u32 m0, s38, 65536
  s_nop 0
  buffer_load_dwordx4 v2, s[20:23], s33 offen lds
  s_add_u32 s33, s37, 2129920
  s_add_u32 m0, s38, 66560
  s_nop 0
  buffer_load_dwordx4 v2, s[20:23], s33 offen lds
  s_add_u32 s33, s37, 2162688
  s_add_u32 m0, s38, 67584
  s_nop 0
  buffer_load_dwordx4 v3, s[20:23], s33 offen lds
  s_add_u32 s33, s37, 2195456
  s_add_u32 m0, s38, 68608
  s_nop 0
  buffer_load_dwordx4 v3, s[20:23], s33 offen lds
  s_add_u32 s33, s37, 2621440
  s_add_u32 m0, s38, 81920
  s_nop 0
  buffer_load_dwordx4 v2, s[20:23], s33 offen lds
  s_add_u32 s33, s37, 2654208
  s_add_u32 m0, s38, 82944
  s_nop 0
  buffer_load_dwordx4 v2, s[20:23], s33 offen lds
  s_add_u32 s33, s37, 2686976
  s_add_u32 m0, s38, 83968
  s_nop 0
  buffer_load_dwordx4 v3, s[20:23], s33 offen lds
  s_add_u32 s33, s37, 2719744
  s_add_u32 m0, s38, 84992
  s_nop 0
  buffer_load_dwordx4 v3, s[20:23], s33 offen lds
  s_waitcnt vmcnt(20)
  s_barrier
  s_cmp_lg_u32 s3, 0
  s_cbranch_scc1 SIG_21
  s_lshl_b32 s33, s4, 2
  v_mov_b32 v10, s32
  s_mov_b64 exec, 1
  buffer_atomic_add v10, off, s[12:15], s33 offset:160 sc1
  s_mov_b64 exec, -1
SIG_21:
  ds_read_b64_tr_b16 a[0:1], v4 offset:0
  ds_read_b64_tr_b16 a[2:3], v4 offset:1024
  ds_read_b64_tr_b16 a[4:5], v4 offset:8192
  ds_read_b64_tr_b16 a[6:7], v4 offset:9216
  ds_read_b64_tr_b16 a[8:9], v5 offset:0
  ds_read_b64_tr_b16 a[10:11], v5 offset:1024
  ds_read_b64_tr_b16 a[12:13], v5 offset:8192
  ds_read_b64_tr_b16 a[14:15], v5 offset:9216
  s_waitcnt lgkmcnt(0)
  s_add_u32 s33, s37, 3145728
  s_add_u32 m0, s38, 98304
  s_nop 0
  buffer_load_dwordx4 v2, s[20:23], s33 offen lds
  s_add_u32 s33, s37, 3178496
  s_add_u32 m0, s38, 99328
  s_nop 0
  buffer_load_dwordx4 v2, s[20:23], s33 offen lds
  s_add_u32 s33, s37, 3211264
  s_add_u32 m0, s38, 100352
  s_nop 0
  buffer_load_dwordx4 v3, s[20:23], s33 offen lds
  s_add_u32 s33, s37, 3244032
  s_add_u32 m0, s38, 101376
  s_nop 0
  buffer_load_dwordx4 v3, s[20:23], s33 offen lds
  s_waitcnt vmcnt(20)
  s_barrier
  ds_read_b64_tr_b16 a[16:17], v4 offset:16384
  ds_read_b64_tr_b16 a[18:19], v4 offset:17408
  ds_read_b64_tr_b16 a[20:21], v4 offset:24576
  ds_read_b64_tr_b16 a[22:23], v4 offset:25600
  ds_read_b64_tr_b16 a[24:25], v5 offset:16384
  ds_read_b64_tr_b16 a[26:27], v5 offset:17408
  ds_read_b64_tr_b16 a[28:29], v5 offset:24576
  ds_read_b64_tr_b16 a[30:31], v5 offset:25600
  s_waitcnt lgkmcnt(0)
  s_add_u32 s33, s37, 3670016
  s_add_u32 m0, s38, 114688
  s_nop 0
  buffer_load_dwordx4 v2, s[20:23], s33 offen lds
  s_add_u32 s33, s37, 3702784
  s_add_u32 m0, s38, 115712
  s_nop 0
  buffer_load_dwordx4 v2, s[20:23], s33 offen lds
  s_add_u32 s33, s37, 3735552
  s_add_u32 m0, s38, 116736
  s_nop 0
  buffer_load_dwordx4 v3, s[20:23], s33 offen lds
  s_add_u32 s33, s37, 3768320
  s_add_u32 m0, s38, 117760
  s_nop 0
  buffer_load_dwordx4 v3, s[20:23], s33 offen lds
  s_waitcnt vmcnt(20)
  s_barrier
  ds_read_b64_tr_b16 a[32:33], v4 offset:32768
  ds_read_b64_tr_b16 a[34:35], v4 offset:33792
  ds_read_b64_tr_b16 a[36:37], v4 offset:40960
  ds_read_b64_tr_b16 a[38:39], v4 offset:41984
  ds_read_b64_tr_b16 a[40:41], v5 offset:32768
  ds_read_b64_tr_b16 a[42:43], v5 offset:33792
  ds_read_b64_tr_b16 a[44:45], v5 offset:40960
  ds_read_b64_tr_b16 a[46:47], v5 offset:41984
  s_waitcnt lgkmcnt(0)
  s_add_u32 s33, s37, 0
  s_add_u32 m0, s38, 0
  s_nop 0
  buffer_load_dwordx4 v2, s[24:27], s33 offen lds
  s_add_u32 s33, s37, 32768
  s_add_u32 m0, s38, 1024
  s_nop 0
  buffer_load_dwordx4 v2, s[24:27], s33 offen lds
  s_add_u32 s33, s37, 65536
  s_add_u32 m0, s38, 2048
  s_nop 0
  buffer_load_dwordx4 v3, s[24:27], s33 offen lds
  s_add_u32 s33, s37, 98304
  s_add_u32 m0, s38, 3072
  s_nop 0
  buffer_load_dwordx4 v3, s[24:27], s33 offen lds
  s_waitcnt vmcnt(20)
  s_barrier
  ds_read_b64_tr_b16 a[48:49], v4 offset:49152
  ds_read_b64_tr_b16 a[50:51], v4 offset:50176
  ds_read_b64_tr_b16 a[52:53], v4 offset:57344
  ds_read_b64_tr_b16 a[54:55], v4 offset:58368
  ds_read_b64_tr_b16 a[56:57], v5 offset:49152
  ds_read_b64_tr_b16 a[58:59], v5 offset:50176
  ds_read_b64_tr_b16 a[60:61], v5 offset:57344
  ds_read_b64_tr_b16 a[62:63], v5 offset:58368
  s_waitcnt lgkmcnt(0)
  s_add_u32 s33, s37, 524288
  s_add_u32 m0, s38, 16384
  s_nop 0
  buffer_load_dwordx4 v2, s[24:27], s33 offen lds
  s_add_u32 s33, s37, 557056
  s_add_u32 m0, s38, 17408
  s_nop 0
  buffer_load_dwordx4 v2, s[24:27], s33 offen lds
  s_add_u32 s33, s37, 589824
  s_add_u32 m0, s38, 18432
  s_nop 0
  buffer_load_dwordx4 v3, s[24:27], s33 offen lds
  s_add_u32 s33, s37, 622592
  s_add_u32 m0, s38, 19456
  s_nop 0
  buffer_load_dwordx4 v3, s[24:27], s33 offen lds
  s_waitcnt vmcnt(20)
  s_barrier
  ds_read_b64_tr_b16 a[64:65], v6 offset:0
  ds_read_b64_tr_b16 a[66:67], v6 offset:1024
  ds_read_b64_tr_b16 a[68:69], v6 offset:8192
  ds_read_b64_tr_b16 a[70:71], v6 offset:9216
  ds_read_b64_tr_b16 a[72:73], v7 offset:0
  ds_read_b64_tr_b16 a[74:75], v7 offset:1024
  ds_read_b64_tr_b16 a[76:77], v7 offset:8192
  ds_read_b64_tr_b16 a[78:79], v7 offset:9216
  s_waitcnt lgkmcnt(0)
  s_add_u32 s33, s37, 1048576
  s_add_u32 m0, s38, 32768
  s_nop 0
  buffer_load_dwordx4 v2, s[24:27], s33 offen lds
  s_add_u32 s33, s37, 1081344
  s_add_u32 m0, s38, 33792
  s_nop 0
  buffer_load_dwordx4 v2, s[24:27], s33 offen lds
  s_add_u32 s33, s37, 1114112
  s_add_u32 m0, s38, 34816
  s_nop 0
  buffer_load_dwordx4 v3, s[24:27], s33 offen lds
  s_add_u32 s33, s37, 1146880
  s_add_u32 m0, s38, 35840
  s_nop 0
  buffer_load_dwordx4 v3, s[24:27], s33 offen lds
  s_waitcnt vmcnt(20)
  s_barrier
  ds_read_b64_tr_b16 a[80:81], v6 offset:16384
  ds_read_b64_tr_b16 a[82:83], v6 offset:17408
  ds_read_b64_tr_b16 a[84:85], v6 offset:24576
  ds_read_b64_tr_b16 a[86:87], v6 offset:25600
  ds_read_b64_tr_b16 a[88:89], v7 offset:16384
  ds_read_b64_tr_b16 a[90:91], v7 offset:17408
  ds_read_b64_tr_b16 a[92:93], v7 offset:24576
  ds_read_b64_tr_b16 a[94:95], v7 offset:25600
  s_waitcnt lgkmcnt(0)
  s_add_u32 s33, s37, 1572864
  s_add_u32 m0, s38, 49152
  s_nop 0
  buffer_load_dwordx4 v2, s[24:27], s33 offen lds
  s_add_u32 s33, s37, 1605632
  s_add_u32 m0, s38, 50176
  s_nop 0
  buffer_load_dwordx4 v2, s[24:27], s33 offen lds
  s_add_u32 s33, s37, 1638400
  s_add_u32 m0, s38, 51200
  s_nop 0
  buffer_load_dwordx4 v3, s[24:27], s33 offen lds
  s_add_u32 s33, s37, 1671168
  s_add_u32 m0, s38, 52224
  s_nop 0
  buffer_load_dwordx4 v3, s[24:27], s33 offen lds
  s_waitcnt vmcnt(20)
  s_barrier
  ds_read_b64_tr_b16 a[96:97], v6 offset:32768
  ds_read_b64_tr_b16 a[98:99], v6 offset:33792
  ds_read_b64_tr_b16 a[100:101], v6 offset:40960
  ds_read_b64_tr_b16 a[102:103], v6 offset:41984
  ds_read_b64_tr_b16 a[104:105], v7 offset:32768
  ds_read_b64_tr_b16 a[106:107], v7 offset:33792
  ds_read_b64_tr_b16 a[108:109], v7 offset:40960
  ds_read_b64_tr_b16 a[110:111], v7 offset:41984
  s_waitcnt lgkmcnt(0)
  s_add_u32 s33, s37, 2097152
  s_add_u32 m0, s38, 65536
  s_nop 0
  buffer_load_dwordx4 v2, s[24:27], s33 offen lds
  s_add_u32 s33, s37, 2129920
  s_add_u32 m0, s38, 66560
  s_nop 0
  buffer_load_dwordx4 v2, s[24:27], s33 offen lds
  s_add_u32 s33, s37, 2162688
  s_add_u32 m0, s38, 67584
  s_nop 0
  buffer_load_dwordx4 v3, s[24:27], s33 offen lds
  s_add_u32 s33, s37, 2195456
  s_add_u32 m0, s38, 68608
  s_nop 0
  buffer_load_dwordx4 v3, s[24:27], s33 offen lds
  s_waitcnt vmcnt(20)
  s_barrier
  ds_read_b64_tr_b16 a[112:113], v6 offset:49152
  ds_read_b64_tr_b16 a[114:115], v6 offset:50176
  ds_read_b64_tr_b16 a[116:117], v6 offset:57344
  ds_read_b64_tr_b16 a[118:119], v6 offset:58368
  ds_read_b64_tr_b16 a[120:121], v7 offset:49152
  ds_read_b64_tr_b16 a[122:123], v7 offset:50176
  ds_read_b64_tr_b16 a[124:125], v7 offset:57344
  ds_read_b64_tr_b16 a[126:127], v7 offset:58368
  s_waitcnt lgkmcnt(0)
  s_add_u32 s33, s37, 2621440
  s_add_u32 m0, s38, 81920
  s_nop 0
  buffer_load_dwordx4 v2, s[24:27], s33 offen lds
  s_add_u32 s33, s37, 2654208
  s_add_u32 m0, s38, 82944
  s_nop 0
  buffer_load_dwordx4 v2, s[24:27], s33 offen lds
  s_add_u32 s33, s37, 2686976
  s_add_u32 m0, s38, 83968
  s_nop 0
  buffer_load_dwordx4 v3, s[24:27], s33 offen lds
  s_add_u32 s33, s37, 2719744
  s_add_u32 m0, s38, 84992
  s_nop 0
  buffer_load_dwordx4 v3, s[24:27], s33 offen lds
  s_waitcnt vmcnt(20)
  s_barrier
  ds_read_b64_tr_b16 a[128:129], v4 offset:0
  ds_read_b64_tr_b16 a[130:131], v4 offset:1024
  ds_read_b64_tr_b16 a[132:133], v4 offset:8192
  ds_read_b64_tr_b16 a[134:135], v4 offset:9216
  ds_read_b64_tr_b16 a[136:137], v5 offset:0
  ds_read_b64_tr_b16 a[138:139], v5 offset:1024
  ds_read_b64_tr_b16 a[140:141], v5 offset:8192
  ds_read_b64_tr_b16 a[142:143], v5 offset:9216
  s_waitcnt lgkmcnt(0)
  s_add_u32 s33, s37, 3145728
  s_add_u32 m0, s38, 98304
  s_nop 0
  buffer_load_dwordx4 v2, s[24:27], s33 offen lds
  s_add_u32 s33, s37, 3178496
  s_add_u32 m0, s38, 99328
  s_nop 0
  buffer_load_dwordx4 v2, s[24:27], s33 offen lds
  s_add_u32 s33, s37, 3211264
  s_add_u32 m0, s38, 100352
  s_nop 0
  buffer_load_dwordx4 v3, s[24:27], s33 offen lds
  s_add_u32 s33, s37, 3244032
  s_add_u32 m0, s38, 101376
  s_nop 0
  buffer_load_dwordx4 v3, s[24:27], s33 offen lds
  s_waitcnt vmcnt(20)
  s_barrier
  ds_read_b64_tr_b16 a[144:145], v4 offset:16384
  ds_read_b64_tr_b16 a[146:147], v4 offset:17408
  ds_read_b64_tr_b16 a[148:149], v4 offset:24576
  ds_read_b64_tr_b16 a[150:151], v4 offset:25600
  ds_read_b64_tr_b16 a[152:153], v5 offset:16384
  ds_read_b64_tr_b16 a[154:155], v5 offset:17408
  ds_read_b64_tr_b16 a[156:157], v5 offset:24576
  ds_read_b64_tr_b16 a[158:159], v5 offset:25600
  s_waitcnt lgkmcnt(0)
  s_add_u32 s33, s37, 3670016
  s_add_u32 m0, s38, 114688
  s_nop 0
  buffer_load_dwordx4 v2, s[24:27], s33 offen lds
  s_add_u32 s33, s37, 3702784
  s_add_u32 m0, s38, 115712
  s_nop 0
  buffer_load_dwordx4 v2, s[24:27], s33 offen lds
  s_add_u32 s33, s37, 3735552
  s_add_u32 m0, s38, 116736
  s_nop 0
  buffer_load_dwordx4 v3, s[24:27], s33 offen lds
  s_add_u32 s33, s37, 3768320
  s_add_u32 m0, s38, 117760
  s_nop 0
  buffer_load_dwordx4 v3, s[24:27], s33 offen lds
  s_waitcnt vmcnt(20)
  s_barrier
  ds_read_b64_tr_b16 a[160:161], v4 offset:32768
  ds_read_b64_tr_b16 a[162:163], v4 offset:33792
  ds_read_b64_tr_b16 a[164:165], v4 offset:40960
  ds_read_b64_tr_b16 a[166:167], v4 offset:41984
  ds_read_b64_tr_b16 a[168:169], v5 offset:32768
  ds_read_b64_tr_b16 a[170:171], v5 offset:33792
  ds_read_b64_tr_b16 a[172:173], v5 offset:40960
  ds_read_b64_tr_b16 a[174:175], v5 offset:41984
  s_waitcnt lgkmcnt(0)
  s_waitcnt vmcnt(16)
  s_barrier
  ds_read_b64_tr_b16 a[176:177], v4 offset:49152
  ds_read_b64_tr_b16 a[178:179], v4 offset:50176
  ds_read_b64_tr_b16 a[180:181], v4 offset:57344
  ds_read_b64_tr_b16 a[182:183], v4 offset:58368
  ds_read_b64_tr_b16 a[184:185], v5 offset:49152
  ds_read_b64_tr_b16 a[186:187], v5 offset:50176
  ds_read_b64_tr_b16 a[188:189], v5 offset:57344
  ds_read_b64_tr_b16 a[190:191], v5 offset:58368
  s_waitcnt lgkmcnt(0)
  s_waitcnt vmcnt(12)
  s_barrier
  ds_read_b64_tr_b16 a[192:193], v6 offset:0
  ds_read_b64_tr_b16 a[194:195], v6 offset:1024
  ds_read_b64_tr_b16 a[196:197], v6 offset:8192
  ds_read_b64_tr_b16 a[198:199], v6 offset:9216
  ds_read_b64_tr_b16 a[200:201], v7 offset:0
  ds_read_b64_tr_b16 a[202:203], v7 offset:1024
  ds_read_b64_tr_b16 a[204:205], v7 offset:8192
  ds_read_b64_tr_b16 a[206:207], v7 offset:9216
  s_waitcnt lgkmcnt(0)
  s_waitcnt vmcnt(8)
  s_barrier
  ds_read_b64_tr_b16 a[208:209], v6 offset:16384
  ds_read_b64_tr_b16 a[210:211], v6 offset:17408
  ds_read_b64_tr_b16 a[212:213], v6 offset:24576
  ds_read_b64_tr_b16 a[214:215], v6 offset:25600
  ds_read_b64_tr_b16 a[216:217], v7 offset:16384
  ds_read_b64_tr_b16 a[218:219], v7 offset:17408
  ds_read_b64_tr_b16 a[220:221], v7 offset:24576
  ds_read_b64_tr_b16 a[222:223], v7 offset:25600
  s_waitcnt lgkmcnt(0)
  s_waitcnt vmcnt(4)
  s_barrier
  ds_read_b64_tr_b16 a[224:225], v6 offset:32768
  ds_read_b64_tr_b16 a[226:227], v6 offset:33792
  ds_read_b64_tr_b16 a[228:229], v6 offset:40960
  ds_read_b64_tr_b16 a[230:231], v6 offset:41984
  ds_read_b64_tr_b16 a[232:233], v7 offset:32768
  ds_read_b64_tr_b16 a[234:235], v7 offset:33792
  ds_read_b64_tr_b16 a[236:237], v7 offset:40960
  ds_read_b64_tr_b16 a[238:239], v7 offset:41984
  s_waitcnt lgkmcnt(0)
  s_waitcnt vmcnt(0)
  s_barrier
  ds_read_b64_tr_b16 a[240:241], v6 offset:49152
  ds_read_b64_tr_b16 a[242:243], v6 offset:50176
  ds_read_b64_tr_b16 a[244:245], v6 offset:57344
  ds_read_b64_tr_b16 a[246:247], v6 offset:58368
  ds_read_b64_tr_b16 a[248:249], v7 offset:49152
  ds_read_b64_tr_b16 a[250:251], v7 offset:50176
  ds_read_b64_tr_b16 a[252:253], v7 offset:57344
  ds_read_b64_tr_b16 a[254:255], v7 offset:58368
  s_waitcnt lgkmcnt(0)
  s_branch LOADED_16
LDW1_18:
  s_add_u32 s33, s37, 0
  s_add_u32 m0, s38, 0
  s_nop 0
  buffer_load_dwordx4 v2, s[20:23], s33 offen lds
  s_add_u32 s33, s37, 32768
  s_add_u32 m0, s38, 1024
  s_nop 0
  buffer_load_dwordx4 v2, s[20:23], s33 offen lds
  s_add_u32 s33, s37, 65536
  s_add_u32 m0, s38, 2048
  s_nop 0
  buffer_load_dwordx4 v3, s[20:23], s33 offen lds
  s_add_u32 s33, s37, 98304
  s_add_u32 m0, s38, 3072
  s_nop 0
  buffer_load_dwordx4 v3, s[20:23], s33 offen lds
  s_add_u32 s33, s37, 524288
  s_add_u32 m0, s38, 16384
  s_nop 0
  buffer_load_dwordx4 v2, s[20:23], s33 offen lds
  s_add_u32 s33, s37, 557056
  s_add_u32 m0, s38, 17408
  s_nop 0
  buffer_load_dwordx4 v2, s[20:23], s33 offen lds
  s_add_u32 s33, s37, 589824
  s_add_u32 m0, s38, 18432
  s_nop 0
  buffer_load_dwordx4 v3, s[20:23], s33 offen lds
  s_add_u32 s33, s37, 622592
  s_add_u32 m0, s38, 19456
  s_nop 0
  buffer_load_dwordx4 v3, s[20:23], s33 offen lds
  s_add_u32 s33, s37, 1048576
  s_add_u32 m0, s38, 32768
  s_nop 0
  buffer_load_dwordx4 v2, s[20:23], s33 offen lds
  s_add_u32 s33, s37, 1081344
  s_add_u32 m0, s38, 33792
  s_nop 0
  buffer_load_dwordx4 v2, s[20:23], s33 offen lds
  s_add_u32 s33, s37, 1114112
  s_add_u32 m0, s38, 34816
  s_nop 0
  buffer_load_dwordx4 v3, s[20:23], s33 offen lds
  s_add_u32 s33, s37, 1146880
  s_add_u32 m0, s38, 35840
  s_nop 0
  buffer_load_dwordx4 v3, s[20:23], s33 offen lds
  s_add_u32 s33, s37, 1572864
  s_add_u32 m0, s38, 49152
  s_nop 0
  buffer_load_dwordx4 v2, s[20:23], s33 offen lds
  s_add_u32 s33, s37, 1605632
  s_add_u32 m0, s38, 50176
  s_nop 0
  buffer_load_dwordx4 v2, s[20:23], s33 offen lds
  s_add_u32 s33, s37, 1638400
  s_add_u32 m0, s38, 51200
  s_nop 0
  buffer_load_dwordx4 v3, s[20:23], s33 offen lds
  s_add_u32 s33, s37, 1671168
  s_add_u32 m0, s38, 52224
  s_nop 0
  buffer_load_dwordx4 v3, s[20:23], s33 offen lds
  s_add_u32 s33, s37, 2097152
  s_add_u32 m0, s38, 65536
  s_nop 0
  buffer_load_dwordx4 v2, s[20:23], s33 offen lds
  s_add_u32 s33, s37, 2129920
  s_add_u32 m0, s38, 66560
  s_nop 0
  buffer_load_dwordx4 v2, s[20:23], s33 offen lds
  s_add_u32 s33, s37, 2162688
  s_add_u32 m0, s38, 67584
  s_nop 0
  buffer_load_dwordx4 v3, s[20:23], s33 offen lds
  s_add_u32 s33, s37, 2195456
  s_add_u32 m0, s38, 68608
  s_nop 0
  buffer_load_dwordx4 v3, s[20:23], s33 offen lds
  s_add_u32 s33, s37, 2621440
  s_add_u32 m0, s38, 81920
  s_nop 0
  buffer_load_dwordx4 v2, s[20:23], s33 offen lds
  s_add_u32 s33, s37, 2654208
  s_add_u32 m0, s38, 82944
  s_nop 0
  buffer_load_dwordx4 v2, s[20:23], s33 offen lds
  s_add_u32 s33, s37, 2686976
  s_add_u32 m0, s38, 83968
  s_nop 0
  buffer_load_dwordx4 v3, s[20:23], s33 offen lds
  s_add_u32 s33, s37, 2719744
  s_add_u32 m0, s38, 84992
  s_nop 0
  buffer_load_dwordx4 v3, s[20:23], s33 offen lds
  s_waitcnt vmcnt(20)
  s_barrier
  s_cmp_lg_u32 s3, 0
  s_cbranch_scc1 SIG_22
  s_lshl_b32 s33, s4, 2
  v_mov_b32 v10, s32
  s_mov_b64 exec, 1
  buffer_atomic_add v10, off, s[12:15], s33 offset:160 sc1
  s_mov_b64 exec, -1
SIG_22:
  ds_read_b64_tr_b16 a[96:97], v4 offset:0
  ds_read_b64_tr_b16 a[98:99], v4 offset:1024
  ds_read_b64_tr_b16 a[100:101], v4 offset:8192
  ds_read_b64_tr_b16 a[102:103], v4 offset:9216
  ds_read_b64_tr_b16 a[104:105], v5 offset:0
  ds_read_b64_tr_b16 a[106:107], v5 offset:1024
  ds_read_b64_tr_b16 a[108:109], v5 offset:8192
  ds_read_b64_tr_b16 a[110:111], v5 offset:9216
  s_waitcnt lgkmcnt(0)
  s_add_u32 s33, s37, 3145728
  s_add_u32 m0, s38, 98304
  s_nop 0
  buffer_load_dwordx4 v2, s[20:23], s33 offen lds
  s_add_u32 s33, s37, 3178496
  s_add_u32 m0, s38, 99328
  s_nop 0
  buffer_load_dwordx4 v2, s[20:23], s33 offen lds
  s_add_u32 s33, s37, 3211264
  s_add_u32 m0, s38, 100352
  s_nop 0
  buffer_load_dwordx4 v3, s[20:23], s33 offen lds
  s_add_u32 s33, s37, 3244032
  s_add_u32 m0, s38, 101376
  s_nop 0
  buffer_load_dwordx4 v3, s[20:23], s33 offen lds
  s_waitcnt vmcnt(20)
  s_barrier
  ds_read_b64_tr_b16 a[112:113], v4 offset:16384
  ds_read_b64_tr_b16 a[114:115], v4 offset:17408
  ds_read_b64_tr_b16 a[116:117], v4 offset:24576
  ds_read_b64_tr_b16 a[118:119], v4 offset:25600
  ds_read_b64_tr_b16 a[120:121], v5 offset:16384
  ds_read_b64_tr_b16 a[122:123], v5 offset:17408
  ds_read_b64_tr_b16 a[124:125], v5 offset:24576
  ds_read_b64_tr_b16 a[126:127], v5 offset:25600
  s_waitcnt lgkmcnt(0)
  s_add_u32 s33, s37, 3670016
  s_add_u32 m0, s38, 114688
  s_nop 0
  buffer_load_dwordx4 v2, s[20:23], s33 offen lds
  s_add_u32 s33, s37, 3702784
  s_add_u32 m0, s38, 115712
  s_nop 0
  buffer_load_dwordx4 v2, s[20:23], s33 offen lds
  s_add_u32 s33, s37, 3735552
  s_add_u32 m0, s38, 116736
  s_nop 0
  buffer_load_dwordx4 v3, s[20:23], s33 offen lds
  s_add_u32 s33, s37, 3768320
  s_add_u32 m0, s38, 117760
  s_nop 0
  buffer_load_dwordx4 v3, s[20:23], s33 offen lds
  s_waitcnt vmcnt(20)
  s_barrier
  ds_read_b64_tr_b16 a[0:1], v4 offset:32768
  ds_read_b64_tr_b16 a[2:3], v4 offset:33792
  ds_read_b64_tr_b16 a[4:5], v4 offset:40960
  ds_read_b64_tr_b16 a[6:7], v4 offset:41984
  ds_read_b64_tr_b16 a[8:9], v5 offset:32768
  ds_read_b64_tr_b16 a[10:11], v5 offset:33792
  ds_read_b64_tr_b16 a[12:13], v5 offset:40960
  ds_read_b64_tr_b16 a[14:15], v5 offset:41984
  s_waitcnt lgkmcnt(0)
  s_add_u32 s33, s37, 0
  s_add_u32 m0, s38, 0
  s_nop 0
  buffer_load_dwordx4 v2, s[24:27], s33 offen lds
  s_add_u32 s33, s37, 32768
  s_add_u32 m0, s38, 1024
  s_nop 0
  buffer_load_dwordx4 v2, s[24:27], s33 offen lds
  s_add_u32 s33, s37, 65536
  s_add_u32 m0, s38, 2048
  s_nop 0
  buffer_load_dwordx4 v3, s[24:27], s33 offen lds
  s_add_u32 s33, s37, 98304
  s_add_u32 m0, s38, 3072
  s_nop 0
  buffer_load_dwordx4 v3, s[24:27], s33 offen lds
  s_waitcnt vmcnt(20)
  s_barrier
  ds_read_b64_tr_b16 a[16:17], v4 offset:49152
  ds_read_b64_tr_b16 a[18:19], v4 offset:50176
  ds_read_b64_tr_b16 a[20:21], v4 offset:57344
  ds_read_b64_tr_b16 a[22:23], v4 offset:58368
  ds_read_b64_tr_b16 a[24:25], v5 offset:49152
  ds_read_b64_tr_b16 a[26:27], v5 offset:50176
  ds_read_b64_tr_b16 a[28:29], v5 offset:57344
  ds_read_b64_tr_b16 a[30:31], v5 offset:58368
  s_waitcnt lgkmcnt(0)
  s_add_u32 s33, s37, 524288
  s_add_u32 m0, s38, 16384
  s_nop 0
  buffer_load_dwordx4 v2, s[24:27], s33 offen lds
  s_add_u32 s33, s37, 557056
  s_add_u32 m0, s38, 17408
  s_nop 0
  buffer_load_dwordx4 v2, s[24:27], s33 offen lds
  s_add_u32 s33, s37, 589824
  s_add_u32 m0, s38, 18432
  s_nop 0
  buffer_load_dwordx4 v3, s[24:27], s33 offen lds
  s_add_u32 s33, s37, 622592
  s_add_u32 m0, s38, 19456
  s_nop 0
  buffer_load_dwordx4 v3, s[24:27], s33 offen lds
  s_waitcnt vmcnt(20)
  s_barrier
  ds_read_b64_tr_b16 a[32:33], v6 offset:0
  ds_read_b64_tr_b16 a[34:35], v6 offset:1024
  ds_read_b64_tr_b16 a[36:37], v6 offset:8192
  ds_read_b64_tr_b16 a[38:39], v6 offset:9216
  ds_read_b64_tr_b16 a[40:41], v7 offset:0
  ds_read_b64_tr_b16 a[42:43], v7 offset:1024
  ds_read_b64_tr_b16 a[44:45], v7 offset:8192
  ds_read_b64_tr_b16 a[46:47], v7 offset:9216
  s_waitcnt lgkmcnt(0)
  s_add_u32 s33, s37, 1048576
  s_add_u32 m0, s38, 32768
  s_nop 0
  buffer_load_dwordx4 v2, s[24:27], s33 offen lds
  s_add_u32 s33, s37, 1081344
  s_add_u32 m0, s38, 33792
  s_nop 0
  buffer_load_dwordx4 v2, s[24:27], s33 offen lds
  s_add_u32 s33, s37, 1114112
  s_add_u32 m0, s38, 34816
  s_nop 0
  buffer_load_dwordx4 v3, s[24:27], s33 offen lds
  s_add_u32 s33, s37, 1146880
  s_add_u32 m0, s38, 35840
  s_nop 0
  buffer_load_dwordx4 v3, s[24:27], s33 offen lds
  s_waitcnt vmcnt(20)
  s_barrier
  ds_read_b64_tr_b16 a[48:49], v6 offset:16384
  ds_read_b64_tr_b16 a[50:51], v6 offset:17408
  ds_read_b64_tr_b16 a[52:53], v6 offset:24576
  ds_read_b64_tr_b16 a[54:55], v6 offset:25600
  ds_read_b64_tr_b16 a[56:57], v7 offset:16384
  ds_read_b64_tr_b16 a[58:59], v7 offset:17408
  ds_read_b64_tr_b16 a[60:61], v7 offset:24576
  ds_read_b64_tr_b16 a[62:63], v7 offset:25600
  s_waitcnt lgkmcnt(0)
  s_add_u32 s33, s37, 1572864
  s_add_u32 m0, s38, 49152
  s_nop 0
  buffer_load_dwordx4 v2, s[24:27], s33 offen lds
  s_add_u32 s33, s37, 1605632
  s_add_u32 m0, s38, 50176
  s_nop 0
  buffer_load_dwordx4 v2, s[24:27], s33 offen lds
  s_add_u32 s33, s37, 1638400
  s_add_u32 m0, s38, 51200
  s_nop 0
  buffer_load_dwordx4 v3, s[24:27], s33 offen lds
  s_add_u32 s33, s37, 1671168
  s_add_u32 m0, s38, 52224
  s_nop 0
  buffer_load_dwordx4 v3, s[24:27], s33 offen lds
  s_waitcnt vmcnt(20)
  s_barrier
  ds_read_b64_tr_b16 a[64:65], v6 offset:32768
  ds_read_b64_tr_b16 a[66:67], v6 offset:33792
  ds_read_b64_tr_b16 a[68:69], v6 offset:40960
  ds_read_b64_tr_b16 a[70:71], v6 offset:41984
  ds_read_b64_tr_b16 a[72:73], v7 offset:32768
  ds_read_b64_tr_b16 a[74:75], v7 offset:33792
  ds_read_b64_tr_b16 a[76:77], v7 offset:40960
  ds_read_b64_tr_b16 a[78:79], v7 offset:41984
  s_waitcnt lgkmcnt(0)
  s_add_u32 s33, s37, 2097152
  s_add_u32 m0, s38, 65536
  s_nop 0
  buffer_load_dwordx4 v2, s[24:27], s33 offen lds
  s_add_u32 s33, s37, 2129920
  s_add_u32 m0, s38, 66560
  s_nop 0
  buffer_load_dwordx4 v2, s[24:27], s33 offen lds
  s_add_u32 s33, s37, 2162688
  s_add_u32 m0, s38, 67584
  s_nop 0
  buffer_load_dwordx4 v3, s[24:27], s33 offen lds
  s_add_u32 s33, s37, 2195456
  s_add_u32 m0, s38, 68608
  s_nop 0
  buffer_load_dwordx4 v3, s[24:27], s33 offen lds
  s_waitcnt vmcnt(20)
  s_barrier
  ds_read_b64_tr_b16 a[80:81], v6 offset:49152
  ds_read_b64_tr_b16 a[82:83], v6 offset:50176
  ds_read_b64_tr_b16 a[84:85], v6 offset:57344
  ds_read_b64_tr_b16 a[86:87], v6 offset:58368
  ds_read_b64_tr_b16 a[88:89], v7 offset:49152
  ds_read_b64_tr_b16 a[90:91], v7 offset:50176
  ds_read_b64_tr_b16 a[92:93], v7 offset:57344
  ds_read_b64_tr_b16 a[94:95], v7 offset:58368
  s_waitcnt lgkmcnt(0)
  s_add_u32 s33, s37, 2621440
  s_add_u32 m0, s38, 81920
  s_nop 0
  buffer_load_dwordx4 v2, s[24:27], s33 offen lds
  s_add_u32 s33, s37, 2654208
  s_add_u32 m0, s38, 82944
  s_nop 0
  buffer_load_dwordx4 v2, s[24:27], s33 offen lds
  s_add_u32 s33, s37, 2686976
  s_add_u32 m0, s38, 83968
  s_nop 0
  buffer_load_dwordx4 v3, s[24:27], s33 offen lds
  s_add_u32 s33, s37, 2719744
  s_add_u32 m0, s38, 84992
  s_nop 0
  buffer_load_dwordx4 v3, s[24:27], s33 offen lds
  s_waitcnt vmcnt(20)
  s_barrier
  ds_read_b64_tr_b16 a[224:225], v4 offset:0
  ds_read_b64_tr_b16 a[226:227], v4 offset:1024
  ds_read_b64_tr_b16 a[228:229], v4 offset:8192
  ds_read_b64_tr_b16 a[230:231], v4 offset:9216
  ds_read_b64_tr_b16 a[232:233], v5 offset:0
  ds_read_b64_tr_b16 a[234:235], v5 offset:1024
  ds_read_b64_tr_b16 a[236:237], v5 offset:8192
  ds_read_b64_tr_b16 a[238:239], v5 offset:9216
  s_waitcnt lgkmcnt(0)
  s_add_u32 s33, s37, 3145728
  s_add_u32 m0, s38, 98304
  s_nop 0
  buffer_load_dwordx4 v2, s[24:27], s33 offen lds
  s_add_u32 s33, s37, 3178496
  s_add_u32 m0, s38, 99328
  s_nop 0
  buffer_load_dwordx4 v2, s[24:27], s33 offen lds
  s_add_u32 s33, s37, 3211264
  s_add_u32 m0, s38, 100352
  s_nop 0
  buffer_load_dwordx4 v3, s[24:27], s33 offen lds
  s_add_u32 s33, s37, 3244032
  s_add_u32 m0, s38, 101376
  s_nop 0
  buffer_load_dwordx4 v3, s[24:27], s33 offen lds
  s_waitcnt vmcnt(20)
  s_barrier
  ds_read_b64_tr_b16 a[240:241], v4 offset:16384
  ds_read_b64_tr_b16 a[242:243], v4 offset:17408
  ds_read_b64_tr_b16 a[244:245], v4 offset:24576
  ds_read_b64_tr_b16 a[246:247], v4 offset:25600
  ds_read_b64_tr_b16 a[248:249], v5 offset:16384
  ds_read_b64_tr_b16 a[250:251], v5 offset:17408
  ds_read_b64_tr_b16 a[252:253], v5 offset:24576
  ds_read_b64_tr_b16 a[254:255], v5 offset:25600
  s_waitcnt lgkmcnt(0)
  s_add_u32 s33, s37, 3670016
  s_add_u32 m0, s38, 114688
  s_nop 0
  buffer_load_dwordx4 v2, s[24:27], s33 offen lds
  s_add_u32 s33, s37, 3702784
  s_add_u32 m0, s38, 115712
  s_nop 0
  buffer_load_dwordx4 v2, s[24:27], s33 offen lds
  s_add_u32 s33, s37, 3735552
  s_add_u32 m0, s38, 116736
  s_nop 0
  buffer_load_dwordx4 v3, s[24:27], s33 offen lds
  s_add_u32 s33, s37, 3768320
  s_add_u32 m0, s38, 117760
  s_nop 0
  buffer_load_dwordx4 v3, s[24:27], s33 offen lds
  s_waitcnt vmcnt(20)
  s_barrier
  ds_read_b64_tr_b16 a[128:129], v4 offset:32768
  ds_read_b64_tr_b16 a[130:131], v4 offset:33792
  ds_read_b64_tr_b16 a[132:133], v4 offset:40960
  ds_read_b64_tr_b16 a[134:135], v4 offset:41984
  ds_read_b64_tr_b16 a[136:137], v5 offset:32768
  ds_read_b64_tr_b16 a[138:139], v5 offset:33792
  ds_read_b64_tr_b16 a[140:141], v5 offset:40960
  ds_read_b64_tr_b16 a[142:143], v5 offset:41984
  s_waitcnt lgkmcnt(0)
  s_waitcnt vmcnt(16)
  s_barrier
  ds_read_b64_tr_b16 a[144:145], v4 offset:49152
  ds_read_b64_tr_b16 a[146:147], v4 offset:50176
  ds_read_b64_tr_b16 a[148:149], v4 offset:57344
  ds_read_b64_tr_b16 a[150:151], v4 offset:58368
  ds_read_b64_tr_b16 a[152:153], v5 offset:49152
  ds_read_b64_tr_b16 a[154:155], v5 offset:50176
  ds_read_b64_tr_b16 a[156:157], v5 offset:57344
  ds_read_b64_tr_b16 a[158:159], v5 offset:58368
  s_waitcnt lgkmcnt(0)
  s_waitcnt vmcnt(12)
  s_barrier
  ds_read_b64_tr_b16 a[160:161], v6 offset:0
  ds_read_b64_tr_b16 a[162:163], v6 offset:1024
  ds_read_b64_tr_b16 a[164:165], v6 offset:8192
  ds_read_b64_tr_b16 a[166:167], v6 offset:9216
  ds_read_b64_tr_b16 a[168:169], v7 offset:0
  ds_read_b64_tr_b16 a[170:171], v7 offset:1024
  ds_read_b64_tr_b16 a[172:173], v7 offset:8192
  ds_read_b64_tr_b16 a[174:175], v7 offset:9216
  s_waitcnt lgkmcnt(0)
  s_waitcnt vmcnt(8)
  s_barrier
  ds_read_b64_tr_b16 a[176:177], v6 offset:16384
  ds_read_b64_tr_b16 a[178:179], v6 offset:17408
  ds_read_b64_tr_b16 a[180:181], v6 offset:24576
  ds_read_b64_tr_b16 a[182:183], v6 offset:25600
  ds_read_b64_tr_b16 a[184:185], v7 offset:16384
  ds_read_b64_tr_b16 a[186:187], v7 offset:17408
  ds_read_b64_tr_b16 a[188:189], v7 offset:24576
  ds_read_b64_tr_b16 a[190:191], v7 offset:25600
  s_waitcnt lgkmcnt(0)
  s_waitcnt vmcnt(4)
  s_barrier
  ds_read_b64_tr_b16 a[192:193], v6 offset:32768
  ds_read_b64_tr_b16 a[194:195], v6 offset:33792
  ds_read_b64_tr_b16 a[196:197], v6 offset:40960
  ds_read_b64_tr_b16 a[198:199], v6 offset:41984
  ds_read_b64_tr_b16 a[200:201], v7 offset:32768
  ds_read_b64_tr_b16 a[202:203], v7 offset:33792
  ds_read_b64_tr_b16 a[204:205], v7 offset:40960
  ds_read_b64_tr_b16 a[206:207], v7 offset:41984
  s_waitcnt lgkmcnt(0)
  s_waitcnt vmcnt(0)
  s_barrier
  ds_read_b64_tr_b16 a[208:209], v6 offset:49152
  ds_read_b64_tr_b16 a[210:211], v6 offset:50176
  ds_read_b64_tr_b16 a[212:213], v6 offset:57344
  ds_read_b64_tr_b16 a[214:215], v6 offset:58368
  ds_read_b64_tr_b16 a[216:217], v7 offset:49152
  ds_read_b64_tr_b16 a[218:219], v7 offset:50176
  ds_read_b64_tr_b16 a[220:221], v7 offset:57344
  ds_read_b64_tr_b16 a[222:223], v7 offset:58368
  s_waitcnt lgkmcnt(0)
  s_branch LOADED_16
LDW2_19:
  s_add_u32 s33, s37, 0
  s_add_u32 m0, s38, 0
  s_nop 0
  buffer_load_dwordx4 v2, s[20:23], s33 offen lds
  s_add_u32 s33, s37, 32768
  s_add_u32 m0, s38, 1024
  s_nop 0
  buffer_load_dwordx4 v2, s[20:23], s33 offen lds
  s_add_u32 s33, s37, 65536
  s_add_u32 m0, s38, 2048
  s_nop 0
  buffer_load_dwordx4 v3, s[20:23], s33 offen lds
  s_add_u32 s33, s37, 98304
  s_add_u32 m0, s38, 3072
  s_nop 0
  buffer_load_dwordx4 v3, s[20:23], s33 offen lds
  s_add_u32 s33, s37, 524288
  s_add_u32 m0, s38, 16384
  s_nop 0
  buffer_load_dwordx4 v2, s[20:23], s33 offen lds
  s_add_u32 s33, s37, 557056
  s_add_u32 m0, s38, 17408
  s_nop 0
  buffer_load_dwordx4 v2, s[20:23], s33 offen lds
  s_add_u32 s33, s37, 589824
  s_add_u32 m0, s38, 18432
  s_nop 0
  buffer_load_dwordx4 v3, s[20:23], s33 offen lds
  s_add_u32 s33, s37, 622592
  s_add_u32 m0, s38, 19456
  s_nop 0
  buffer_load_dwordx4 v3, s[20:23], s33 offen lds
  s_add_u32 s33, s37, 1048576
  s_add_u32 m0, s38, 32768
  s_nop 0
  buffer_load_dwordx4 v2, s[20:23], s33 offen lds
  s_add_u32 s33, s37, 1081344
  s_add_u32 m0, s38, 33792
  s_nop 0
  buffer_load_dwordx4 v2, s[20:23], s33 offen lds
  s_add_u32 s33, s37, 1114112
  s_add_u32 m0, s38, 34816
  s_nop 0
  buffer_load_dwordx4 v3, s[20:23], s33 offen lds
  s_add_u32 s33, s37, 1146880
  s_add_u32 m0, s38, 35840
  s_nop 0
  buffer_load_dwordx4 v3, s[20:23], s33 offen lds
  s_add_u32 s33, s37, 1572864
  s_add_u32 m0, s38, 49152
  s_nop 0
  buffer_load_dwordx4 v2, s[20:23], s33 offen lds
  s_add_u32 s33, s37, 1605632
  s_add_u32 m0, s38, 50176
  s_nop 0
  buffer_load_dwordx4 v2, s[20:23], s33 offen lds
  s_add_u32 s33, s37, 1638400
  s_add_u32 m0, s38, 51200
  s_nop 0
  buffer_load_dwordx4 v3, s[20:23], s33 offen lds
  s_add_u32 s33, s37, 1671168
  s_add_u32 m0, s38, 52224
  s_nop 0
  buffer_load_dwordx4 v3, s[20:23], s33 offen lds
  s_add_u32 s33, s37, 2097152
  s_add_u32 m0, s38, 65536
  s_nop 0
  buffer_load_dwordx4 v2, s[20:23], s33 offen lds
  s_add_u32 s33, s37, 2129920
  s_add_u32 m0, s38, 66560
  s_nop 0
  buffer_load_dwordx4 v2, s[20:23], s33 offen lds
  s_add_u32 s33, s37, 2162688
  s_add_u32 m0, s38, 67584
  s_nop 0
  buffer_load_dwordx4 v3, s[20:23], s33 offen lds
  s_add_u32 s33, s37, 2195456
  s_add_u32 m0, s38, 68608
  s_nop 0
  buffer_load_dwordx4 v3, s[20:23], s33 offen lds
  s_add_u32 s33, s37, 2621440
  s_add_u32 m0, s38, 81920
  s_nop 0
  buffer_load_dwordx4 v2, s[20:23], s33 offen lds
  s_add_u32 s33, s37, 2654208
  s_add_u32 m0, s38, 82944
  s_nop 0
  buffer_load_dwordx4 v2, s[20:23], s33 offen lds
  s_add_u32 s33, s37, 2686976
  s_add_u32 m0, s38, 83968
  s_nop 0
  buffer_load_dwordx4 v3, s[20:23], s33 offen lds
  s_add_u32 s33, s37, 2719744
  s_add_u32 m0, s38, 84992
  s_nop 0
  buffer_load_dwordx4 v3, s[20:23], s33 offen lds
  s_waitcnt vmcnt(20)
  s_barrier
  s_cmp_lg_u32 s3, 0
  s_cbranch_scc1 SIG_23
  s_lshl_b32 s33, s4, 2
  v_mov_b32 v10, s32
  s_mov_b64 exec, 1
  buffer_atomic_add v10, off, s[12:15], s33 offset:160 sc1
  s_mov_b64 exec, -1
SIG_23:
  ds_read_b64_tr_b16 a[64:65], v4 offset:0
  ds_read_b64_tr_b16 a[66:67], v4 offset:1024
  ds_read_b64_tr_b16 a[68:69], v4 offset:8192
  ds_read_b64_tr_b16 a[70:71], v4 offset:9216
  ds_read_b64_tr_b16 a[72:73], v5 offset:0
  ds_read_b64_tr_b16 a[74:75], v5 offset:1024
  ds_read_b64_tr_b16 a[76:77], v5 offset:8192
  ds_read_b64_tr_b16 a[78:79], v5 offset:9216
  s_waitcnt lgkmcnt(0)
  s_add_u32 s33, s37, 3145728
  s_add_u32 m0, s38, 98304
  s_nop 0
  buffer_load_dwordx4 v2, s[20:23], s33 offen lds
  s_add_u32 s33, s37, 3178496
  s_add_u32 m0, s38, 99328
  s_nop 0
  buffer_load_dwordx4 v2, s[20:23], s33 offen lds
  s_add_u32 s33, s37, 3211264
  s_add_u32 m0, s38, 100352
  s_nop 0
  buffer_load_dwordx4 v3, s[20:23], s33 offen lds
  s_add_u32 s33, s37, 3244032
  s_add_u32 m0, s38, 101376
  s_nop 0
  buffer_load_dwordx4 v3, s[20:23], s33 offen lds
  s_waitcnt vmcnt(20)
  s_barrier
  ds_read_b64_tr_b16 a[80:81], v4 offset:16384
  ds_read_b64_tr_b16 a[82:83], v4 offset:17408
  ds_read_b64_tr_b16 a[84:85], v4 offset:24576
  ds_read_b64_tr_b16 a[86:87], v4 offset:25600
  ds_read_b64_tr_b16 a[88:89], v5 offset:16384
  ds_read_b64_tr_b16 a[90:91], v5 offset:17408
  ds_read_b64_tr_b16 a[92:93], v5 offset:24576
  ds_read_b64_tr_b16 a[94:95], v5 offset:25600
  s_waitcnt lgkmcnt(0)
  s_add_u32 s33, s37, 3670016
  s_add_u32 m0, s38, 114688
  s_nop 0
  buffer_load_dwordx4 v2, s[20:23], s33 offen lds
  s_add_u32 s33, s37, 3702784
  s_add_u32 m0, s38, 115712
  s_nop 0
  buffer_load_dwordx4 v2, s[20:23], s33 offen lds
  s_add_u32 s33, s37, 3735552
  s_add_u32 m0, s38, 116736
  s_nop 0
  buffer_load_dwordx4 v3, s[20:23], s33 offen lds
  s_add_u32 s33, s37, 3768320
  s_add_u32 m0, s38, 117760
  s_nop 0
  buffer_load_dwordx4 v3, s[20:23], s33 offen lds
  s_waitcnt vmcnt(20)
  s_barrier
  ds_read_b64_tr_b16 a[96:97], v4 offset:32768
  ds_read_b64_tr_b16 a[98:99], v4 offset:33792
  ds_read_b64_tr_b16 a[100:101], v4 offset:40960
  ds_read_b64_tr_b16 a[102:103], v4 offset:41984
  ds_read_b64_tr_b16 a[104:105], v5 offset:32768
  ds_read_b64_tr_b16 a[106:107], v5 offset:33792
  ds_read_b64_tr_b16 a[108:109], v5 offset:40960
  ds_read_b64_tr_b16 a[110:111], v5 offset:41984
  s_waitcnt lgkmcnt(0)
  s_add_u32 s33, s37, 0
  s_add_u32 m0, s38, 0
  s_nop 0
  buffer_load_dwordx4 v2, s[24:27], s33 offen lds
  s_add_u32 s33, s37, 32768
  s_add_u32 m0, s38, 1024
  s_nop 0
  buffer_load_dwordx4 v2, s[24:27], s33 offen lds
  s_add_u32 s33, s37, 65536
  s_add_u32 m0, s38, 2048
  s_nop 0
  buffer_load_dwordx4 v3, s[24:27], s33 offen lds
  s_add_u32 s33, s37, 98304
  s_add_u32 m0, s38, 3072
  s_nop 0
  buffer_load_dwordx4 v3, s[24:27], s33 offen lds
  s_waitcnt vmcnt(20)
  s_barrier
  ds_read_b64_tr_b16 a[112:113], v4 offset:49152
  ds_read_b64_tr_b16 a[114:115], v4 offset:50176
  ds_read_b64_tr_b16 a[116:117], v4 offset:57344
  ds_read_b64_tr_b16 a[118:119], v4 offset:58368
  ds_read_b64_tr_b16 a[120:121], v5 offset:49152
  ds_read_b64_tr_b16 a[122:123], v5 offset:50176
  ds_read_b64_tr_b16 a[124:125], v5 offset:57344
  ds_read_b64_tr_b16 a[126:127], v5 offset:58368
  s_waitcnt lgkmcnt(0)
  s_add_u32 s33, s37, 524288
  s_add_u32 m0, s38, 16384
  s_nop 0
  buffer_load_dwordx4 v2, s[24:27], s33 offen lds
  s_add_u32 s33, s37, 557056
  s_add_u32 m0, s38, 17408
  s_nop 0
  buffer_load_dwordx4 v2, s[24:27], s33 offen lds
  s_add_u32 s33, s37, 589824
  s_add_u32 m0, s38, 18432
  s_nop 0
  buffer_load_dwordx4 v3, s[24:27], s33 offen lds
  s_add_u32 s33, s37, 622592
  s_add_u32 m0, s38, 19456
  s_nop 0
  buffer_load_dwordx4 v3, s[24:27], s33 offen lds
  s_waitcnt vmcnt(20)
  s_barrier
  ds_read_b64_tr_b16 a[0:1], v6 offset:0
  ds_read_b64_tr_b16 a[2:3], v6 offset:1024
  ds_read_b64_tr_b16 a[4:5], v6 offset:8192
  ds_read_b64_tr_b16 a[6:7], v6 offset:9216
  ds_read_b64_tr_b16 a[8:9], v7 offset:0
  ds_read_b64_tr_b16 a[10:11], v7 offset:1024
  ds_read_b64_tr_b16 a[12:13], v7 offset:8192
  ds_read_b64_tr_b16 a[14:15], v7 offset:9216
  s_waitcnt lgkmcnt(0)
  s_add_u32 s33, s37, 1048576
  s_add_u32 m0, s38, 32768
  s_nop 0
  buffer_load_dwordx4 v2, s[24:27], s33 offen lds
  s_add_u32 s33, s37, 1081344
  s_add_u32 m0, s38, 33792
  s_nop 0
  buffer_load_dwordx4 v2, s[24:27], s33 offen lds
  s_add_u32 s33, s37, 1114112
  s_add_u32 m0, s38, 34816
  s_nop 0
  buffer_load_dwordx4 v3, s[24:27], s33 offen lds
  s_add_u32 s33, s37, 1146880
  s_add_u32 m0, s38, 35840
  s_nop 0
  buffer_load_dwordx4 v3, s[24:27], s33 offen lds
  s_waitcnt vmcnt(20)
  s_barrier
  ds_read_b64_tr_b16 a[16:17], v6 offset:16384
  ds_read_b64_tr_b16 a[18:19], v6 offset:17408
  ds_read_b64_tr_b16 a[20:21], v6 offset:24576
  ds_read_b64_tr_b16 a[22:23], v6 offset:25600
  ds_read_b64_tr_b16 a[24:25], v7 offset:16384
  ds_read_b64_tr_b16 a[26:27], v7 offset:17408
  ds_read_b64_tr_b16 a[28:29], v7 offset:24576
  ds_read_b64_tr_b16 a[30:31], v7 offset:25600
  s_waitcnt lgkmcnt(0)
  s_add_u32 s33, s37, 1572864
  s_add_u32 m0, s38, 49152
  s_nop 0
  buffer_load_dwordx4 v2, s[24:27], s33 offen lds
  s_add_u32 s33, s37, 1605632
  s_add_u32 m0, s38, 50176
  s_nop 0
  buffer_load_dwordx4 v2, s[24:27], s33 offen lds
  s_add_u32 s33, s37, 1638400
  s_add_u32 m0, s38, 51200
  s_nop 0
  buffer_load_dwordx4 v3, s[24:27], s33 offen lds
  s_add_u32 s33, s37, 1671168
  s_add_u32 m0, s38, 52224
  s_nop 0
  buffer_load_dwordx4 v3, s[24:27], s33 offen lds
  s_waitcnt vmcnt(20)
  s_barrier
  ds_read_b64_tr_b16 a[32:33], v6 offset:32768
  ds_read_b64_tr_b16 a[34:35], v6 offset:33792
  ds_read_b64_tr_b16 a[36:37], v6 offset:40960
  ds_read_b64_tr_b16 a[38:39], v6 offset:41984
  ds_read_b64_tr_b16 a[40:41], v7 offset:32768
  ds_read_b64_tr_b16 a[42:43], v7 offset:33792
  ds_read_b64_tr_b16 a[44:45], v7 offset:40960
  ds_read_b64_tr_b16 a[46:47], v7 offset:41984
  s_waitcnt lgkmcnt(0)
  s_add_u32 s33, s37, 2097152
  s_add_u32 m0, s38, 65536
  s_nop 0
  buffer_load_dwordx4 v2, s[24:27], s33 offen lds
  s_add_u32 s33, s37, 2129920
  s_add_u32 m0, s38, 66560
  s_nop 0
  buffer_load_dwordx4 v2, s[24:27], s33 offen lds
  s_add_u32 s33, s37, 2162688
  s_add_u32 m0, s38, 67584
  s_nop 0
  buffer_load_dwordx4 v3, s[24:27], s33 offen lds
  s_add_u32 s33, s37, 2195456
  s_add_u32 m0, s38, 68608
  s_nop 0
  buffer_load_dwordx4 v3, s[24:27], s33 offen lds
  s_waitcnt vmcnt(20)
  s_barrier
  ds_read_b64_tr_b16 a[48:49], v6 offset:49152
  ds_read_b64_tr_b16 a[50:51], v6 offset:50176
  ds_read_b64_tr_b16 a[52:53], v6 offset:57344
  ds_read_b64_tr_b16 a[54:55], v6 offset:58368
  ds_read_b64_tr_b16 a[56:57], v7 offset:49152
  ds_read_b64_tr_b16 a[58:59], v7 offset:50176
  ds_read_b64_tr_b16 a[60:61], v7 offset:57344
  ds_read_b64_tr_b16 a[62:63], v7 offset:58368
  s_waitcnt lgkmcnt(0)
  s_add_u32 s33, s37, 2621440
  s_add_u32 m0, s38, 81920
  s_nop 0
  buffer_load_dwordx4 v2, s[24:27], s33 offen lds
  s_add_u32 s33, s37, 2654208
  s_add_u32 m0, s38, 82944
  s_nop 0
  buffer_load_dwordx4 v2, s[24:27], s33 offen lds
  s_add_u32 s33, s37, 2686976
  s_add_u32 m0, s38, 83968
  s_nop 0
  buffer_load_dwordx4 v3, s[24:27], s33 offen lds
  s_add_u32 s33, s37, 2719744
  s_add_u32 m0, s38, 84992
  s_nop 0
  buffer_load_dwordx4 v3, s[24:27], s33 offen lds
  s_waitcnt vmcnt(20)
  s_barrier
  ds_read_b64_tr_b16 a[192:193], v4 offset:0
  ds_read_b64_tr_b16 a[194:195], v4 offset:1024
  ds_read_b64_tr_b16 a[196:197], v4 offset:8192
  ds_read_b64_tr_b16 a[198:199], v4 offset:9216
  ds_read_b64_tr_b16 a[200:201], v5 offset:0
  ds_read_b64_tr_b16 a[202:203], v5 offset:1024
  ds_read_b64_tr_b16 a[204:205], v5 offset:8192
  ds_read_b64_tr_b16 a[206:207], v5 offset:9216
  s_waitcnt lgkmcnt(0)
  s_add_u32 s33, s37, 3145728
  s_add_u32 m0, s38, 98304
  s_nop 0
  buffer_load_dwordx4 v2, s[24:27], s33 offen lds
  s_add_u32 s33, s37, 3178496
  s_add_u32 m0, s38, 99328
  s_nop 0
  buffer_load_dwordx4 v2, s[24:27], s33 offen lds
  s_add_u32 s33, s37, 3211264
  s_add_u32 m0, s38, 100352
  s_nop 0
  buffer_load_dwordx4 v3, s[24:27], s33 offen lds
  s_add_u32 s33, s37, 3244032
  s_add_u32 m0, s38, 101376
  s_nop 0
  buffer_load_dwordx4 v3, s[24:27], s33 offen lds
  s_waitcnt vmcnt(20)
  s_barrier
  ds_read_b64_tr_b16 a[208:209], v4 offset:16384
  ds_read_b64_tr_b16 a[210:211], v4 offset:17408
  ds_read_b64_tr_b16 a[212:213], v4 offset:24576
  ds_read_b64_tr_b16 a[214:215], v4 offset:25600
  ds_read_b64_tr_b16 a[216:217], v5 offset:16384
  ds_read_b64_tr_b16 a[218:219], v5 offset:17408
  ds_read_b64_tr_b16 a[220:221], v5 offset:24576
  ds_read_b64_tr_b16 a[222:223], v5 offset:25600
  s_waitcnt lgkmcnt(0)
  s_add_u32 s33, s37, 3670016
  s_add_u32 m0, s38, 114688
  s_nop 0
  buffer_load_dwordx4 v2, s[24:27], s33 offen lds
  s_add_u32 s33, s37, 3702784
  s_add_u32 m0, s38, 115712
  s_nop 0
  buffer_load_dwordx4 v2, s[24:27], s33 offen lds
  s_add_u32 s33, s37, 3735552
  s_add_u32 m0, s38, 116736
  s_nop 0
  buffer_load_dwordx4 v3, s[24:27], s33 offen lds
  s_add_u32 s33, s37, 3768320
  s_add_u32 m0, s38, 117760
  s_nop 0
  buffer_load_dwordx4 v3, s[24:27], s33 offen lds
  s_waitcnt vmcnt(20)
  s_barrier
  ds_read_b64_tr_b16 a[224:225], v4 offset:32768
  ds_read_b64_tr_b16 a[226:227], v4 offset:33792
  ds_read_b64_tr_b16 a[228:229], v4 offset:40960
  ds_read_b64_tr_b16 a[230:231], v4 offset:41984
  ds_read_b64_tr_b16 a[232:233], v5 offset:32768
  ds_read_b64_tr_b16 a[234:235], v5 offset:33792
  ds_read_b64_tr_b16 a[236:237], v5 offset:40960
  ds_read_b64_tr_b16 a[238:239], v5 offset:41984
  s_waitcnt lgkmcnt(0)
  s_waitcnt vmcnt(16)
  s_barrier
  ds_read_b64_tr_b16 a[240:241], v4 offset:49152
  ds_read_b64_tr_b16 a[242:243], v4 offset:50176
  ds_read_b64_tr_b16 a[244:245], v4 offset:57344
  ds_read_b64_tr_b16 a[246:247], v4 offset:58368
  ds_read_b64_tr_b16 a[248:249], v5 offset:49152
  ds_read_b64_tr_b16 a[250:251], v5 offset:50176
  ds_read_b64_tr_b16 a[252:253], v5 offset:57344
  ds_read_b64_tr_b16 a[254:255], v5 offset:58368
  s_waitcnt lgkmcnt(0)
  s_waitcnt vmcnt(12)
  s_barrier
  ds_read_b64_tr_b16 a[128:129], v6 offset:0
  ds_read_b64_tr_b16 a[130:131], v6 offset:1024
  ds_read_b64_tr_b16 a[132:133], v6 offset:8192
  ds_read_b64_tr_b16 a[134:135], v6 offset:9216
  ds_read_b64_tr_b16 a[136:137], v7 offset:0
  ds_read_b64_tr_b16 a[138:139], v7 offset:1024
  ds_read_b64_tr_b16 a[140:141], v7 offset:8192
  ds_read_b64_tr_b16 a[142:143], v7 offset:9216
  s_waitcnt lgkmcnt(0)
  s_waitcnt vmcnt(8)
  s_barrier
  ds_read_b64_tr_b16 a[144:145], v6 offset:16384
  ds_read_b64_tr_b16 a[146:147], v6 offset:17408
  ds_read_b64_tr_b16 a[148:149], v6 offset:24576
  ds_read_b64_tr_b16 a[150:151], v6 offset:25600
  ds_read_b64_tr_b16 a[152:153], v7 offset:16384
  ds_read_b64_tr_b16 a[154:155], v7 offset:17408
  ds_read_b64_tr_b16 a[156:157], v7 offset:24576
  ds_read_b64_tr_b16 a[158:159], v7 offset:25600
  s_waitcnt lgkmcnt(0)
  s_waitcnt vmcnt(4)
  s_barrier
  ds_read_b64_tr_b16 a[160:161], v6 offset:32768
  ds_read_b64_tr_b16 a[162:163], v6 offset:33792
  ds_read_b64_tr_b16 a[164:165], v6 offset:40960
  ds_read_b64_tr_b16 a[166:167], v6 offset:41984
  ds_read_b64_tr_b16 a[168:169], v7 offset:32768
  ds_read_b64_tr_b16 a[170:171], v7 offset:33792
  ds_read_b64_tr_b16 a[172:173], v7 offset:40960
  ds_read_b64_tr_b16 a[174:175], v7 offset:41984
  s_waitcnt lgkmcnt(0)
  s_waitcnt vmcnt(0)
  s_barrier
  ds_read_b64_tr_b16 a[176:177], v6 offset:49152
  ds_read_b64_tr_b16 a[178:179], v6 offset:50176
  ds_read_b64_tr_b16 a[180:181], v6 offset:57344
  ds_read_b64_tr_b16 a[182:183], v6 offset:58368
  ds_read_b64_tr_b16 a[184:185], v7 offset:49152
  ds_read_b64_tr_b16 a[186:187], v7 offset:50176
  ds_read_b64_tr_b16 a[188:189], v7 offset:57344
  ds_read_b64_tr_b16 a[190:191], v7 offset:58368
  s_waitcnt lgkmcnt(0)
  s_branch LOADED_16
LDW3_20:
  s_add_u32 s33, s37, 0
  s_add_u32 m0, s38, 0
  s_nop 0
  buffer_load_dwordx4 v2, s[20:23], s33 offen lds
  s_add_u32 s33, s37, 32768
  s_add_u32 m0, s38, 1024
  s_nop 0
  buffer_load_dwordx4 v2, s[20:23], s33 offen lds
  s_add_u32 s33, s37, 65536
  s_add_u32 m0, s38, 2048
  s_nop 0
  buffer_load_dwordx4 v3, s[20:23], s33 offen lds
  s_add_u32 s33, s37, 98304
  s_add_u32 m0, s38, 3072
  s_nop 0
  buffer_load_dwordx4 v3, s[20:23], s33 offen lds
  s_add_u32 s33, s37, 524288
  s_add_u32 m0, s38, 16384
  s_nop 0
  buffer_load_dwordx4 v2, s[20:23], s33 offen lds
  s_add_u32 s33, s37, 557056
  s_add_u32 m0, s38, 17408
  s_nop 0
  buffer_load_dwordx4 v2, s[20:23], s33 offen lds
  s_add_u32 s33, s37, 589824
  s_add_u32 m0, s38, 18432
  s_nop 0
  buffer_load_dwordx4 v3, s[20:23], s33 offen lds
  s_add_u32 s33, s37, 622592
  s_add_u32 m0, s38, 19456
  s_nop 0
  buffer_load_dwordx4 v3, s[20:23], s33 offen lds
  s_add_u32 s33, s37, 1048576
  s_add_u32 m0, s38, 32768
  s_nop 0
  buffer_load_dwordx4 v2, s[20:23], s33 offen lds
  s_add_u32 s33, s37, 1081344
  s_add_u32 m0, s38, 33792
  s_nop 0
  buffer_load_dwordx4 v2, s[20:23], s33 offen lds
  s_add_u32 s33, s37, 1114112
  s_add_u32 m0, s38, 34816
  s_nop 0
  buffer_load_dwordx4 v3, s[20:23], s33 offen lds
  s_add_u32 s33, s37, 1146880
  s_add_u32 m0, s38, 35840
  s_nop 0
  buffer_load_dwordx4 v3, s[20:23], s33 offen lds
  s_add_u32 s33, s37, 1572864
  s_add_u32 m0, s38, 49152
  s_nop 0
  buffer_load_dwordx4 v2, s[20:23], s33 offen lds
  s_add_u32 s33, s37, 1605632
  s_add_u32 m0, s38, 50176
  s_nop 0
  buffer_load_dwordx4 v2, s[20:23], s33 offen lds
  s_add_u32 s33, s37, 1638400
  s_add_u32 m0, s38, 51200
  s_nop 0
  buffer_load_dwordx4 v3, s[20:23], s33 offen lds
  s_add_u32 s33, s37, 1671168
  s_add_u32 m0, s38, 52224
  s_nop 0
  buffer_load_dwordx4 v3, s[20:23], s33 offen lds
  s_add_u32 s33, s37, 2097152
  s_add_u32 m0, s38, 65536
  s_nop 0
  buffer_load_dwordx4 v2, s[20:23], s33 offen lds
  s_add_u32 s33, s37, 2129920
  s_add_u32 m0, s38, 66560
  s_nop 0
  buffer_load_dwordx4 v2, s[20:23], s33 offen lds
  s_add_u32 s33, s37, 2162688
  s_add_u32 m0, s38, 67584
  s_nop 0
  buffer_load_dwordx4 v3, s[20:23], s33 offen lds
  s_add_u32 s33, s37, 2195456
  s_add_u32 m0, s38, 68608
  s_nop 0
  buffer_load_dwordx4 v3, s[20:23], s33 offen lds
  s_add_u32 s33, s37, 2621440
  s_add_u32 m0, s38, 81920
  s_nop 0
  buffer_load_dwordx4 v2, s[20:23], s33 offen lds
  s_add_u32 s33, s37, 2654208
  s_add_u32 m0, s38, 82944
  s_nop 0
  buffer_load_dwordx4 v2, s[20:23], s33 offen lds
  s_add_u32 s33, s37, 2686976
  s_add_u32 m0, s38, 83968
  s_nop 0
  buffer_load_dwordx4 v3, s[20:23], s33 offen lds
  s_add_u32 s33, s37, 2719744
  s_add_u32 m0, s38, 84992
  s_nop 0
  buffer_load_dwordx4 v3, s[20:23], s33 offen lds
  s_waitcnt vmcnt(20)
  s_barrier
  s_cmp_lg_u32 s3, 0
  s_cbranch_scc1 SIG_24
  s_lshl_b32 s33, s4, 2
  v_mov_b32 v10, s32
  s_mov_b64 exec, 1
  buffer_atomic_add v10, off, s[12:15], s33 offset:160 sc1
  s_mov_b64 exec, -1
SIG_24:
  ds_read_b64_tr_b16 a[32:33], v4 offset:0
  ds_read_b64_tr_b16 a[34:35], v4 offset:1024
  ds_read_b64_tr_b16 a[36:37], v4 offset:8192
  ds_read_b64_tr_b16 a[38:39], v4 offset:9216
  ds_read_b64_tr_b16 a[40:41], v5 offset:0
  ds_read_b64_tr_b16 a[42:43], v5 offset:1024
  ds_read_b64_tr_b16 a[44:45], v5 offset:8192
  ds_read_b64_tr_b16 a[46:47], v5 offset:9216
  s_waitcnt lgkmcnt(0)
  s_add_u32 s33, s37, 3145728
  s_add_u32 m0, s38, 98304
  s_nop 0
  buffer_load_dwordx4 v2, s[20:23], s33 offen lds
  s_add_u32 s33, s37, 3178496
  s_add_u32 m0, s38, 99328
  s_nop 0
  buffer_load_dwordx4 v2, s[20:23], s33 offen lds
  s_add_u32 s33, s37, 3211264
  s_add_u32 m0, s38, 100352
  s_nop 0
  buffer_load_dwordx4 v3, s[20:23], s33 offen lds
  s_add_u32 s33, s37, 3244032
  s_add_u32 m0, s38, 101376
  s_nop 0
  buffer_load_dwordx4 v3, s[20:23], s33 offen lds
  s_waitcnt vmcnt(20)
  s_barrier
  ds_read_b64_tr_b16 a[48:49], v4 offset:16384
  ds_read_b64_tr_b16 a[50:51], v4 offset:17408
  ds_read_b64_tr_b16 a[52:53], v4 offset:24576
  ds_read_b64_tr_b16 a[54:55], v4 offset:25600
  ds_read_b64_tr_b16 a[56:57], v5 offset:16384
  ds_read_b64_tr_b16 a[58:59], v5 offset:17408
  ds_read_b64_tr_b16 a[60:61], v5 offset:24576
  ds_read_b64_tr_b16 a[62:63], v5 offset:25600
  s_waitcnt lgkmcnt(0)
  s_add_u32 s33, s37, 3670016
  s_add_u32 m0, s38, 114688
  s_nop 0
  buffer_load_dwordx4 v2, s[20:23], s33 offen lds
  s_add_u32 s33, s37, 3702784
  s_add_u32 m0, s38, 115712
  s_nop 0
  buffer_load_dwordx4 v2, s[20:23], s33 offen lds
  s_add_u32 s33, s37, 3735552
  s_add_u32 m0, s38, 116736
  s_nop 0
  buffer_load_dwordx4 v3, s[20:23], s33 offen lds
  s_add_u32 s33, s37, 3768320
  s_add_u32 m0, s38, 117760
  s_nop 0
  buffer_load_dwordx4 v3, s[20:23], s33 offen lds
  s_waitcnt vmcnt(20)
  s_barrier
  ds_read_b64_tr_b16 a[64:65], v4 offset:32768
  ds_read_b64_tr_b16 a[66:67], v4 offset:33792
  ds_read_b64_tr_b16 a[68:69], v4 offset:40960
  ds_read_b64_tr_b16 a[70:71], v4 offset:41984
  ds_read_b64_tr_b16 a[72:73], v5 offset:32768
  ds_read_b64_tr_b16 a[74:75], v5 offset:33792
  ds_read_b64_tr_b16 a[76:77], v5 offset:40960
  ds_read_b64_tr_b16 a[78:79], v5 offset:41984
  s_waitcnt lgkmcnt(0)
  s_add_u32 s33, s37, 0
  s_add_u32 m0, s38, 0
  s_nop 0
  buffer_load_dwordx4 v2, s[24:27], s33 offen lds
  s_add_u32 s33, s37, 32768
  s_add_u32 m0, s38, 1024
  s_nop 0
  buffer_load_dwordx4 v2, s[24:27], s33 offen lds
  s_add_u32 s33, s37, 65536
  s_add_u32 m0, s38, 2048
  s_nop 0
  buffer_load_dwordx4 v3, s[24:27], s33 offen lds
  s_add_u32 s33, s37, 98304
  s_add_u32 m0, s38, 3072
  s_nop 0
  buffer_load_dwordx4 v3, s[24:27], s33 offen lds
  s_waitcnt vmcnt(20)
  s_barrier
  ds_read_b64_tr_b16 a[80:81], v4 offset:49152
  ds_read_b64_tr_b16 a[82:83], v4 offset:50176
  ds_read_b64_tr_b16 a[84:85], v4 offset:57344
  ds_read_b64_tr_b16 a[86:87], v4 offset:58368
  ds_read_b64_tr_b16 a[88:89], v5 offset:49152
  ds_read_b64_tr_b16 a[90:91], v5 offset:50176
  ds_read_b64_tr_b16 a[92:93], v5 offset:57344
  ds_read_b64_tr_b16 a[94:95], v5 offset:58368
  s_waitcnt lgkmcnt(0)
  s_add_u32 s33, s37, 524288
  s_add_u32 m0, s38, 16384
  s_nop 0
  buffer_load_dwordx4 v2, s[24:27], s33 offen lds
  s_add_u32 s33, s37, 557056
  s_add_u32 m0, s38, 17408
  s_nop 0
  buffer_load_dwordx4 v2, s[24:27], s33 offen lds
  s_add_u32 s33, s37, 589824
  s_add_u32 m0, s38, 18432
  s_nop 0
  buffer_load_dwordx4 v3, s[24:27], s33 offen lds
  s_add_u32 s33, s37, 622592
  s_add_u32 m0, s38, 19456
  s_nop 0
  buffer_load_dwordx4 v3, s[24:27], s33 offen lds
  s_waitcnt vmcnt(20)
  s_barrier
  ds_read_b64_tr_b16 a[96:97], v6 offset:0
  ds_read_b64_tr_b16 a[98:99], v6 offset:1024
  ds_read_b64_tr_b16 a[100:101], v6 offset:8192
  ds_read_b64_tr_b16 a[102:103], v6 offset:9216
  ds_read_b64_tr_b16 a[104:105], v7 offset:0
  ds_read_b64_tr_b16 a[106:107], v7 offset:1024
  ds_read_b64_tr_b16 a[108:109], v7 offset:8192
  ds_read_b64_tr_b16 a[110:111], v7 offset:9216
  s_waitcnt lgkmcnt(0)
  s_add_u32 s33, s37, 1048576
  s_add_u32 m0, s38, 32768
  s_nop 0
  buffer_load_dwordx4 v2, s[24:27], s33 offen lds
  s_add_u32 s33, s37, 1081344
  s_add_u32 m0, s38, 33792
  s_nop 0
  buffer_load_dwordx4 v2, s[24:27], s33 offen lds
  s_add_u32 s33, s37, 1114112
  s_add_u32 m0, s38, 34816
  s_nop 0
  buffer_load_dwordx4 v3, s[24:27], s33 offen lds
  s_add_u32 s33, s37, 1146880
  s_add_u32 m0, s38, 35840
  s_nop 0
  buffer_load_dwordx4 v3, s[24:27], s33 offen lds
  s_waitcnt vmcnt(20)
  s_barrier
  ds_read_b64_tr_b16 a[112:113], v6 offset:16384
  ds_read_b64_tr_b16 a[114:115], v6 offset:17408
  ds_read_b64_tr_b16 a[116:117], v6 offset:24576
  ds_read_b64_tr_b16 a[118:119], v6 offset:25600
  ds_read_b64_tr_b16 a[120:121], v7 offset:16384
  ds_read_b64_tr_b16 a[122:123], v7 offset:17408
  ds_read_b64_tr_b16 a[124:125], v7 offset:24576
  ds_read_b64_tr_b16 a[126:127], v7 offset:25600
  s_waitcnt lgkmcnt(0)
  s_add_u32 s33, s37, 1572864
  s_add_u32 m0, s38, 49152
  s_nop 0
  buffer_load_dwordx4 v2, s[24:27], s33 offen lds
  s_add_u32 s33, s37, 1605632
  s_add_u32 m0, s38, 50176
  s_nop 0
  buffer_load_dwordx4 v2, s[24:27], s33 offen lds
  s_add_u32 s33, s37, 1638400
  s_add_u32 m0, s38, 51200
  s_nop 0
  buffer_load_dwordx4 v3, s[24:27], s33 offen lds
  s_add_u32 s33, s37, 1671168
  s_add_u32 m0, s38, 52224
  s_nop 0
  buffer_load_dwordx4 v3, s[24:27], s33 offen lds
  s_waitcnt vmcnt(20)
  s_barrier
  ds_read_b64_tr_b16 a[0:1], v6 offset:32768
  ds_read_b64_tr_b16 a[2:3], v6 offset:33792
  ds_read_b64_tr_b16 a[4:5], v6 offset:40960
  ds_read_b64_tr_b16 a[6:7], v6 offset:41984
  ds_read_b64_tr_b16 a[8:9], v7 offset:32768
  ds_read_b64_tr_b16 a[10:11], v7 offset:33792
  ds_read_b64_tr_b16 a[12:13], v7 offset:40960
  ds_read_b64_tr_b16 a[14:15], v7 offset:41984
  s_waitcnt lgkmcnt(0)
  s_add_u32 s33, s37, 2097152
  s_add_u32 m0, s38, 65536
  s_nop 0
  buffer_load_dwordx4 v2, s[24:27], s33 offen lds
  s_add_u32 s33, s37, 2129920
  s_add_u32 m0, s38, 66560
  s_nop 0
  buffer_load_dwordx4 v2, s[24:27], s33 offen lds
  s_add_u32 s33, s37, 2162688
  s_add_u32 m0, s38, 67584
  s_nop 0
  buffer_load_dwordx4 v3, s[24:27], s33 offen lds
  s_add_u32 s33, s37, 2195456
  s_add_u32 m0, s38, 68608
  s_nop 0
  buffer_load_dwordx4 v3, s[24:27], s33 offen lds
  s_waitcnt vmcnt(20)
  s_barrier
  ds_read_b64_tr_b16 a[16:17], v6 offset:49152
  ds_read_b64_tr_b16 a[18:19], v6 offset:50176
  ds_read_b64_tr_b16 a[20:21], v6 offset:57344
  ds_read_b64_tr_b16 a[22:23], v6 offset:58368
  ds_read_b64_tr_b16 a[24:25], v7 offset:49152
  ds_read_b64_tr_b16 a[26:27], v7 offset:50176
  ds_read_b64_tr_b16 a[28:29], v7 offset:57344
  ds_read_b64_tr_b16 a[30:31], v7 offset:58368
  s_waitcnt lgkmcnt(0)
  s_add_u32 s33, s37, 2621440
  s_add_u32 m0, s38, 81920
  s_nop 0
  buffer_load_dwordx4 v2, s[24:27], s33 offen lds
  s_add_u32 s33, s37, 2654208
  s_add_u32 m0, s38, 82944
  s_nop 0
  buffer_load_dwordx4 v2, s[24:27], s33 offen lds
  s_add_u32 s33, s37, 2686976
  s_add_u32 m0, s38, 83968
  s_nop 0
  buffer_load_dwordx4 v3, s[24:27], s33 offen lds
  s_add_u32 s33, s37, 2719744
  s_add_u32 m0, s38, 84992
  s_nop 0
  buffer_load_dwordx4 v3, s[24:27], s33 offen lds
  s_waitcnt vmcnt(20)
  s_barrier
  ds_read_b64_tr_b16 a[160:161], v4 offset:0
  ds_read_b64_tr_b16 a[162:163], v4 offset:1024
  ds_read_b64_tr_b16 a[164:165], v4 offset:8192
  ds_read_b64_tr_b16 a[166:167], v4 offset:9216
  ds_read_b64_tr_b16 a[168:169], v5 offset:0
  ds_read_b64_tr_b16 a[170:171], v5 offset:1024
  ds_read_b64_tr_b16 a[172:173], v5 offset:8192
  ds_read_b64_tr_b16 a[174:175], v5 offset:9216
  s_waitcnt lgkmcnt(0)
  s_add_u32 s33, s37, 3145728
  s_add_u32 m0, s38, 98304
  s_nop 0
  buffer_load_dwordx4 v2, s[24:27], s33 offen lds
  s_add_u32 s33, s37, 3178496
  s_add_u32 m0, s38, 99328
  s_nop 0
  buffer_load_dwordx4 v2, s[24:27], s33 offen lds
  s_add_u32 s33, s37, 3211264
  s_add_u32 m0, s38, 100352
  s_nop 0
  buffer_load_dwordx4 v3, s[24:27], s33 offen lds
  s_add_u32 s33, s37, 3244032
  s_add_u32 m0, s38, 101376
  s_nop 0
  buffer_load_dwordx4 v3, s[24:27], s33 offen lds
  s_waitcnt vmcnt(20)
  s_barrier
  ds_read_b64_tr_b16 a[176:177], v4 offset:16384
  ds_read_b64_tr_b16 a[178:179], v4 offset:17408
  ds_read_b64_tr_b16 a[180:181], v4 offset:24576
  ds_read_b64_tr_b16 a[182:183], v4 offset:25600
  ds_read_b64_tr_b16 a[184:185], v5 offset:16384
  ds_read_b64_tr_b16 a[186:187], v5 offset:17408
  ds_read_b64_tr_b16 a[188:189], v5 offset:24576
  ds_read_b64_tr_b16 a[190:191], v5 offset:25600
  s_waitcnt lgkmcnt(0)
  s_add_u32 s33, s37, 3670016
  s_add_u32 m0, s38, 114688
  s_nop 0
  buffer_load_dwordx4 v2, s[24:27], s33 offen lds
  s_add_u32 s33, s37, 3702784
  s_add_u32 m0, s38, 115712
  s_nop 0
  buffer_load_dwordx4 v2, s[24:27], s33 offen lds
  s_add_u32 s33, s37, 3735552
  s_add_u32 m0, s38, 116736
  s_nop 0
  buffer_load_dwordx4 v3, s[24:27], s33 offen lds
  s_add_u32 s33, s37, 3768320
  s_add_u32 m0, s38, 117760
  s_nop 0
  buffer_load_dwordx4 v3, s[24:27], s33 offen lds
  s_waitcnt vmcnt(20)
  s_barrier
  ds_read_b64_tr_b16 a[192:193], v4 offset:32768
  ds_read_b64_tr_b16 a[194:195], v4 offset:33792
  ds_read_b64_tr_b16 a[196:197], v4 offset:40960
  ds_read_b64_tr_b16 a[198:199], v4 offset:41984
  ds_read_b64_tr_b16 a[200:201], v5 offset:32768
  ds_read_b64_tr_b16 a[202:203], v5 offset:33792
  ds_read_b64_tr_b16 a[204:205], v5 offset:40960
  ds_read_b64_tr_b16 a[206:207], v5 offset:41984
  s_waitcnt lgkmcnt(0)
  s_waitcnt vmcnt(16)
  s_barrier
  ds_read_b64_tr_b16 a[208:209], v4 offset:49152
  ds_read_b64_tr_b16 a[210:211], v4 offset:50176
  ds_read_b64_tr_b16 a[212:213], v4 offset:57344
  ds_read_b64_tr_b16 a[214:215], v4 offset:58368
  ds_read_b64_tr_b16 a[216:217], v5 offset:49152
  ds_read_b64_tr_b16 a[218:219], v5 offset:50176
  ds_read_b64_tr_b16 a[220:221], v5 offset:57344
  ds_read_b64_tr_b16 a[222:223], v5 offset:58368
  s_waitcnt lgkmcnt(0)
  s_waitcnt vmcnt(12)
  s_barrier
  ds_read_b64_tr_b16 a[224:225], v6 offset:0
  ds_read_b64_tr_b16 a[226:227], v6 offset:1024
  ds_read_b64_tr_b16 a[228:229], v6 offset:8192
  ds_read_b64_tr_b16 a[230:231], v6 offset:9216
  ds_read_b64_tr_b16 a[232:233], v7 offset:0
  ds_read_b64_tr_b16 a[234:235], v7 offset:1024
  ds_read_b64_tr_b16 a[236:237], v7 offset:8192
  ds_read_b64_tr_b16 a[238:239], v7 offset:9216
  s_waitcnt lgkmcnt(0)
  s_waitcnt vmcnt(8)
  s_barrier
  ds_read_b64_tr_b16 a[240:241], v6 offset:16384
  ds_read_b64_tr_b16 a[242:243], v6 offset:17408
  ds_read_b64_tr_b16 a[244:245], v6 offset:24576
  ds_read_b64_tr_b16 a[246:247], v6 offset:25600
  ds_read_b64_tr_b16 a[248:249], v7 offset:16384
  ds_read_b64_tr_b16 a[250:251], v7 offset:17408
  ds_read_b64_tr_b16 a[252:253], v7 offset:24576
  ds_read_b64_tr_b16 a[254:255], v7 offset:25600
  s_waitcnt lgkmcnt(0)
  s_waitcnt vmcnt(4)
  s_barrier
  ds_read_b64_tr_b16 a[128:129], v6 offset:32768
  ds_read_b64_tr_b16 a[130:131], v6 offset:33792
  ds_read_b64_tr_b16 a[132:133], v6 offset:40960
  ds_read_b64_tr_b16 a[134:135], v6 offset:41984
  ds_read_b64_tr_b16 a[136:137], v7 offset:32768
  ds_read_b64_tr_b16 a[138:139], v7 offset:33792
  ds_read_b64_tr_b16 a[140:141], v7 offset:40960
  ds_read_b64_tr_b16 a[142:143], v7 offset:41984
  s_waitcnt lgkmcnt(0)
  s_waitcnt vmcnt(0)
  s_barrier
  ds_read_b64_tr_b16 a[144:145], v6 offset:49152
  ds_read_b64_tr_b16 a[146:147], v6 offset:50176
  ds_read_b64_tr_b16 a[148:149], v6 offset:57344
  ds_read_b64_tr_b16 a[150:151], v6 offset:58368
  ds_read_b64_tr_b16 a[152:153], v7 offset:49152
  ds_read_b64_tr_b16 a[154:155], v7 offset:50176
  ds_read_b64_tr_b16 a[156:157], v7 offset:57344
  ds_read_b64_tr_b16 a[158:159], v7 offset:58368
  s_waitcnt lgkmcnt(0)
LOADED_16:
  s_barrier
  v_mov_b32 v27, v0
  v_lshlrev_b32 v13, 4, v27
  v_and_b32 v26, 15, v27
  v_lshrrev_b32 v25, 4, v27
  s_lshl_b32 s33, s3, 8
  v_lshlrev_b32 v28, 17, v25
  v_lshlrev_b32 v29, 4, v26
  v_add3_u32 v18, v28, v29, s33
  v_lshlrev_b32 v28, 10, v25
  v_add3_u32 v20, v28, v29, s33
  v_lshrrev_b32 v28, 3, v27
  v_lshlrev_b32 v28, 10, v28
  v_and_b32 v29, 7, v27
  v_xor_b32 v29, v29, v25
  v_lshlrev_b32 v29, 4, v29
  v_add_u32 v19, v28, v29
  v_lshrrev_b32 v28, 1, v25
  v_lshlrev_b32 v28, 7, v28
  v_lshlrev_b32 v30, 3, v26
  v_add3_u32 v28, v28, v30, s33
  v_and_b32 v30, 1, v25
  v_lshlrev_b32 v30, 2, v30
  v_add_u32 v21, v28, v30
  v_and_b32 v29, 3, v26
  v_mov_b32 v30, 0x3f80
  v_mov_b32 v31, 0x3f800000
  v_cmp_eq_u32 vcc, 0, v29
  s_nop 1
  v_cndmask_b32 v30, v31, v30, vcc
  v_cmp_gt_u32 vcc, 2, v29
  s_nop 1
  v_cndmask_b32 v22, 0, v30, vcc
  s_mov_b32 s52, 0xf000f
  s_mov_b32 s53, 0xf000f
  s_mov_b32 s54, 0xf000f0
  s_mov_b32 s55, 0xf000f0
  s_mov_b32 s56, 0xf000f00
  s_mov_b32 s57, 0xf000f00
  s_mov_b32 s58, 0xf000f000
  s_mov_b32 s59, 0xf000f000
  v_and_b32 v28, 31, v27
  v_lshlrev_b32 v23, 2, v28
  s_lshl_b32 s33, s4, 21
  s_add_u32 s33, s33, 67108864
  s_lshl_b32 s34, s5, 10
  s_add_u32 s45, s33, s34
  s_lshl_b32 s34, s5, 15
  s_add_u32 s46, s33, s34
  s_lshl_b32 s33, s4, 9
  s_lshl_b32 s34, s3, 7
  s_add_u32 s33, s33, s34
  s_add_u32 s47, s33, 65536
  s_mov_b32 s43, 0
  s_lshl_b32 s33, s3, 11
  v_add_u32 v1, s33, v13
  v_lshrrev_b32 v28, 1, v26
  v_xor_b32 v28, v28, v25
  v_lshlrev_b32 v28, 4, v28
  v_lshlrev_b32 v29, 7, v26
  v_add_u32 v32, v28, v29
  s_add_u32 s33, s3, 0
  s_and_b32 s33, s33, 3
  s_lshl_b32 s34, s33, 13
  v_add_u32 v6, s34, v32
  s_lshl_b32 s33, s33, 15
  s_lshl_b32 s34, s3, 12
  s_add_u32 s33, s33, s34
  s_add_u32 s33, s33, 32768
  v_add_u32 v2, s33, v13
  s_add_u32 s33, s3, 1
  s_and_b32 s33, s33, 3
  s_lshl_b32 s34, s33, 13
  v_add_u32 v7, s34, v32
  s_lshl_b32 s34, s33, 11
  v_add_u32 v10, s34, v13
  s_lshl_b32 s33, s33, 15
  s_lshl_b32 s34, s3, 12
  s_add_u32 s33, s33, s34
  s_add_u32 s33, s33, 32768
  v_add_u32 v3, s33, v13
  s_add_u32 s33, s3, 2
  s_and_b32 s33, s33, 3
  s_lshl_b32 s34, s33, 13
  v_add_u32 v8, s34, v32
  s_lshl_b32 s34, s33, 11
  v_add_u32 v11, s34, v13
  s_lshl_b32 s33, s33, 15
  s_lshl_b32 s34, s3, 12
  s_add_u32 s33, s33, s34
  s_add_u32 s33, s33, 32768
  v_add_u32 v4, s33, v13
  s_add_u32 s33, s3, 3
  s_and_b32 s33, s33, 3
  s_lshl_b32 s34, s33, 13
  v_add_u32 v9, s34, v32
  s_lshl_b32 s34, s33, 11
  v_add_u32 v12, s34, v13
  s_lshl_b32 s33, s33, 15
  s_lshl_b32 s34, s3, 12
  s_add_u32 s33, s33, s34
  s_add_u32 s33, s33, 32768
  v_add_u32 v5, s33, v13
  v_lshrrev_b32 v28, 2, v26
  v_xor_b32 v29, v25, v28
  v_lshlrev_b32 v29, 3, v29
  v_lshlrev_b32 v30, 5, v26
  s_lshl_b32 s33, s3, 10
  s_add_u32 s33, s33, 24576
  v_add3_u32 v14, v29, v30, s33
  v_lshlrev_b32 v29, 2, v25
  v_add_u32 v29, v29, v28
  v_lshlrev_b32 v29, 5, v29
  v_and_b32 v30, 3, v26
  v_xor_b32 v31, v30, v25
  v_lshlrev_b32 v31, 3, v31
  s_mov_b32 s33, 24576
  v_add3_u32 v15, v29, v31, s33
  v_mov_b32 v28, 0x44444444
  v_mov_b32 v29, 0xeeeeeeee
  v_cmp_lt_u32 vcc, 1, v30
  s_nop 1
  v_cndmask_b32 v16, v28, v29, vcc
  v_lshlrev_b32 v28, 9, v25
  v_lshlrev_b32 v29, 4, v26
  s_lshr_b32 s33, s3, 1
  s_lshl_b32 s33, s33, 11
  s_and_b32 s34, s3, 1
  s_lshl_b32 s34, s34, 2
  s_add_u32 s33, s33, s34
  s_add_u32 s33, s33, 16384
  v_add3_u32 v17, v28, v29, s33
  s_sub_u32 s42, s4, 1
  s_mov_b64 s[50:51], 0
  v_and_b32 v25, 7, v27
  v_lshlrev_b32 v25, 2, v25
RDY_25:
  buffer_load_dword v24, v25, s[12:15], 0 offen offset:160 sc1
  s_waitcnt vmcnt(0)
  v_readlane_b32 s33, v24, s4
  v_and_b32 v24, 63, v24
  v_cmp_ne_u32 vcc, 32, v24
  s_cbranch_vccz RDYOK_26
  s_sleep 4
  s_sub_u32 s6, s6, 1
  s_cbranch_scc1 GIVEUP
  s_branch RDY_25
RDYOK_26:
  s_bfe_u32 s34, s33, 0x80006
  s_mul_i32 s34, s34, s34
  s_lshr_b32 s33, s33, 14
  s_lshl_b32 s33, s33, 5
  s_cmp_lg_u32 s33, s34
  s_cselect_b32 s7, 1, 0
  s_mov_b32 s48, s42
  s_bitcmp1_b64 s[50:51], s48
  s_cbranch_scc1 AP_H0OK
  s_mov_b32 s33, 81920
AP_H0:
  buffer_load_dword v24, v13, s[8:11], s33 offen sc1
  s_waitcnt vmcnt(0)
  v_cmp_ne_u32 s[50:51], 0, v24
  s_nop 3
  s_bitcmp1_b64 s[50:51], s48
  s_cbranch_scc1 AP_H0OK
  s_sleep 2
  s_sub_u32 s6, s6, 1
  s_cbranch_scc1 GIVEUP
  s_branch AP_H0
AP_H0OK:
  s_lshl_b32 s33, s48, 15
  s_add_u32 s33, s33, 2097152
  s_lshl_b32 s34, s3, 8
  s_add_u32 s34, s34, s33
  s_lshl_b32 s35, s3, 13
  s_add_u32 s39, s34, 0
  s_add_u32 m0, s35, 0
  s_nop 0
  buffer_load_dwordx4 v19, s[8:11], s39 offen sc1 lds
  s_add_u32 s39, s34, 16384
  s_add_u32 m0, s35, 2048
  s_nop 0
  buffer_load_dwordx4 v19, s[8:11], s39 offen sc1 lds
  s_add_u32 s39, s34, 128
  s_add_u32 m0, s35, 4096
  s_nop 0
  buffer_load_dwordx4 v19, s[8:11], s39 offen sc1 lds
  s_add_u32 s39, s34, 16512
  s_add_u32 m0, s35, 6144
  s_nop 0
  buffer_load_dwordx4 v19, s[8:11], s39 offen sc1 lds
  v_xor_b32 v19, 64, v19
  s_add_u32 s39, s34, 8192
  s_add_u32 m0, s35, 1024
  s_nop 0
  buffer_load_dwordx4 v19, s[8:11], s39 offen sc1 lds
  s_add_u32 s39, s34, 24576
  s_add_u32 m0, s35, 3072
  s_nop 0
  buffer_load_dwordx4 v19, s[8:11], s39 offen sc1 lds
  s_add_u32 s39, s34, 8320
  s_add_u32 m0, s35, 5120
  s_nop 0
  buffer_load_dwordx4 v19, s[8:11], s39 offen sc1 lds
  s_add_u32 s39, s34, 24704
  s_add_u32 m0, s35, 7168
  s_nop 0
  buffer_load_dwordx4 v19, s[8:11], s39 offen sc1 lds
  v_xor_b32 v19, 64, v19
  s_waitcnt vmcnt(0)
AP_KV:
  s_barrier
  ds_read_b128 v[60:63], v6 offset:0
  ds_read_b128 v[64:67], v6 offset:2048
  v_xor_b32 v6, 64, v6
  ds_read_b128 v[68:71], v6 offset:0
  ds_read_b128 v[72:75], v6 offset:2048
  v_xor_b32 v6, 64, v6
  ds_read_b128 v[76:79], v6 offset:4096
  ds_read_b128 v[80:83], v6 offset:6144
  v_xor_b32 v6, 64, v6
  s_waitcnt lgkmcnt(4)
  v_mfma_f32_16x16x32_bf16 v[28:31], a[0:3], v[60:63], 0
  ds_read_b128 v[84:87], v6 offset:4096
  v_mfma_f32_16x16x32_bf16 v[32:35], a[0:3], v[64:67], 0
  ds_read_b128 v[88:91], v6 offset:6144
  v_mfma_f32_16x16x32_bf16 v[36:39], a[8:11], v[60:63], 0
  v_xor_b32 v6, 64, v6
  v_mfma_f32_16x16x32_bf16 v[40:43], a[8:11], v[64:67], 0
  v_mfma_f32_16x16x32_bf16 v[44:47], v[60:63], a[128:131], 0
  v_mfma_f32_16x16x32_bf16 v[48:51], v[64:67], a[128:131], 0
  v_mfma_f32_16x16x32_bf16 v[52:55], v[60:63], a[136:139], 0
  v_mfma_f32_16x16x32_bf16 v[56:59], v[64:67], a[136:139], 0
  s_waitcnt lgkmcnt(4)
  v_mfma_f32_16x16x32_bf16 v[28:31], a[4:7], v[68:71], v[28:31]
  ds_read_b128 v[60:63], v7 offset:0
  v_mfma_f32_16x16x32_bf16 v[32:35], a[4:7], v[72:75], v[32:35]
  ds_read_b128 v[64:67], v7 offset:2048
  v_mfma_f32_16x16x32_bf16 v[36:39], a[12:15], v[68:71], v[36:39]
  v_xor_b32 v7, 64, v7
  v_mfma_f32_16x16x32_bf16 v[40:43], a[12:15], v[72:75], v[40:43]
  v_mfma_f32_16x16x32_bf16 v[44:47], v[68:71], a[132:135], v[44:47]
  v_mfma_f32_16x16x32_bf16 v[48:51], v[72:75], a[132:135], v[48:51]
  v_mfma_f32_16x16x32_bf16 v[52:55], v[68:71], a[140:143], v[52:55]
  v_mfma_f32_16x16x32_bf16 v[56:59], v[72:75], a[140:143], v[56:59]
  s_waitcnt lgkmcnt(4)
  v_mfma_f32_16x16x32_bf16 v[28:31], a[16:19], v[76:79], v[28:31]
  ds_read_b128 v[68:71], v7 offset:0
  v_mfma_f32_16x16x32_bf16 v[32:35], a[16:19], v[80:83], v[32:35]
  ds_read_b128 v[72:75], v7 offset:2048
  v_mfma_f32_16x16x32_bf16 v[36:39], a[24:27], v[76:79], v[36:39]
  v_xor_b32 v7, 64, v7
  v_mfma_f32_16x16x32_bf16 v[40:43], a[24:27], v[80:83], v[40:43]
  v_mfma_f32_16x16x32_bf16 v[44:47], v[76:79], a[144:147], v[44:47]
  v_mfma_f32_16x16x32_bf16 v[48:51], v[80:83], a[144:147], v[48:51]
  v_mfma_f32_16x16x32_bf16 v[52:55], v[76:79], a[152:155], v[52:55]
  v_mfma_f32_16x16x32_bf16 v[56:59], v[80:83], a[152:155], v[56:59]
  s_waitcnt lgkmcnt(4)
  v_mfma_f32_16x16x32_bf16 v[28:31], a[20:23], v[84:87], v[28:31]
  ds_read_b128 v[76:79], v7 offset:4096
  v_mfma_f32_16x16x32_bf16 v[32:35], a[20:23], v[88:91], v[32:35]
  ds_read_b128 v[80:83], v7 offset:6144
  v_mfma_f32_16x16x32_bf16 v[36:39], a[28:31], v[84:87], v[36:39]
  v_xor_b32 v7, 64, v7
  v_mfma_f32_16x16x32_bf16 v[40:43], a[28:31], v[88:91], v[40:43]
  v_mfma_f32_16x16x32_bf16 v[44:47], v[84:87], a[148:151], v[44:47]
  v_mfma_f32_16x16x32_bf16 v[48:51], v[88:91], a[148:151], v[48:51]
  v_mfma_f32_16x16x32_bf16 v[52:55], v[84:87], a[156:159], v[52:55]
  v_mfma_f32_16x16x32_bf16 v[56:59], v[88:91], a[156:159], v[56:59]
  s_waitcnt lgkmcnt(4)
  v_mfma_f32_16x16x32_bf16 v[28:31], a[32:35], v[60:63], v[28:31]
  ds_read_b128 v[84:87], v7 offset:4096
  v_mfma_f32_16x16x32_bf16 v[32:35], a[32:35], v[64:67], v[32:35]
  ds_read_b128 v[88:91], v7 offset:6144
  v_mfma_f32_16x16x32_bf16 v[36:39], a[40:43], v[60:63], v[36:39]
  v_xor_b32 v7, 64, v7
  v_mfma_f32_16x16x32_bf16 v[40:43], a[40:43], v[64:67], v[40:43]
  v_mfma_f32_16x16x32_bf16 v[44:47], v[60:63], a[160:163], v[44:47]
  v_mfma_f32_16x16x32_bf16 v[48:51], v[64:67], a[160:163], v[48:51]
  v_mfma_f32_16x16x32_bf16 v[52:55], v[60:63], a[168:171], v[52:55]
  v_mfma_f32_16x16x32_bf16 v[56:59], v[64:67], a[168:171], v[56:59]
  s_waitcnt lgkmcnt(4)
  v_mfma_f32_16x16x32_bf16 v[28:31], a[36:39], v[68:71], v[28:31]
  ds_read_b128 v[60:63], v8 offset:0
  v_mfma_f32_16x16x32_bf16 v[32:35], a[36:39], v[72:75], v[32:35]
  ds_read_b128 v[64:67], v8 offset:2048
  v_mfma_f32_16x16x32_bf16 v[36:39], a[44:47], v[68:71], v[36:39]
  v_xor_b32 v8, 64, v8
  v_mfma_f32_16x16x32_bf16 v[40:43], a[44:47], v[72:75], v[40:43]
  v_mfma_f32_16x16x32_bf16 v[44:47], v[68:71], a[164:167], v[44:47]
  v_mfma_f32_16x16x32_bf16 v[48:51], v[72:75], a[164:167], v[48:51]
  v_mfma_f32_16x16x32_bf16 v[52:55], v[68:71], a[172:175], v[52:55]
  v_mfma_f32_16x16x32_bf16 v[56:59], v[72:75], a[172:175], v[56:59]
  s_waitcnt lgkmcnt(4)
  v_mfma_f32_16x16x32_bf16 v[28:31], a[48:51], v[76:79], v[28:31]
  ds_read_b128 v[68:71], v8 offset:0
  v_mfma_f32_16x16x32_bf16 v[32:35], a[48:51], v[80:83], v[32:35]
  ds_read_b128 v[72:75], v8 offset:2048
  v_mfma_f32_16x16x32_bf16 v[36:39], a[56:59], v[76:79], v[36:39]
  v_xor_b32 v8, 64, v8
  v_mfma_f32_16x16x32_bf16 v[40:43], a[56:59], v[80:83], v[40:43]
  v_mfma_f32_16x16x32_bf16 v[44:47], v[76:79], a[176:179], v[44:47]
  v_mfma_f32_16x16x32_bf16 v[48:51], v[80:83], a[176:179], v[48:51]
  v_mfma_f32_16x16x32_bf16 v[52:55], v[76:79], a[184:187], v[52:55]
  v_mfma_f32_16x16x32_bf16 v[56:59], v[80:83], a[184:187], v[56:59]
  s_waitcnt lgkmcnt(4)
  v_mfma_f32_16x16x32_bf16 v[28:31], a[52:55], v[84:87], v[28:31]
  ds_read_b128 v[76:79], v8 offset:4096
  v_mfma_f32_16x16x32_bf16 v[32:35], a[52:55], v[88:91], v[32:35]
  ds_read_b128 v[80:83], v8 offset:6144
  v_mfma_f32_16x16x32_bf16 v[36:39], a[60:63], v[84:87], v[36:39]
  v_xor_b32 v8, 64, v8
  v_mfma_f32_16x16x32_bf16 v[40:43], a[60:63], v[88:91], v[40:43]
  v_mfma_f32_16x16x32_bf16 v[44:47], v[84:87], a[180:183], v[44:47]
  v_mfma_f32_16x16x32_bf16 v[48:51], v[88:91], a[180:183], v[48:51]
  v_mfma_f32_16x16x32_bf16 v[52:55], v[84:87], a[188:191], v[52:55]
  v_mfma_f32_16x16x32_bf16 v[56:59], v[88:91], a[188:191], v[56:59]
  s_waitcnt lgkmcnt(4)
  v_mfma_f32_16x16x32_bf16 v[28:31], a[64:67], v[60:63], v[28:31]
  ds_read_b128 v[84:87], v8 offset:4096
  v_mfma_f32_16x16x32_bf16 v[32:35], a[64:67], v[64:67], v[32:35]
  ds_read_b128 v[88:91], v8 offset:6144
  v_mfma_f32_16x16x32_bf16 v[36:39], a[72:75], v[60:63], v[36:39]
  v_xor_b32 v8, 64, v8
  v_mfma_f32_16x16x32_bf16 v[40:43], a[72:75], v[64:67], v[40:43]
  v_mfma_f32_16x16x32_bf16 v[44:47], v[60:63], a[192:195], v[44:47]
  v_mfma_f32_16x16x32_bf16 v[48:51], v[64:67], a[192:195], v[48:51]
  v_mfma_f32_16x16x32_bf16 v[52:55], v[60:63], a[200:203], v[52:55]
  v_mfma_f32_16x16x32_bf16 v[56:59], v[64:67], a[200:203], v[56:59]
  s_waitcnt lgkmcnt(4)
  v_mfma_f32_16x16x32_bf16 v[28:31], a[68:71], v[68:71], v[28:31]
  ds_read_b128 v[60:63], v9 offset:0
  v_mfma_f32_16x16x32_bf16 v[32:35], a[68:71], v[72:75], v[32:35]
  ds_read_b128 v[64:67], v9 offset:2048
  v_mfma_f32_16x16x32_bf16 v[36:39], a[76:79], v[68:71], v[36:39]
  v_xor_b32 v9, 64, v9
  v_mfma_f32_16x16x32_bf16 v[40:43], a[76:79], v[72:75], v[40:43]
  v_mfma_f32_16x16x32_bf16 v[44:47], v[68:71], a[196:199], v[44:47]
  v_mfma_f32_16x16x32_bf16 v[48:51], v[72:75], a[196:199], v[48:51]
  v_mfma_f32_16x16x32_bf16 v[52:55], v[68:71], a[204:207], v[52:55]
  v_mfma_f32_16x16x32_bf16 v[56:59], v[72:75], a[204:207], v[56:59]
  s_waitcnt lgkmcnt(4)
  v_mfma_f32_16x16x32_bf16 v[28:31], a[80:83], v[76:79], v[28:31]
  ds_read_b128 v[68:71], v9 offset:0
  v_mfma_f32_16x16x32_bf16 v[32:35], a[80:83], v[80:83], v[32:35]
  ds_read_b128 v[72:75], v9 offset:2048
  v_mfma_f32_16x16x32_bf16 v[36:39], a[88:91], v[76:79], v[36:39]
  v_xor_b32 v9, 64, v9
  v_mfma_f32_16x16x32_bf16 v[40:43], a[88:91], v[80:83], v[40:43]
  v_mfma_f32_16x16x32_bf16 v[44:47], v[76:79], a[208:211], v[44:47]
  v_mfma_f32_16x16x32_bf16 v[48:51], v[80:83], a[208:211], v[48:51]
  v_mfma_f32_16x16x32_bf16 v[52:55], v[76:79], a[216:219], v[52:55]
  v_mfma_f32_16x16x32_bf16 v[56:59], v[80:83], a[216:219], v[56:59]
  s_waitcnt lgkmcnt(4)
  v_mfma_f32_16x16x32_bf16 v[28:31], a[84:87], v[84:87], v[28:31]
  ds_read_b128 v[76:79], v9 offset:4096
  v_mfma_f32_16x16x32_bf16 v[32:35], a[84:87], v[88:91], v[32:35]
  ds_read_b128 v[80:83], v9 offset:6144
  v_mfma_f32_16x16x32_bf16 v[36:39], a[92:95], v[84:87], v[36:39]
  v_xor_b32 v9, 64, v9
  v_mfma_f32_16x16x32_bf16 v[40:43], a[92:95], v[88:91], v[40:43]
  v_mfma_f32_16x16x32_bf16 v[44:47], v[84:87], a[212:215], v[44:47]
  v_mfma_f32_16x16x32_bf16 v[48:51], v[88:91], a[212:215], v[48:51]
  v_mfma_f32_16x16x32_bf16 v[52:55], v[84:87], a[220:223], v[52:55]
  v_mfma_f32_16x16x32_bf16 v[56:59], v[88:91], a[220:223], v[56:59]
  s_waitcnt lgkmcnt(4)
  v_mfma_f32_16x16x32_bf16 v[28:31], a[96:99], v[60:63], v[28:31]
  ds_read_b128 v[84:87], v9 offset:4096
  v_mfma_f32_16x16x32_bf16 v[32:35], a[96:99], v[64:67], v[32:35]
  ds_read_b128 v[88:91], v9 offset:6144
  v_mfma_f32_16x16x32_bf16 v[36:39], a[104:107], v[60:63], v[36:39]
  v_xor_b32 v9, 64, v9
  v_mfma_f32_16x16x32_bf16 v[40:43], a[104:107], v[64:67], v[40:43]
  v_mfma_f32_16x16x32_bf16 v[44:47], v[60:63], a[224:227], v[44:47]
  v_mfma_f32_16x16x32_bf16 v[48:51], v[64:67], a[224:227], v[48:51]
  v_mfma_f32_16x16x32_bf16 v[52:55], v[60:63], a[232:235], v[52:55]
  v_mfma_f32_16x16x32_bf16 v[56:59], v[64:67], a[232:235], v[56:59]
  s_waitcnt lgkmcnt(4)
  v_mfma_f32_16x16x32_bf16 v[28:31], a[100:103], v[68:71], v[28:31]
  s_lshl_b32 s33, s48, 18
  v_mfma_f32_16x16x32_bf16 v[32:35], a[100:103], v[72:75], v[32:35]
  s_lshl_b32 s34, s5, 13
  v_mfma_f32_16x16x32_bf16 v[36:39], a[108:111], v[68:71], v[36:39]
  s_add_u32 s33, s33, s34
  v_mfma_f32_16x16x32_bf16 v[40:43], a[108:111], v[72:75], v[40:43]
  s_add_u32 s34, s33, 16777216
  v_mfma_f32_16x16x32_bf16 v[44:47], v[68:71], a[228:231], v[44:47]
  s_add_u32 s35, s33, 33554432
  v_mfma_f32_16x16x32_bf16 v[48:51], v[72:75], a[228:231], v[48:51]
  v_mfma_f32_16x16x32_bf16 v[52:55], v[68:71], a[236:239], v[52:55]
  v_mfma_f32_16x16x32_bf16 v[56:59], v[72:75], a[236:239], v[56:59]
  s_waitcnt lgkmcnt(2)
  v_mfma_f32_16x16x32_bf16 v[28:31], a[112:115], v[76:79], v[28:31]
  s_lshl_b32 s33, s5, 10
  v_mfma_f32_16x16x32_bf16 v[32:35], a[112:115], v[80:83], v[32:35]
  s_lshl_b32 s37, s48, 4
  v_mfma_f32_16x16x32_bf16 v[36:39], a[120:123], v[76:79], v[36:39]
  s_add_u32 s33, s33, s37
  v_mfma_f32_16x16x32_bf16 v[40:43], a[120:123], v[80:83], v[40:43]
  s_lshl_b32 s37, s3, 2
  v_mfma_f32_16x16x32_bf16 v[44:47], v[76:79], a[240:243], v[44:47]
  s_add_u32 s33, s33, s37
  v_mfma_f32_16x16x32_bf16 v[48:51], v[80:83], a[240:243], v[48:51]
  s_add_u32 s37, s33, 0
  v_mfma_f32_16x16x32_bf16 v[52:55], v[76:79], a[248:251], v[52:55]
  v_mfma_f32_16x16x32_bf16 v[56:59], v[80:83], a[248:251], v[56:59]
  s_waitcnt lgkmcnt(0)
  s_barrier
  v_mfma_f32_16x16x32_bf16 v[28:31], a[116:119], v[84:87], v[28:31]
  v_mfma_f32_16x16x32_bf16 v[32:35], a[116:119], v[88:91], v[32:35]
  v_mfma_f32_16x16x32_bf16 v[36:39], a[124:127], v[84:87], v[36:39]
  v_mfma_f32_16x16x32_bf16 v[40:43], a[124:127], v[88:91], v[40:43]
  v_mfma_f32_16x16x32_bf16 v[44:47], v[84:87], a[244:247], v[44:47]
  v_mfma_f32_16x16x32_bf16 v[48:51], v[88:91], a[244:247], v[48:51]
  v_mfma_f32_16x16x32_bf16 v[52:55], v[84:87], a[252:255], v[52:55]
  v_mfma_f32_16x16x32_bf16 v[56:59], v[88:91], a[252:255], v[56:59]
  v_cvt_pk_bf16_f32 v104, v28, v29
  v_cvt_pk_bf16_f32 v105, v30, v31
  v_cvt_pk_bf16_f32 v106, v36, v37
  v_cvt_pk_bf16_f32 v107, v38, v39
  buffer_store_dwordx4 v[104:107], v1, s[8:11], s34 offen offset:0 sc1
  v_cvt_pk_bf16_f32 v108, v32, v33
  v_cvt_pk_bf16_f32 v109, v34, v35
  v_cvt_pk_bf16_f32 v110, v40, v41
  v_cvt_pk_bf16_f32 v111, v42, v43
  buffer_store_dwordx4 v[108:111], v1, s[8:11], s34 offen offset:1024 sc1
  v_cvt_pk_bf16_f32 v112, v44, v45
  v_cvt_pk_bf16_f32 v113, v46, v47
  v_cvt_pk_bf16_f32 v114, v48, v49
  v_cvt_pk_bf16_f32 v115, v50, v51
  buffer_store_dwordx4 v[112:115], v1, s[8:11], s35 offen offset:0 sc1
  v_cvt_pk_bf16_f32 v116, v52, v53
  v_cvt_pk_bf16_f32 v117, v54, v55
  v_cvt_pk_bf16_f32 v118, v56, v57
  v_cvt_pk_bf16_f32 v119, v58, v59
  buffer_store_dwordx4 v[116:119], v1, s[8:11], s35 offen offset:1024 sc1
  s_add_u32 s48, s48, 5
  s_sub_u32 s33, s48, s42
  s_cmp_eq_u32 s33, 15
  s_cselect_b32 s48, s42, s48
  s_bitcmp1_b64 s[50:51], s48
  s_cbranch_scc1 AP_H1OK
  s_mov_b32 s33, 81920
AP_H1:
  buffer_load_dword v24, v13, s[8:11], s33 offen sc1
  s_waitcnt vmcnt(0)
  v_cmp_ne_u32 s[50:51], 0, v24
  s_nop 3
  s_bitcmp1_b64 s[50:51], s48
  s_cbranch_scc1 AP_H1OK
  s_sleep 2
  s_sub_u32 s6, s6, 1
  s_cbranch_scc1 GIVEUP
  s_branch AP_H1
AP_H1OK:
  s_lshl_b32 s33, s48, 15
  s_add_u32 s33, s33, 2097152
  s_lshl_b32 s34, s3, 8
  s_add_u32 s34, s34, s33
  s_lshl_b32 s35, s3, 13
  s_add_u32 s39, s34, 0
  s_add_u32 m0, s35, 0
  s_nop 0
  buffer_load_dwordx4 v19, s[8:11], s39 offen sc1 lds
  s_add_u32 s39, s34, 16384
  s_add_u32 m0, s35, 2048
  s_nop 0
  buffer_load_dwordx4 v19, s[8:11], s39 offen sc1 lds
  s_add_u32 s39, s34, 128
  s_add_u32 m0, s35, 4096
  s_nop 0
  buffer_load_dwordx4 v19, s[8:11], s39 offen sc1 lds
  s_add_u32 s39, s34, 16512
  s_add_u32 m0, s35, 6144
  s_nop 0
  buffer_load_dwordx4 v19, s[8:11], s39 offen sc1 lds
  v_xor_b32 v19, 64, v19
  s_add_u32 s39, s34, 8192
  s_add_u32 m0, s35, 1024
  s_nop 0
  buffer_load_dwordx4 v19, s[8:11], s39 offen sc1 lds
  s_add_u32 s39, s34, 24576
  s_add_u32 m0, s35, 3072
  s_nop 0
  buffer_load_dwordx4 v19, s[8:11], s39 offen sc1 lds
  s_add_u32 s39, s34, 8320
  s_add_u32 m0, s35, 5120
  s_nop 0
  buffer_load_dwordx4 v19, s[8:11], s39 offen sc1 lds
  s_add_u32 s39, s34, 24704
  s_add_u32 m0, s35, 7168
  s_nop 0
  buffer_load_dwordx4 v19, s[8:11], s39 offen sc1 lds
  v_xor_b32 v19, 64, v19
  v_mov_b32 v0, 2
  s_waitcnt vmcnt(8)
  s_mov_b64 exec, 1
  buffer_store_dword v0, off, s[8:11], s37 sc1
  s_mov_b64 exec, -1
  s_waitcnt vmcnt(1)
  s_cmp_lg_u32 s48, s42
  s_cbranch_scc1 AP_KV
  v_lshrrev_b32 v0, 4, v13
  s_mov_b32 s16, s74
  s_mov_b32 s17, s75
  s_mov_b32 s18, 4194304
  s_mov_b32 s19, 0x00020000
  s_mov_b32 s28, s68
  s_mov_b32 s29, s69
  s_mov_b32 s30, 4194304
  s_mov_b32 s31, 0x00020000
  v_bfe_u32 v10, v0, 4, 1
  v_lshlrev_b32 v10, 14, v10
  v_lshrrev_b32 v11, 5, v0
  v_lshlrev_b32 v11, 12, v11
  v_and_b32 v12, 15, v0
  v_lshlrev_b32 v13, 3, v12
  s_lshl_b32 s33, s3, 8
  v_add3_u32 v10, v10, v11, v13
  v_add_u32 v1, s33, v10
  v_lshrrev_b32 v10, 4, v0
  v_lshrrev_b32 v11, 1, v12
  v_xor_b32 v11, v11, v10
  v_lshlrev_b32 v11, 5, v11
  v_and_b32 v13, 1, v0
  v_lshlrev_b32 v13, 4, v13
  v_lshlrev_b32 v10, 13, v10
  v_add3_u32 v10, v10, v11, v13
  s_lshl_b32 s33, s3, 17
  v_add_u32 v2, s33, v10
  v_xor_b32 v3, 0x80, v2
  v_bfe_u32 v10, v0, 2, 2
  v_lshrrev_b32 v11, 4, v0
  v_lshlrev_b32 v13, 3, v11
  v_add_u32 v13, v13, v10
  v_lshlrev_b32 v13, 8, v13
  v_and_b32 v11, 1, v11
  v_lshlrev_b32 v11, 2, v11
  v_add_u32 v10, v10, v11
  s_lshl_b32 s33, s3, 1
  v_xor_b32 v10, s33, v10
  v_lshlrev_b32 v10, 5, v10
  v_and_b32 v11, 3, v0
  v_lshlrev_b32 v11, 3, v11
  v_add3_u32 v10, v10, v11, v13
  v_add_u32 v4, 32768, v10
  v_xor_b32 v5, 32, v4
  v_add_u32 v6, 0x10000, v4
  v_add_u32 v7, 0x10000, v5
  s_lshl_b32 s33, s3, 12
  s_add_u32 s33, s33, 32768
  v_lshlrev_b32 v10, 4, v0
  v_add_u32 v8, s33, v10
  v_add_u32 v9, 0x10000, v8
  s_lshl_b32 s36, s5, 17
  s_lshl_b32 s37, s5, 8
  s_lshl_b32 s38, s3, 12
  s_add_u32 s38, s38, 32768
  s_mov_b32 s39, 0x05040100
  s_mov_b32 s40, 0x07060302
  s_cmp_eq_u32 s3, 1
  s_cbranch_scc1 LDW1_29
  s_cmp_eq_u32 s3, 2
  s_cbranch_scc1 LDW2_30
  s_cmp_eq_u32 s3, 3
  s_cbranch_scc1 LDW3_31
LDW0_28:
  s_add_u32 s33, s36, 0
  buffer_load_dwordx2 v[16:17], v1, s[16:19], s33 offen offset:0
  buffer_load_dwordx2 v[18:19], v1, s[16:19], s33 offen offset:1024
  buffer_load_dwordx2 v[24:25], v1, s[16:19], s33 offen offset:2048
  buffer_load_dwordx2 v[26:27], v1, s[16:19], s33 offen offset:3072
  s_add_u32 s33, s36, 32768
  buffer_load_dwordx2 v[20:21], v1, s[16:19], s33 offen offset:0
  buffer_load_dwordx2 v[22:23], v1, s[16:19], s33 offen offset:1024
  buffer_load_dwordx2 v[28:29], v1, s[16:19], s33 offen offset:2048
  buffer_load_dwordx2 v[30:31], v1, s[16:19], s33 offen offset:3072
  s_add_u32 s33, s36, 8192
  buffer_load_dwordx2 v[32:33], v1, s[16:19], s33 offen offset:0
  buffer_load_dwordx2 v[34:35], v1, s[16:19], s33 offen offset:1024
  buffer_load_dwordx2 v[40:41], v1, s[16:19], s33 offen offset:2048
  buffer_load_dwordx2 v[42:43], v1, s[16:19], s33 offen offset:3072
  s_add_u32 s33, s36, 40960
  buffer_load_dwordx2 v[36:37], v1, s[16:19], s33 offen offset:0
  buffer_load_dwordx2 v[38:39], v1, s[16:19], s33 offen offset:1024
  buffer_load_dwordx2 v[44:45], v1, s[16:19], s33 offen offset:2048
  buffer_load_dwordx2 v[46:47], v1, s[16:19], s33 offen offset:3072
  s_add_u32 s33, s36, 0
  buffer_load_dwordx2 v[48:49], v1, s[16:19], s33 offen offset:128
  buffer_load_dwordx2 v[50:51], v1, s[16:19], s33 offen offset:1152
  buffer_load_dwordx2 v[56:57], v1, s[16:19], s33 offen offset:2176
  buffer_load_dwordx2 v[58:59], v1, s[16:19], s33 offen offset:3200
  s_add_u32 s33, s36, 32768
  buffer_load_dwordx2 v[52:53], v1, s[16:19], s33 offen offset:128
  buffer_load_dwordx2 v[54:55], v1, s[16:19], s33 offen offset:1152
  buffer_load_dwordx2 v[60:61], v1, s[16:19], s33 offen offset:2176
  buffer_load_dwordx2 v[62:63], v1, s[16:19], s33 offen offset:3200
  s_add_u32 s33, s36, 8192
  buffer_load_dwordx2 v[64:65], v1, s[16:19], s33 offen offset:128
  buffer_load_dwordx2 v[66:67], v1, s[16:19], s33 offen offset:1152
  buffer_load_dwordx2 v[72:73], v1, s[16:19], s33 offen offset:2176
  buffer_load_dwordx2 v[74:75], v1, s[16:19], s33 offen offset:3200
  s_add_u32 s33, s36, 40960
  buffer_load_dwordx2 v[68:69], v1, s[16:19], s33 offen offset:128
  buffer_load_dwordx2 v[70:71], v1, s[16:19], s33 offen offset:1152
  buffer_load_dwordx2 v[76:77], v1, s[16:19], s33 offen offset:2176
  buffer_load_dwordx2 v[78:79], v1, s[16:19], s33 offen offset:3200
  s_add_u32 s33, s36, 65536
  buffer_load_dwordx2 v[80:81], v1, s[16:19], s33 offen offset:0
  buffer_load_dwordx2 v[82:83], v1, s[16:19], s33 offen offset:1024
  buffer_load_dwordx2 v[88:89], v1, s[16:19], s33 offen offset:2048
  buffer_load_dwordx2 v[90:91], v1, s[16:19], s33 offen offset:3072
  s_add_u32 s33, s36, 98304
  buffer_load_dwordx2 v[84:85], v1, s[16:19], s33 offen offset:0
  buffer_load_dwordx2 v[86:87], v1, s[16:19], s33 offen offset:1024
  buffer_load_dwordx2 v[92:93], v1, s[16:19], s33 offen offset:2048
  buffer_load_dwordx2 v[94:95], v1, s[16:19], s33 offen offset:3072
  s_add_u32 s33, s36, 73728
  buffer_load_dwordx2 v[96:97], v1, s[16:19], s33 offen offset:0
  buffer_load_dwordx2 v[98:99], v1, s[16:19], s33 offen offset:1024
  buffer_load_dwordx2 v[104:105], v1, s[16:19], s33 offen offset:2048
  buffer_load_dwordx2 v[106:107], v1, s[16:19], s33 offen offset:3072
  s_add_u32 s33, s36, 106496
  buffer_load_dwordx2 v[100:101], v1, s[16:19], s33 offen offset:0
  buffer_load_dwordx2 v[102:103], v1, s[16:19], s33 offen offset:1024
  buffer_load_dwordx2 v[108:109], v1, s[16:19], s33 offen offset:2048
  buffer_load_dwordx2 v[110:111], v1, s[16:19], s33 offen offset:3072
  s_waitcnt vmcnt(40)
  v_perm_b32 v128, v18, v16, s39
  v_perm_b32 v129, v22, v20, s39
  v_perm_b32 v130, v26, v24, s39
  v_perm_b32 v131, v30, v28, s39
  v_perm_b32 v144, v18, v16, s40
  v_perm_b32 v145, v22, v20, s40
  v_perm_b32 v146, v26, v24, s40
  v_perm_b32 v147, v30, v28, s40
  v_perm_b32 v160, v19, v17, s39
  v_perm_b32 v161, v23, v21, s39
  v_perm_b32 v162, v27, v25, s39
  v_perm_b32 v163, v31, v29, s39
  v_perm_b32 v176, v19, v17, s40
  v_perm_b32 v177, v23, v21, s40
  v_perm_b32 v178, v27, v25, s40
  v_perm_b32 v179, v31, v29, s40
  s_add_u32 s33, s36, 65536
  buffer_load_dwordx2 v[16:17], v1, s[16:19], s33 offen offset:128
  buffer_load_dwordx2 v[18:19], v1, s[16:19], s33 offen offset:1152
  buffer_load_dwordx2 v[24:25], v1, s[16:19], s33 offen offset:2176
  buffer_load_dwordx2 v[26:27], v1, s[16:19], s33 offen offset:3200
  s_add_u32 s33, s36, 98304
  buffer_load_dwordx2 v[20:21], v1, s[16:19], s33 offen offset:128
  buffer_load_dwordx2 v[22:23], v1, s[16:19], s33 offen offset:1152
  buffer_load_dwordx2 v[28:29], v1, s[16:19], s33 offen offset:2176
  buffer_load_dwordx2 v[30:31], v1, s[16:19], s33 offen offset:3200
  s_waitcnt vmcnt(40)
  v_perm_b32 v132, v34, v32, s39
  v_perm_b32 v133, v38, v36, s39
  v_perm_b32 v134, v42, v40, s39
  v_perm_b32 v135, v46, v44, s39
  v_perm_b32 v148, v34, v32, s40
  v_perm_b32 v149, v38, v36, s40
  v_perm_b32 v150, v42, v40, s40
  v_perm_b32 v151, v46, v44, s40
  v_perm_b32 v164, v35, v33, s39
  v_perm_b32 v165, v39, v37, s39
  v_perm_b32 v166, v43, v41, s39
  v_perm_b32 v167, v47, v45, s39
  v_perm_b32 v180, v35, v33, s40
  v_perm_b32 v181, v39, v37, s40
  v_perm_b32 v182, v43, v41, s40
  v_perm_b32 v183, v47, v45, s40
  s_add_u32 s33, s36, 73728
  buffer_load_dwordx2 v[32:33], v1, s[16:19], s33 offen offset:128
  buffer_load_dwordx2 v[34:35], v1, s[16:19], s33 offen offset:1152
  buffer_load_dwordx2 v[40:41], v1, s[16:19], s33 offen offset:2176
  buffer_load_dwordx2 v[42:43], v1, s[16:19], s33 offen offset:3200
  s_add_u32 s33, s36, 106496
  buffer_load_dwordx2 v[36:37], v1, s[16:19], s33 offen offset:128
  buffer_load_dwordx2 v[38:39], v1, s[16:19], s33 offen offset:1152
  buffer_load_dwordx2 v[44:45], v1, s[16:19], s33 offen offset:2176
  buffer_load_dwordx2 v[46:47], v1, s[16:19], s33 offen offset:3200
  s_waitcnt vmcnt(40)
  v_perm_b32 v192, v50, v48, s39
  v_perm_b32 v193, v54, v52, s39
  v_perm_b32 v194, v58, v56, s39
  v_perm_b32 v195, v62, v60, s39
  v_perm_b32 v208, v50, v48, s40
  v_perm_b32 v209, v54, v52, s40
  v_perm_b32 v210, v58, v56, s40
  v_perm_b32 v211, v62, v60, s40
  v_perm_b32 v224, v51, v49, s39
  v_perm_b32 v225, v55, v53, s39
  v_perm_b32 v226, v59, v57, s39
  v_perm_b32 v227, v63, v61, s39
  v_perm_b32 v240, v51, v49, s40
  v_perm_b32 v241, v55, v53, s40
  v_perm_b32 v242, v59, v57, s40
  v_perm_b32 v243, v63, v61, s40
  s_add_u32 s33, s37, 0
  s_add_u32 m0, s38, 0
  s_nop 0
  buffer_load_dwordx4 v2, s[28:31], s33 offen lds
  s_add_u32 s33, s37, 32768
  s_add_u32 m0, s38, 1024
  s_nop 0
  buffer_load_dwordx4 v2, s[28:31], s33 offen lds
  s_add_u32 s33, s37, 65536
  s_add_u32 m0, s38, 2048
  s_nop 0
  buffer_load_dwordx4 v3, s[28:31], s33 offen lds
  s_add_u32 s33, s37, 98304
  s_add_u32 m0, s38, 3072
  s_nop 0
  buffer_load_dwordx4 v3, s[28:31], s33 offen lds
  s_waitcnt vmcnt(36)
  v_perm_b32 v196, v66, v64, s39
  v_perm_b32 v197, v70, v68, s39
  v_perm_b32 v198, v74, v72, s39
  v_perm_b32 v199, v78, v76, s39
  v_perm_b32 v212, v66, v64, s40
  v_perm_b32 v213, v70, v68, s40
  v_perm_b32 v214, v74, v72, s40
  v_perm_b32 v215, v78, v76, s40
  v_perm_b32 v228, v67, v65, s39
  v_perm_b32 v229, v71, v69, s39
  v_perm_b32 v230, v75, v73, s39
  v_perm_b32 v231, v79, v77, s39
  v_perm_b32 v244, v67, v65, s40
  v_perm_b32 v245, v71, v69, s40
  v_perm_b32 v246, v75, v73, s40
  v_perm_b32 v247, v79, v77, s40
  s_add_u32 s33, s37, 524288
  s_add_u32 m0, s38, 16384
  s_nop 0
  buffer_load_dwordx4 v2, s[28:31], s33 offen lds
  s_add_u32 s33, s37, 557056
  s_add_u32 m0, s38, 17408
  s_nop 0
  buffer_load_dwordx4 v2, s[28:31], s33 offen lds
  s_add_u32 s33, s37, 589824
  s_add_u32 m0, s38, 18432
  s_nop 0
  buffer_load_dwordx4 v3, s[28:31], s33 offen lds
  s_add_u32 s33, s37, 622592
  s_add_u32 m0, s38, 19456
  s_nop 0
  buffer_load_dwordx4 v3, s[28:31], s33 offen lds
  s_waitcnt vmcnt(32)
  v_perm_b32 v136, v82, v80, s39
  v_perm_b32 v137, v86, v84, s39
  v_perm_b32 v138, v90, v88, s39
  v_perm_b32 v139, v94, v92, s39
  v_perm_b32 v152, v82, v80, s40
  v_perm_b32 v153, v86, v84, s40
  v_perm_b32 v154, v90, v88, s40
  v_perm_b32 v155, v94, v92, s40
  v_perm_b32 v168, v83, v81, s39
  v_perm_b32 v169, v87, v85, s39
  v_perm_b32 v170, v91, v89, s39
  v_perm_b32 v171, v95, v93, s39
  v_perm_b32 v184, v83, v81, s40
  v_perm_b32 v185, v87, v85, s40
  v_perm_b32 v186, v91, v89, s40
  v_perm_b32 v187, v95, v93, s40
  s_add_u32 s33, s37, 1048576
  s_add_u32 m0, s38, 32768
  s_nop 0
  buffer_load_dwordx4 v2, s[28:31], s33 offen lds
  s_add_u32 s33, s37, 1081344
  s_add_u32 m0, s38, 33792
  s_nop 0
  buffer_load_dwordx4 v2, s[28:31], s33 offen lds
  s_add_u32 s33, s37, 1114112
  s_add_u32 m0, s38, 34816
  s_nop 0
  buffer_load_dwordx4 v3, s[28:31], s33 offen lds
  s_add_u32 s33, s37, 1146880
  s_add_u32 m0, s38, 35840
  s_nop 0
  buffer_load_dwordx4 v3, s[28:31], s33 offen lds
  s_waitcnt vmcnt(28)
  v_perm_b32 v140, v98, v96, s39
  v_perm_b32 v141, v102, v100, s39
  v_perm_b32 v142, v106, v104, s39
  v_perm_b32 v143, v110, v108, s39
  v_perm_b32 v156, v98, v96, s40
  v_perm_b32 v157, v102, v100, s40
  v_perm_b32 v158, v106, v104, s40
  v_perm_b32 v159, v110, v108, s40
  v_perm_b32 v172, v99, v97, s39
  v_perm_b32 v173, v103, v101, s39
  v_perm_b32 v174, v107, v105, s39
  v_perm_b32 v175, v111, v109, s39
  v_perm_b32 v188, v99, v97, s40
  v_perm_b32 v189, v103, v101, s40
  v_perm_b32 v190, v107, v105, s40
  v_perm_b32 v191, v111, v109, s40
  s_add_u32 s33, s37, 1572864
  s_add_u32 m0, s38, 49152
  s_nop 0
  buffer_load_dwordx4 v2, s[28:31], s33 offen lds
  s_add_u32 s33, s37, 1605632
  s_add_u32 m0, s38, 50176
  s_nop 0
  buffer_load_dwordx4 v2, s[28:31], s33 offen lds
  s_add_u32 s33, s37, 1638400
  s_add_u32 m0, s38, 51200
  s_nop 0
  buffer_load_dwordx4 v3, s[28:31], s33 offen lds
  s_add_u32 s33, s37, 1671168
  s_add_u32 m0, s38, 52224
  s_nop 0
  buffer_load_dwordx4 v3, s[28:31], s33 offen lds
  s_waitcnt vmcnt(24)
  v_perm_b32 v200, v18, v16, s39
  v_perm_b32 v201, v22, v20, s39
  v_perm_b32 v202, v26, v24, s39
  v_perm_b32 v203, v30, v28, s39
  v_perm_b32 v216, v18, v16, s40
  v_perm_b32 v217, v22, v20, s40
  v_perm_b32 v218, v26, v24, s40
  v_perm_b32 v219, v30, v28, s40
  v_perm_b32 v232, v19, v17, s39
  v_perm_b32 v233, v23, v21, s39
  v_perm_b32 v234, v27, v25, s39
  v_perm_b32 v235, v31, v29, s39
  v_perm_b32 v248, v19, v17, s40
  v_perm_b32 v249, v23, v21, s40
  v_perm_b32 v250, v27, v25, s40
  v_perm_b32 v251, v31, v29, s40
  s_add_u32 s33, s37, 2097152
  s_add_u32 m0, s38, 65536
  s_nop 0
  buffer_load_dwordx4 v2, s[28:31], s33 offen lds
  s_add_u32 s33, s37, 2129920
  s_add_u32 m0, s38, 66560
  s_nop 0
  buffer_load_dwordx4 v2, s[28:31], s33 offen lds
  s_add_u32 s33, s37, 2162688
  s_add_u32 m0, s38, 67584
  s_nop 0
  buffer_load_dwordx4 v3, s[28:31], s33 offen lds
  s_add_u32 s33, s37, 2195456
  s_add_u32 m0, s38, 68608
  s_nop 0
  buffer_load_dwordx4 v3, s[28:31], s33 offen lds
  s_waitcnt vmcnt(20)
  v_perm_b32 v204, v34, v32, s39
  v_perm_b32 v205, v38, v36, s39
  v_perm_b32 v206, v42, v40, s39
  v_perm_b32 v207, v46, v44, s39
  v_perm_b32 v220, v34, v32, s40
  v_perm_b32 v221, v38, v36, s40
  v_perm_b32 v222, v42, v40, s40
  v_perm_b32 v223, v46, v44, s40
  v_perm_b32 v236, v35, v33, s39
  v_perm_b32 v237, v39, v37, s39
  v_perm_b32 v238, v43, v41, s39
  v_perm_b32 v239, v47, v45, s39
  v_perm_b32 v252, v35, v33, s40
  v_perm_b32 v253, v39, v37, s40
  v_perm_b32 v254, v43, v41, s40
  v_perm_b32 v255, v47, v45, s40
  s_add_u32 s33, s37, 2621440
  s_add_u32 m0, s38, 81920
  s_nop 0
  buffer_load_dwordx4 v2, s[28:31], s33 offen lds
  s_add_u32 s33, s37, 2654208
  s_add_u32 m0, s38, 82944
  s_nop 0
  buffer_load_dwordx4 v2, s[28:31], s33 offen lds
  s_add_u32 s33, s37, 2686976
  s_add_u32 m0, s38, 83968
  s_nop 0
  buffer_load_dwordx4 v3, s[28:31], s33 offen lds
  s_add_u32 s33, s37, 2719744
  s_add_u32 m0, s38, 84992
  s_nop 0
  buffer_load_dwordx4 v3, s[28:31], s33 offen lds
  s_waitcnt vmcnt(20)
  s_barrier
  ds_read_b64_tr_b16 v[16:17], v4 offset:0
  ds_read_b64_tr_b16 v[18:19], v4 offset:1024
  ds_read_b64_tr_b16 v[20:21], v4 offset:8192
  ds_read_b64_tr_b16 v[22:23], v4 offset:9216
  ds_read_b64_tr_b16 v[24:25], v5 offset:0
  ds_read_b64_tr_b16 v[26:27], v5 offset:1024
  ds_read_b64_tr_b16 v[28:29], v5 offset:8192
  ds_read_b64_tr_b16 v[30:31], v5 offset:9216
  s_waitcnt lgkmcnt(0)
  s_add_u32 s33, s37, 3145728
  s_add_u32 m0, s38, 98304
  s_nop 0
  buffer_load_dwordx4 v2, s[28:31], s33 offen lds
  s_add_u32 s33, s37, 3178496
  s_add_u32 m0, s38, 99328
  s_nop 0
  buffer_load_dwordx4 v2, s[28:31], s33 offen lds
  s_add_u32 s33, s37, 3211264
  s_add_u32 m0, s38, 100352
  s_nop 0
  buffer_load_dwordx4 v3, s[28:31], s33 offen lds
  s_add_u32 s33, s37, 3244032
  s_add_u32 m0, s38, 101376
  s_nop 0
  buffer_load_dwordx4 v3, s[28:31], s33 offen lds
  s_waitcnt vmcnt(20)
  s_barrier
  ds_write_b128 v8, v[16:19] offset:0
  ds_write_b128 v8, v[20:23] offset:1024
  ds_write_b128 v8, v[24:27] offset:2048
  ds_write_b128 v8, v[28:31] offset:3072
  ds_read_b64_tr_b16 v[32:33], v4 offset:16384
  ds_read_b64_tr_b16 v[34:35], v4 offset:17408
  ds_read_b64_tr_b16 v[36:37], v4 offset:24576
  ds_read_b64_tr_b16 v[38:39], v4 offset:25600
  ds_read_b64_tr_b16 v[40:41], v5 offset:16384
  ds_read_b64_tr_b16 v[42:43], v5 offset:17408
  ds_read_b64_tr_b16 v[44:45], v5 offset:24576
  ds_read_b64_tr_b16 v[46:47], v5 offset:25600
  s_waitcnt lgkmcnt(0)
  s_add_u32 s33, s37, 3670016
  s_add_u32 m0, s38, 114688
  s_nop 0
  buffer_load_dwordx4 v2, s[28:31], s33 offen lds
  s_add_u32 s33, s37, 3702784
  s_add_u32 m0, s38, 115712
  s_nop 0
  buffer_load_dwordx4 v2, s[28:31], s33 offen lds
  s_add_u32 s33, s37, 3735552
  s_add_u32 m0, s38, 116736
  s_nop 0
  buffer_load_dwordx4 v3, s[28:31], s33 offen lds
  s_add_u32 s33, s37, 3768320
  s_add_u32 m0, s38, 117760
  s_nop 0
  buffer_load_dwordx4 v3, s[28:31], s33 offen lds
  s_waitcnt vmcnt(20)
  s_barrier
  ds_write_b128 v8, v[32:35] offset:16384
  ds_write_b128 v8, v[36:39] offset:17408
  ds_write_b128 v8, v[40:43] offset:18432
  ds_write_b128 v8, v[44:47] offset:19456
  ds_read_b64_tr_b16 v[16:17], v4 offset:32768
  ds_read_b64_tr_b16 v[18:19], v4 offset:33792
  ds_read_b64_tr_b16 v[20:21], v4 offset:40960
  ds_read_b64_tr_b16 v[22:23], v4 offset:41984
  ds_read_b64_tr_b16 v[24:25], v5 offset:32768
  ds_read_b64_tr_b16 v[26:27], v5 offset:33792
  ds_read_b64_tr_b16 v[28:29], v5 offset:40960
  ds_read_b64_tr_b16 v[30:31], v5 offset:41984
  s_waitcnt lgkmcnt(0)
  s_waitcnt vmcnt(16)
  s_barrier
  ds_write_b128 v8, v[16:19] offset:32768
  ds_write_b128 v8, v[20:23] offset:33792
  ds_write_b128 v8, v[24:27] offset:34816
  ds_write_b128 v8, v[28:31] offset:35840
  ds_read_b64_tr_b16 v[32:33], v4 offset:49152
  ds_read_b64_tr_b16 v[34:35], v4 offset:50176
  ds_read_b64_tr_b16 v[36:37], v4 offset:57344
  ds_read_b64_tr_b16 v[38:39], v4 offset:58368
  ds_read_b64_tr_b16 v[40:41], v5 offset:49152
  ds_read_b64_tr_b16 v[42:43], v5 offset:50176
  ds_read_b64_tr_b16 v[44:45], v5 offset:57344
  ds_read_b64_tr_b16 v[46:47], v5 offset:58368
  s_waitcnt lgkmcnt(0)
  s_waitcnt vmcnt(12)
  s_barrier
  ds_write_b128 v8, v[32:35] offset:49152
  ds_write_b128 v8, v[36:39] offset:50176
  ds_write_b128 v8, v[40:43] offset:51200
  ds_write_b128 v8, v[44:47] offset:52224
  ds_read_b64_tr_b16 v[16:17], v6 offset:0
  ds_read_b64_tr_b16 v[18:19], v6 offset:1024
  ds_read_b64_tr_b16 v[20:21], v6 offset:8192
  ds_read_b64_tr_b16 v[22:23], v6 offset:9216
  ds_read_b64_tr_b16 v[24:25], v7 offset:0
  ds_read_b64_tr_b16 v[26:27], v7 offset:1024
  ds_read_b64_tr_b16 v[28:29], v7 offset:8192
  ds_read_b64_tr_b16 v[30:31], v7 offset:9216
  s_waitcnt lgkmcnt(0)
  s_waitcnt vmcnt(8)
  s_barrier
  ds_write_b128 v9, v[16:19] offset:0
  ds_write_b128 v9, v[20:23] offset:1024
  ds_write_b128 v9, v[24:27] offset:2048
  ds_write_b128 v9, v[28:31] offset:3072
  ds_read_b64_tr_b16 v[32:33], v6 offset:16384
  ds_read_b64_tr_b16 v[34:35], v6 offset:17408
  ds_read_b64_tr_b16 v[36:37], v6 offset:24576
  ds_read_b64_tr_b16 v[38:39], v6 offset:25600
  ds_read_b64_tr_b16 v[40:41], v7 offset:16384
  ds_read_b64_tr_b16 v[42:43], v7 offset:17408
  ds_read_b64_tr_b16 v[44:45], v7 offset:24576
  ds_read_b64_tr_b16 v[46:47], v7 offset:25600
  s_waitcnt lgkmcnt(0)
  s_waitcnt vmcnt(4)
  s_barrier
  ds_write_b128 v9, v[32:35] offset:16384
  ds_write_b128 v9, v[36:39] offset:17408
  ds_write_b128 v9, v[40:43] offset:18432
  ds_write_b128 v9, v[44:47] offset:19456
  ds_read_b64_tr_b16 v[16:17], v6 offset:32768
  ds_read_b64_tr_b16 v[18:19], v6 offset:33792
  ds_read_b64_tr_b16 v[20:21], v6 offset:40960
  ds_read_b64_tr_b16 v[22:23], v6 offset:41984
  ds_read_b64_tr_b16 v[24:25], v7 offset:32768
  ds_read_b64_tr_b16 v[26:27], v7 offset:33792
  ds_read_b64_tr_b16 v[28:29], v7 offset:40960
  ds_read_b64_tr_b16 v[30:31], v7 offset:41984
  s_waitcnt lgkmcnt(0)
  s_waitcnt vmcnt(0)
  s_barrier
  ds_write_b128 v9, v[16:19] offset:32768
  ds_write_b128 v9, v[20:23] offset:33792
  ds_write_b128 v9, v[24:27] offset:34816
  ds_write_b128 v9, v[28:31] offset:35840
  ds_read_b64_tr_b16 v[32:33], v6 offset:49152
  ds_read_b64_tr_b16 v[34:35], v6 offset:50176
  ds_read_b64_tr_b16 v[36:37], v6 offset:57344
  ds_read_b64_tr_b16 v[38:39], v6 offset:58368
  ds_read_b64_tr_b16 v[40:41], v7 offset:49152
  ds_read_b64_tr_b16 v[42:43], v7 offset:50176
  ds_read_b64_tr_b16 v[44:45], v7 offset:57344
  ds_read_b64_tr_b16 v[46:47], v7 offset:58368
  s_waitcnt lgkmcnt(0)
  s_barrier
  ds_write_b128 v9, v[32:35] offset:49152
  ds_write_b128 v9, v[36:39] offset:50176
  ds_write_b128 v9, v[40:43] offset:51200
  ds_write_b128 v9, v[44:47] offset:52224
  s_waitcnt lgkmcnt(0)
  s_branch LOADED_27
LDW1_29:
  s_add_u32 s33, s36, 0
  buffer_load_dwordx2 v[16:17], v1, s[16:19], s33 offen offset:0
  buffer_load_dwordx2 v[18:19], v1, s[16:19], s33 offen offset:1024
  buffer_load_dwordx2 v[24:25], v1, s[16:19], s33 offen offset:2048
  buffer_load_dwordx2 v[26:27], v1, s[16:19], s33 offen offset:3072
  s_add_u32 s33, s36, 32768
  buffer_load_dwordx2 v[20:21], v1, s[16:19], s33 offen offset:0
  buffer_load_dwordx2 v[22:23], v1, s[16:19], s33 offen offset:1024
  buffer_load_dwordx2 v[28:29], v1, s[16:19], s33 offen offset:2048
  buffer_load_dwordx2 v[30:31], v1, s[16:19], s33 offen offset:3072
  s_add_u32 s33, s36, 8192
  buffer_load_dwordx2 v[32:33], v1, s[16:19], s33 offen offset:0
  buffer_load_dwordx2 v[34:35], v1, s[16:19], s33 offen offset:1024
  buffer_load_dwordx2 v[40:41], v1, s[16:19], s33 offen offset:2048
  buffer_load_dwordx2 v[42:43], v1, s[16:19], s33 offen offset:3072
  s_add_u32 s33, s36, 40960
  buffer_load_dwordx2 v[36:37], v1, s[16:19], s33 offen offset:0
  buffer_load_dwordx2 v[38:39], v1, s[16:19], s33 offen offset:1024
  buffer_load_dwordx2 v[44:45], v1, s[16:19], s33 offen offset:2048
  buffer_load_dwordx2 v[46:47], v1, s[16:19], s33 offen offset:3072
  s_add_u32 s33, s36, 0
  buffer_load_dwordx2 v[48:49], v1, s[16:19], s33 offen offset:128
  buffer_load_dwordx2 v[50:51], v1, s[16:19], s33 offen offset:1152
  buffer_load_dwordx2 v[56:57], v1, s[16:19], s33 offen offset:2176
  buffer_load_dwordx2 v[58:59], v1, s[16:19], s33 offen offset:3200
  s_add_u32 s33, s36, 32768
  buffer_load_dwordx2 v[52:53], v1, s[16:19], s33 offen offset:128
  buffer_load_dwordx2 v[54:55], v1, s[16:19], s33 offen offset:1152
  buffer_load_dwordx2 v[60:61], v1, s[16:19], s33 offen offset:2176
  buffer_load_dwordx2 v[62:63], v1, s[16:19], s33 offen offset:3200
  s_add_u32 s33, s36, 8192
  buffer_load_dwordx2 v[64:65], v1, s[16:19], s33 offen offset:128
  buffer_load_dwordx2 v[66:67], v1, s[16:19], s33 offen offset:1152
  buffer_load_dwordx2 v[72:73], v1, s[16:19], s33 offen offset:2176
  buffer_load_dwordx2 v[74:75], v1, s[16:19], s33 offen offset:3200
  s_add_u32 s33, s36, 40960
  buffer_load_dwordx2 v[68:69], v1, s[16:19], s33 offen offset:128
  buffer_load_dwordx2 v[70:71], v1, s[16:19], s33 offen offset:1152
  buffer_load_dwordx2 v[76:77], v1, s[16:19], s33 offen offset:2176
  buffer_load_dwordx2 v[78:79], v1, s[16:19], s33 offen offset:3200
  s_add_u32 s33, s36, 65536
  buffer_load_dwordx2 v[80:81], v1, s[16:19], s33 offen offset:0
  buffer_load_dwordx2 v[82:83], v1, s[16:19], s33 offen offset:1024
  buffer_load_dwordx2 v[88:89], v1, s[16:19], s33 offen offset:2048
  buffer_load_dwordx2 v[90:91], v1, s[16:19], s33 offen offset:3072
  s_add_u32 s33, s36, 98304
  buffer_load_dwordx2 v[84:85], v1, s[16:19], s33 offen offset:0
  buffer_load_dwordx2 v[86:87], v1, s[16:19], s33 offen offset:1024
  buffer_load_dwordx2 v[92:93], v1, s[16:19], s33 offen offset:2048
  buffer_load_dwordx2 v[94:95], v1, s[16:19], s33 offen offset:3072
  s_add_u32 s33, s36, 73728
  buffer_load_dwordx2 v[96:97], v1, s[16:19], s33 offen offset:0
  buffer_load_dwordx2 v[98:99], v1, s[16:19], s33 offen offset:1024
  buffer_load_dwordx2 v[104:105], v1, s[16:19], s33 offen offset:2048
  buffer_load_dwordx2 v[106:107], v1, s[16:19], s33 offen offset:3072
  s_add_u32 s33, s36, 106496
  buffer_load_dwordx2 v[100:101], v1, s[16:19], s33 offen offset:0
  buffer_load_dwordx2 v[102:103], v1, s[16:19], s33 offen offset:1024
  buffer_load_dwordx2 v[108:109], v1, s[16:19], s33 offen offset:2048
  buffer_load_dwordx2 v[110:111], v1, s[16:19], s33 offen offset:3072
  s_waitcnt vmcnt(40)
  v_perm_b32 v128, v18, v16, s39
  v_perm_b32 v129, v22, v20, s39
  v_perm_b32 v130, v26, v24, s39
  v_perm_b32 v131, v30, v28, s39
  v_perm_b32 v144, v18, v16, s40
  v_perm_b32 v145, v22, v20, s40
  v_perm_b32 v146, v26, v24, s40
  v_perm_b32 v147, v30, v28, s40
  v_perm_b32 v160, v19, v17, s39
  v_perm_b32 v161, v23, v21, s39
  v_perm_b32 v162, v27, v25, s39
  v_perm_b32 v163, v31, v29, s39
  v_perm_b32 v176, v19, v17, s40
  v_perm_b32 v177, v23, v21, s40
  v_perm_b32 v178, v27, v25, s40
  v_perm_b32 v179, v31, v29, s40
  s_add_u32 s33, s36, 65536
  buffer_load_dwordx2 v[16:17], v1, s[16:19], s33 offen offset:128
  buffer_load_dwordx2 v[18:19], v1, s[16:19], s33 offen offset:1152
  buffer_load_dwordx2 v[24:25], v1, s[16:19], s33 offen offset:2176
  buffer_load_dwordx2 v[26:27], v1, s[16:19], s33 offen offset:3200
  s_add_u32 s33, s36, 98304
  buffer_load_dwordx2 v[20:21], v1, s[16:19], s33 offen offset:128
  buffer_load_dwordx2 v[22:23], v1, s[16:19], s33 offen offset:1152
  buffer_load_dwordx2 v[28:29], v1, s[16:19], s33 offen offset:2176
  buffer_load_dwordx2 v[30:31], v1, s[16:19], s33 offen offset:3200
  s_waitcnt vmcnt(40)
  v_perm_b32 v132, v34, v32, s39
  v_perm_b32 v133, v38, v36, s39
  v_perm_b32 v134, v42, v40, s39
  v_perm_b32 v135, v46, v44, s39
  v_perm_b32 v148, v34, v32, s40
  v_perm_b32 v149, v38, v36, s40
  v_perm_b32 v150, v42, v40, s40
  v_perm_b32 v151, v46, v44, s40
  v_perm_b32 v164, v35, v33, s39
  v_perm_b32 v165, v39, v37, s39
  v_perm_b32 v166, v43, v41, s39
  v_perm_b32 v167, v47, v45, s39
  v_perm_b32 v180, v35, v33, s40
  v_perm_b32 v181, v39, v37, s40
  v_perm_b32 v182, v43, v41, s40
  v_perm_b32 v183, v47, v45, s40
  s_add_u32 s33, s36, 73728
  buffer_load_dwordx2 v[32:33], v1, s[16:19], s33 offen offset:128
  buffer_load_dwordx2 v[34:35], v1, s[16:19], s33 offen offset:1152
  buffer_load_dwordx2 v[40:41], v1, s[16:19], s33 offen offset:2176
  buffer_load_dwordx2 v[42:43], v1, s[16:19], s33 offen offset:3200
  s_add_u32 s33, s36, 106496
  buffer_load_dwordx2 v[36:37], v1, s[16:19], s33 offen offset:128
  buffer_load_dwordx2 v[38:39], v1, s[16:19], s33 offen offset:1152
  buffer_load_dwordx2 v[44:45], v1, s[16:19], s33 offen offset:2176
  buffer_load_dwordx2 v[46:47], v1, s[16:19], s33 offen offset:3200
  s_waitcnt vmcnt(40)
  v_perm_b32 v192, v50, v48, s39
  v_perm_b32 v193, v54, v52, s39
  v_perm_b32 v194, v58, v56, s39
  v_perm_b32 v195, v62, v60, s39
  v_perm_b32 v208, v50, v48, s40
  v_perm_b32 v209, v54, v52, s40
  v_perm_b32 v210, v58, v56, s40
  v_perm_b32 v211, v62, v60, s40
  v_perm_b32 v224, v51, v49, s39
  v_perm_b32 v225, v55, v53, s39
  v_perm_b32 v226, v59, v57, s39
  v_perm_b32 v227, v63, v61, s39
  v_perm_b32 v240, v51, v49, s40
  v_perm_b32 v241, v55, v53, s40
  v_perm_b32 v242, v59, v57, s40
  v_perm_b32 v243, v63, v61, s40
  s_add_u32 s33, s37, 0
  s_add_u32 m0, s38, 0
  s_nop 0
  buffer_load_dwordx4 v2, s[28:31], s33 offen lds
  s_add_u32 s33, s37, 32768
  s_add_u32 m0, s38, 1024
  s_nop 0
  buffer_load_dwordx4 v2, s[28:31], s33 offen lds
  s_add_u32 s33, s37, 65536
  s_add_u32 m0, s38, 2048
  s_nop 0
  buffer_load_dwordx4 v3, s[28:31], s33 offen lds
  s_add_u32 s33, s37, 98304
  s_add_u32 m0, s38, 3072
  s_nop 0
  buffer_load_dwordx4 v3, s[28:31], s33 offen lds
  s_waitcnt vmcnt(36)
  v_perm_b32 v196, v66, v64, s39
  v_perm_b32 v197, v70, v68, s39
  v_perm_b32 v198, v74, v72, s39
  v_perm_b32 v199, v78, v76, s39
  v_perm_b32 v212, v66, v64, s40
  v_perm_b32 v213, v70, v68, s40
  v_perm_b32 v214, v74, v72, s40
  v_perm_b32 v215, v78, v76, s40
  v_perm_b32 v228, v67, v65, s39
  v_perm_b32 v229, v71, v69, s39
  v_perm_b32 v230, v75, v73, s39
  v_perm_b32 v231, v79, v77, s39
  v_perm_b32 v244, v67, v65, s40
  v_perm_b32 v245, v71, v69, s40
  v_perm_b32 v246, v75, v73, s40
  v_perm_b32 v247, v79, v77, s40
  s_add_u32 s33, s37, 524288
  s_add_u32 m0, s38, 16384
  s_nop 0
  buffer_load_dwordx4 v2, s[28:31], s33 offen lds
  s_add_u32 s33, s37, 557056
  s_add_u32 m0, s38, 17408
  s_nop 0
  buffer_load_dwordx4 v2, s[28:31], s33 offen lds
  s_add_u32 s33, s37, 589824
  s_add_u32 m0, s38, 18432
  s_nop 0
  buffer_load_dwordx4 v3, s[28:31], s33 offen lds
  s_add_u32 s33, s37, 622592
  s_add_u32 m0, s38, 19456
  s_nop 0
  buffer_load_dwordx4 v3, s[28:31], s33 offen lds
  s_waitcnt vmcnt(32)
  v_perm_b32 v136, v82, v80, s39
  v_perm_b32 v137, v86, v84, s39
  v_perm_b32 v138, v90, v88, s39
  v_perm_b32 v139, v94, v92, s39
  v_perm_b32 v152, v82, v80, s40
  v_perm_b32 v153, v86, v84, s40
  v_perm_b32 v154, v90, v88, s40
  v_perm_b32 v155, v94, v92, s40
  v_perm_b32 v168, v83, v81, s39
  v_perm_b32 v169, v87, v85, s39
  v_perm_b32 v170, v91, v89, s39
  v_perm_b32 v171, v95, v93, s39
  v_perm_b32 v184, v83, v81, s40
  v_perm_b32 v185, v87, v85, s40
  v_perm_b32 v186, v91, v89, s40
  v_perm_b32 v187, v95, v93, s40
  s_add_u32 s33, s37, 1048576
  s_add_u32 m0, s38, 32768
  s_nop 0
  buffer_load_dwordx4 v2, s[28:31], s33 offen lds
  s_add_u32 s33, s37, 1081344
  s_add_u32 m0, s38, 33792
  s_nop 0
  buffer_load_dwordx4 v2, s[28:31], s33 offen lds
  s_add_u32 s33, s37, 1114112
  s_add_u32 m0, s38, 34816
  s_nop 0
  buffer_load_dwordx4 v3, s[28:31], s33 offen lds
  s_add_u32 s33, s37, 1146880
  s_add_u32 m0, s38, 35840
  s_nop 0
  buffer_load_dwordx4 v3, s[28:31], s33 offen lds
  s_waitcnt vmcnt(28)
  v_perm_b32 v140, v98, v96, s39
  v_perm_b32 v141, v102, v100, s39
  v_perm_b32 v142, v106, v104, s39
  v_perm_b32 v143, v110, v108, s39
  v_perm_b32 v156, v98, v96, s40
  v_perm_b32 v157, v102, v100, s40
  v_perm_b32 v158, v106, v104, s40
  v_perm_b32 v159, v110, v108, s40
  v_perm_b32 v172, v99, v97, s39
  v_perm_b32 v173, v103, v101, s39
  v_perm_b32 v174, v107, v105, s39
  v_perm_b32 v175, v111, v109, s39
  v_perm_b32 v188, v99, v97, s40
  v_perm_b32 v189, v103, v101, s40
  v_perm_b32 v190, v107, v105, s40
  v_perm_b32 v191, v111, v109, s40
  s_add_u32 s33, s37, 1572864
  s_add_u32 m0, s38, 49152
  s_nop 0
  buffer_load_dwordx4 v2, s[28:31], s33 offen lds
  s_add_u32 s33, s37, 1605632
  s_add_u32 m0, s38, 50176
  s_nop 0
  buffer_load_dwordx4 v2, s[28:31], s33 offen lds
  s_add_u32 s33, s37, 1638400
  s_add_u32 m0, s38, 51200
  s_nop 0
  buffer_load_dwordx4 v3, s[28:31], s33 offen lds
  s_add_u32 s33, s37, 1671168
  s_add_u32 m0, s38, 52224
  s_nop 0
  buffer_load_dwordx4 v3, s[28:31], s33 offen lds
  s_waitcnt vmcnt(24)
  v_perm_b32 v200, v18, v16, s39
  v_perm_b32 v201, v22, v20, s39
  v_perm_b32 v202, v26, v24, s39
  v_perm_b32 v203, v30, v28, s39
  v_perm_b32 v216, v18, v16, s40
  v_perm_b32 v217, v22, v20, s40
  v_perm_b32 v218, v26, v24, s40
  v_perm_b32 v219, v30, v28, s40
  v_perm_b32 v232, v19, v17, s39
  v_perm_b32 v233, v23, v21, s39
  v_perm_b32 v234, v27, v25, s39
  v_perm_b32 v235, v31, v29, s39
  v_perm_b32 v248, v19, v17, s40
  v_perm_b32 v249, v23, v21, s40
  v_perm_b32 v250, v27, v25, s40
  v_perm_b32 v251, v31, v29, s40
  s_add_u32 s33, s37, 2097152
  s_add_u32 m0, s38, 65536
  s_nop 0
  buffer_load_dwordx4 v2, s[28:31], s33 offen lds
  s_add_u32 s33, s37, 2129920
  s_add_u32 m0, s38, 66560
  s_nop 0
  buffer_load_dwordx4 v2, s[28:31], s33 offen lds
  s_add_u32 s33, s37, 2162688
  s_add_u32 m0, s38, 67584
  s_nop 0
  buffer_load_dwordx4 v3, s[28:31], s33 offen lds
  s_add_u32 s33, s37, 2195456
  s_add_u32 m0, s38, 68608
  s_nop 0
  buffer_load_dwordx4 v3, s[28:31], s33 offen lds
  s_waitcnt vmcnt(20)
  v_perm_b32 v204, v34, v32, s39
  v_perm_b32 v205, v38, v36, s39
  v_perm_b32 v206, v42, v40, s39
  v_perm_b32 v207, v46, v44, s39
  v_perm_b32 v220, v34, v32, s40
  v_perm_b32 v221, v38, v36, s40
  v_perm_b32 v222, v42, v40, s40
  v_perm_b32 v223, v46, v44, s40
  v_perm_b32 v236, v35, v33, s39
  v_perm_b32 v237, v39, v37, s39
  v_perm_b32 v238, v43, v41, s39
  v_perm_b32 v239, v47, v45, s39
  v_perm_b32 v252, v35, v33, s40
  v_perm_b32 v253, v39, v37, s40
  v_perm_b32 v254, v43, v41, s40
  v_perm_b32 v255, v47, v45, s40
  s_add_u32 s33, s37, 2621440
  s_add_u32 m0, s38, 81920
  s_nop 0
  buffer_load_dwordx4 v2, s[28:31], s33 offen lds
  s_add_u32 s33, s37, 2654208
  s_add_u32 m0, s38, 82944
  s_nop 0
  buffer_load_dwordx4 v2, s[28:31], s33 offen lds
  s_add_u32 s33, s37, 2686976
  s_add_u32 m0, s38, 83968
  s_nop 0
  buffer_load_dwordx4 v3, s[28:31], s33 offen lds
  s_add_u32 s33, s37, 2719744
  s_add_u32 m0, s38, 84992
  s_nop 0
  buffer_load_dwordx4 v3, s[28:31], s33 offen lds
  s_waitcnt vmcnt(20)
  s_barrier
  ds_read_b64_tr_b16 v[16:17], v4 offset:0
  ds_read_b64_tr_b16 v[18:19], v4 offset:1024
  ds_read_b64_tr_b16 v[20:21], v4 offset:8192
  ds_read_b64_tr_b16 v[22:23], v4 offset:9216
  ds_read_b64_tr_b16 v[24:25], v5 offset:0
  ds_read_b64_tr_b16 v[26:27], v5 offset:1024
  ds_read_b64_tr_b16 v[28:29], v5 offset:8192
  ds_read_b64_tr_b16 v[30:31], v5 offset:9216
  s_waitcnt lgkmcnt(0)
  s_add_u32 s33, s37, 3145728
  s_add_u32 m0, s38, 98304
  s_nop 0
  buffer_load_dwordx4 v2, s[28:31], s33 offen lds
  s_add_u32 s33, s37, 3178496
  s_add_u32 m0, s38, 99328
  s_nop 0
  buffer_load_dwordx4 v2, s[28:31], s33 offen lds
  s_add_u32 s33, s37, 3211264
  s_add_u32 m0, s38, 100352
  s_nop 0
  buffer_load_dwordx4 v3, s[28:31], s33 offen lds
  s_add_u32 s33, s37, 3244032
  s_add_u32 m0, s38, 101376
  s_nop 0
  buffer_load_dwordx4 v3, s[28:31], s33 offen lds
  s_waitcnt vmcnt(20)
  s_barrier
  ds_write_b128 v8, v[16:19] offset:0
  ds_write_b128 v8, v[20:23] offset:1024
  ds_write_b128 v8, v[24:27] offset:2048
  ds_write_b128 v8, v[28:31] offset:3072
  ds_read_b64_tr_b16 v[32:33], v4 offset:16384
  ds_read_b64_tr_b16 v[34:35], v4 offset:17408
  ds_read_b64_tr_b16 v[36:37], v4 offset:24576
  ds_read_b64_tr_b16 v[38:39], v4 offset:25600
  ds_read_b64_tr_b16 v[40:41], v5 offset:16384
  ds_read_b64_tr_b16 v[42:43], v5 offset:17408
  ds_read_b64_tr_b16 v[44:45], v5 offset:24576
  ds_read_b64_tr_b16 v[46:47], v5 offset:25600
  s_waitcnt lgkmcnt(0)
  s_add_u32 s33, s37, 3670016
  s_add_u32 m0, s38, 114688
  s_nop 0
  buffer_load_dwordx4 v2, s[28:31], s33 offen lds
  s_add_u32 s33, s37, 3702784
  s_add_u32 m0, s38, 115712
  s_nop 0
  buffer_load_dwordx4 v2, s[28:31], s33 offen lds
  s_add_u32 s33, s37, 3735552
  s_add_u32 m0, s38, 116736
  s_nop 0
  buffer_load_dwordx4 v3, s[28:31], s33 offen lds
  s_add_u32 s33, s37, 3768320
  s_add_u32 m0, s38, 117760
  s_nop 0
  buffer_load_dwordx4 v3, s[28:31], s33 offen lds
  s_waitcnt vmcnt(20)
  s_barrier
  ds_write_b128 v8, v[32:35] offset:16384
  ds_write_b128 v8, v[36:39] offset:17408
  ds_write_b128 v8, v[40:43] offset:18432
  ds_write_b128 v8, v[44:47] offset:19456
  ds_read_b64_tr_b16 v[16:17], v4 offset:32768
  ds_read_b64_tr_b16 v[18:19], v4 offset:33792
  ds_read_b64_tr_b16 v[20:21], v4 offset:40960
  ds_read_b64_tr_b16 v[22:23], v4 offset:41984
  ds_read_b64_tr_b16 v[24:25], v5 offset:32768
  ds_read_b64_tr_b16 v[26:27], v5 offset:33792
  ds_read_b64_tr_b16 v[28:29], v5 offset:40960
  ds_read_b64_tr_b16 v[30:31], v5 offset:41984
  s_waitcnt lgkmcnt(0)
  s_waitcnt vmcnt(16)
  s_barrier
  ds_write_b128 v8, v[16:19] offset:32768
  ds_write_b128 v8, v[20:23] offset:33792
  ds_write_b128 v8, v[24:27] offset:34816
  ds_write_b128 v8, v[28:31] offset:35840
  ds_read_b64_tr_b16 v[32:33], v4 offset:49152
  ds_read_b64_tr_b16 v[34:35], v4 offset:50176
  ds_read_b64_tr_b16 v[36:37], v4 offset:57344
  ds_read_b64_tr_b16 v[38:39], v4 offset:58368
  ds_read_b64_tr_b16 v[40:41], v5 offset:49152
  ds_read_b64_tr_b16 v[42:43], v5 offset:50176
  ds_read_b64_tr_b16 v[44:45], v5 offset:57344
  ds_read_b64_tr_b16 v[46:47], v5 offset:58368
  s_waitcnt lgkmcnt(0)
  s_waitcnt vmcnt(12)
  s_barrier
  ds_write_b128 v8, v[32:35] offset:49152
  ds_write_b128 v8, v[36:39] offset:50176
  ds_write_b128 v8, v[40:43] offset:51200
  ds_write_b128 v8, v[44:47] offset:52224
  ds_read_b64_tr_b16 v[16:17], v6 offset:0
  ds_read_b64_tr_b16 v[18:19], v6 offset:1024
  ds_read_b64_tr_b16 v[20:21], v6 offset:8192
  ds_read_b64_tr_b16 v[22:23], v6 offset:9216
  ds_read_b64_tr_b16 v[24:25], v7 offset:0
  ds_read_b64_tr_b16 v[26:27], v7 offset:1024
  ds_read_b64_tr_b16 v[28:29], v7 offset:8192
  ds_read_b64_tr_b16 v[30:31], v7 offset:9216
  s_waitcnt lgkmcnt(0)
  s_waitcnt vmcnt(8)
  s_barrier
  ds_write_b128 v9, v[16:19] offset:0
  ds_write_b128 v9, v[20:23] offset:1024
  ds_write_b128 v9, v[24:27] offset:2048
  ds_write_b128 v9, v[28:31] offset:3072
  ds_read_b64_tr_b16 v[32:33], v6 offset:16384
  ds_read_b64_tr_b16 v[34:35], v6 offset:17408
  ds_read_b64_tr_b16 v[36:37], v6 offset:24576
  ds_read_b64_tr_b16 v[38:39], v6 offset:25600
  ds_read_b64_tr_b16 v[40:41], v7 offset:16384
  ds_read_b64_tr_b16 v[42:43], v7 offset:17408
  ds_read_b64_tr_b16 v[44:45], v7 offset:24576
  ds_read_b64_tr_b16 v[46:47], v7 offset:25600
  s_waitcnt lgkmcnt(0)
  s_waitcnt vmcnt(4)
  s_barrier
  ds_write_b128 v9, v[32:35] offset:16384
  ds_write_b128 v9, v[36:39] offset:17408
  ds_write_b128 v9, v[40:43] offset:18432
  ds_write_b128 v9, v[44:47] offset:19456
  ds_read_b64_tr_b16 v[16:17], v6 offset:32768
  ds_read_b64_tr_b16 v[18:19], v6 offset:33792
  ds_read_b64_tr_b16 v[20:21], v6 offset:40960
  ds_read_b64_tr_b16 v[22:23], v6 offset:41984
  ds_read_b64_tr_b16 v[24:25], v7 offset:32768
  ds_read_b64_tr_b16 v[26:27], v7 offset:33792
  ds_read_b64_tr_b16 v[28:29], v7 offset:40960
  ds_read_b64_tr_b16 v[30:31], v7 offset:41984
  s_waitcnt lgkmcnt(0)
  s_waitcnt vmcnt(0)
  s_barrier
  ds_write_b128 v9, v[16:19] offset:32768
  ds_write_b128 v9, v[20:23] offset:33792
  ds_write_b128 v9, v[24:27] offset:34816
  ds_write_b128 v9, v[28:31] offset:35840
  ds_read_b64_tr_b16 v[32:33], v6 offset:49152
  ds_read_b64_tr_b16 v[34:35], v6 offset:50176
  ds_read_b64_tr_b16 v[36:37], v6 offset:57344
  ds_read_b64_tr_b16 v[38:39], v6 offset:58368
  ds_read_b64_tr_b16 v[40:41], v7 offset:49152
  ds_read_b64_tr_b16 v[42:43], v7 offset:50176
  ds_read_b64_tr_b16 v[44:45], v7 offset:57344
  ds_read_b64_tr_b16 v[46:47], v7 offset:58368
  s_waitcnt lgkmcnt(0)
  s_barrier
  ds_write_b128 v9, v[32:35] offset:49152
  ds_write_b128 v9, v[36:39] offset:50176
  ds_write_b128 v9, v[40:43] offset:51200
  ds_write_b128 v9, v[44:47] offset:52224
  s_waitcnt lgkmcnt(0)
  s_branch LOADED_27
LDW2_30:
  s_add_u32 s33, s36, 0
  buffer_load_dwordx2 v[16:17], v1, s[16:19], s33 offen offset:0
  buffer_load_dwordx2 v[18:19], v1, s[16:19], s33 offen offset:1024
  buffer_load_dwordx2 v[24:25], v1, s[16:19], s33 offen offset:2048
  buffer_load_dwordx2 v[26:27], v1, s[16:19], s33 offen offset:3072
  s_add_u32 s33, s36, 32768
  buffer_load_dwordx2 v[20:21], v1, s[16:19], s33 offen offset:0
  buffer_load_dwordx2 v[22:23], v1, s[16:19], s33 offen offset:1024
  buffer_load_dwordx2 v[28:29], v1, s[16:19], s33 offen offset:2048
  buffer_load_dwordx2 v[30:31], v1, s[16:19], s33 offen offset:3072
  s_add_u32 s33, s36, 8192
  buffer_load_dwordx2 v[32:33], v1, s[16:19], s33 offen offset:0
  buffer_load_dwordx2 v[34:35], v1, s[16:19], s33 offen offset:1024
  buffer_load_dwordx2 v[40:41], v1, s[16:19], s33 offen offset:2048
  buffer_load_dwordx2 v[42:43], v1, s[16:19], s33 offen offset:3072
  s_add_u32 s33, s36, 40960
  buffer_load_dwordx2 v[36:37], v1, s[16:19], s33 offen offset:0
  buffer_load_dwordx2 v[38:39], v1, s[16:19], s33 offen offset:1024
  buffer_load_dwordx2 v[44:45], v1, s[16:19], s33 offen offset:2048
  buffer_load_dwordx2 v[46:47], v1, s[16:19], s33 offen offset:3072
  s_add_u32 s33, s36, 0
  buffer_load_dwordx2 v[48:49], v1, s[16:19], s33 offen offset:128
  buffer_load_dwordx2 v[50:51], v1, s[16:19], s33 offen offset:1152
  buffer_load_dwordx2 v[56:57], v1, s[16:19], s33 offen offset:2176
  buffer_load_dwordx2 v[58:59], v1, s[16:19], s33 offen offset:3200
  s_add_u32 s33, s36, 32768
  buffer_load_dwordx2 v[52:53], v1, s[16:19], s33 offen offset:128
  buffer_load_dwordx2 v[54:55], v1, s[16:19], s33 offen offset:1152
  buffer_load_dwordx2 v[60:61], v1, s[16:19], s33 offen offset:2176
  buffer_load_dwordx2 v[62:63], v1, s[16:19], s33 offen offset:3200
  s_add_u32 s33, s36, 8192
  buffer_load_dwordx2 v[64:65], v1, s[16:19], s33 offen offset:128
  buffer_load_dwordx2 v[66:67], v1, s[16:19], s33 offen offset:1152
  buffer_load_dwordx2 v[72:73], v1, s[16:19], s33 offen offset:2176
  buffer_load_dwordx2 v[74:75], v1, s[16:19], s33 offen offset:3200
  s_add_u32 s33, s36, 40960
  buffer_load_dwordx2 v[68:69], v1, s[16:19], s33 offen offset:128
  buffer_load_dwordx2 v[70:71], v1, s[16:19], s33 offen offset:1152
  buffer_load_dwordx2 v[76:77], v1, s[16:19], s33 offen offset:2176
  buffer_load_dwordx2 v[78:79], v1, s[16:19], s33 offen offset:3200
  s_add_u32 s33, s36, 65536
  buffer_load_dwordx2 v[80:81], v1, s[16:19], s33 offen offset:0
  buffer_load_dwordx2 v[82:83], v1, s[16:19], s33 offen offset:1024
  buffer_load_dwordx2 v[88:89], v1, s[16:19], s33 offen offset:2048
  buffer_load_dwordx2 v[90:91], v1, s[16:19], s33 offen offset:3072
  s_add_u32 s33, s36, 98304
  buffer_load_dwordx2 v[84:85], v1, s[16:19], s33 offen offset:0
  buffer_load_dwordx2 v[86:87], v1, s[16:19], s33 offen offset:1024
  buffer_load_dwordx2 v[92:93], v1, s[16:19], s33 offen offset:2048
  buffer_load_dwordx2 v[94:95], v1, s[16:19], s33 offen offset:3072
  s_add_u32 s33, s36, 73728
  buffer_load_dwordx2 v[96:97], v1, s[16:19], s33 offen offset:0
  buffer_load_dwordx2 v[98:99], v1, s[16:19], s33 offen offset:1024
  buffer_load_dwordx2 v[104:105], v1, s[16:19], s33 offen offset:2048
  buffer_load_dwordx2 v[106:107], v1, s[16:19], s33 offen offset:3072
  s_add_u32 s33, s36, 106496
  buffer_load_dwordx2 v[100:101], v1, s[16:19], s33 offen offset:0
  buffer_load_dwordx2 v[102:103], v1, s[16:19], s33 offen offset:1024
  buffer_load_dwordx2 v[108:109], v1, s[16:19], s33 offen offset:2048
  buffer_load_dwordx2 v[110:111], v1, s[16:19], s33 offen offset:3072
  s_waitcnt vmcnt(40)
  v_perm_b32 v128, v18, v16, s39
  v_perm_b32 v129, v22, v20, s39
  v_perm_b32 v130, v26, v24, s39
  v_perm_b32 v131, v30, v28, s39
  v_perm_b32 v144, v18, v16, s40
  v_perm_b32 v145, v22, v20, s40
  v_perm_b32 v146, v26, v24, s40
  v_perm_b32 v147, v30, v28, s40
  v_perm_b32 v160, v19, v17, s39
  v_perm_b32 v161, v23, v21, s39
  v_perm_b32 v162, v27, v25, s39
  v_perm_b32 v163, v31, v29, s39
  v_perm_b32 v176, v19, v17, s40
  v_perm_b32 v177, v23, v21, s40
  v_perm_b32 v178, v27, v25, s40
  v_perm_b32 v179, v31, v29, s40
  s_add_u32 s33, s36, 65536
  buffer_load_dwordx2 v[16:17], v1, s[16:19], s33 offen offset:128
  buffer_load_dwordx2 v[18:19], v1, s[16:19], s33 offen offset:1152
  buffer_load_dwordx2 v[24:25], v1, s[16:19], s33 offen offset:2176
  buffer_load_dwordx2 v[26:27], v1, s[16:19], s33 offen offset:3200
  s_add_u32 s33, s36, 98304
  buffer_load_dwordx2 v[20:21], v1, s[16:19], s33 offen offset:128
  buffer_load_dwordx2 v[22:23], v1, s[16:19], s33 offen offset:1152
  buffer_load_dwordx2 v[28:29], v1, s[16:19], s33 offen offset:2176
  buffer_load_dwordx2 v[30:31], v1, s[16:19], s33 offen offset:3200
  s_waitcnt vmcnt(40)
  v_perm_b32 v132, v34, v32, s39
  v_perm_b32 v133, v38, v36, s39
  v_perm_b32 v134, v42, v40, s39
  v_perm_b32 v135, v46, v44, s39
  v_perm_b32 v148, v34, v32, s40
  v_perm_b32 v149, v38, v36, s40
  v_perm_b32 v150, v42, v40, s40
  v_perm_b32 v151, v46, v44, s40
  v_perm_b32 v164, v35, v33, s39
  v_perm_b32 v165, v39, v37, s39
  v_perm_b32 v166, v43, v41, s39
  v_perm_b32 v167, v47, v45, s39
  v_perm_b32 v180, v35, v33, s40
  v_perm_b32 v181, v39, v37, s40
  v_perm_b32 v182, v43, v41, s40
  v_perm_b32 v183, v47, v45, s40
  s_add_u32 s33, s36, 73728
  buffer_load_dwordx2 v[32:33], v1, s[16:19], s33 offen offset:128
  buffer_load_dwordx2 v[34:35], v1, s[16:19], s33 offen offset:1152
  buffer_load_dwordx2 v[40:41], v1, s[16:19], s33 offen offset:2176
  buffer_load_dwordx2 v[42:43], v1, s[16:19], s33 offen offset:3200
  s_add_u32 s33, s36, 106496
  buffer_load_dwordx2 v[36:37], v1, s[16:19], s33 offen offset:128
  buffer_load_dwordx2 v[38:39], v1, s[16:19], s33 offen offset:1152
  buffer_load_dwordx2 v[44:45], v1, s[16:19], s33 offen offset:2176
  buffer_load_dwordx2 v[46:47], v1, s[16:19], s33 offen offset:3200
  s_waitcnt vmcnt(40)
  v_perm_b32 v192, v50, v48, s39
  v_perm_b32 v193, v54, v52, s39
  v_perm_b32 v194, v58, v56, s39
  v_perm_b32 v195, v62, v60, s39
  v_perm_b32 v208, v50, v48, s40
  v_perm_b32 v209, v54, v52, s40
  v_perm_b32 v210, v58, v56, s40
  v_perm_b32 v211, v62, v60, s40
  v_perm_b32 v224, v51, v49, s39
  v_perm_b32 v225, v55, v53, s39
  v_perm_b32 v226, v59, v57, s39
  v_perm_b32 v227, v63, v61, s39
  v_perm_b32 v240, v51, v49, s40
  v_perm_b32 v241, v55, v53, s40
  v_perm_b32 v242, v59, v57, s40
  v_perm_b32 v243, v63, v61, s40
  s_add_u32 s33, s37, 0
  s_add_u32 m0, s38, 0
  s_nop 0
  buffer_load_dwordx4 v2, s[28:31], s33 offen lds
  s_add_u32 s33, s37, 32768
  s_add_u32 m0, s38, 1024
  s_nop 0
  buffer_load_dwordx4 v2, s[28:31], s33 offen lds
  s_add_u32 s33, s37, 65536
  s_add_u32 m0, s38, 2048
  s_nop 0
  buffer_load_dwordx4 v3, s[28:31], s33 offen lds
  s_add_u32 s33, s37, 98304
  s_add_u32 m0, s38, 3072
  s_nop 0
  buffer_load_dwordx4 v3, s[28:31], s33 offen lds
  s_waitcnt vmcnt(36)
  v_perm_b32 v196, v66, v64, s39
  v_perm_b32 v197, v70, v68, s39
  v_perm_b32 v198, v74, v72, s39
  v_perm_b32 v199, v78, v76, s39
  v_perm_b32 v212, v66, v64, s40
  v_perm_b32 v213, v70, v68, s40
  v_perm_b32 v214, v74, v72, s40
  v_perm_b32 v215, v78, v76, s40
  v_perm_b32 v228, v67, v65, s39
  v_perm_b32 v229, v71, v69, s39
  v_perm_b32 v230, v75, v73, s39
  v_perm_b32 v231, v79, v77, s39
  v_perm_b32 v244, v67, v65, s40
  v_perm_b32 v245, v71, v69, s40
  v_perm_b32 v246, v75, v73, s40
  v_perm_b32 v247, v79, v77, s40
  s_add_u32 s33, s37, 524288
  s_add_u32 m0, s38, 16384
  s_nop 0
  buffer_load_dwordx4 v2, s[28:31], s33 offen lds
  s_add_u32 s33, s37, 557056
  s_add_u32 m0, s38, 17408
  s_nop 0
  buffer_load_dwordx4 v2, s[28:31], s33 offen lds
  s_add_u32 s33, s37, 589824
  s_add_u32 m0, s38, 18432
  s_nop 0
  buffer_load_dwordx4 v3, s[28:31], s33 offen lds
  s_add_u32 s33, s37, 622592
  s_add_u32 m0, s38, 19456
  s_nop 0
  buffer_load_dwordx4 v3, s[28:31], s33 offen lds
  s_waitcnt vmcnt(32)
  v_perm_b32 v136, v82, v80, s39
  v_perm_b32 v137, v86, v84, s39
  v_perm_b32 v138, v90, v88, s39
  v_perm_b32 v139, v94, v92, s39
  v_perm_b32 v152, v82, v80, s40
  v_perm_b32 v153, v86, v84, s40
  v_perm_b32 v154, v90, v88, s40
  v_perm_b32 v155, v94, v92, s40
  v_perm_b32 v168, v83, v81, s39
  v_perm_b32 v169, v87, v85, s39
  v_perm_b32 v170, v91, v89, s39
  v_perm_b32 v171, v95, v93, s39
  v_perm_b32 v184, v83, v81, s40
  v_perm_b32 v185, v87, v85, s40
  v_perm_b32 v186, v91, v89, s40
  v_perm_b32 v187, v95, v93, s40
  s_add_u32 s33, s37, 1048576
  s_add_u32 m0, s38, 32768
  s_nop 0
  buffer_load_dwordx4 v2, s[28:31], s33 offen lds
  s_add_u32 s33, s37, 1081344
  s_add_u32 m0, s38, 33792
  s_nop 0
  buffer_load_dwordx4 v2, s[28:31], s33 offen lds
  s_add_u32 s33, s37, 1114112
  s_add_u32 m0, s38, 34816
  s_nop 0
  buffer_load_dwordx4 v3, s[28:31], s33 offen lds
  s_add_u32 s33, s37, 1146880
  s_add_u32 m0, s38, 35840
  s_nop 0
  buffer_load_dwordx4 v3, s[28:31], s33 offen lds
  s_waitcnt vmcnt(28)
  v_perm_b32 v140, v98, v96, s39
  v_perm_b32 v141, v102, v100, s39
  v_perm_b32 v142, v106, v104, s39
  v_perm_b32 v143, v110, v108, s39
  v_perm_b32 v156, v98, v96, s40
  v_perm_b32 v157, v102, v100, s40
  v_perm_b32 v158, v106, v104, s40
  v_perm_b32 v159, v110, v108, s40
  v_perm_b32 v172, v99, v97, s39
  v_perm_b32 v173, v103, v101, s39
  v_perm_b32 v174, v107, v105, s39
  v_perm_b32 v175, v111, v109, s39
  v_perm_b32 v188, v99, v97, s40
  v_perm_b32 v189, v103, v101, s40
  v_perm_b32 v190, v107, v105, s40
  v_perm_b32 v191, v111, v109, s40
  s_add_u32 s33, s37, 1572864
  s_add_u32 m0, s38, 49152
  s_nop 0
  buffer_load_dwordx4 v2, s[28:31], s33 offen lds
  s_add_u32 s33, s37, 1605632
  s_add_u32 m0, s38, 50176
  s_nop 0
  buffer_load_dwordx4 v2, s[28:31], s33 offen lds
  s_add_u32 s33, s37, 1638400
  s_add_u32 m0, s38, 51200
  s_nop 0
  buffer_load_dwordx4 v3, s[28:31], s33 offen lds
  s_add_u32 s33, s37, 1671168
  s_add_u32 m0, s38, 52224
  s_nop 0
  buffer_load_dwordx4 v3, s[28:31], s33 offen lds
  s_waitcnt vmcnt(24)
  v_perm_b32 v200, v18, v16, s39
  v_perm_b32 v201, v22, v20, s39
  v_perm_b32 v202, v26, v24, s39
  v_perm_b32 v203, v30, v28, s39
  v_perm_b32 v216, v18, v16, s40
  v_perm_b32 v217, v22, v20, s40
  v_perm_b32 v218, v26, v24, s40
  v_perm_b32 v219, v30, v28, s40
  v_perm_b32 v232, v19, v17, s39
  v_perm_b32 v233, v23, v21, s39
  v_perm_b32 v234, v27, v25, s39
  v_perm_b32 v235, v31, v29, s39
  v_perm_b32 v248, v19, v17, s40
  v_perm_b32 v249, v23, v21, s40
  v_perm_b32 v250, v27, v25, s40
  v_perm_b32 v251, v31, v29, s40
  s_add_u32 s33, s37, 2097152
  s_add_u32 m0, s38, 65536
  s_nop 0
  buffer_load_dwordx4 v2, s[28:31], s33 offen lds
  s_add_u32 s33, s37, 2129920
  s_add_u32 m0, s38, 66560
  s_nop 0
  buffer_load_dwordx4 v2, s[28:31], s33 offen lds
  s_add_u32 s33, s37, 2162688
  s_add_u32 m0, s38, 67584
  s_nop 0
  buffer_load_dwordx4 v3, s[28:31], s33 offen lds
  s_add_u32 s33, s37, 2195456
  s_add_u32 m0, s38, 68608
  s_nop 0
  buffer_load_dwordx4 v3, s[28:31], s33 offen lds
  s_waitcnt vmcnt(20)
  v_perm_b32 v204, v34, v32, s39
  v_perm_b32 v205, v38, v36, s39
  v_perm_b32 v206, v42, v40, s39
  v_perm_b32 v207, v46, v44, s39
  v_perm_b32 v220, v34, v32, s40
  v_perm_b32 v221, v38, v36, s40
  v_perm_b32 v222, v42, v40, s40
  v_perm_b32 v223, v46, v44, s40
  v_perm_b32 v236, v35, v33, s39
  v_perm_b32 v237, v39, v37, s39
  v_perm_b32 v238, v43, v41, s39
  v_perm_b32 v239, v47, v45, s39
  v_perm_b32 v252, v35, v33, s40
  v_perm_b32 v253, v39, v37, s40
  v_perm_b32 v254, v43, v41, s40
  v_perm_b32 v255, v47, v45, s40
  s_add_u32 s33, s37, 2621440
  s_add_u32 m0, s38, 81920
  s_nop 0
  buffer_load_dwordx4 v2, s[28:31], s33 offen lds
  s_add_u32 s33, s37, 2654208
  s_add_u32 m0, s38, 82944
  s_nop 0
  buffer_load_dwordx4 v2, s[28:31], s33 offen lds
  s_add_u32 s33, s37, 2686976
  s_add_u32 m0, s38, 83968
  s_nop 0
  buffer_load_dwordx4 v3, s[28:31], s33 offen lds
  s_add_u32 s33, s37, 2719744
  s_add_u32 m0, s38, 84992
  s_nop 0
  buffer_load_dwordx4 v3, s[28:31], s33 offen lds
  s_waitcnt vmcnt(20)
  s_barrier
  ds_read_b64_tr_b16 v[16:17], v4 offset:0
  ds_read_b64_tr_b16 v[18:19], v4 offset:1024
  ds_read_b64_tr_b16 v[20:21], v4 offset:8192
  ds_read_b64_tr_b16 v[22:23], v4 offset:9216
  ds_read_b64_tr_b16 v[24:25], v5 offset:0
  ds_read_b64_tr_b16 v[26:27], v5 offset:1024
  ds_read_b64_tr_b16 v[28:29], v5 offset:8192
  ds_read_b64_tr_b16 v[30:31], v5 offset:9216
  s_waitcnt lgkmcnt(0)
  s_add_u32 s33, s37, 3145728
  s_add_u32 m0, s38, 98304
  s_nop 0
  buffer_load_dwordx4 v2, s[28:31], s33 offen lds
  s_add_u32 s33, s37, 3178496
  s_add_u32 m0, s38, 99328
  s_nop 0
  buffer_load_dwordx4 v2, s[28:31], s33 offen lds
  s_add_u32 s33, s37, 3211264
  s_add_u32 m0, s38, 100352
  s_nop 0
  buffer_load_dwordx4 v3, s[28:31], s33 offen lds
  s_add_u32 s33, s37, 3244032
  s_add_u32 m0, s38, 101376
  s_nop 0
  buffer_load_dwordx4 v3, s[28:31], s33 offen lds
  s_waitcnt vmcnt(20)
  s_barrier
  ds_write_b128 v8, v[16:19] offset:0
  ds_write_b128 v8, v[20:23] offset:1024
  ds_write_b128 v8, v[24:27] offset:2048
  ds_write_b128 v8, v[28:31] offset:3072
  ds_read_b64_tr_b16 v[32:33], v4 offset:16384
  ds_read_b64_tr_b16 v[34:35], v4 offset:17408
  ds_read_b64_tr_b16 v[36:37], v4 offset:24576
  ds_read_b64_tr_b16 v[38:39], v4 offset:25600
  ds_read_b64_tr_b16 v[40:41], v5 offset:16384
  ds_read_b64_tr_b16 v[42:43], v5 offset:17408
  ds_read_b64_tr_b16 v[44:45], v5 offset:24576
  ds_read_b64_tr_b16 v[46:47], v5 offset:25600
  s_waitcnt lgkmcnt(0)
  s_add_u32 s33, s37, 3670016
  s_add_u32 m0, s38, 114688
  s_nop 0
  buffer_load_dwordx4 v2, s[28:31], s33 offen lds
  s_add_u32 s33, s37, 3702784
  s_add_u32 m0, s38, 115712
  s_nop 0
  buffer_load_dwordx4 v2, s[28:31], s33 offen lds
  s_add_u32 s33, s37, 3735552
  s_add_u32 m0, s38, 116736
  s_nop 0
  buffer_load_dwordx4 v3, s[28:31], s33 offen lds
  s_add_u32 s33, s37, 3768320
  s_add_u32 m0, s38, 117760
  s_nop 0
  buffer_load_dwordx4 v3, s[28:31], s33 offen lds
  s_waitcnt vmcnt(20)
  s_barrier
  ds_write_b128 v8, v[32:35] offset:16384
  ds_write_b128 v8, v[36:39] offset:17408
  ds_write_b128 v8, v[40:43] offset:18432
  ds_write_b128 v8, v[44:47] offset:19456
  ds_read_b64_tr_b16 v[16:17], v4 offset:32768
  ds_read_b64_tr_b16 v[18:19], v4 offset:33792
  ds_read_b64_tr_b16 v[20:21], v4 offset:40960
  ds_read_b64_tr_b16 v[22:23], v4 offset:41984
  ds_read_b64_tr_b16 v[24:25], v5 offset:32768
  ds_read_b64_tr_b16 v[26:27], v5 offset:33792
  ds_read_b64_tr_b16 v[28:29], v5 offset:40960
  ds_read_b64_tr_b16 v[30:31], v5 offset:41984
  s_waitcnt lgkmcnt(0)
  s_waitcnt vmcnt(16)
  s_barrier
  ds_write_b128 v8, v[16:19] offset:32768
  ds_write_b128 v8, v[20:23] offset:33792
  ds_write_b128 v8, v[24:27] offset:34816
  ds_write_b128 v8, v[28:31] offset:35840
  ds_read_b64_tr_b16 v[32:33], v4 offset:49152
  ds_read_b64_tr_b16 v[34:35], v4 offset:50176
  ds_read_b64_tr_b16 v[36:37], v4 offset:57344
  ds_read_b64_tr_b16 v[38:39], v4 offset:58368
  ds_read_b64_tr_b16 v[40:41], v5 offset:49152
  ds_read_b64_tr_b16 v[42:43], v5 offset:50176
  ds_read_b64_tr_b16 v[44:45], v5 offset:57344
  ds_read_b64_tr_b16 v[46:47], v5 offset:58368
  s_waitcnt lgkmcnt(0)
  s_waitcnt vmcnt(12)
  s_barrier
  ds_write_b128 v8, v[32:35] offset:49152
  ds_write_b128 v8, v[36:39] offset:50176
  ds_write_b128 v8, v[40:43] offset:51200
  ds_write_b128 v8, v[44:47] offset:52224
  ds_read_b64_tr_b16 v[16:17], v6 offset:0
  ds_read_b64_tr_b16 v[18:19], v6 offset:1024
  ds_read_b64_tr_b16 v[20:21], v6 offset:8192
  ds_read_b64_tr_b16 v[22:23], v6 offset:9216
  ds_read_b64_tr_b16 v[24:25], v7 offset:0
  ds_read_b64_tr_b16 v[26:27], v7 offset:1024
  ds_read_b64_tr_b16 v[28:29], v7 offset:8192
  ds_read_b64_tr_b16 v[30:31], v7 offset:9216
  s_waitcnt lgkmcnt(0)
  s_waitcnt vmcnt(8)
  s_barrier
  ds_write_b128 v9, v[16:19] offset:0
  ds_write_b128 v9, v[20:23] offset:1024
  ds_write_b128 v9, v[24:27] offset:2048
  ds_write_b128 v9, v[28:31] offset:3072
  ds_read_b64_tr_b16 v[32:33], v6 offset:16384
  ds_read_b64_tr_b16 v[34:35], v6 offset:17408
  ds_read_b64_tr_b16 v[36:37], v6 offset:24576
  ds_read_b64_tr_b16 v[38:39], v6 offset:25600
  ds_read_b64_tr_b16 v[40:41], v7 offset:16384
  ds_read_b64_tr_b16 v[42:43], v7 offset:17408
  ds_read_b64_tr_b16 v[44:45], v7 offset:24576
  ds_read_b64_tr_b16 v[46:47], v7 offset:25600
  s_waitcnt lgkmcnt(0)
  s_waitcnt vmcnt(4)
  s_barrier
  ds_write_b128 v9, v[32:35] offset:16384
  ds_write_b128 v9, v[36:39] offset:17408
  ds_write_b128 v9, v[40:43] offset:18432
  ds_write_b128 v9, v[44:47] offset:19456
  ds_read_b64_tr_b16 v[16:17], v6 offset:32768
  ds_read_b64_tr_b16 v[18:19], v6 offset:33792
  ds_read_b64_tr_b16 v[20:21], v6 offset:40960
  ds_read_b64_tr_b16 v[22:23], v6 offset:41984
  ds_read_b64_tr_b16 v[24:25], v7 offset:32768
  ds_read_b64_tr_b16 v[26:27], v7 offset:33792
  ds_read_b64_tr_b16 v[28:29], v7 offset:40960
  ds_read_b64_tr_b16 v[30:31], v7 offset:41984
  s_waitcnt lgkmcnt(0)
  s_waitcnt vmcnt(0)
  s_barrier
  ds_write_b128 v9, v[16:19] offset:32768
  ds_write_b128 v9, v[20:23] offset:33792
  ds_write_b128 v9, v[24:27] offset:34816
  ds_write_b128 v9, v[28:31] offset:35840
  ds_read_b64_tr_b16 v[32:33], v6 offset:49152
  ds_read_b64_tr_b16 v[34:35], v6 offset:50176
  ds_read_b64_tr_b16 v[36:37], v6 offset:57344
  ds_read_b64_tr_b16 v[38:39], v6 offset:58368
  ds_read_b64_tr_b16 v[40:41], v7 offset:49152
  ds_read_b64_tr_b16 v[42:43], v7 offset:50176
  ds_read_b64_tr_b16 v[44:45], v7 offset:57344
  ds_read_b64_tr_b16 v[46:47], v7 offset:58368
  s_waitcnt lgkmcnt(0)
  s_barrier
  ds_write_b128 v9, v[32:35] offset:49152
  ds_write_b128 v9, v[36:39] offset:50176
  ds_write_b128 v9, v[40:43] offset:51200
  ds_write_b128 v9, v[44:47] offset:52224
  s_waitcnt lgkmcnt(0)
  s_branch LOADED_27
LDW3_31:
  s_add_u32 s33, s36, 0
  buffer_load_dwordx2 v[16:17], v1, s[16:19], s33 offen offset:0
  buffer_load_dwordx2 v[18:19], v1, s[16:19], s33 offen offset:1024
  buffer_load_dwordx2 v[24:25], v1, s[16:19], s33 offen offset:2048
  buffer_load_dwordx2 v[26:27], v1, s[16:19], s33 offen offset:3072
  s_add_u32 s33, s36, 32768
  buffer_load_dwordx2 v[20:21], v1, s[16:19], s33 offen offset:0
  buffer_load_dwordx2 v[22:23], v1, s[16:19], s33 offen offset:1024
  buffer_load_dwordx2 v[28:29], v1, s[16:19], s33 offen offset:2048
  buffer_load_dwordx2 v[30:31], v1, s[16:19], s33 offen offset:3072
  s_add_u32 s33, s36, 8192
  buffer_load_dwordx2 v[32:33], v1, s[16:19], s33 offen offset:0
  buffer_load_dwordx2 v[34:35], v1, s[16:19], s33 offen offset:1024
  buffer_load_dwordx2 v[40:41], v1, s[16:19], s33 offen offset:2048
  buffer_load_dwordx2 v[42:43], v1, s[16:19], s33 offen offset:3072
  s_add_u32 s33, s36, 40960
  buffer_load_dwordx2 v[36:37], v1, s[16:19], s33 offen offset:0
  buffer_load_dwordx2 v[38:39], v1, s[16:19], s33 offen offset:1024
  buffer_load_dwordx2 v[44:45], v1, s[16:19], s33 offen offset:2048
  buffer_load_dwordx2 v[46:47], v1, s[16:19], s33 offen offset:3072
  s_add_u32 s33, s36, 0
  buffer_load_dwordx2 v[48:49], v1, s[16:19], s33 offen offset:128
  buffer_load_dwordx2 v[50:51], v1, s[16:19], s33 offen offset:1152
  buffer_load_dwordx2 v[56:57], v1, s[16:19], s33 offen offset:2176
  buffer_load_dwordx2 v[58:59], v1, s[16:19], s33 offen offset:3200
  s_add_u32 s33, s36, 32768
  buffer_load_dwordx2 v[52:53], v1, s[16:19], s33 offen offset:128
  buffer_load_dwordx2 v[54:55], v1, s[16:19], s33 offen offset:1152
  buffer_load_dwordx2 v[60:61], v1, s[16:19], s33 offen offset:2176
  buffer_load_dwordx2 v[62:63], v1, s[16:19], s33 offen offset:3200
  s_add_u32 s33, s36, 8192
  buffer_load_dwordx2 v[64:65], v1, s[16:19], s33 offen offset:128
  buffer_load_dwordx2 v[66:67], v1, s[16:19], s33 offen offset:1152
  buffer_load_dwordx2 v[72:73], v1, s[16:19], s33 offen offset:2176
  buffer_load_dwordx2 v[74:75], v1, s[16:19], s33 offen offset:3200
  s_add_u32 s33, s36, 40960
  buffer_load_dwordx2 v[68:69], v1, s[16:19], s33 offen offset:128
  buffer_load_dwordx2 v[70:71], v1, s[16:19], s33 offen offset:1152
  buffer_load_dwordx2 v[76:77], v1, s[16:19], s33 offen offset:2176
  buffer_load_dwordx2 v[78:79], v1, s[16:19], s33 offen offset:3200
  s_add_u32 s33, s36, 65536
  buffer_load_dwordx2 v[80:81], v1, s[16:19], s33 offen offset:0
  buffer_load_dwordx2 v[82:83], v1, s[16:19], s33 offen offset:1024
  buffer_load_dwordx2 v[88:89], v1, s[16:19], s33 offen offset:2048
  buffer_load_dwordx2 v[90:91], v1, s[16:19], s33 offen offset:3072
  s_add_u32 s33, s36, 98304
  buffer_load_dwordx2 v[84:85], v1, s[16:19], s33 offen offset:0
  buffer_load_dwordx2 v[86:87], v1, s[16:19], s33 offen offset:1024
  buffer_load_dwordx2 v[92:93], v1, s[16:19], s33 offen offset:2048
  buffer_load_dwordx2 v[94:95], v1, s[16:19], s33 offen offset:3072
  s_add_u32 s33, s36, 73728
  buffer_load_dwordx2 v[96:97], v1, s[16:19], s33 offen offset:0
  buffer_load_dwordx2 v[98:99], v1, s[16:19], s33 offen offset:1024
  buffer_load_dwordx2 v[104:105], v1, s[16:19], s33 offen offset:2048
  buffer_load_dwordx2 v[106:107], v1, s[16:19], s33 offen offset:3072
  s_add_u32 s33, s36, 106496
  buffer_load_dwordx2 v[100:101], v1, s[16:19], s33 offen offset:0
  buffer_load_dwordx2 v[102:103], v1, s[16:19], s33 offen offset:1024
  buffer_load_dwordx2 v[108:109], v1, s[16:19], s33 offen offset:2048
  buffer_load_dwordx2 v[110:111], v1, s[16:19], s33 offen offset:3072
  s_waitcnt vmcnt(40)
  v_perm_b32 v128, v18, v16, s39
  v_perm_b32 v129, v22, v20, s39
  v_perm_b32 v130, v26, v24, s39
  v_perm_b32 v131, v30, v28, s39
  v_perm_b32 v144, v18, v16, s40
  v_perm_b32 v145, v22, v20, s40
  v_perm_b32 v146, v26, v24, s40
  v_perm_b32 v147, v30, v28, s40
  v_perm_b32 v160, v19, v17, s39
  v_perm_b32 v161, v23, v21, s39
  v_perm_b32 v162, v27, v25, s39
  v_perm_b32 v163, v31, v29, s39
  v_perm_b32 v176, v19, v17, s40
  v_perm_b32 v177, v23, v21, s40
  v_perm_b32 v178, v27, v25, s40
  v_perm_b32 v179, v31, v29, s40
  s_add_u32 s33, s36, 65536
  buffer_load_dwordx2 v[16:17], v1, s[16:19], s33 offen offset:128
  buffer_load_dwordx2 v[18:19], v1, s[16:19], s33 offen offset:1152
  buffer_load_dwordx2 v[24:25], v1, s[16:19], s33 offen offset:2176
  buffer_load_dwordx2 v[26:27], v1, s[16:19], s33 offen offset:3200
  s_add_u32 s33, s36, 98304
  buffer_load_dwordx2 v[20:21], v1, s[16:19], s33 offen offset:128
  buffer_load_dwordx2 v[22:23], v1, s[16:19], s33 offen offset:1152
  buffer_load_dwordx2 v[28:29], v1, s[16:19], s33 offen offset:2176
  buffer_load_dwordx2 v[30:31], v1, s[16:19], s33 offen offset:3200
  s_waitcnt vmcnt(40)
  v_perm_b32 v132, v34, v32, s39
  v_perm_b32 v133, v38, v36, s39
  v_perm_b32 v134, v42, v40, s39
  v_perm_b32 v135, v46, v44, s39
  v_perm_b32 v148, v34, v32, s40
  v_perm_b32 v149, v38, v36, s40
  v_perm_b32 v150, v42, v40, s40
  v_perm_b32 v151, v46, v44, s40
  v_perm_b32 v164, v35, v33, s39
  v_perm_b32 v165, v39, v37, s39
  v_perm_b32 v166, v43, v41, s39
  v_perm_b32 v167, v47, v45, s39
  v_perm_b32 v180, v35, v33, s40
  v_perm_b32 v181, v39, v37, s40
  v_perm_b32 v182, v43, v41, s40
  v_perm_b32 v183, v47, v45, s40
  s_add_u32 s33, s36, 73728
  buffer_load_dwordx2 v[32:33], v1, s[16:19], s33 offen offset:128
  buffer_load_dwordx2 v[34:35], v1, s[16:19], s33 offen offset:1152
  buffer_load_dwordx2 v[40:41], v1, s[16:19], s33 offen offset:2176
  buffer_load_dwordx2 v[42:43], v1, s[16:19], s33 offen offset:3200
  s_add_u32 s33, s36, 106496
  buffer_load_dwordx2 v[36:37], v1, s[16:19], s33 offen offset:128
  buffer_load_dwordx2 v[38:39], v1, s[16:19], s33 offen offset:1152
  buffer_load_dwordx2 v[44:45], v1, s[16:19], s33 offen offset:2176
  buffer_load_dwordx2 v[46:47], v1, s[16:19], s33 offen offset:3200
  s_waitcnt vmcnt(40)
  v_perm_b32 v192, v50, v48, s39
  v_perm_b32 v193, v54, v52, s39
  v_perm_b32 v194, v58, v56, s39
  v_perm_b32 v195, v62, v60, s39
  v_perm_b32 v208, v50, v48, s40
  v_perm_b32 v209, v54, v52, s40
  v_perm_b32 v210, v58, v56, s40
  v_perm_b32 v211, v62, v60, s40
  v_perm_b32 v224, v51, v49, s39
  v_perm_b32 v225, v55, v53, s39
  v_perm_b32 v226, v59, v57, s39
  v_perm_b32 v227, v63, v61, s39
  v_perm_b32 v240, v51, v49, s40
  v_perm_b32 v241, v55, v53, s40
  v_perm_b32 v242, v59, v57, s40
  v_perm_b32 v243, v63, v61, s40
  s_add_u32 s33, s37, 0
  s_add_u32 m0, s38, 0
  s_nop 0
  buffer_load_dwordx4 v2, s[28:31], s33 offen lds
  s_add_u32 s33, s37, 32768
  s_add_u32 m0, s38, 1024
  s_nop 0
  buffer_load_dwordx4 v2, s[28:31], s33 offen lds
  s_add_u32 s33, s37, 65536
  s_add_u32 m0, s38, 2048
  s_nop 0
  buffer_load_dwordx4 v3, s[28:31], s33 offen lds
  s_add_u32 s33, s37, 98304
  s_add_u32 m0, s38, 3072
  s_nop 0
  buffer_load_dwordx4 v3, s[28:31], s33 offen lds
  s_waitcnt vmcnt(36)
  v_perm_b32 v196, v66, v64, s39
  v_perm_b32 v197, v70, v68, s39
  v_perm_b32 v198, v74, v72, s39
  v_perm_b32 v199, v78, v76, s39
  v_perm_b32 v212, v66, v64, s40
  v_perm_b32 v213, v70, v68, s40
  v_perm_b32 v214, v74, v72, s40
  v_perm_b32 v215, v78, v76, s40
  v_perm_b32 v228, v67, v65, s39
  v_perm_b32 v229, v71, v69, s39
  v_perm_b32 v230, v75, v73, s39
  v_perm_b32 v231, v79, v77, s39
  v_perm_b32 v244, v67, v65, s40
  v_perm_b32 v245, v71, v69, s40
  v_perm_b32 v246, v75, v73, s40
  v_perm_b32 v247, v79, v77, s40
  s_add_u32 s33, s37, 524288
  s_add_u32 m0, s38, 16384
  s_nop 0
  buffer_load_dwordx4 v2, s[28:31], s33 offen lds
  s_add_u32 s33, s37, 557056
  s_add_u32 m0, s38, 17408
  s_nop 0
  buffer_load_dwordx4 v2, s[28:31], s33 offen lds
  s_add_u32 s33, s37, 589824
  s_add_u32 m0, s38, 18432
  s_nop 0
  buffer_load_dwordx4 v3, s[28:31], s33 offen lds
  s_add_u32 s33, s37, 622592
  s_add_u32 m0, s38, 19456
  s_nop 0
  buffer_load_dwordx4 v3, s[28:31], s33 offen lds
  s_waitcnt vmcnt(32)
  v_perm_b32 v136, v82, v80, s39
  v_perm_b32 v137, v86, v84, s39
  v_perm_b32 v138, v90, v88, s39
  v_perm_b32 v139, v94, v92, s39
  v_perm_b32 v152, v82, v80, s40
  v_perm_b32 v153, v86, v84, s40
  v_perm_b32 v154, v90, v88, s40
  v_perm_b32 v155, v94, v92, s40
  v_perm_b32 v168, v83, v81, s39
  v_perm_b32 v169, v87, v85, s39
  v_perm_b32 v170, v91, v89, s39
  v_perm_b32 v171, v95, v93, s39
  v_perm_b32 v184, v83, v81, s40
  v_perm_b32 v185, v87, v85, s40
  v_perm_b32 v186, v91, v89, s40
  v_perm_b32 v187, v95, v93, s40
  s_add_u32 s33, s37, 1048576
  s_add_u32 m0, s38, 32768
  s_nop 0
  buffer_load_dwordx4 v2, s[28:31], s33 offen lds
  s_add_u32 s33, s37, 1081344
  s_add_u32 m0, s38, 33792
  s_nop 0
  buffer_load_dwordx4 v2, s[28:31], s33 offen lds
  s_add_u32 s33, s37, 1114112
  s_add_u32 m0, s38, 34816
  s_nop 0
  buffer_load_dwordx4 v3, s[28:31], s33 offen lds
  s_add_u32 s33, s37, 1146880
  s_add_u32 m0, s38, 35840
  s_nop 0
  buffer_load_dwordx4 v3, s[28:31], s33 offen lds
  s_waitcnt vmcnt(28)
  v_perm_b32 v140, v98, v96, s39
  v_perm_b32 v141, v102, v100, s39
  v_perm_b32 v142, v106, v104, s39
  v_perm_b32 v143, v110, v108, s39
  v_perm_b32 v156, v98, v96, s40
  v_perm_b32 v157, v102, v100, s40
  v_perm_b32 v158, v106, v104, s40
  v_perm_b32 v159, v110, v108, s40
  v_perm_b32 v172, v99, v97, s39
  v_perm_b32 v173, v103, v101, s39
  v_perm_b32 v174, v107, v105, s39
  v_perm_b32 v175, v111, v109, s39
  v_perm_b32 v188, v99, v97, s40
  v_perm_b32 v189, v103, v101, s40
  v_perm_b32 v190, v107, v105, s40
  v_perm_b32 v191, v111, v109, s40
  s_add_u32 s33, s37, 1572864
  s_add_u32 m0, s38, 49152
  s_nop 0
  buffer_load_dwordx4 v2, s[28:31], s33 offen lds
  s_add_u32 s33, s37, 1605632
  s_add_u32 m0, s38, 50176
  s_nop 0
  buffer_load_dwordx4 v2, s[28:31], s33 offen lds
  s_add_u32 s33, s37, 1638400
  s_add_u32 m0, s38, 51200
  s_nop 0
  buffer_load_dwordx4 v3, s[28:31], s33 offen lds
  s_add_u32 s33, s37, 1671168
  s_add_u32 m0, s38, 52224
  s_nop 0
  buffer_load_dwordx4 v3, s[28:31], s33 offen lds
  s_waitcnt vmcnt(24)
  v_perm_b32 v200, v18, v16, s39
  v_perm_b32 v201, v22, v20, s39
  v_perm_b32 v202, v26, v24, s39
  v_perm_b32 v203, v30, v28, s39
  v_perm_b32 v216, v18, v16, s40
  v_perm_b32 v217, v22, v20, s40
  v_perm_b32 v218, v26, v24, s40
  v_perm_b32 v219, v30, v28, s40
  v_perm_b32 v232, v19, v17, s39
  v_perm_b32 v233, v23, v21, s39
  v_perm_b32 v234, v27, v25, s39
  v_perm_b32 v235, v31, v29, s39
  v_perm_b32 v248, v19, v17, s40
  v_perm_b32 v249, v23, v21, s40
  v_perm_b32 v250, v27, v25, s40
  v_perm_b32 v251, v31, v29, s40
  s_add_u32 s33, s37, 2097152
  s_add_u32 m0, s38, 65536
  s_nop 0
  buffer_load_dwordx4 v2, s[28:31], s33 offen lds
  s_add_u32 s33, s37, 2129920
  s_add_u32 m0, s38, 66560
  s_nop 0
  buffer_load_dwordx4 v2, s[28:31], s33 offen lds
  s_add_u32 s33, s37, 2162688
  s_add_u32 m0, s38, 67584
  s_nop 0
  buffer_load_dwordx4 v3, s[28:31], s33 offen lds
  s_add_u32 s33, s37, 2195456
  s_add_u32 m0, s38, 68608
  s_nop 0
  buffer_load_dwordx4 v3, s[28:31], s33 offen lds
  s_waitcnt vmcnt(20)
  v_perm_b32 v204, v34, v32, s39
  v_perm_b32 v205, v38, v36, s39
  v_perm_b32 v206, v42, v40, s39
  v_perm_b32 v207, v46, v44, s39
  v_perm_b32 v220, v34, v32, s40
  v_perm_b32 v221, v38, v36, s40
  v_perm_b32 v222, v42, v40, s40
  v_perm_b32 v223, v46, v44, s40
  v_perm_b32 v236, v35, v33, s39
  v_perm_b32 v237, v39, v37, s39
  v_perm_b32 v238, v43, v41, s39
  v_perm_b32 v239, v47, v45, s39
  v_perm_b32 v252, v35, v33, s40
  v_perm_b32 v253, v39, v37, s40
  v_perm_b32 v254, v43, v41, s40
  v_perm_b32 v255, v47, v45, s40
  s_add_u32 s33, s37, 2621440
  s_add_u32 m0, s38, 81920
  s_nop 0
  buffer_load_dwordx4 v2, s[28:31], s33 offen lds
  s_add_u32 s33, s37, 2654208
  s_add_u32 m0, s38, 82944
  s_nop 0
  buffer_load_dwordx4 v2, s[28:31], s33 offen lds
  s_add_u32 s33, s37, 2686976
  s_add_u32 m0, s38, 83968
  s_nop 0
  buffer_load_dwordx4 v3, s[28:31], s33 offen lds
  s_add_u32 s33, s37, 2719744
  s_add_u32 m0, s38, 84992
  s_nop 0
  buffer_load_dwordx4 v3, s[28:31], s33 offen lds
  s_waitcnt vmcnt(20)
  s_barrier
  ds_read_b64_tr_b16 v[16:17], v4 offset:0
  ds_read_b64_tr_b16 v[18:19], v4 offset:1024
  ds_read_b64_tr_b16 v[20:21], v4 offset:8192
  ds_read_b64_tr_b16 v[22:23], v4 offset:9216
  ds_read_b64_tr_b16 v[24:25], v5 offset:0
  ds_read_b64_tr_b16 v[26:27], v5 offset:1024
  ds_read_b64_tr_b16 v[28:29], v5 offset:8192
  ds_read_b64_tr_b16 v[30:31], v5 offset:9216
  s_waitcnt lgkmcnt(0)
  s_add_u32 s33, s37, 3145728
  s_add_u32 m0, s38, 98304
  s_nop 0
  buffer_load_dwordx4 v2, s[28:31], s33 offen lds
  s_add_u32 s33, s37, 3178496
  s_add_u32 m0, s38, 99328
  s_nop 0
  buffer_load_dwordx4 v2, s[28:31], s33 offen lds
  s_add_u32 s33, s37, 3211264
  s_add_u32 m0, s38, 100352
  s_nop 0
  buffer_load_dwordx4 v3, s[28:31], s33 offen lds
  s_add_u32 s33, s37, 3244032
  s_add_u32 m0, s38, 101376
  s_nop 0
  buffer_load_dwordx4 v3, s[28:31], s33 offen lds
  s_waitcnt vmcnt(20)
  s_barrier
  ds_write_b128 v8, v[16:19] offset:0
  ds_write_b128 v8, v[20:23] offset:1024
  ds_write_b128 v8, v[24:27] offset:2048
  ds_write_b128 v8, v[28:31] offset:3072
  ds_read_b64_tr_b16 v[32:33], v4 offset:16384
  ds_read_b64_tr_b16 v[34:35], v4 offset:17408
  ds_read_b64_tr_b16 v[36:37], v4 offset:24576
  ds_read_b64_tr_b16 v[38:39], v4 offset:25600
  ds_read_b64_tr_b16 v[40:41], v5 offset:16384
  ds_read_b64_tr_b16 v[42:43], v5 offset:17408
  ds_read_b64_tr_b16 v[44:45], v5 offset:24576
  ds_read_b64_tr_b16 v[46:47], v5 offset:25600
  s_waitcnt lgkmcnt(0)
  s_add_u32 s33, s37, 3670016
  s_add_u32 m0, s38, 114688
  s_nop 0
  buffer_load_dwordx4 v2, s[28:31], s33 offen lds
  s_add_u32 s33, s37, 3702784
  s_add_u32 m0, s38, 115712
  s_nop 0
  buffer_load_dwordx4 v2, s[28:31], s33 offen lds
  s_add_u32 s33, s37, 3735552
  s_add_u32 m0, s38, 116736
  s_nop 0
  buffer_load_dwordx4 v3, s[28:31], s33 offen lds
  s_add_u32 s33, s37, 3768320
  s_add_u32 m0, s38, 117760
  s_nop 0
  buffer_load_dwordx4 v3, s[28:31], s33 offen lds
  s_waitcnt vmcnt(20)
  s_barrier
  ds_write_b128 v8, v[32:35] offset:16384
  ds_write_b128 v8, v[36:39] offset:17408
  ds_write_b128 v8, v[40:43] offset:18432
  ds_write_b128 v8, v[44:47] offset:19456
  ds_read_b64_tr_b16 v[16:17], v4 offset:32768
  ds_read_b64_tr_b16 v[18:19], v4 offset:33792
  ds_read_b64_tr_b16 v[20:21], v4 offset:40960
  ds_read_b64_tr_b16 v[22:23], v4 offset:41984
  ds_read_b64_tr_b16 v[24:25], v5 offset:32768
  ds_read_b64_tr_b16 v[26:27], v5 offset:33792
  ds_read_b64_tr_b16 v[28:29], v5 offset:40960
  ds_read_b64_tr_b16 v[30:31], v5 offset:41984
  s_waitcnt lgkmcnt(0)
  s_waitcnt vmcnt(16)
  s_barrier
  ds_write_b128 v8, v[16:19] offset:32768
  ds_write_b128 v8, v[20:23] offset:33792
  ds_write_b128 v8, v[24:27] offset:34816
  ds_write_b128 v8, v[28:31] offset:35840
  ds_read_b64_tr_b16 v[32:33], v4 offset:49152
  ds_read_b64_tr_b16 v[34:35], v4 offset:50176
  ds_read_b64_tr_b16 v[36:37], v4 offset:57344
  ds_read_b64_tr_b16 v[38:39], v4 offset:58368
  ds_read_b64_tr_b16 v[40:41], v5 offset:49152
  ds_read_b64_tr_b16 v[42:43], v5 offset:50176
  ds_read_b64_tr_b16 v[44:45], v5 offset:57344
  ds_read_b64_tr_b16 v[46:47], v5 offset:58368
  s_waitcnt lgkmcnt(0)
  s_waitcnt vmcnt(12)
  s_barrier
  ds_write_b128 v8, v[32:35] offset:49152
  ds_write_b128 v8, v[36:39] offset:50176
  ds_write_b128 v8, v[40:43] offset:51200
  ds_write_b128 v8, v[44:47] offset:52224
  ds_read_b64_tr_b16 v[16:17], v6 offset:0
  ds_read_b64_tr_b16 v[18:19], v6 offset:1024
  ds_read_b64_tr_b16 v[20:21], v6 offset:8192
  ds_read_b64_tr_b16 v[22:23], v6 offset:9216
  ds_read_b64_tr_b16 v[24:25], v7 offset:0
  ds_read_b64_tr_b16 v[26:27], v7 offset:1024
  ds_read_b64_tr_b16 v[28:29], v7 offset:8192
  ds_read_b64_tr_b16 v[30:31], v7 offset:9216
  s_waitcnt lgkmcnt(0)
  s_waitcnt vmcnt(8)
  s_barrier
  ds_write_b128 v9, v[16:19] offset:0
  ds_write_b128 v9, v[20:23] offset:1024
  ds_write_b128 v9, v[24:27] offset:2048
  ds_write_b128 v9, v[28:31] offset:3072
  ds_read_b64_tr_b16 v[32:33], v6 offset:16384
  ds_read_b64_tr_b16 v[34:35], v6 offset:17408
  ds_read_b64_tr_b16 v[36:37], v6 offset:24576
  ds_read_b64_tr_b16 v[38:39], v6 offset:25600
  ds_read_b64_tr_b16 v[40:41], v7 offset:16384
  ds_read_b64_tr_b16 v[42:43], v7 offset:17408
  ds_read_b64_tr_b16 v[44:45], v7 offset:24576
  ds_read_b64_tr_b16 v[46:47], v7 offset:25600
  s_waitcnt lgkmcnt(0)
  s_waitcnt vmcnt(4)
  s_barrier
  ds_write_b128 v9, v[32:35] offset:16384
  ds_write_b128 v9, v[36:39] offset:17408
  ds_write_b128 v9, v[40:43] offset:18432
  ds_write_b128 v9, v[44:47] offset:19456
  ds_read_b64_tr_b16 v[16:17], v6 offset:32768
  ds_read_b64_tr_b16 v[18:19], v6 offset:33792
  ds_read_b64_tr_b16 v[20:21], v6 offset:40960
  ds_read_b64_tr_b16 v[22:23], v6 offset:41984
  ds_read_b64_tr_b16 v[24:25], v7 offset:32768
  ds_read_b64_tr_b16 v[26:27], v7 offset:33792
  ds_read_b64_tr_b16 v[28:29], v7 offset:40960
  ds_read_b64_tr_b16 v[30:31], v7 offset:41984
  s_waitcnt lgkmcnt(0)
  s_waitcnt vmcnt(0)
  s_barrier
  ds_write_b128 v9, v[16:19] offset:32768
  ds_write_b128 v9, v[20:23] offset:33792
  ds_write_b128 v9, v[24:27] offset:34816
  ds_write_b128 v9, v[28:31] offset:35840
  ds_read_b64_tr_b16 v[32:33], v6 offset:49152
  ds_read_b64_tr_b16 v[34:35], v6 offset:50176
  ds_read_b64_tr_b16 v[36:37], v6 offset:57344
  ds_read_b64_tr_b16 v[38:39], v6 offset:58368
  ds_read_b64_tr_b16 v[40:41], v7 offset:49152
  ds_read_b64_tr_b16 v[42:43], v7 offset:50176
  ds_read_b64_tr_b16 v[44:45], v7 offset:57344
  ds_read_b64_tr_b16 v[46:47], v7 offset:58368
  s_waitcnt lgkmcnt(0)
  s_barrier
  ds_write_b128 v9, v[32:35] offset:49152
  ds_write_b128 v9, v[36:39] offset:50176
  ds_write_b128 v9, v[40:43] offset:51200
  ds_write_b128 v9, v[44:47] offset:52224
  s_waitcnt lgkmcnt(0)
LOADED_27:
  s_barrier
  v_mov_b32 v27, v0
  s_mov_b32 s16, s64
  s_mov_b32 s17, s65
  s_mov_b32 s18, 2097152
  s_mov_b32 s19, 0x00020000
  v_lshlrev_b32 v13, 4, v27
  v_and_b32 v26, 15, v27
  v_lshrrev_b32 v25, 4, v27
  s_lshl_b32 s33, s3, 8
  v_lshlrev_b32 v28, 17, v25
  v_lshlrev_b32 v29, 4, v26
  v_add3_u32 v18, v28, v29, s33
  v_lshlrev_b32 v28, 10, v25
  v_add3_u32 v20, v28, v29, s33
  v_lshrrev_b32 v28, 3, v27
  v_lshlrev_b32 v28, 10, v28
  v_and_b32 v29, 7, v27
  v_xor_b32 v29, v29, v25
  v_lshlrev_b32 v29, 4, v29
  v_add_u32 v19, v28, v29
  v_lshrrev_b32 v28, 1, v25
  v_lshlrev_b32 v28, 7, v28
  v_lshlrev_b32 v30, 3, v26
  v_add3_u32 v28, v28, v30, s33
  v_and_b32 v30, 1, v25
  v_lshlrev_b32 v30, 2, v30
  v_add_u32 v21, v28, v30
  v_and_b32 v29, 3, v26
  v_mov_b32 v30, 0x3f80
  v_mov_b32 v31, 0x3f800000
  v_cmp_eq_u32 vcc, 0, v29
  s_nop 1
  v_cndmask_b32 v30, v31, v30, vcc
  v_cmp_gt_u32 vcc, 2, v29
  s_nop 1
  v_cndmask_b32 v22, 0, v30, vcc
  s_mov_b32 s52, 0xf000f
  s_mov_b32 s53, 0xf000f
  s_mov_b32 s54, 0xf000f0
  s_mov_b32 s55, 0xf000f0
  s_mov_b32 s56, 0xf000f00
  s_mov_b32 s57, 0xf000f00
  s_mov_b32 s58, 0xf000f000
  s_mov_b32 s59, 0xf000f000
  v_and_b32 v28, 31, v27
  v_lshlrev_b32 v23, 2, v28
  s_lshl_b32 s33, s4, 21
  s_add_u32 s33, s33, 67108864
  s_lshl_b32 s34, s5, 10
  s_add_u32 s45, s33, s34
  s_lshl_b32 s34, s5, 15
  s_add_u32 s46, s33, s34
  s_lshl_b32 s33, s4, 9
  s_lshl_b32 s34, s3, 7
  s_add_u32 s33, s33, s34
  s_add_u32 s47, s33, 65536
  s_mov_b32 s43, 0
  s_lshl_b32 s33, s3, 11
  v_add_u32 v1, s33, v13
  v_lshrrev_b32 v28, 1, v26
  v_xor_b32 v28, v28, v25
  v_lshlrev_b32 v28, 4, v28
  v_lshlrev_b32 v29, 7, v26
  v_add_u32 v32, v28, v29
  s_add_u32 s33, s3, 0
  s_and_b32 s33, s33, 3
  s_lshl_b32 s34, s33, 13
  v_add_u32 v6, s34, v32
  s_lshl_b32 s33, s33, 15
  s_lshl_b32 s34, s3, 12
  s_add_u32 s33, s33, s34
  s_add_u32 s33, s33, 32768
  v_add_u32 v2, s33, v13
  s_add_u32 s33, s3, 1
  s_and_b32 s33, s33, 3
  s_lshl_b32 s34, s33, 13
  v_add_u32 v7, s34, v32
  s_lshl_b32 s34, s33, 11
  v_add_u32 v10, s34, v13
  s_lshl_b32 s33, s33, 15
  s_lshl_b32 s34, s3, 12
  s_add_u32 s33, s33, s34
  s_add_u32 s33, s33, 32768
  v_add_u32 v3, s33, v13
  s_add_u32 s33, s3, 2
  s_and_b32 s33, s33, 3
  s_lshl_b32 s34, s33, 13
  v_add_u32 v8, s34, v32
  s_lshl_b32 s34, s33, 11
  v_add_u32 v11, s34, v13
  s_lshl_b32 s33, s33, 15
  s_lshl_b32 s34, s3, 12
  s_add_u32 s33, s33, s34
  s_add_u32 s33, s33, 32768
  v_add_u32 v4, s33, v13
  s_add_u32 s33, s3, 3
  s_and_b32 s33, s33, 3
  s_lshl_b32 s34, s33, 13
  v_add_u32 v9, s34, v32
  s_lshl_b32 s34, s33, 11
  v_add_u32 v12, s34, v13
  s_lshl_b32 s33, s33, 15
  s_lshl_b32 s34, s3, 12
  s_add_u32 s33, s33, s34
  s_add_u32 s33, s33, 32768
  v_add_u32 v5, s33, v13
  v_lshrrev_b32 v28, 2, v26
  v_xor_b32 v29, v25, v28
  v_lshlrev_b32 v29, 3, v29
  v_lshlrev_b32 v30, 5, v26
  s_lshl_b32 s33, s3, 10
  s_add_u32 s33, s33, 24576
  v_add3_u32 v14, v29, v30, s33
  v_lshlrev_b32 v29, 2, v25
  v_add_u32 v29, v29, v28
  v_lshlrev_b32 v29, 5, v29
  v_and_b32 v30, 3, v26
  v_xor_b32 v31, v30, v25
  v_lshlrev_b32 v31, 3, v31
  s_mov_b32 s33, 24576
  v_add3_u32 v15, v29, v31, s33
  v_mov_b32 v28, 0x44444444
  v_mov_b32 v29, 0xeeeeeeee
  v_cmp_lt_u32 vcc, 1, v30
  s_nop 1
  v_cndmask_b32 v16, v28, v29, vcc
  v_lshlrev_b32 v28, 9, v25
  v_lshlrev_b32 v29, 4, v26
  s_lshr_b32 s33, s3, 1
  s_lshl_b32 s33, s33, 11
  s_and_b32 s34, s3, 1
  s_lshl_b32 s34, s34, 2
  s_add_u32 s33, s33, s34
  s_add_u32 s33, s33, 16384
  v_add3_u32 v17, v28, v29, s33
  s_sub_u32 s42, s4, 1
  v_lshlrev_b32 v28, 2, v25
  v_add_u32 v28, 0, v28
  v_cmp_ge_u32 s[64:65], v26, v28
  v_lshlrev_b32 v28, 2, v25
  v_add_u32 v28, 1, v28
  v_cmp_ge_u32 s[66:67], v26, v28
  v_lshlrev_b32 v28, 2, v25
  v_add_u32 v28, 2, v28
  v_cmp_ge_u32 s[68:69], v26, v28
  v_lshlrev_b32 v28, 2, v25
  v_add_u32 v28, 3, v28
  v_cmp_ge_u32 s[70:71], v26, v28
  s_mov_b32 s44, 0x3e0293ee
  s_mov_b32 s49, 0xf149f2ca
AP_MP:
  buffer_load_dword v0, off, s[12:15], 0 offset:4 sc1
  s_waitcnt vmcnt(0)
  v_cmp_le_u32 vcc, 64, v0
  s_cbranch_vccnz AP_MOK
  s_sleep 2
  s_sub_u32 s6, s6, 1
  s_cbranch_scc1 GIVEUP
  s_branch AP_MP
AP_MOK:
  v_lshlrev_b32 v24, 1, v21
  s_mov_b32 s33, 135168
  buffer_load_dwordx2 v[122:123], v24, s[8:11], s33 offen sc1
  s_mov_b32 s33, 139264
  buffer_load_dwordx2 v[124:125], v24, s[8:11], s33 offen sc1
  s_mov_b32 s33, 137216
  buffer_load_dwordx2 v[126:127], v24, s[8:11], s33 offen sc1
  s_cmp_lg_u32 s4, 4
  s_cbranch_scc1 AP_NA
  v_mov_b64 v[28:29], -1
  v_mov_b64 v[30:31], -1
  s_lshl_b32 s33, s4, 5
  s_add_u32 s33, s33, s5
  s_lshl_b32 s33, s33, 15
  s_add_u32 s33, s33, 100663296
  buffer_store_dwordx4 v[28:31], v20, s[8:11], s33 offen sc1
  s_add_u32 s33, s33, 4096
  buffer_store_dwordx4 v[28:31], v20, s[8:11], s33 offen sc1
  s_add_u32 s33, s33, 4096
  buffer_store_dwordx4 v[28:31], v20, s[8:11], s33 offen sc1
  s_add_u32 s33, s33, 4096
  buffer_store_dwordx4 v[28:31], v20, s[8:11], s33 offen sc1
  s_add_u32 s33, s33, 4096
  buffer_store_dwordx4 v[28:31], v20, s[8:11], s33 offen sc1
  s_add_u32 s33, s33, 4096
  buffer_store_dwordx4 v[28:31], v20, s[8:11], s33 offen sc1
  s_add_u32 s33, s33, 4096
  buffer_store_dwordx4 v[28:31], v20, s[8:11], s33 offen sc1
  s_add_u32 s33, s33, 4096
  buffer_store_dwordx4 v[28:31], v20, s[8:11], s33 offen sc1
  s_add_u32 s33, s4, 59
  s_cmp_eq_u32 s33, 64
  s_cselect_b32 s33, 59, s33
  s_lshl_b32 s33, s33, 5
  s_add_u32 s33, s33, s5
  s_lshl_b32 s33, s33, 10
  s_add_u32 s34, s33, 6291456
  s_add_u32 s33, s33, 4194304
  s_waitcnt vmcnt(0)
AP_NA:
  s_mul_i32 s33, s42, 8192
  s_add_u32 s33, s33, 573440
  s_lshl_b32 s34, s5, 6
  s_add_u32 s33, s33, s34
AP_SG:
  buffer_load_dword v0, off, s[8:11], s33 sc1
  s_waitcnt vmcnt(0)
  v_cmp_ne_u32 vcc, -1, v0
  s_cbranch_vccnz AP_SGOK
  s_sleep 8
  s_sub_u32 s6, s6, 1
  s_cbranch_scc1 GIVEUP
  s_branch AP_SG
AP_SGOK:
  s_lshl_b32 s33, s42, 18
  s_lshl_b32 s34, s5, 13
  s_add_u32 s33, s33, s34
  s_add_u32 s34, s33, 16777216
  s_add_u32 s35, s33, 33554432
  buffer_load_dwordx4 v[112:115], v1, s[8:11], s34 offen offset:0 sc1
  buffer_load_dwordx4 v[116:119], v1, s[8:11], s34 offen offset:1024 sc1
  buffer_load_dwordx4 v[28:31], v1, s[8:11], s35 offen offset:0 sc1
  buffer_load_dwordx4 v[32:35], v1, s[8:11], s35 offen offset:1024 sc1
  s_waitcnt vmcnt(4)
  s_cmp_lg_u32 s7, 0
  s_cbranch_scc1 AS_LOOP
AF_LOOP:
  ds_read_b128 v[68:71], v2 offset:0
  ds_read_b128 v[72:75], v2 offset:2048
  ds_read_b128 v[84:87], v2 offset:1024
  ds_read_b128 v[88:91], v2 offset:3072
  s_barrier
  ds_read_b128 v[60:63], v6 offset:0
  ds_read_b128 v[64:67], v6 offset:2048
  v_xor_b32 v6, 64, v6
  ds_read_b128 v[76:79], v6 offset:0
  ds_read_b128 v[80:83], v6 offset:2048
  v_xor_b32 v6, 64, v6
  s_waitcnt lgkmcnt(2)
  v_mfma_f32_16x16x32_bf16 v[36:39], v[68:71], v[60:63], 0
  ds_read_b128 v[100:103], v2 offset:16384
  v_mfma_f32_16x16x32_bf16 v[40:43], v[68:71], v[64:67], 0
  ds_read_b128 v[104:107], v2 offset:18432
  v_mfma_f32_16x16x32_bf16 v[44:47], v[72:75], v[60:63], 0
  ds_read_b128 v[92:95], v6 offset:4096
  v_mfma_f32_16x16x32_bf16 v[48:51], v[72:75], v[64:67], 0
  ds_read_b128 v[96:99], v6 offset:6144
  v_xor_b32 v6, 64, v6
  s_waitcnt lgkmcnt(4)
  v_mfma_f32_16x16x32_bf16 v[36:39], v[84:87], v[76:79], v[36:39]
  ds_read_b128 v[68:71], v2 offset:17408
  v_mfma_f32_16x16x32_bf16 v[40:43], v[84:87], v[80:83], v[40:43]
  ds_read_b128 v[72:75], v2 offset:19456
  v_mfma_f32_16x16x32_bf16 v[44:47], v[88:91], v[76:79], v[44:47]
  ds_read_b128 v[60:63], v6 offset:4096
  v_mfma_f32_16x16x32_bf16 v[48:51], v[88:91], v[80:83], v[48:51]
  ds_read_b128 v[64:67], v6 offset:6144
  v_xor_b32 v6, 64, v6
  s_waitcnt lgkmcnt(4)
  v_mfma_f32_16x16x32_bf16 v[36:39], v[100:103], v[92:95], v[36:39]
  ds_read_b128 v[84:87], v3 offset:0
  v_mfma_f32_16x16x32_bf16 v[40:43], v[100:103], v[96:99], v[40:43]
  ds_read_b128 v[88:91], v3 offset:2048
  v_mfma_f32_16x16x32_bf16 v[44:47], v[104:107], v[92:95], v[44:47]
  ds_read_b128 v[76:79], v7 offset:0
  v_mfma_f32_16x16x32_bf16 v[48:51], v[104:107], v[96:99], v[48:51]
  ds_read_b128 v[80:83], v7 offset:2048
  v_xor_b32 v7, 64, v7
  s_waitcnt lgkmcnt(4)
  v_mfma_f32_16x16x32_bf16 v[36:39], v[68:71], v[60:63], v[36:39]
  ds_read_b128 v[100:103], v3 offset:1024
  v_mfma_f32_16x16x32_bf16 v[40:43], v[68:71], v[64:67], v[40:43]
  ds_read_b128 v[104:107], v3 offset:3072
  v_mfma_f32_16x16x32_bf16 v[44:47], v[72:75], v[60:63], v[44:47]
  ds_read_b128 v[92:95], v7 offset:0
  v_mfma_f32_16x16x32_bf16 v[48:51], v[72:75], v[64:67], v[48:51]
  ds_read_b128 v[96:99], v7 offset:2048
  v_xor_b32 v7, 64, v7
  s_waitcnt lgkmcnt(4)
  v_mfma_f32_16x16x32_bf16 v[36:39], v[84:87], v[76:79], v[36:39]
  ds_read_b128 v[68:71], v3 offset:16384
  v_mfma_f32_16x16x32_bf16 v[40:43], v[84:87], v[80:83], v[40:43]
  ds_read_b128 v[72:75], v3 offset:18432
  v_mfma_f32_16x16x32_bf16 v[44:47], v[88:91], v[76:79], v[44:47]
  ds_read_b128 v[60:63], v7 offset:4096
  v_mfma_f32_16x16x32_bf16 v[48:51], v[88:91], v[80:83], v[48:51]
  ds_read_b128 v[64:67], v7 offset:6144
  v_xor_b32 v7, 64, v7
  s_waitcnt lgkmcnt(4)
  v_mfma_f32_16x16x32_bf16 v[36:39], v[100:103], v[92:95], v[36:39]
  ds_read_b128 v[84:87], v3 offset:17408
  v_mfma_f32_16x16x32_bf16 v[40:43], v[100:103], v[96:99], v[40:43]
  ds_read_b128 v[88:91], v3 offset:19456
  v_mfma_f32_16x16x32_bf16 v[44:47], v[104:107], v[92:95], v[44:47]
  ds_read_b128 v[76:79], v7 offset:4096
  v_mfma_f32_16x16x32_bf16 v[48:51], v[104:107], v[96:99], v[48:51]
  ds_read_b128 v[80:83], v7 offset:6144
  v_xor_b32 v7, 64, v7
  s_waitcnt lgkmcnt(4)
  v_mfma_f32_16x16x32_bf16 v[36:39], v[68:71], v[60:63], v[36:39]
  ds_read_b128 v[100:103], v4 offset:0
  v_mfma_f32_16x16x32_bf16 v[40:43], v[68:71], v[64:67], v[40:43]
  ds_read_b128 v[104:107], v4 offset:2048
  v_mfma_f32_16x16x32_bf16 v[44:47], v[72:75], v[60:63], v[44:47]
  ds_read_b128 v[92:95], v8 offset:0
  v_mfma_f32_16x16x32_bf16 v[48:51], v[72:75], v[64:67], v[48:51]
  ds_read_b128 v[96:99], v8 offset:2048
  v_xor_b32 v8, 64, v8
  s_waitcnt lgkmcnt(4)
  v_mfma_f32_16x16x32_bf16 v[36:39], v[84:87], v[76:79], v[36:39]
  ds_read_b128 v[68:71], v4 offset:1024
  v_mfma_f32_16x16x32_bf16 v[40:43], v[84:87], v[80:83], v[40:43]
  ds_read_b128 v[72:75], v4 offset:3072
  v_mfma_f32_16x16x32_bf16 v[44:47], v[88:91], v[76:79], v[44:47]
  ds_read_b128 v[60:63], v8 offset:0
  v_mfma_f32_16x16x32_bf16 v[48:51], v[88:91], v[80:83], v[48:51]
  ds_read_b128 v[64:67], v8 offset:2048
  v_xor_b32 v8, 64, v8
  s_waitcnt lgkmcnt(4)
  v_mfma_f32_16x16x32_bf16 v[36:39], v[100:103], v[92:95], v[36:39]
  ds_read_b128 v[84:87], v4 offset:16384
  v_mfma_f32_16x16x32_bf16 v[40:43], v[100:103], v[96:99], v[40:43]
  ds_read_b128 v[88:91], v4 offset:18432
  v_mfma_f32_16x16x32_bf16 v[44:47], v[104:107], v[92:95], v[44:47]
  ds_read_b128 v[76:79], v8 offset:4096
  v_mfma_f32_16x16x32_bf16 v[48:51], v[104:107], v[96:99], v[48:51]
  ds_read_b128 v[80:83], v8 offset:6144
  v_xor_b32 v8, 64, v8
  s_waitcnt lgkmcnt(4)
  v_mfma_f32_16x16x32_bf16 v[36:39], v[68:71], v[60:63], v[36:39]
  ds_read_b128 v[100:103], v4 offset:17408
  v_mfma_f32_16x16x32_bf16 v[40:43], v[68:71], v[64:67], v[40:43]
  ds_read_b128 v[104:107], v4 offset:19456
  v_mfma_f32_16x16x32_bf16 v[44:47], v[72:75], v[60:63], v[44:47]
  ds_read_b128 v[92:95], v8 offset:4096
  v_mfma_f32_16x16x32_bf16 v[48:51], v[72:75], v[64:67], v[48:51]
  ds_read_b128 v[96:99], v8 offset:6144
  v_xor_b32 v8, 64, v8
  s_waitcnt lgkmcnt(4)
  v_mfma_f32_16x16x32_bf16 v[36:39], v[84:87], v[76:79], v[36:39]
  ds_read_b128 v[68:71], v5 offset:0
  v_mfma_f32_16x16x32_bf16 v[40:43], v[84:87], v[80:83], v[40:43]
  ds_read_b128 v[72:75], v5 offset:2048
  v_mfma_f32_16x16x32_bf16 v[44:47], v[88:91], v[76:79], v[44:47]
  ds_read_b128 v[60:63], v9 offset:0
  v_mfma_f32_16x16x32_bf16 v[48:51], v[88:91], v[80:83], v[48:51]
  ds_read_b128 v[64:67], v9 offset:2048
  v_xor_b32 v9, 64, v9
  s_waitcnt lgkmcnt(4)
  v_mfma_f32_16x16x32_bf16 v[36:39], v[100:103], v[92:95], v[36:39]
  ds_read_b128 v[84:87], v5 offset:1024
  v_mfma_f32_16x16x32_bf16 v[40:43], v[100:103], v[96:99], v[40:43]
  ds_read_b128 v[88:91], v5 offset:3072
  v_mfma_f32_16x16x32_bf16 v[44:47], v[104:107], v[92:95], v[44:47]
  ds_read_b128 v[76:79], v9 offset:0
  v_mfma_f32_16x16x32_bf16 v[48:51], v[104:107], v[96:99], v[48:51]
  ds_read_b128 v[80:83], v9 offset:2048
  v_xor_b32 v9, 64, v9
  s_waitcnt lgkmcnt(4)
  v_mfma_f32_16x16x32_bf16 v[36:39], v[68:71], v[60:63], v[36:39]
  ds_read_b128 v[100:103], v5 offset:16384
  v_mfma_f32_16x16x32_bf16 v[40:43], v[68:71], v[64:67], v[40:43]
  ds_read_b128 v[104:107], v5 offset:18432
  v_mfma_f32_16x16x32_bf16 v[44:47], v[72:75], v[60:63], v[44:47]
  ds_read_b128 v[92:95], v9 offset:4096
  v_mfma_f32_16x16x32_bf16 v[48:51], v[72:75], v[64:67], v[48:51]
  ds_read_b128 v[96:99], v9 offset:6144
  v_xor_b32 v9, 64, v9
  s_waitcnt lgkmcnt(4)
  v_mfma_f32_16x16x32_bf16 v[36:39], v[84:87], v[76:79], v[36:39]
  ds_read_b128 v[68:71], v5 offset:17408
  v_mfma_f32_16x16x32_bf16 v[40:43], v[84:87], v[80:83], v[40:43]
  ds_read_b128 v[72:75], v5 offset:19456
  v_mfma_f32_16x16x32_bf16 v[44:47], v[88:91], v[76:79], v[44:47]
  ds_read_b128 v[60:63], v9 offset:4096
  v_mfma_f32_16x16x32_bf16 v[48:51], v[88:91], v[80:83], v[48:51]
  ds_read_b128 v[64:67], v9 offset:6144
  v_xor_b32 v9, 64, v9
  s_waitcnt lgkmcnt(4)
  v_mfma_f32_16x16x32_bf16 v[36:39], v[100:103], v[92:95], v[36:39]
  s_lshl_b32 s41, s42, 5
  v_mfma_f32_16x16x32_bf16 v[40:43], v[100:103], v[96:99], v[40:43]
  s_add_u32 s41, s41, s5
  v_mfma_f32_16x16x32_bf16 v[44:47], v[104:107], v[92:95], v[44:47]
  s_lshl_b32 s41, s41, 10
  v_mfma_f32_16x16x32_bf16 v[48:51], v[104:107], v[96:99], v[48:51]
  s_add_u32 s48, s42, 15
  s_waitcnt lgkmcnt(0)
  s_barrier
  v_mfma_f32_16x16x32_bf16 v[36:39], v[68:71], v[60:63], v[36:39]
  v_mfma_f32_16x16x32_bf16 v[40:43], v[68:71], v[64:67], v[40:43]
  v_mfma_f32_16x16x32_bf16 v[44:47], v[72:75], v[60:63], v[44:47]
  v_mfma_f32_16x16x32_bf16 v[48:51], v[72:75], v[64:67], v[48:51]
  s_waitcnt vmcnt(0)
  ds_write_b128 v1, v[112:115] offset:0
  ds_write_b128 v1, v[116:119] offset:1024
  v_cvt_pk_bf16_f32 v52, v36, v37
  v_cvt_pk_bf16_f32 v53, v38, v39
  v_cvt_pk_bf16_f32 v54, v44, v45
  v_cvt_pk_bf16_f32 v55, v46, v47
  ds_write_b128 v1, v[52:55] offset:8192
  v_cvt_pk_bf16_f32 v56, v40, v41
  v_cvt_pk_bf16_f32 v57, v42, v43
  v_cvt_pk_bf16_f32 v58, v48, v49
  v_cvt_pk_bf16_f32 v59, v50, v51
  ds_write_b128 v1, v[56:59] offset:9216
  buffer_load_dword v120, v21, s[16:19], s41 offen
  s_waitcnt lgkmcnt(0)
  s_barrier
  ds_read_b128 v[76:79], v13 offset:0
  ds_read_b128 v[80:83], v13 offset:1024
  ds_read_b128 v[84:87], v13 offset:8192
  ds_read_b128 v[88:91], v13 offset:9216
  ds_read_b128 v[104:107], v13 offset:2048
  ds_read_b128 v[108:111], v13 offset:3072
  ds_read_b128 v[112:115], v13 offset:10240
  ds_read_b128 v[116:119], v13 offset:11264
  s_waitcnt lgkmcnt(4)
  v_mfma_f32_16x16x32_bf16 v[36:39], v[76:79], v[84:87], 0
  v_mfma_f32_16x16x32_bf16 v[40:43], v[76:79], v[88:91], 0
  v_mfma_f32_16x16x32_bf16 v[44:47], v[80:83], v[88:91], 0
  ds_read_b128 v[76:79], v13 offset:4096
  ds_read_b128 v[80:83], v13 offset:5120
  ds_read_b128 v[84:87], v13 offset:12288
  ds_read_b128 v[88:91], v13 offset:13312
  s_waitcnt lgkmcnt(4)
  v_mfma_f32_16x16x32_bf16 v[36:39], v[104:107], v[112:115], v[36:39]
  v_mfma_f32_16x16x32_bf16 v[40:43], v[104:107], v[116:119], v[40:43]
  v_mfma_f32_16x16x32_bf16 v[44:47], v[108:111], v[116:119], v[44:47]
  ds_read_b128 v[104:107], v13 offset:6144
  ds_read_b128 v[108:111], v13 offset:7168
  ds_read_b128 v[112:115], v13 offset:14336
  ds_read_b128 v[116:119], v13 offset:15360
  s_waitcnt lgkmcnt(4)
  v_mfma_f32_16x16x32_bf16 v[36:39], v[76:79], v[84:87], v[36:39]
  v_mfma_f32_16x16x32_bf16 v[40:43], v[76:79], v[88:91], v[40:43]
  v_mfma_f32_16x16x32_bf16 v[44:47], v[80:83], v[88:91], v[44:47]
  s_waitcnt lgkmcnt(0)
  v_mfma_f32_16x16x32_bf16 v[36:39], v[104:107], v[112:115], v[36:39]
  v_mfma_f32_16x16x32_bf16 v[40:43], v[104:107], v[116:119], v[40:43]
  v_mfma_f32_16x16x32_bf16 v[44:47], v[108:111], v[116:119], v[44:47]
  s_cmp_lt_u32 s42, 63
  s_cbranch_scc1 AF_NT
  s_lshl_b32 s34, s4, 20
  s_add_u32 s34, s34, 100663296
  s_lshl_b32 s33, s5, 10
  s_add_u32 s45, s33, s34
  s_lshl_b32 s33, s5, 15
  s_add_u32 s46, s33, s34
  v_lshlrev_b32 v24, 2, v13
  s_lshl_b32 s33, s4, 5
  s_add_u32 s33, s33, s5
  s_lshl_b32 s33, s33, 2
  s_add_u32 s33, s33, s3
  s_lshl_b32 s33, s33, 13
  s_add_u32 s33, s33, 100663296
  buffer_load_dword v25, v24, s[8:11], s33 offen sc1
  s_add_u32 s33, s33, 4096
  buffer_load_dword v24, v24, s[8:11], s33 offen sc1
AF_NT:
  s_lshl_b32 s37, s3, 11
  s_lshl_b32 s38, s42, 13
  s_add_u32 s38, s38, 524288
  s_cmp_ge_u32 s42, 62
  s_cselect_b32 s33, 8192, 0
  s_sub_u32 s33, s38, s33
  s_lshl_b32 s34, s5, 6
  s_add_u32 s33, s33, s34
  s_add_u32 s33, s33, s37
AF_LP:
  buffer_load_dword v0, off, s[8:11], s33 sc1
  s_waitcnt vmcnt(0)
  v_cmp_ne_u32 vcc, -1, v0
  s_cbranch_vccnz AF_MP
  s_sleep 4
  s_sub_u32 s6, s6, 1
  s_cbranch_scc1 GIVEUP
  s_branch AF_LP
AF_MP:
  buffer_load_dwordx4 v[56:59], v1, s[8:11], s38 offen sc1
  buffer_load_dwordx4 v[60:63], v1, s[8:11], s38 offen offset:1024 sc1
  s_waitcnt vmcnt(0)
  v_max3_u32 v0, v56, v57, v58
  v_max3_u32 v24, v59, v60, v61
  v_max_u32 v0, v0, v62
  v_max3_u32 v0, v0, v24, v63
  v_cmp_eq_u32 vcc, -1, v0
  s_cbranch_vccz AF_MOK
  s_sleep 2
  s_sub_u32 s6, s6, 1
  s_cbranch_scc1 GIVEUP
  s_branch AF_MP
AF_MOK:
  ds_write_b128 v1, v[56:59] offset:16384
  ds_write_b128 v1, v[60:63] offset:17408
  v_mov_b64 v[88:89], 0
  v_mov_b64 v[90:91], 0
  v_mov_b64 v[92:93], 0
  v_mov_b64 v[94:95], 0
  v_mov_b64 v[96:97], 0
  v_mov_b64 v[98:99], 0
  v_mov_b64 v[100:101], 0
  v_mov_b64 v[102:103], 0
  v_mov_b32 v24, s49
  v_cndmask_b32 v36, v24, v36, s[64:65]
  v_cndmask_b32 v44, v24, v44, s[64:65]
  v_cndmask_b32 v37, v24, v37, s[66:67]
  v_cndmask_b32 v45, v24, v45, s[66:67]
  v_cndmask_b32 v38, v24, v38, s[68:69]
  v_cndmask_b32 v46, v24, v46, s[68:69]
  v_cndmask_b32 v39, v24, v39, s[70:71]
  v_cndmask_b32 v47, v24, v47, s[70:71]
  s_waitcnt lgkmcnt(0)
  s_barrier
  ds_read_b128 v[64:67], v10 offset:16384
  ds_read_b128 v[68:71], v10 offset:17408
  ds_read_b128 v[72:75], v11 offset:16384
  ds_read_b128 v[76:79], v11 offset:17408
  ds_read_b128 v[80:83], v12 offset:16384
  ds_read_b128 v[84:87], v12 offset:17408
  v_smfmac_f32_16x16x64_bf16 v[88:91], v[56:59], a[0:7], v16
  v_smfmac_f32_16x16x64_bf16 v[92:95], v[56:59], a[8:15], v16
  v_smfmac_f32_16x16x64_bf16 v[88:91], v[60:63], a[16:23], v16
  v_smfmac_f32_16x16x64_bf16 v[92:95], v[60:63], a[24:31], v16
  s_waitcnt lgkmcnt(5)
  v_smfmac_f32_16x16x64_bf16 v[88:91], v[64:67], a[32:39], v16
  v_smfmac_f32_16x16x64_bf16 v[92:95], v[64:67], a[40:47], v16
  s_waitcnt lgkmcnt(4)
  v_smfmac_f32_16x16x64_bf16 v[88:91], v[68:71], a[48:55], v16
  v_smfmac_f32_16x16x64_bf16 v[92:95], v[68:71], a[56:63], v16
  s_waitcnt lgkmcnt(3)
  v_smfmac_f32_16x16x64_bf16 v[88:91], v[72:75], a[64:71], v16
  v_smfmac_f32_16x16x64_bf16 v[92:95], v[72:75], a[72:79], v16
  s_waitcnt lgkmcnt(2)
  v_smfmac_f32_16x16x64_bf16 v[88:91], v[76:79], a[80:87], v16
  v_smfmac_f32_16x16x64_bf16 v[92:95], v[76:79], a[88:95], v16
  s_waitcnt lgkmcnt(1)
  v_smfmac_f32_16x16x64_bf16 v[88:91], v[80:83], a[96:103], v16
  v_smfmac_f32_16x16x64_bf16 v[92:95], v[80:83], a[104:111], v16
  s_waitcnt lgkmcnt(0)
  v_smfmac_f32_16x16x64_bf16 v[88:91], v[84:87], a[112:119], v16
  v_smfmac_f32_16x16x64_bf16 v[92:95], v[84:87], a[120:127], v16
  v_smfmac_f32_16x16x64_bf16 v[96:99], v[56:59], a[128:135], v16
  v_smfmac_f32_16x16x64_bf16 v[100:103], v[56:59], a[136:143], v16
  v_smfmac_f32_16x16x64_bf16 v[96:99], v[60:63], a[144:151], v16
  v_smfmac_f32_16x16x64_bf16 v[100:103], v[60:63], a[152:159], v16
  v_add_f32 v88, v88, v90
  v_add_f32 v89, v89, v91
  v_smfmac_f32_16x16x64_bf16 v[96:99], v[64:67], a[160:167], v16
  v_smfmac_f32_16x16x64_bf16 v[100:103], v[64:67], a[168:175], v16
  v_add_f32 v92, v92, v94
  v_add_f32 v93, v93, v95
  v_smfmac_f32_16x16x64_bf16 v[96:99], v[68:71], a[176:183], v16
  v_smfmac_f32_16x16x64_bf16 v[100:103], v[68:71], a[184:191], v16
  v_cvt_pk_bf16_f32 v88, v88, v89
  v_cvt_pk_bf16_f32 v92, v92, v93
  v_smfmac_f32_16x16x64_bf16 v[96:99], v[72:75], a[192:199], v16
  v_smfmac_f32_16x16x64_bf16 v[100:103], v[72:75], a[200:207], v16
  ds_write_b32 v14, v88
  ds_write_b32 v14, v92 offset:512
  v_smfmac_f32_16x16x64_bf16 v[96:99], v[76:79], a[208:215], v16
  v_smfmac_f32_16x16x64_bf16 v[100:103], v[76:79], a[216:223], v16
  v_smfmac_f32_16x16x64_bf16 v[96:99], v[80:83], a[224:231], v16
  v_smfmac_f32_16x16x64_bf16 v[100:103], v[80:83], a[232:239], v16
  v_smfmac_f32_16x16x64_bf16 v[96:99], v[84:87], a[240:247], v16
  v_smfmac_f32_16x16x64_bf16 v[100:103], v[84:87], a[248:255], v16
  s_waitcnt lgkmcnt(0)
  s_barrier
  ds_read_b64_tr_b16 v[104:105], v15 offset:0
  ds_read_b64_tr_b16 v[106:107], v15 offset:512
  ds_read_b128 v[56:59], v13 offset:8192
  ds_read_b128 v[60:63], v13 offset:9216
  ds_read_b64_tr_b16 v[108:109], v15 offset:1024
  ds_read_b64_tr_b16 v[110:111], v15 offset:1536
  ds_read_b128 v[64:67], v13 offset:10240
  ds_read_b128 v[68:71], v13 offset:11264
  ds_read_b64_tr_b16 v[112:113], v15 offset:2048
  ds_read_b64_tr_b16 v[114:115], v15 offset:2560
  ds_read_b128 v[72:75], v13 offset:12288
  ds_read_b128 v[76:79], v13 offset:13312
  ds_read_b64_tr_b16 v[116:117], v15 offset:3072
  ds_read_b64_tr_b16 v[118:119], v15 offset:3584
  ds_read_b128 v[80:83], v13 offset:14336
  ds_read_b128 v[84:87], v13 offset:15360
  v_add_f32 v96, v96, v98
  v_add_f32 v97, v97, v99
  v_add_f32 v100, v100, v102
  v_add_f32 v101, v101, v103
  v_cvt_pk_bf16_f32 v96, v96, v97
  v_cvt_pk_bf16_f32 v97, v100, v101
  v_mov_b64 v[98:99], 0
  s_waitcnt lgkmcnt(12)
  v_mfma_f32_16x16x32_bf16 v[48:51], v[104:107], v[56:59], 0
  v_mfma_f32_16x16x32_bf16 v[52:55], v[104:107], v[60:63], 0
  s_waitcnt lgkmcnt(8)
  v_mfma_f32_16x16x32_bf16 v[48:51], v[108:111], v[64:67], v[48:51]
  v_mfma_f32_16x16x32_bf16 v[52:55], v[108:111], v[68:71], v[52:55]
  s_waitcnt lgkmcnt(4)
  v_mfma_f32_16x16x32_bf16 v[48:51], v[112:115], v[72:75], v[48:51]
  v_mfma_f32_16x16x32_bf16 v[52:55], v[112:115], v[76:79], v[52:55]
  s_waitcnt lgkmcnt(0)
  v_mfma_f32_16x16x32_bf16 v[48:51], v[116:119], v[80:83], v[48:51]
  v_mfma_f32_16x16x32_bf16 v[52:55], v[116:119], v[84:87], v[52:55]
  v_max3_f32 v0, v36, v37, v38
  v_max3_f32 v24, v40, v41, v42
  v_max3_f32 v25, v43, v44, v45
  v_max3_f32 v24, v24, v46, v47
  v_max_f32 v0, v0, v39
  v_max_f32 v24, v24, v25
  v_mov_b64 v[58:59], 0
  v_mov_b64 v[64:65], 0
  v_mov_b64 v[66:67], 0
  v_mov_b64 v[68:69], 0
  v_mov_b64 v[70:71], 0
  v_mov_b64 v[72:73], 0
  v_mov_b64 v[74:75], 0
  v_mov_b64 v[76:77], 0
  v_mov_b64 v[78:79], 0
  v_mov_b32 v80, 0x3f803f80
  v_mov_b32 v81, 0x3f803f80
  v_mov_b64 v[82:83], v[80:81]
  v_max3_f32 v0, v0, v48, v49
  v_max3_f32 v24, v24, v52, v53
  v_mov_b32 v25, v0
  v_mov_b32 v26, v24
  s_nop 0
  v_permlane16_swap_b32 v0, v25
  v_permlane16_swap_b32 v24, v26
  v_max_f32 v0, v0, v25
  v_max_f32 v24, v24, v26
  v_mov_b32 v25, v0
  v_mov_b32 v26, v24
  s_nop 0
  v_permlane32_swap_b32 v0, v25
  v_permlane32_swap_b32 v24, v26
  v_max_f32 v0, v0, v25
  v_max_f32 v24, v24, v26
  v_mul_f32 v0, s44, v0
  v_mul_f32 v24, s44, v24
  v_fma_f32 v36, v36, s44, -v0
  v_fma_f32 v37, v37, s44, -v0
  v_fma_f32 v38, v38, s44, -v0
  v_fma_f32 v39, v39, s44, -v0
  v_fma_f32 v48, v48, s44, -v0
  v_fma_f32 v49, v49, s44, -v0
  v_fma_f32 v40, v40, s44, -v24
  v_fma_f32 v41, v41, s44, -v24
  v_fma_f32 v42, v42, s44, -v24
  v_fma_f32 v43, v43, s44, -v24
  v_fma_f32 v44, v44, s44, -v24
  v_fma_f32 v45, v45, s44, -v24
  v_fma_f32 v46, v46, s44, -v24
  v_fma_f32 v47, v47, s44, -v24
  v_fma_f32 v52, v52, s44, -v24
  v_fma_f32 v53, v53, s44, -v24
  v_exp_f32 v36, v36
  v_exp_f32 v37, v37
  v_exp_f32 v38, v38
  v_exp_f32 v39, v39
  v_exp_f32 v48, v48
  v_exp_f32 v49, v49
  v_exp_f32 v40, v40
  v_exp_f32 v41, v41
  v_exp_f32 v42, v42
  v_exp_f32 v43, v43
  v_exp_f32 v44, v44
  v_exp_f32 v45, v45
  v_exp_f32 v46, v46
  v_exp_f32 v47, v47
  v_exp_f32 v52, v52
  v_exp_f32 v53, v53
  v_cvt_pk_bf16_f32 v56, v36, v37
  v_cvt_pk_bf16_f32 v57, v38, v39
  v_cvt_pk_bf16_f32 v64, v48, v49
  v_cvt_pk_bf16_f32 v69, v48, v49
  v_cvt_pk_bf16_f32 v60, v40, v41
  v_cvt_pk_bf16_f32 v61, v42, v43
  v_cvt_pk_bf16_f32 v62, v44, v45
  v_cvt_pk_bf16_f32 v63, v46, v47
  v_cvt_pk_bf16_f32 v72, v52, v53
  v_cvt_pk_bf16_f32 v77, v52, v53
  v_mfma_f32_16x16x32_bf16 v[84:87], v[80:83], v[56:59], 0
  v_mfma_f32_16x16x32_bf16 v[88:91], v[80:83], v[60:63], 0
  v_mfma_f32_16x16x32_bf16 v[84:87], v[80:83], v[64:67], v[84:87]
  v_mfma_f32_16x16x32_bf16 v[88:91], v[80:83], v[72:75], v[88:91]
  v_mfma_f32_16x16x32_bf16 v[104:107], v[28:31], v[56:59], 0
  v_mfma_f32_16x16x32_bf16 v[108:111], v[32:35], v[56:59], 0
  v_mfma_f32_16x16x32_bf16 v[104:107], v[96:99], v[64:67], v[104:107]
  v_mfma_f32_16x16x32_bf16 v[108:111], v[96:99], v[68:71], v[108:111]
  v_rcp_f32 v0, v84
  v_rcp_f32 v24, v88
  v_mfma_f32_16x16x32_bf16 v[112:115], v[28:31], v[60:63], 0
  v_mfma_f32_16x16x32_bf16 v[116:119], v[32:35], v[60:63], 0
  v_mfma_f32_16x16x32_bf16 v[112:115], v[96:99], v[72:75], v[112:115]
  v_mfma_f32_16x16x32_bf16 v[116:119], v[96:99], v[76:79], v[116:119]
  v_mul_f32 v104, v104, v0
  v_mul_f32 v105, v105, v0
  v_mul_f32 v106, v106, v0
  v_mul_f32 v107, v107, v0
  v_cvt_pk_bf16_f32 v104, v104, v105
  v_cvt_pk_bf16_f32 v105, v106, v107
  ds_write_b32 v17, v104 offset:0
  ds_write_b32 v17, v105 offset:8
  v_mul_f32 v108, v108, v0
  v_mul_f32 v109, v109, v0
  v_mul_f32 v110, v110, v0
  v_mul_f32 v111, v111, v0
  v_cvt_pk_bf16_f32 v108, v108, v109
  v_cvt_pk_bf16_f32 v109, v110, v111
  ds_write_b32 v17, v108 offset:256
  ds_write_b32 v17, v109 offset:264
  v_mul_f32 v112, v112, v24
  v_mul_f32 v113, v113, v24
  v_mul_f32 v114, v114, v24
  v_mul_f32 v115, v115, v24
  v_cvt_pk_bf16_f32 v112, v112, v113
  v_cvt_pk_bf16_f32 v113, v114, v115
  ds_write_b32 v17, v112 offset:4096
  ds_write_b32 v17, v113 offset:4104
  v_mul_f32 v116, v116, v24
  v_mul_f32 v117, v117, v24
  v_mul_f32 v118, v118, v24
  v_mul_f32 v119, v119, v24
  v_cvt_pk_bf16_f32 v116, v116, v117
  v_cvt_pk_bf16_f32 v117, v118, v119
  ds_write_b32 v17, v116 offset:4352
  ds_write_b32 v17, v117 offset:4360
  s_waitcnt lgkmcnt(0)
  s_barrier
  ds_read_b128 v[56:59], v13 offset:16384
  ds_read_b128 v[60:63], v13 offset:17408
  ds_read_b128 v[64:67], v13 offset:18432
  ds_read_b128 v[68:71], v13 offset:19456
  ds_read_b128 v[72:75], v13 offset:20480
  ds_read_b128 v[76:79], v13 offset:21504
  ds_read_b128 v[80:83], v13 offset:22528
  ds_read_b128 v[84:87], v13 offset:23552
  s_waitcnt lgkmcnt(0)
  s_cmp_ge_u32 s48, 64
  s_cbranch_scc1 AF_NOKV
  s_bitcmp1_b64 s[50:51], s48
  s_cbranch_scc1 AF_HNOK
  s_mov_b32 s33, 81920
AF_HN:
  buffer_load_dword v24, v13, s[8:11], s33 offen sc1
  s_waitcnt vmcnt(0)
  v_cmp_ne_u32 s[50:51], 0, v24
  s_nop 3
  s_bitcmp1_b64 s[50:51], s48
  s_cbranch_scc1 AF_HNOK
  s_sleep 2
  s_sub_u32 s6, s6, 1
  s_cbranch_scc1 GIVEUP
  s_branch AF_HN
AF_HNOK:
  s_lshl_b32 s33, s48, 15
  s_add_u32 s33, s33, 2097152
  s_lshl_b32 s34, s3, 8
  s_add_u32 s34, s34, s33
  s_lshl_b32 s35, s3, 13
  s_barrier
  v_mfma_f32_16x16x32_bf16 v[88:91], v[56:59], v[128:131], 0
  s_add_u32 s39, s34, 0
  s_add_u32 m0, s35, 0
  v_mfma_f32_16x16x32_bf16 v[92:95], v[56:59], v[144:147], 0
  buffer_load_dwordx4 v19, s[8:11], s39 offen sc1 lds
  v_mfma_f32_16x16x32_bf16 v[96:99], v[56:59], v[160:163], 0
  s_add_u32 s39, s34, 16384
  s_add_u32 m0, s35, 2048
  v_mfma_f32_16x16x32_bf16 v[100:103], v[56:59], v[176:179], 0
  buffer_load_dwordx4 v19, s[8:11], s39 offen sc1 lds
  v_mfma_f32_16x16x32_bf16 v[104:107], v[56:59], v[192:195], 0
  s_add_u32 s39, s34, 128
  s_add_u32 m0, s35, 4096
  v_mfma_f32_16x16x32_bf16 v[108:111], v[56:59], v[208:211], 0
  buffer_load_dwordx4 v19, s[8:11], s39 offen sc1 lds
  v_mfma_f32_16x16x32_bf16 v[112:115], v[56:59], v[224:227], 0
  s_add_u32 s39, s34, 16512
  s_add_u32 m0, s35, 6144
  v_mfma_f32_16x16x32_bf16 v[116:119], v[56:59], v[240:243], 0
  buffer_load_dwordx4 v19, s[8:11], s39 offen sc1 lds
  v_xor_b32 v19, 64, v19
  v_mfma_f32_16x16x32_bf16 v[88:91], v[60:63], v[132:135], v[88:91]
  s_add_u32 s39, s34, 8192
  s_add_u32 m0, s35, 1024
  v_mfma_f32_16x16x32_bf16 v[92:95], v[60:63], v[148:151], v[92:95]
  buffer_load_dwordx4 v19, s[8:11], s39 offen sc1 lds
  v_mfma_f32_16x16x32_bf16 v[96:99], v[60:63], v[164:167], v[96:99]
  s_add_u32 s39, s34, 24576
  s_add_u32 m0, s35, 3072
  v_mfma_f32_16x16x32_bf16 v[100:103], v[60:63], v[180:183], v[100:103]
  buffer_load_dwordx4 v19, s[8:11], s39 offen sc1 lds
  v_mfma_f32_16x16x32_bf16 v[104:107], v[60:63], v[196:199], v[104:107]
  s_add_u32 s39, s34, 8320
  s_add_u32 m0, s35, 5120
  v_mfma_f32_16x16x32_bf16 v[108:111], v[60:63], v[212:215], v[108:111]
  buffer_load_dwordx4 v19, s[8:11], s39 offen sc1 lds
  v_mfma_f32_16x16x32_bf16 v[112:115], v[60:63], v[228:231], v[112:115]
  s_add_u32 s39, s34, 24704
  s_add_u32 m0, s35, 7168
  v_mfma_f32_16x16x32_bf16 v[116:119], v[60:63], v[244:247], v[116:119]
  buffer_load_dwordx4 v19, s[8:11], s39 offen sc1 lds
  v_xor_b32 v19, 64, v19
  v_mfma_f32_16x16x32_bf16 v[88:91], v[64:67], v[136:139], v[88:91]
  v_mfma_f32_16x16x32_bf16 v[92:95], v[64:67], v[152:155], v[92:95]
  v_mfma_f32_16x16x32_bf16 v[96:99], v[64:67], v[168:171], v[96:99]
  v_mfma_f32_16x16x32_bf16 v[100:103], v[64:67], v[184:187], v[100:103]
  v_mfma_f32_16x16x32_bf16 v[104:107], v[64:67], v[200:203], v[104:107]
  v_mfma_f32_16x16x32_bf16 v[108:111], v[64:67], v[216:219], v[108:111]
  v_mfma_f32_16x16x32_bf16 v[112:115], v[64:67], v[232:235], v[112:115]
  v_mfma_f32_16x16x32_bf16 v[116:119], v[64:67], v[248:251], v[116:119]
  v_mfma_f32_16x16x32_bf16 v[88:91], v[68:71], v[140:143], v[88:91]
  v_mfma_f32_16x16x32_bf16 v[92:95], v[68:71], v[156:159], v[92:95]
  v_mfma_f32_16x16x32_bf16 v[96:99], v[68:71], v[172:175], v[96:99]
  v_mfma_f32_16x16x32_bf16 v[100:103], v[68:71], v[188:191], v[100:103]
  v_mfma_f32_16x16x32_bf16 v[104:107], v[68:71], v[204:207], v[104:107]
  v_mfma_f32_16x16x32_bf16 v[108:111], v[68:71], v[220:223], v[108:111]
  v_mfma_f32_16x16x32_bf16 v[112:115], v[68:71], v[236:239], v[112:115]
  v_mfma_f32_16x16x32_bf16 v[116:119], v[68:71], v[252:255], v[116:119]
  v_mfma_f32_16x16x32_bf16 v[28:31], v[72:75], v[128:131], 0
  v_mfma_f32_16x16x32_bf16 v[32:35], v[72:75], v[144:147], 0
  v_mfma_f32_16x16x32_bf16 v[36:39], v[72:75], v[160:163], 0
  v_cvt_pk_bf16_f32 v60, v88, v92
  v_mfma_f32_16x16x32_bf16 v[40:43], v[72:75], v[176:179], 0
  v_cvt_pk_bf16_f32 v61, v96, v100
  v_mfma_f32_16x16x32_bf16 v[44:47], v[72:75], v[192:195], 0
  v_cvt_pk_bf16_f32 v62, v104, v108
  v_mfma_f32_16x16x32_bf16 v[48:51], v[72:75], v[208:211], 0
  v_cvt_pk_bf16_f32 v63, v112, v116
  v_mfma_f32_16x16x32_bf16 v[52:55], v[72:75], v[224:227], 0
  s_add_u32 s36, s45, 0
  buffer_store_dwordx4 v[60:63], v18, s[8:11], s36 offen
  v_mfma_f32_16x16x32_bf16 v[56:59], v[72:75], v[240:243], 0
  v_cvt_pk_bf16_f32 v64, v89, v93
  v_mfma_f32_16x16x32_bf16 v[28:31], v[76:79], v[132:135], v[28:31]
  v_cvt_pk_bf16_f32 v65, v97, v101
  v_mfma_f32_16x16x32_bf16 v[32:35], v[76:79], v[148:151], v[32:35]
  v_cvt_pk_bf16_f32 v66, v105, v109
  v_mfma_f32_16x16x32_bf16 v[36:39], v[76:79], v[164:167], v[36:39]
  v_cvt_pk_bf16_f32 v67, v113, v117
  v_mfma_f32_16x16x32_bf16 v[40:43], v[76:79], v[180:183], v[40:43]
  s_add_u32 s36, s45, 32768
  buffer_store_dwordx4 v[64:67], v18, s[8:11], s36 offen
  v_mfma_f32_16x16x32_bf16 v[44:47], v[76:79], v[196:199], v[44:47]
  v_cvt_pk_bf16_f32 v60, v90, v94
  v_mfma_f32_16x16x32_bf16 v[48:51], v[76:79], v[212:215], v[48:51]
  v_cvt_pk_bf16_f32 v61, v98, v102
  v_mfma_f32_16x16x32_bf16 v[52:55], v[76:79], v[228:231], v[52:55]
  v_cvt_pk_bf16_f32 v62, v106, v110
  v_mfma_f32_16x16x32_bf16 v[56:59], v[76:79], v[244:247], v[56:59]
  v_cvt_pk_bf16_f32 v63, v114, v118
  v_mfma_f32_16x16x32_bf16 v[28:31], v[80:83], v[136:139], v[28:31]
  s_add_u32 s36, s45, 65536
  buffer_store_dwordx4 v[60:63], v18, s[8:11], s36 offen
  v_mfma_f32_16x16x32_bf16 v[32:35], v[80:83], v[152:155], v[32:35]
  v_cvt_pk_bf16_f32 v64, v91, v95
  v_mfma_f32_16x16x32_bf16 v[36:39], v[80:83], v[168:171], v[36:39]
  v_cvt_pk_bf16_f32 v65, v99, v103
  v_mfma_f32_16x16x32_bf16 v[40:43], v[80:83], v[184:187], v[40:43]
  v_cvt_pk_bf16_f32 v66, v107, v111
  v_mfma_f32_16x16x32_bf16 v[44:47], v[80:83], v[200:203], v[44:47]
  v_cvt_pk_bf16_f32 v67, v115, v119
  v_mfma_f32_16x16x32_bf16 v[48:51], v[80:83], v[216:219], v[48:51]
  s_add_u32 s36, s45, 98304
  buffer_store_dwordx4 v[64:67], v18, s[8:11], s36 offen
  v_mfma_f32_16x16x32_bf16 v[52:55], v[80:83], v[232:235], v[52:55]
  v_mfma_f32_16x16x32_bf16 v[56:59], v[80:83], v[248:251], v[56:59]
  v_mfma_f32_16x16x32_bf16 v[28:31], v[84:87], v[140:143], v[28:31]
  v_mfma_f32_16x16x32_bf16 v[32:35], v[84:87], v[156:159], v[32:35]
  v_mfma_f32_16x16x32_bf16 v[36:39], v[84:87], v[172:175], v[36:39]
  v_mfma_f32_16x16x32_bf16 v[40:43], v[84:87], v[188:191], v[40:43]
  v_mfma_f32_16x16x32_bf16 v[44:47], v[84:87], v[204:207], v[44:47]
  v_mfma_f32_16x16x32_bf16 v[48:51], v[84:87], v[220:223], v[48:51]
  v_mfma_f32_16x16x32_bf16 v[52:55], v[84:87], v[236:239], v[52:55]
  v_mfma_f32_16x16x32_bf16 v[56:59], v[84:87], v[252:255], v[56:59]
  v_cvt_pk_bf16_f32 v60, v28, v32
  v_cvt_pk_bf16_f32 v61, v36, v40
  v_cvt_pk_bf16_f32 v62, v44, v48
  s_nop 3
  v_cvt_pk_bf16_f32 v63, v52, v56
  s_add_u32 s36, s45, 524288
  buffer_store_dwordx4 v[60:63], v18, s[8:11], s36 offen
  v_cvt_pk_bf16_f32 v64, v29, v33
  v_cvt_pk_bf16_f32 v65, v37, v41
  v_cvt_pk_bf16_f32 v66, v45, v49
  v_cvt_pk_bf16_f32 v67, v53, v57
  s_add_u32 s36, s45, 557056
  buffer_store_dwordx4 v[64:67], v18, s[8:11], s36 offen
  v_cvt_pk_bf16_f32 v60, v30, v34
  v_cvt_pk_bf16_f32 v61, v38, v42
  v_cvt_pk_bf16_f32 v62, v46, v50
  v_cvt_pk_bf16_f32 v63, v54, v58
  s_add_u32 s36, s45, 589824
  buffer_store_dwordx4 v[60:63], v18, s[8:11], s36 offen
  v_cvt_pk_bf16_f32 v64, v31, v35
  v_cvt_pk_bf16_f32 v65, v39, v43
  v_cvt_pk_bf16_f32 v66, v47, v51
  v_cvt_pk_bf16_f32 v67, v55, v59
  s_add_u32 s36, s45, 622592
  buffer_store_dwordx4 v[64:67], v18, s[8:11], s36 offen
  s_add_u32 s43, s43, 1
  s_lshl_b32 s33, s5, 2
  s_add_u32 s33, s33, s47
  v_mov_b32 v0, s43
  s_waitcnt vmcnt(0)
  s_mov_b64 exec, 1
  buffer_store_dword v0, off, s[8:11], s33
  s_mov_b64 exec, -1
  s_xor_b32 s45, s45, 0x100000
  s_barrier
  ds_read_b128 v[60:63], v6 offset:0
  ds_read_b128 v[64:67], v6 offset:2048
  v_xor_b32 v6, 64, v6
  ds_read_b128 v[68:71], v6 offset:0
  ds_read_b128 v[72:75], v6 offset:2048
  v_xor_b32 v6, 64, v6
  ds_read_b128 v[76:79], v6 offset:4096
  ds_read_b128 v[80:83], v6 offset:6144
  v_xor_b32 v6, 64, v6
  s_waitcnt lgkmcnt(4)
  v_mfma_f32_16x16x32_bf16 v[28:31], a[0:3], v[60:63], 0
  ds_read_b128 v[84:87], v6 offset:4096
  v_mfma_f32_16x16x32_bf16 v[32:35], a[0:3], v[64:67], 0
  ds_read_b128 v[88:91], v6 offset:6144
  v_mfma_f32_16x16x32_bf16 v[36:39], a[8:11], v[60:63], 0
  v_xor_b32 v6, 64, v6
  v_mfma_f32_16x16x32_bf16 v[40:43], a[8:11], v[64:67], 0
  v_mfma_f32_16x16x32_bf16 v[44:47], v[60:63], a[128:131], 0
  v_mfma_f32_16x16x32_bf16 v[48:51], v[64:67], a[128:131], 0
  v_mfma_f32_16x16x32_bf16 v[52:55], v[60:63], a[136:139], 0
  v_mfma_f32_16x16x32_bf16 v[56:59], v[64:67], a[136:139], 0
  s_waitcnt lgkmcnt(4)
  v_mfma_f32_16x16x32_bf16 v[28:31], a[4:7], v[68:71], v[28:31]
  ds_read_b128 v[60:63], v7 offset:0
  v_mfma_f32_16x16x32_bf16 v[32:35], a[4:7], v[72:75], v[32:35]
  ds_read_b128 v[64:67], v7 offset:2048
  v_mfma_f32_16x16x32_bf16 v[36:39], a[12:15], v[68:71], v[36:39]
  v_xor_b32 v7, 64, v7
  v_mfma_f32_16x16x32_bf16 v[40:43], a[12:15], v[72:75], v[40:43]
  v_mfma_f32_16x16x32_bf16 v[44:47], v[68:71], a[132:135], v[44:47]
  v_mfma_f32_16x16x32_bf16 v[48:51], v[72:75], a[132:135], v[48:51]
  v_mfma_f32_16x16x32_bf16 v[52:55], v[68:71], a[140:143], v[52:55]
  v_mfma_f32_16x16x32_bf16 v[56:59], v[72:75], a[140:143], v[56:59]
  s_waitcnt lgkmcnt(4)
  v_mfma_f32_16x16x32_bf16 v[28:31], a[16:19], v[76:79], v[28:31]
  ds_read_b128 v[68:71], v7 offset:0
  v_mfma_f32_16x16x32_bf16 v[32:35], a[16:19], v[80:83], v[32:35]
  ds_read_b128 v[72:75], v7 offset:2048
  v_mfma_f32_16x16x32_bf16 v[36:39], a[24:27], v[76:79], v[36:39]
  v_xor_b32 v7, 64, v7
  v_mfma_f32_16x16x32_bf16 v[40:43], a[24:27], v[80:83], v[40:43]
  v_mfma_f32_16x16x32_bf16 v[44:47], v[76:79], a[144:147], v[44:47]
  v_mfma_f32_16x16x32_bf16 v[48:51], v[80:83], a[144:147], v[48:51]
  v_mfma_f32_16x16x32_bf16 v[52:55], v[76:79], a[152:155], v[52:55]
  v_mfma_f32_16x16x32_bf16 v[56:59], v[80:83], a[152:155], v[56:59]
  s_waitcnt lgkmcnt(4)
  v_mfma_f32_16x16x32_bf16 v[28:31], a[20:23], v[84:87], v[28:31]
  ds_read_b128 v[76:79], v7 offset:4096
  v_mfma_f32_16x16x32_bf16 v[32:35], a[20:23], v[88:91], v[32:35]
  ds_read_b128 v[80:83], v7 offset:6144
  v_mfma_f32_16x16x32_bf16 v[36:39], a[28:31], v[84:87], v[36:39]
  v_xor_b32 v7, 64, v7
  v_mfma_f32_16x16x32_bf16 v[40:43], a[28:31], v[88:91], v[40:43]
  v_mfma_f32_16x16x32_bf16 v[44:47], v[84:87], a[148:151], v[44:47]
  v_mfma_f32_16x16x32_bf16 v[48:51], v[88:91], a[148:151], v[48:51]
  v_mfma_f32_16x16x32_bf16 v[52:55], v[84:87], a[156:159], v[52:55]
  v_mfma_f32_16x16x32_bf16 v[56:59], v[88:91], a[156:159], v[56:59]
  s_waitcnt lgkmcnt(4)
  v_mfma_f32_16x16x32_bf16 v[28:31], a[32:35], v[60:63], v[28:31]
  ds_read_b128 v[84:87], v7 offset:4096
  v_mfma_f32_16x16x32_bf16 v[32:35], a[32:35], v[64:67], v[32:35]
  ds_read_b128 v[88:91], v7 offset:6144
  v_mfma_f32_16x16x32_bf16 v[36:39], a[40:43], v[60:63], v[36:39]
  v_xor_b32 v7, 64, v7
  v_mfma_f32_16x16x32_bf16 v[40:43], a[40:43], v[64:67], v[40:43]
  v_mfma_f32_16x16x32_bf16 v[44:47], v[60:63], a[160:163], v[44:47]
  v_mfma_f32_16x16x32_bf16 v[48:51], v[64:67], a[160:163], v[48:51]
  v_mfma_f32_16x16x32_bf16 v[52:55], v[60:63], a[168:171], v[52:55]
  v_mfma_f32_16x16x32_bf16 v[56:59], v[64:67], a[168:171], v[56:59]
  s_waitcnt lgkmcnt(4)
  v_mfma_f32_16x16x32_bf16 v[28:31], a[36:39], v[68:71], v[28:31]
  ds_read_b128 v[60:63], v8 offset:0
  v_mfma_f32_16x16x32_bf16 v[32:35], a[36:39], v[72:75], v[32:35]
  ds_read_b128 v[64:67], v8 offset:2048
  v_mfma_f32_16x16x32_bf16 v[36:39], a[44:47], v[68:71], v[36:39]
  v_xor_b32 v8, 64, v8
  v_mfma_f32_16x16x32_bf16 v[40:43], a[44:47], v[72:75], v[40:43]
  v_mfma_f32_16x16x32_bf16 v[44:47], v[68:71], a[164:167], v[44:47]
  v_mfma_f32_16x16x32_bf16 v[48:51], v[72:75], a[164:167], v[48:51]
  v_mfma_f32_16x16x32_bf16 v[52:55], v[68:71], a[172:175], v[52:55]
  v_mfma_f32_16x16x32_bf16 v[56:59], v[72:75], a[172:175], v[56:59]
  s_waitcnt lgkmcnt(4)
  v_mfma_f32_16x16x32_bf16 v[28:31], a[48:51], v[76:79], v[28:31]
  ds_read_b128 v[68:71], v8 offset:0
  v_mfma_f32_16x16x32_bf16 v[32:35], a[48:51], v[80:83], v[32:35]
  ds_read_b128 v[72:75], v8 offset:2048
  v_mfma_f32_16x16x32_bf16 v[36:39], a[56:59], v[76:79], v[36:39]
  v_xor_b32 v8, 64, v8
  v_mfma_f32_16x16x32_bf16 v[40:43], a[56:59], v[80:83], v[40:43]
  v_mfma_f32_16x16x32_bf16 v[44:47], v[76:79], a[176:179], v[44:47]
  v_mfma_f32_16x16x32_bf16 v[48:51], v[80:83], a[176:179], v[48:51]
  v_mfma_f32_16x16x32_bf16 v[52:55], v[76:79], a[184:187], v[52:55]
  v_mfma_f32_16x16x32_bf16 v[56:59], v[80:83], a[184:187], v[56:59]
  s_waitcnt lgkmcnt(4)
  v_mfma_f32_16x16x32_bf16 v[28:31], a[52:55], v[84:87], v[28:31]
  ds_read_b128 v[76:79], v8 offset:4096
  v_mfma_f32_16x16x32_bf16 v[32:35], a[52:55], v[88:91], v[32:35]
  ds_read_b128 v[80:83], v8 offset:6144
  v_mfma_f32_16x16x32_bf16 v[36:39], a[60:63], v[84:87], v[36:39]
  v_xor_b32 v8, 64, v8
  v_mfma_f32_16x16x32_bf16 v[40:43], a[60:63], v[88:91], v[40:43]
  v_mfma_f32_16x16x32_bf16 v[44:47], v[84:87], a[180:183], v[44:47]
  v_mfma_f32_16x16x32_bf16 v[48:51], v[88:91], a[180:183], v[48:51]
  v_mfma_f32_16x16x32_bf16 v[52:55], v[84:87], a[188:191], v[52:55]
  v_mfma_f32_16x16x32_bf16 v[56:59], v[88:91], a[188:191], v[56:59]
  s_waitcnt lgkmcnt(4)
  v_mfma_f32_16x16x32_bf16 v[28:31], a[64:67], v[60:63], v[28:31]
  ds_read_b128 v[84:87], v8 offset:4096
  v_mfma_f32_16x16x32_bf16 v[32:35], a[64:67], v[64:67], v[32:35]
  ds_read_b128 v[88:91], v8 offset:6144
  v_mfma_f32_16x16x32_bf16 v[36:39], a[72:75], v[60:63], v[36:39]
  v_xor_b32 v8, 64, v8
  v_mfma_f32_16x16x32_bf16 v[40:43], a[72:75], v[64:67], v[40:43]
  v_mfma_f32_16x16x32_bf16 v[44:47], v[60:63], a[192:195], v[44:47]
  v_mfma_f32_16x16x32_bf16 v[48:51], v[64:67], a[192:195], v[48:51]
  v_mfma_f32_16x16x32_bf16 v[52:55], v[60:63], a[200:203], v[52:55]
  v_mfma_f32_16x16x32_bf16 v[56:59], v[64:67], a[200:203], v[56:59]
  s_waitcnt lgkmcnt(4)
  v_mfma_f32_16x16x32_bf16 v[28:31], a[68:71], v[68:71], v[28:31]
  ds_read_b128 v[60:63], v9 offset:0
  v_mfma_f32_16x16x32_bf16 v[32:35], a[68:71], v[72:75], v[32:35]
  ds_read_b128 v[64:67], v9 offset:2048
  v_mfma_f32_16x16x32_bf16 v[36:39], a[76:79], v[68:71], v[36:39]
  v_xor_b32 v9, 64, v9
  v_mfma_f32_16x16x32_bf16 v[40:43], a[76:79], v[72:75], v[40:43]
  buffer_load_dword v108, v23, s[8:11], s47 offen sc1
  v_mfma_f32_16x16x32_bf16 v[44:47], v[68:71], a[196:199], v[44:47]
  v_mfma_f32_16x16x32_bf16 v[48:51], v[72:75], a[196:199], v[48:51]
  v_mfma_f32_16x16x32_bf16 v[52:55], v[68:71], a[204:207], v[52:55]
  v_mfma_f32_16x16x32_bf16 v[56:59], v[72:75], a[204:207], v[56:59]
  s_waitcnt lgkmcnt(4)
  v_mfma_f32_16x16x32_bf16 v[28:31], a[80:83], v[76:79], v[28:31]
  ds_read_b128 v[68:71], v9 offset:0
  v_mfma_f32_16x16x32_bf16 v[32:35], a[80:83], v[80:83], v[32:35]
  ds_read_b128 v[72:75], v9 offset:2048
  v_mfma_f32_16x16x32_bf16 v[36:39], a[88:91], v[76:79], v[36:39]
  v_xor_b32 v9, 64, v9
  v_mfma_f32_16x16x32_bf16 v[40:43], a[88:91], v[80:83], v[40:43]
  v_mfma_f32_16x16x32_bf16 v[44:47], v[76:79], a[208:211], v[44:47]
  v_mfma_f32_16x16x32_bf16 v[48:51], v[80:83], a[208:211], v[48:51]
  v_mfma_f32_16x16x32_bf16 v[52:55], v[76:79], a[216:219], v[52:55]
  v_mfma_f32_16x16x32_bf16 v[56:59], v[80:83], a[216:219], v[56:59]
  s_waitcnt lgkmcnt(4)
  v_mfma_f32_16x16x32_bf16 v[28:31], a[84:87], v[84:87], v[28:31]
  ds_read_b128 v[76:79], v9 offset:4096
  v_mfma_f32_16x16x32_bf16 v[32:35], a[84:87], v[88:91], v[32:35]
  ds_read_b128 v[80:83], v9 offset:6144
  v_mfma_f32_16x16x32_bf16 v[36:39], a[92:95], v[84:87], v[36:39]
  v_xor_b32 v9, 64, v9
  v_mfma_f32_16x16x32_bf16 v[40:43], a[92:95], v[88:91], v[40:43]
  v_mfma_f32_16x16x32_bf16 v[44:47], v[84:87], a[212:215], v[44:47]
  v_mfma_f32_16x16x32_bf16 v[48:51], v[88:91], a[212:215], v[48:51]
  v_mfma_f32_16x16x32_bf16 v[52:55], v[84:87], a[220:223], v[52:55]
  v_mfma_f32_16x16x32_bf16 v[56:59], v[88:91], a[220:223], v[56:59]
  s_waitcnt lgkmcnt(4)
  v_mfma_f32_16x16x32_bf16 v[28:31], a[96:99], v[60:63], v[28:31]
  ds_read_b128 v[84:87], v9 offset:4096
  v_mfma_f32_16x16x32_bf16 v[32:35], a[96:99], v[64:67], v[32:35]
  ds_read_b128 v[88:91], v9 offset:6144
  v_mfma_f32_16x16x32_bf16 v[36:39], a[104:107], v[60:63], v[36:39]
  v_xor_b32 v9, 64, v9
  v_mfma_f32_16x16x32_bf16 v[40:43], a[104:107], v[64:67], v[40:43]
  v_mfma_f32_16x16x32_bf16 v[44:47], v[60:63], a[224:227], v[44:47]
  v_mfma_f32_16x16x32_bf16 v[48:51], v[64:67], a[224:227], v[48:51]
  v_mfma_f32_16x16x32_bf16 v[52:55], v[60:63], a[232:235], v[52:55]
  v_mfma_f32_16x16x32_bf16 v[56:59], v[64:67], a[232:235], v[56:59]
  s_waitcnt lgkmcnt(4)
  v_mfma_f32_16x16x32_bf16 v[28:31], a[100:103], v[68:71], v[28:31]
  s_lshl_b32 s33, s48, 18
  v_mfma_f32_16x16x32_bf16 v[32:35], a[100:103], v[72:75], v[32:35]
  s_lshl_b32 s34, s5, 13
  v_mfma_f32_16x16x32_bf16 v[36:39], a[108:111], v[68:71], v[36:39]
  s_add_u32 s33, s33, s34
  v_mfma_f32_16x16x32_bf16 v[40:43], a[108:111], v[72:75], v[40:43]
  s_add_u32 s34, s33, 16777216
  v_mfma_f32_16x16x32_bf16 v[44:47], v[68:71], a[228:231], v[44:47]
  s_add_u32 s35, s33, 33554432
  v_mfma_f32_16x16x32_bf16 v[48:51], v[72:75], a[228:231], v[48:51]
  v_mfma_f32_16x16x32_bf16 v[52:55], v[68:71], a[236:239], v[52:55]
  v_mfma_f32_16x16x32_bf16 v[56:59], v[72:75], a[236:239], v[56:59]
  s_waitcnt lgkmcnt(2)
  v_mfma_f32_16x16x32_bf16 v[28:31], a[112:115], v[76:79], v[28:31]
  s_lshl_b32 s33, s5, 10
  v_mfma_f32_16x16x32_bf16 v[32:35], a[112:115], v[80:83], v[32:35]
  s_lshl_b32 s37, s48, 4
  v_mfma_f32_16x16x32_bf16 v[36:39], a[120:123], v[76:79], v[36:39]
  s_add_u32 s33, s33, s37
  v_mfma_f32_16x16x32_bf16 v[40:43], a[120:123], v[80:83], v[40:43]
  s_lshl_b32 s37, s3, 2
  v_mfma_f32_16x16x32_bf16 v[44:47], v[76:79], a[240:243], v[44:47]
  s_add_u32 s33, s33, s37
  v_mfma_f32_16x16x32_bf16 v[48:51], v[80:83], a[240:243], v[48:51]
  s_add_u32 s37, s33, 0
  v_mfma_f32_16x16x32_bf16 v[52:55], v[76:79], a[248:251], v[52:55]
  v_mfma_f32_16x16x32_bf16 v[56:59], v[80:83], a[248:251], v[56:59]
  s_waitcnt lgkmcnt(0)
  s_barrier
  v_mfma_f32_16x16x32_bf16 v[28:31], a[116:119], v[84:87], v[28:31]
  v_mfma_f32_16x16x32_bf16 v[32:35], a[116:119], v[88:91], v[32:35]
  v_mfma_f32_16x16x32_bf16 v[36:39], a[124:127], v[84:87], v[36:39]
  v_mfma_f32_16x16x32_bf16 v[40:43], a[124:127], v[88:91], v[40:43]
  v_mfma_f32_16x16x32_bf16 v[44:47], v[84:87], a[244:247], v[44:47]
  v_mfma_f32_16x16x32_bf16 v[48:51], v[88:91], a[244:247], v[48:51]
  v_mfma_f32_16x16x32_bf16 v[52:55], v[84:87], a[252:255], v[52:55]
  v_mfma_f32_16x16x32_bf16 v[56:59], v[88:91], a[252:255], v[56:59]
  s_waitcnt vmcnt(0)
  v_cmp_gt_u32 vcc, s43, v108
  s_cbranch_vccz AGPOK_33
AGP_32:
  buffer_load_dword v108, v23, s[8:11], s47 offen sc1
  s_waitcnt vmcnt(0)
  v_cmp_gt_u32 vcc, s43, v108
  s_cbranch_vccz AGPOK_33
  s_sleep 1
  s_sub_u32 s6, s6, 1
  s_cbranch_scc1 GIVEUP
  s_branch AGP_32
AGPOK_33:
  buffer_load_dwordx4 v[60:63], v20, s[8:11], s46 offen sc1
  s_add_u32 s36, s46, 4096
  buffer_load_dwordx4 v[64:67], v20, s[8:11], s36 offen sc1
  s_add_u32 s36, s46, 8192
  buffer_load_dwordx4 v[68:71], v20, s[8:11], s36 offen sc1
  s_add_u32 s36, s46, 12288
  buffer_load_dwordx4 v[72:75], v20, s[8:11], s36 offen sc1
  s_add_u32 s36, s46, 16384
  buffer_load_dwordx4 v[76:79], v20, s[8:11], s36 offen sc1
  s_add_u32 s36, s46, 20480
  buffer_load_dwordx4 v[80:83], v20, s[8:11], s36 offen sc1
  s_add_u32 s36, s46, 24576
  buffer_load_dwordx4 v[84:87], v20, s[8:11], s36 offen sc1
  s_add_u32 s36, s46, 28672
  buffer_load_dwordx4 v[88:91], v20, s[8:11], s36 offen sc1
  s_xor_b32 s46, s46, 0x100000
  v_cvt_pk_bf16_f32 v104, v28, v29
  v_cvt_pk_bf16_f32 v105, v30, v31
  v_cvt_pk_bf16_f32 v106, v36, v37
  v_cvt_pk_bf16_f32 v107, v38, v39
  buffer_store_dwordx4 v[104:107], v1, s[8:11], s34 offen offset:0 sc1
  v_cvt_pk_bf16_f32 v108, v32, v33
  v_cvt_pk_bf16_f32 v109, v34, v35
  v_cvt_pk_bf16_f32 v110, v40, v41
  v_cvt_pk_bf16_f32 v111, v42, v43
  buffer_store_dwordx4 v[108:111], v1, s[8:11], s34 offen offset:1024 sc1
  v_cvt_pk_bf16_f32 v112, v44, v45
  v_cvt_pk_bf16_f32 v113, v46, v47
  v_cvt_pk_bf16_f32 v114, v48, v49
  v_cvt_pk_bf16_f32 v115, v50, v51
  buffer_store_dwordx4 v[112:115], v1, s[8:11], s35 offen offset:0 sc1
  v_cvt_pk_bf16_f32 v116, v52, v53
  v_cvt_pk_bf16_f32 v117, v54, v55
  v_cvt_pk_bf16_f32 v118, v56, v57
  v_cvt_pk_bf16_f32 v119, v58, v59
  buffer_store_dwordx4 v[116:119], v1, s[8:11], s35 offen offset:1024 sc1
  v_cndmask_b32 v92, 0, v22, s[52:53]
  v_cndmask_b32 v93, 0, v22, s[54:55]
  v_cndmask_b32 v94, 0, v22, s[56:57]
  v_cndmask_b32 v95, 0, v22, s[58:59]
  s_waitcnt vmcnt(11)
  s_nop 0
  v_mfma_f32_16x16x32_bf16 v[96:99], v[92:95], v[60:63], 0
  s_waitcnt vmcnt(10)
  v_mfma_f32_16x16x32_bf16 v[96:99], v[92:95], v[64:67], v[96:99]
  s_waitcnt vmcnt(9)
  v_mfma_f32_16x16x32_bf16 v[96:99], v[92:95], v[68:71], v[96:99]
  s_waitcnt vmcnt(8)
  v_mfma_f32_16x16x32_bf16 v[96:99], v[92:95], v[72:75], v[96:99]
  s_waitcnt vmcnt(7)
  v_mfma_f32_16x16x32_bf16 v[96:99], v[92:95], v[76:79], v[96:99]
  s_waitcnt vmcnt(6)
  v_mfma_f32_16x16x32_bf16 v[96:99], v[92:95], v[80:83], v[96:99]
  s_waitcnt vmcnt(5)
  v_mfma_f32_16x16x32_bf16 v[96:99], v[92:95], v[84:87], v[96:99]
  s_waitcnt vmcnt(4)
  v_mfma_f32_16x16x32_bf16 v[96:99], v[92:95], v[88:91], v[96:99]
  v_and_b32 v121, 0xffff0000, v120
  v_lshlrev_b32 v120, 16, v120
  s_nop 4
  v_cvt_pk_bf16_f32 v0, v96, v97
  v_and_b32 v97, 0xffff0000, v0
  v_lshlrev_b32 v96, 16, v0
  v_mul_f32 v96, v96, v122
  v_mul_f32 v97, v97, v123
  v_cvt_pk_bf16_f32 v0, v96, v97
  v_and_b32 v97, 0xffff0000, v0
  v_lshlrev_b32 v96, 16, v0
  v_add_f32 v96, v96, v120
  v_add_f32 v97, v97, v121
  v_cvt_pk_bf16_f32 v100, v96, v97
  v_and_b32 v97, 0xffff0000, v100
  v_lshlrev_b32 v96, 16, v100
  v_min_u32 v100, -2, v100
  s_add_u32 s34, s41, 6291456
  buffer_store_dword v100, v21, s[8:11], s34 offen sc1
  v_add_f32 v102, v96, v97
  s_nop 1
  v_add_f32_dpp v102, v102, v102 row_ror:1 row_mask:0xf bank_mask:0xf
  s_nop 1
  v_add_f32_dpp v102, v102, v102 row_ror:2 row_mask:0xf bank_mask:0xf
  s_nop 1
  v_add_f32_dpp v102, v102, v102 row_ror:4 row_mask:0xf bank_mask:0xf
  s_nop 1
  v_add_f32_dpp v102, v102, v102 row_ror:8 row_mask:0xf bank_mask:0xf
  v_mov_b32 v0, v102
  s_nop 1
  v_permlane16_swap_b32 v102, v0
  v_add_f32 v102, v102, v0
  v_mov_b32 v0, v102
  s_nop 1
  v_permlane32_swap_b32 v102, v0
  v_add_f32 v102, v102, v0
  v_mul_f32 v102, 0x3c000000, v102
  v_sub_f32 v24, v96, v102
  v_sub_f32 v25, v97, v102
  v_mul_f32 v103, v24, v24
  v_fmac_f32 v103, v25, v25
  s_nop 1
  v_add_f32_dpp v103, v103, v103 row_ror:1 row_mask:0xf bank_mask:0xf
  s_nop 1
  v_add_f32_dpp v103, v103, v103 row_ror:2 row_mask:0xf bank_mask:0xf
  s_nop 1
  v_add_f32_dpp v103, v103, v103 row_ror:4 row_mask:0xf bank_mask:0xf
  s_nop 1
  v_add_f32_dpp v103, v103, v103 row_ror:8 row_mask:0xf bank_mask:0xf
  v_mov_b32 v0, v103
  s_nop 1
  v_permlane16_swap_b32 v103, v0
  v_add_f32 v103, v103, v0
  v_mov_b32 v0, v103
  s_nop 1
  v_permlane32_swap_b32 v103, v0
  v_add_f32 v103, v103, v0
  s_lshl_b32 s33, s3, 3
  s_add_u32 s33, s33, 28672
  v_mov_b32 v0, s33
  s_mov_b64 exec, 1
  ds_write_b64 v0, v[102:103]
  s_mov_b64 exec, -1
  v_mov_b32 v0, 2
  s_waitcnt vmcnt(1)
  s_mov_b64 exec, 1
  buffer_store_dword v0, off, s[8:11], s37 sc1
  s_mov_b64 exec, -1
  s_branch AF_NORM
AF_NOKV:
  v_mfma_f32_16x16x32_bf16 v[88:91], v[56:59], v[128:131], 0
  v_mfma_f32_16x16x32_bf16 v[92:95], v[56:59], v[144:147], 0
  v_mfma_f32_16x16x32_bf16 v[96:99], v[56:59], v[160:163], 0
  v_mfma_f32_16x16x32_bf16 v[100:103], v[56:59], v[176:179], 0
  v_mfma_f32_16x16x32_bf16 v[104:107], v[56:59], v[192:195], 0
  v_mfma_f32_16x16x32_bf16 v[108:111], v[56:59], v[208:211], 0
  v_mfma_f32_16x16x32_bf16 v[112:115], v[56:59], v[224:227], 0
  v_mfma_f32_16x16x32_bf16 v[116:119], v[56:59], v[240:243], 0
  v_mfma_f32_16x16x32_bf16 v[88:91], v[60:63], v[132:135], v[88:91]
  v_mfma_f32_16x16x32_bf16 v[92:95], v[60:63], v[148:151], v[92:95]
  v_mfma_f32_16x16x32_bf16 v[96:99], v[60:63], v[164:167], v[96:99]
  v_mfma_f32_16x16x32_bf16 v[100:103], v[60:63], v[180:183], v[100:103]
  v_mfma_f32_16x16x32_bf16 v[104:107], v[60:63], v[196:199], v[104:107]
  v_mfma_f32_16x16x32_bf16 v[108:111], v[60:63], v[212:215], v[108:111]
  v_mfma_f32_16x16x32_bf16 v[112:115], v[60:63], v[228:231], v[112:115]
  v_mfma_f32_16x16x32_bf16 v[116:119], v[60:63], v[244:247], v[116:119]
  v_mfma_f32_16x16x32_bf16 v[88:91], v[64:67], v[136:139], v[88:91]
  v_mfma_f32_16x16x32_bf16 v[92:95], v[64:67], v[152:155], v[92:95]
  v_mfma_f32_16x16x32_bf16 v[96:99], v[64:67], v[168:171], v[96:99]
  v_mfma_f32_16x16x32_bf16 v[100:103], v[64:67], v[184:187], v[100:103]
  v_mfma_f32_16x16x32_bf16 v[104:107], v[64:67], v[200:203], v[104:107]
  v_mfma_f32_16x16x32_bf16 v[108:111], v[64:67], v[216:219], v[108:111]
  v_mfma_f32_16x16x32_bf16 v[112:115], v[64:67], v[232:235], v[112:115]
  v_mfma_f32_16x16x32_bf16 v[116:119], v[64:67], v[248:251], v[116:119]
  v_mfma_f32_16x16x32_bf16 v[88:91], v[68:71], v[140:143], v[88:91]
  v_mfma_f32_16x16x32_bf16 v[92:95], v[68:71], v[156:159], v[92:95]
  v_mfma_f32_16x16x32_bf16 v[96:99], v[68:71], v[172:175], v[96:99]
  v_mfma_f32_16x16x32_bf16 v[100:103], v[68:71], v[188:191], v[100:103]
  v_mfma_f32_16x16x32_bf16 v[104:107], v[68:71], v[204:207], v[104:107]
  v_mfma_f32_16x16x32_bf16 v[108:111], v[68:71], v[220:223], v[108:111]
  v_mfma_f32_16x16x32_bf16 v[112:115], v[68:71], v[236:239], v[112:115]
  v_mfma_f32_16x16x32_bf16 v[116:119], v[68:71], v[252:255], v[116:119]
  v_mfma_f32_16x16x32_bf16 v[28:31], v[72:75], v[128:131], 0
  v_mfma_f32_16x16x32_bf16 v[32:35], v[72:75], v[144:147], 0
  v_mfma_f32_16x16x32_bf16 v[36:39], v[72:75], v[160:163], 0
  v_cvt_pk_bf16_f32 v60, v88, v92
  v_mfma_f32_16x16x32_bf16 v[40:43], v[72:75], v[176:179], 0
  v_cvt_pk_bf16_f32 v61, v96, v100
  v_mfma_f32_16x16x32_bf16 v[44:47], v[72:75], v[192:195], 0
  v_cvt_pk_bf16_f32 v62, v104, v108
  v_mfma_f32_16x16x32_bf16 v[48:51], v[72:75], v[208:211], 0
  v_cvt_pk_bf16_f32 v63, v112, v116
  v_mfma_f32_16x16x32_bf16 v[52:55], v[72:75], v[224:227], 0
  s_add_u32 s36, s45, 0
  buffer_store_dwordx4 v[60:63], v18, s[8:11], s36 offen
  v_mfma_f32_16x16x32_bf16 v[56:59], v[72:75], v[240:243], 0
  v_cvt_pk_bf16_f32 v64, v89, v93
  v_mfma_f32_16x16x32_bf16 v[28:31], v[76:79], v[132:135], v[28:31]
  v_cvt_pk_bf16_f32 v65, v97, v101
  v_mfma_f32_16x16x32_bf16 v[32:35], v[76:79], v[148:151], v[32:35]
  v_cvt_pk_bf16_f32 v66, v105, v109
  v_mfma_f32_16x16x32_bf16 v[36:39], v[76:79], v[164:167], v[36:39]
  v_cvt_pk_bf16_f32 v67, v113, v117
  v_mfma_f32_16x16x32_bf16 v[40:43], v[76:79], v[180:183], v[40:43]
  s_add_u32 s36, s45, 32768
  buffer_store_dwordx4 v[64:67], v18, s[8:11], s36 offen
  v_mfma_f32_16x16x32_bf16 v[44:47], v[76:79], v[196:199], v[44:47]
  v_cvt_pk_bf16_f32 v60, v90, v94
  v_mfma_f32_16x16x32_bf16 v[48:51], v[76:79], v[212:215], v[48:51]
  v_cvt_pk_bf16_f32 v61, v98, v102
  v_mfma_f32_16x16x32_bf16 v[52:55], v[76:79], v[228:231], v[52:55]
  v_cvt_pk_bf16_f32 v62, v106, v110
  v_mfma_f32_16x16x32_bf16 v[56:59], v[76:79], v[244:247], v[56:59]
  v_cvt_pk_bf16_f32 v63, v114, v118
  v_mfma_f32_16x16x32_bf16 v[28:31], v[80:83], v[136:139], v[28:31]
  s_add_u32 s36, s45, 65536
  buffer_store_dwordx4 v[60:63], v18, s[8:11], s36 offen
  v_mfma_f32_16x16x32_bf16 v[32:35], v[80:83], v[152:155], v[32:35]
  v_cvt_pk_bf16_f32 v64, v91, v95
  v_mfma_f32_16x16x32_bf16 v[36:39], v[80:83], v[168:171], v[36:39]
  v_cvt_pk_bf16_f32 v65, v99, v103
  v_mfma_f32_16x16x32_bf16 v[40:43], v[80:83], v[184:187], v[40:43]
  v_cvt_pk_bf16_f32 v66, v107, v111
  v_mfma_f32_16x16x32_bf16 v[44:47], v[80:83], v[200:203], v[44:47]
  v_cvt_pk_bf16_f32 v67, v115, v119
  v_mfma_f32_16x16x32_bf16 v[48:51], v[80:83], v[216:219], v[48:51]
  s_add_u32 s36, s45, 98304
  buffer_store_dwordx4 v[64:67], v18, s[8:11], s36 offen
  v_mfma_f32_16x16x32_bf16 v[52:55], v[80:83], v[232:235], v[52:55]
  v_mfma_f32_16x16x32_bf16 v[56:59], v[80:83], v[248:251], v[56:59]
  v_mfma_f32_16x16x32_bf16 v[28:31], v[84:87], v[140:143], v[28:31]
  v_mfma_f32_16x16x32_bf16 v[32:35], v[84:87], v[156:159], v[32:35]
  v_mfma_f32_16x16x32_bf16 v[36:39], v[84:87], v[172:175], v[36:39]
  v_mfma_f32_16x16x32_bf16 v[40:43], v[84:87], v[188:191], v[40:43]
  v_mfma_f32_16x16x32_bf16 v[44:47], v[84:87], v[204:207], v[44:47]
  v_mfma_f32_16x16x32_bf16 v[48:51], v[84:87], v[220:223], v[48:51]
  v_mfma_f32_16x16x32_bf16 v[52:55], v[84:87], v[236:239], v[52:55]
  v_mfma_f32_16x16x32_bf16 v[56:59], v[84:87], v[252:255], v[56:59]
  v_cvt_pk_bf16_f32 v60, v28, v32
  v_cvt_pk_bf16_f32 v61, v36, v40
  v_cvt_pk_bf16_f32 v62, v44, v48
  s_nop 3
  v_cvt_pk_bf16_f32 v63, v52, v56
  s_add_u32 s36, s45, 524288
  buffer_store_dwordx4 v[60:63], v18, s[8:11], s36 offen
  v_cvt_pk_bf16_f32 v64, v29, v33
  v_cvt_pk_bf16_f32 v65, v37, v41
  v_cvt_pk_bf16_f32 v66, v45, v49
  v_cvt_pk_bf16_f32 v67, v53, v57
  s_add_u32 s36, s45, 557056
  buffer_store_dwordx4 v[64:67], v18, s[8:11], s36 offen
  v_cvt_pk_bf16_f32 v60, v30, v34
  v_cvt_pk_bf16_f32 v61, v38, v42
  v_cvt_pk_bf16_f32 v62, v46, v50
  v_cvt_pk_bf16_f32 v63, v54, v58
  s_add_u32 s36, s45, 589824
  buffer_store_dwordx4 v[60:63], v18, s[8:11], s36 offen
  v_cvt_pk_bf16_f32 v64, v31, v35
  v_cvt_pk_bf16_f32 v65, v39, v43
  v_cvt_pk_bf16_f32 v66, v47, v51
  v_cvt_pk_bf16_f32 v67, v55, v59
  s_add_u32 s36, s45, 622592
  buffer_store_dwordx4 v[64:67], v18, s[8:11], s36 offen
  v_cndmask_b32 v92, 0, v22, s[52:53]
  v_cndmask_b32 v93, 0, v22, s[54:55]
  v_cndmask_b32 v94, 0, v22, s[56:57]
  v_cndmask_b32 v95, 0, v22, s[58:59]
  s_cmp_lt_u32 s42, 63
  s_cbranch_scc1 AF_SG
  s_branch AF_TAIL
AF_SG:
  s_add_u32 s43, s43, 1
  s_lshl_b32 s33, s5, 2
  s_add_u32 s33, s33, s47
  v_mov_b32 v0, s43
  s_waitcnt vmcnt(0)
  s_mov_b64 exec, 1
  buffer_store_dword v0, off, s[8:11], s33
  s_mov_b64 exec, -1
  s_xor_b32 s45, s45, 0x100000
AGP_34:
  buffer_load_dword v0, v23, s[8:11], s47 offen sc1
  s_waitcnt vmcnt(0)
  v_cmp_gt_u32 vcc, s43, v0
  s_cbranch_vccz AGPOK_35
  s_sleep 1
  s_sub_u32 s6, s6, 1
  s_cbranch_scc1 GIVEUP
  s_branch AGP_34
AGPOK_35:
AF_TAIL:
AT_36:
  buffer_load_dwordx4 v[60:63], v20, s[8:11], s46 offen sc1
  s_add_u32 s36, s46, 4096
  buffer_load_dwordx4 v[64:67], v20, s[8:11], s36 offen sc1
  s_add_u32 s36, s46, 8192
  buffer_load_dwordx4 v[68:71], v20, s[8:11], s36 offen sc1
  s_add_u32 s36, s46, 12288
  buffer_load_dwordx4 v[72:75], v20, s[8:11], s36 offen sc1
  s_add_u32 s36, s46, 16384
  buffer_load_dwordx4 v[76:79], v20, s[8:11], s36 offen sc1
  s_add_u32 s36, s46, 20480
  buffer_load_dwordx4 v[80:83], v20, s[8:11], s36 offen sc1
  s_add_u32 s36, s46, 24576
  buffer_load_dwordx4 v[84:87], v20, s[8:11], s36 offen sc1
  s_add_u32 s36, s46, 28672
  buffer_load_dwordx4 v[88:91], v20, s[8:11], s36 offen sc1
  s_waitcnt vmcnt(0)
  v_max3_u32 v0, v60, v64, v68
  v_max3_u32 v0, v0, v72, v76
  v_max3_u32 v0, v0, v80, v84
  v_max_u32 v0, v0, v88
  v_cmp_eq_u32 vcc, -1, v0
  s_cbranch_vccz ATOK_37
  s_sub_u32 s6, s6, 1
  s_cbranch_scc1 GIVEUP
  s_branch AT_36
ATOK_37:
  s_xor_b32 s46, s46, 0x100000
  v_mfma_f32_16x16x32_bf16 v[96:99], v[92:95], v[60:63], 0
  v_mfma_f32_16x16x32_bf16 v[96:99], v[92:95], v[64:67], v[96:99]
  v_mfma_f32_16x16x32_bf16 v[96:99], v[92:95], v[68:71], v[96:99]
  v_mfma_f32_16x16x32_bf16 v[96:99], v[92:95], v[72:75], v[96:99]
  v_mfma_f32_16x16x32_bf16 v[96:99], v[92:95], v[76:79], v[96:99]
  v_mfma_f32_16x16x32_bf16 v[96:99], v[92:95], v[80:83], v[96:99]
  v_mfma_f32_16x16x32_bf16 v[96:99], v[92:95], v[84:87], v[96:99]
  v_mfma_f32_16x16x32_bf16 v[96:99], v[92:95], v[88:91], v[96:99]
  v_and_b32 v121, 0xffff0000, v120
  v_lshlrev_b32 v120, 16, v120
  s_nop 4
  v_cvt_pk_bf16_f32 v0, v96, v97
  v_and_b32 v97, 0xffff0000, v0
  v_lshlrev_b32 v96, 16, v0
  v_mul_f32 v96, v96, v122
  v_mul_f32 v97, v97, v123
  v_cvt_pk_bf16_f32 v0, v96, v97
  v_and_b32 v97, 0xffff0000, v0
  v_lshlrev_b32 v96, 16, v0
  v_add_f32 v96, v96, v120
  v_add_f32 v97, v97, v121
  v_cvt_pk_bf16_f32 v100, v96, v97
  v_and_b32 v97, 0xffff0000, v100
  v_lshlrev_b32 v96, 16, v100
  v_min_u32 v100, -2, v100
  s_add_u32 s34, s41, 6291456
  buffer_store_dword v100, v21, s[8:11], s34 offen sc1
  v_add_f32 v102, v96, v97
  s_nop 1
  v_add_f32_dpp v102, v102, v102 row_ror:1 row_mask:0xf bank_mask:0xf
  s_nop 1
  v_add_f32_dpp v102, v102, v102 row_ror:2 row_mask:0xf bank_mask:0xf
  s_nop 1
  v_add_f32_dpp v102, v102, v102 row_ror:4 row_mask:0xf bank_mask:0xf
  s_nop 1
  v_add_f32_dpp v102, v102, v102 row_ror:8 row_mask:0xf bank_mask:0xf
  v_mov_b32 v0, v102
  s_nop 1
  v_permlane16_swap_b32 v102, v0
  v_add_f32 v102, v102, v0
  v_mov_b32 v0, v102
  s_nop 1
  v_permlane32_swap_b32 v102, v0
  v_add_f32 v102, v102, v0
  v_mul_f32 v102, 0x3c000000, v102
  v_sub_f32 v24, v96, v102
  v_sub_f32 v25, v97, v102
  v_mul_f32 v103, v24, v24
  v_fmac_f32 v103, v25, v25
  s_nop 1
  v_add_f32_dpp v103, v103, v103 row_ror:1 row_mask:0xf bank_mask:0xf
  s_nop 1
  v_add_f32_dpp v103, v103, v103 row_ror:2 row_mask:0xf bank_mask:0xf
  s_nop 1
  v_add_f32_dpp v103, v103, v103 row_ror:4 row_mask:0xf bank_mask:0xf
  s_nop 1
  v_add_f32_dpp v103, v103, v103 row_ror:8 row_mask:0xf bank_mask:0xf
  v_mov_b32 v0, v103
  s_nop 1
  v_permlane16_swap_b32 v103, v0
  v_add_f32 v103, v103, v0
  v_mov_b32 v0, v103
  s_nop 1
  v_permlane32_swap_b32 v103, v0
  v_add_f32 v103, v103, v0
  s_lshl_b32 s33, s3, 3
  s_add_u32 s33, s33, 28672
  v_mov_b32 v0, s33
  s_mov_b64 exec, 1
  ds_write_b64 v0, v[102:103]
  s_mov_b64 exec, -1
AF_NORM:
  v_mov_b32 v24, 28672
  s_waitcnt lgkmcnt(0)
  s_barrier
  ds_read_b128 v[104:107], v24
  ds_read_b128 v[108:111], v24 offset:16
  s_waitcnt lgkmcnt(0)
  v_add_f32 v102, v104, v106
  v_add_f32 v0, v108, v110
  v_add_f32 v102, v102, v0
  v_mul_f32 v102, 0x3e800000, v102
  v_add_f32 v103, v105, v107
  v_add_f32 v0, v109, v111
  v_add_f32 v103, v103, v0
  v_sub_f32 v104, v104, v102
  v_sub_f32 v106, v106, v102
  v_sub_f32 v108, v108, v102
  v_sub_f32 v110, v110, v102
  v_mul_f32 v0, v104, v104
  v_fmac_f32 v0, v106, v106
  v_fmac_f32 v0, v108, v108
  v_fmac_f32 v0, v110, v110
  v_fmac_f32 v103, 0x43000000, v0
  v_mul_f32 v103, 0x3b000000, v103
  v_cvt_pk_bf16_f32 v0, v102, v103
  v_and_b32 v103, 0xffff0000, v0
  v_lshlrev_b32 v102, 16, v0
  v_add_f32 v103, 0x3727c5ac, v103
  v_cvt_pk_bf16_f32 v103, v103, v103
  v_lshlrev_b32 v103, 16, v103
  v_sqrt_f32 v103, v103
  s_nop 0
  v_cvt_pk_bf16_f32 v103, v103, v103
  v_lshlrev_b32 v103, 16, v103
  v_rcp_f32 v103, v103
  v_sub_f32 v96, v96, v102
  v_sub_f32 v97, v97, v102
  v_cvt_pk_bf16_f32 v0, v96, v97
  v_and_b32 v97, 0xffff0000, v0
  v_lshlrev_b32 v96, 16, v0
  v_mul_f32 v96, v96, v103
  v_mul_f32 v97, v97, v103
  v_cvt_pk_bf16_f32 v0, v96, v97
  v_and_b32 v97, 0xffff0000, v0
  v_lshlrev_b32 v96, 16, v0
  v_mul_f32 v96, v96, v124
  v_mul_f32 v97, v97, v125
  v_cvt_pk_bf16_f32 v0, v96, v97
  v_and_b32 v97, 0xffff0000, v0
  v_lshlrev_b32 v96, 16, v0
  v_add_f32 v96, v96, v126
  v_add_f32 v97, v97, v127
  v_cvt_pk_bf16_f32 v96, v96, v97
  v_min_u32 v96, -2, v96
  s_add_u32 s34, s41, 4194304
  buffer_store_dword v96, v21, s[8:11], s34 offen sc1
  s_lshr_b32 s37, s41, 6
  s_lshl_b32 s33, s3, 2
  s_add_u32 s33, s33, s37
  s_add_u32 s37, s33, 32768
  s_add_u32 s42, s42, 5
  s_cmp_ge_u32 s42, 64
  s_cbranch_scc1 AF_FIN
  s_barrier
  s_lshl_b32 s33, s42, 15
  s_add_u32 s33, s33, 2097152
  s_lshl_b32 s34, s3, 8
  s_add_u32 s34, s34, s33
  s_lshl_b32 s35, s3, 13
  s_add_u32 s39, s34, 0
  s_add_u32 m0, s35, 0
  s_nop 0
  buffer_load_dwordx4 v19, s[8:11], s39 offen sc1 lds
  s_add_u32 s39, s34, 16384
  s_add_u32 m0, s35, 2048
  s_nop 0
  buffer_load_dwordx4 v19, s[8:11], s39 offen sc1 lds
  s_add_u32 s39, s34, 128
  s_add_u32 m0, s35, 4096
  s_nop 0
  buffer_load_dwordx4 v19, s[8:11], s39 offen sc1 lds
  s_add_u32 s39, s34, 16512
  s_add_u32 m0, s35, 6144
  s_nop 0
  buffer_load_dwordx4 v19, s[8:11], s39 offen sc1 lds
  v_xor_b32 v19, 64, v19
  s_add_u32 s39, s34, 8192
  s_add_u32 m0, s35, 1024
  s_nop 0
  buffer_load_dwordx4 v19, s[8:11], s39 offen sc1 lds
  s_add_u32 s39, s34, 24576
  s_add_u32 m0, s35, 3072
  s_nop 0
  buffer_load_dwordx4 v19, s[8:11], s39 offen sc1 lds
  s_add_u32 s39, s34, 8320
  s_add_u32 m0, s35, 5120
  s_nop 0
  buffer_load_dwordx4 v19, s[8:11], s39 offen sc1 lds
  s_add_u32 s39, s34, 24704
  s_add_u32 m0, s35, 7168
  s_nop 0
  buffer_load_dwordx4 v19, s[8:11], s39 offen sc1 lds
  v_xor_b32 v19, 64, v19
  s_lshl_b32 s33, s42, 18
  s_lshl_b32 s34, s5, 13
  s_add_u32 s33, s33, s34
  s_add_u32 s34, s33, 16777216
  s_add_u32 s35, s33, 33554432
  buffer_load_dwordx4 v[112:115], v1, s[8:11], s34 offen offset:0 sc1
  buffer_load_dwordx4 v[116:119], v1, s[8:11], s34 offen offset:1024 sc1
  buffer_load_dwordx4 v[28:31], v1, s[8:11], s35 offen offset:0 sc1
  buffer_load_dwordx4 v[32:35], v1, s[8:11], s35 offen offset:1024 sc1
  v_mov_b32 v0, 2
  s_waitcnt vmcnt(12)
  s_mov_b64 exec, 1
  buffer_store_dword v0, off, s[8:11], s37 sc1
  s_mov_b64 exec, -1
  s_waitcnt vmcnt(5)
  s_branch AF_LOOP
AF_FIN:
  v_mov_b32 v0, 2
  s_waitcnt vmcnt(0)
  s_mov_b64 exec, 1
  buffer_store_dword v0, off, s[8:11], s37 sc1
  s_mov_b64 exec, -1
  s_waitcnt vmcnt(0)
  s_waitcnt vmcnt(0)
  s_endpgm
AS_LOOP:
  ds_read_b128 v[68:71], v2 offset:0
  ds_read_b128 v[72:75], v2 offset:2048
  ds_read_b128 v[84:87], v2 offset:1024
  ds_read_b128 v[88:91], v2 offset:3072
  s_barrier
  ds_read_b128 v[60:63], v6 offset:0
  ds_read_b128 v[64:67], v6 offset:2048
  v_xor_b32 v6, 64, v6
  ds_read_b128 v[76:79], v6 offset:0
  ds_read_b128 v[80:83], v6 offset:2048
  v_xor_b32 v6, 64, v6
  s_waitcnt lgkmcnt(2)
  v_mfma_f32_16x16x32_bf16 v[36:39], v[68:71], v[60:63], 0
  ds_read_b128 v[100:103], v2 offset:16384
  v_mfma_f32_16x16x32_bf16 v[40:43], v[68:71], v[64:67], 0
  ds_read_b128 v[104:107], v2 offset:18432
  v_mfma_f32_16x16x32_bf16 v[44:47], v[72:75], v[60:63], 0
  ds_read_b128 v[92:95], v6 offset:4096
  v_mfma_f32_16x16x32_bf16 v[48:51], v[72:75], v[64:67], 0
  ds_read_b128 v[96:99], v6 offset:6144
  v_xor_b32 v6, 64, v6
  s_waitcnt lgkmcnt(4)
  v_mfma_f32_16x16x32_bf16 v[36:39], v[84:87], v[76:79], v[36:39]
  ds_read_b128 v[68:71], v2 offset:17408
  v_mfma_f32_16x16x32_bf16 v[40:43], v[84:87], v[80:83], v[40:43]
  ds_read_b128 v[72:75], v2 offset:19456
  v_mfma_f32_16x16x32_bf16 v[44:47], v[88:91], v[76:79], v[44:47]
  ds_read_b128 v[60:63], v6 offset:4096
  v_mfma_f32_16x16x32_bf16 v[48:51], v[88:91], v[80:83], v[48:51]
  ds_read_b128 v[64:67], v6 offset:6144
  v_xor_b32 v6, 64, v6
  s_waitcnt lgkmcnt(4)
  v_mfma_f32_16x16x32_bf16 v[36:39], v[100:103], v[92:95], v[36:39]
  ds_read_b128 v[84:87], v3 offset:0
  v_mfma_f32_16x16x32_bf16 v[40:43], v[100:103], v[96:99], v[40:43]
  ds_read_b128 v[88:91], v3 offset:2048
  v_mfma_f32_16x16x32_bf16 v[44:47], v[104:107], v[92:95], v[44:47]
  ds_read_b128 v[76:79], v7 offset:0
  v_mfma_f32_16x16x32_bf16 v[48:51], v[104:107], v[96:99], v[48:51]
  ds_read_b128 v[80:83], v7 offset:2048
  v_xor_b32 v7, 64, v7
  s_waitcnt lgkmcnt(4)
  v_mfma_f32_16x16x32_bf16 v[36:39], v[68:71], v[60:63], v[36:39]
  ds_read_b128 v[100:103], v3 offset:1024
  v_mfma_f32_16x16x32_bf16 v[40:43], v[68:71], v[64:67], v[40:43]
  ds_read_b128 v[104:107], v3 offset:3072
  v_mfma_f32_16x16x32_bf16 v[44:47], v[72:75], v[60:63], v[44:47]
  ds_read_b128 v[92:95], v7 offset:0
  v_mfma_f32_16x16x32_bf16 v[48:51], v[72:75], v[64:67], v[48:51]
  ds_read_b128 v[96:99], v7 offset:2048
  v_xor_b32 v7, 64, v7
  s_waitcnt lgkmcnt(4)
  v_mfma_f32_16x16x32_bf16 v[36:39], v[84:87], v[76:79], v[36:39]
  ds_read_b128 v[68:71], v3 offset:16384
  v_mfma_f32_16x16x32_bf16 v[40:43], v[84:87], v[80:83], v[40:43]
  ds_read_b128 v[72:75], v3 offset:18432
  v_mfma_f32_16x16x32_bf16 v[44:47], v[88:91], v[76:79], v[44:47]
  ds_read_b128 v[60:63], v7 offset:4096
  v_mfma_f32_16x16x32_bf16 v[48:51], v[88:91], v[80:83], v[48:51]
  ds_read_b128 v[64:67], v7 offset:6144
  v_xor_b32 v7, 64, v7
  s_waitcnt lgkmcnt(4)
  v_mfma_f32_16x16x32_bf16 v[36:39], v[100:103], v[92:95], v[36:39]
  ds_read_b128 v[84:87], v3 offset:17408
  v_mfma_f32_16x16x32_bf16 v[40:43], v[100:103], v[96:99], v[40:43]
  ds_read_b128 v[88:91], v3 offset:19456
  v_mfma_f32_16x16x32_bf16 v[44:47], v[104:107], v[92:95], v[44:47]
  ds_read_b128 v[76:79], v7 offset:4096
  v_mfma_f32_16x16x32_bf16 v[48:51], v[104:107], v[96:99], v[48:51]
  ds_read_b128 v[80:83], v7 offset:6144
  v_xor_b32 v7, 64, v7
  s_waitcnt lgkmcnt(4)
  v_mfma_f32_16x16x32_bf16 v[36:39], v[68:71], v[60:63], v[36:39]
  ds_read_b128 v[100:103], v4 offset:0
  v_mfma_f32_16x16x32_bf16 v[40:43], v[68:71], v[64:67], v[40:43]
  ds_read_b128 v[104:107], v4 offset:2048
  v_mfma_f32_16x16x32_bf16 v[44:47], v[72:75], v[60:63], v[44:47]
  ds_read_b128 v[92:95], v8 offset:0
  v_mfma_f32_16x16x32_bf16 v[48:51], v[72:75], v[64:67], v[48:51]
  ds_read_b128 v[96:99], v8 offset:2048
  v_xor_b32 v8, 64, v8
  s_waitcnt lgkmcnt(4)
  v_mfma_f32_16x16x32_bf16 v[36:39], v[84:87], v[76:79], v[36:39]
  ds_read_b128 v[68:71], v4 offset:1024
  v_mfma_f32_16x16x32_bf16 v[40:43], v[84:87], v[80:83], v[40:43]
  ds_read_b128 v[72:75], v4 offset:3072
  v_mfma_f32_16x16x32_bf16 v[44:47], v[88:91], v[76:79], v[44:47]
  ds_read_b128 v[60:63], v8 offset:0
  v_mfma_f32_16x16x32_bf16 v[48:51], v[88:91], v[80:83], v[48:51]
  ds_read_b128 v[64:67], v8 offset:2048
  v_xor_b32 v8, 64, v8
  s_waitcnt lgkmcnt(4)
  v_mfma_f32_16x16x32_bf16 v[36:39], v[100:103], v[92:95], v[36:39]
  ds_read_b128 v[84:87], v4 offset:16384
  v_mfma_f32_16x16x32_bf16 v[40:43], v[100:103], v[96:99], v[40:43]
  ds_read_b128 v[88:91], v4 offset:18432
  v_mfma_f32_16x16x32_bf16 v[44:47], v[104:107], v[92:95], v[44:47]
  ds_read_b128 v[76:79], v8 offset:4096
  v_mfma_f32_16x16x32_bf16 v[48:51], v[104:107], v[96:99], v[48:51]
  ds_read_b128 v[80:83], v8 offset:6144
  v_xor_b32 v8, 64, v8
  s_waitcnt lgkmcnt(4)
  v_mfma_f32_16x16x32_bf16 v[36:39], v[68:71], v[60:63], v[36:39]
  ds_read_b128 v[100:103], v4 offset:17408
  v_mfma_f32_16x16x32_bf16 v[40:43], v[68:71], v[64:67], v[40:43]
  ds_read_b128 v[104:107], v4 offset:19456
  v_mfma_f32_16x16x32_bf16 v[44:47], v[72:75], v[60:63], v[44:47]
  ds_read_b128 v[92:95], v8 offset:4096
  v_mfma_f32_16x16x32_bf16 v[48:51], v[72:75], v[64:67], v[48:51]
  ds_read_b128 v[96:99], v8 offset:6144
  v_xor_b32 v8, 64, v8
  s_waitcnt lgkmcnt(4)
  v_mfma_f32_16x16x32_bf16 v[36:39], v[84:87], v[76:79], v[36:39]
  ds_read_b128 v[68:71], v5 offset:0
  v_mfma_f32_16x16x32_bf16 v[40:43], v[84:87], v[80:83], v[40:43]
  ds_read_b128 v[72:75], v5 offset:2048
  v_mfma_f32_16x16x32_bf16 v[44:47], v[88:91], v[76:79], v[44:47]
  ds_read_b128 v[60:63], v9 offset:0
  v_mfma_f32_16x16x32_bf16 v[48:51], v[88:91], v[80:83], v[48:51]
  ds_read_b128 v[64:67], v9 offset:2048
  v_xor_b32 v9, 64, v9
  s_waitcnt lgkmcnt(4)
  v_mfma_f32_16x16x32_bf16 v[36:39], v[100:103], v[92:95], v[36:39]
  ds_read_b128 v[84:87], v5 offset:1024
  v_mfma_f32_16x16x32_bf16 v[40:43], v[100:103], v[96:99], v[40:43]
  ds_read_b128 v[88:91], v5 offset:3072
  v_mfma_f32_16x16x32_bf16 v[44:47], v[104:107], v[92:95], v[44:47]
  ds_read_b128 v[76:79], v9 offset:0
  v_mfma_f32_16x16x32_bf16 v[48:51], v[104:107], v[96:99], v[48:51]
  ds_read_b128 v[80:83], v9 offset:2048
  v_xor_b32 v9, 64, v9
  s_waitcnt lgkmcnt(4)
  v_mfma_f32_16x16x32_bf16 v[36:39], v[68:71], v[60:63], v[36:39]
  ds_read_b128 v[100:103], v5 offset:16384
  v_mfma_f32_16x16x32_bf16 v[40:43], v[68:71], v[64:67], v[40:43]
  ds_read_b128 v[104:107], v5 offset:18432
  v_mfma_f32_16x16x32_bf16 v[44:47], v[72:75], v[60:63], v[44:47]
  ds_read_b128 v[92:95], v9 offset:4096
  v_mfma_f32_16x16x32_bf16 v[48:51], v[72:75], v[64:67], v[48:51]
  ds_read_b128 v[96:99], v9 offset:6144
  v_xor_b32 v9, 64, v9
  s_waitcnt lgkmcnt(4)
  v_mfma_f32_16x16x32_bf16 v[36:39], v[84:87], v[76:79], v[36:39]
  ds_read_b128 v[68:71], v5 offset:17408
  v_mfma_f32_16x16x32_bf16 v[40:43], v[84:87], v[80:83], v[40:43]
  ds_read_b128 v[72:75], v5 offset:19456
  v_mfma_f32_16x16x32_bf16 v[44:47], v[88:91], v[76:79], v[44:47]
  ds_read_b128 v[60:63], v9 offset:4096
  v_mfma_f32_16x16x32_bf16 v[48:51], v[88:91], v[80:83], v[48:51]
  ds_read_b128 v[64:67], v9 offset:6144
  v_xor_b32 v9, 64, v9
  s_waitcnt lgkmcnt(4)
  v_mfma_f32_16x16x32_bf16 v[36:39], v[100:103], v[92:95], v[36:39]
  s_lshl_b32 s41, s42, 5
  v_mfma_f32_16x16x32_bf16 v[40:43], v[100:103], v[96:99], v[40:43]
  s_add_u32 s41, s41, s5
  v_mfma_f32_16x16x32_bf16 v[44:47], v[104:107], v[92:95], v[44:47]
  s_lshl_b32 s41, s41, 10
  v_mfma_f32_16x16x32_bf16 v[48:51], v[104:107], v[96:99], v[48:51]
  s_add_u32 s48, s42, 15
  s_waitcnt lgkmcnt(0)
  s_barrier
  v_mfma_f32_16x16x32_bf16 v[36:39], v[68:71], v[60:63], v[36:39]
  v_mfma_f32_16x16x32_bf16 v[40:43], v[68:71], v[64:67], v[40:43]
  v_mfma_f32_16x16x32_bf16 v[44:47], v[72:75], v[60:63], v[44:47]
  v_mfma_f32_16x16x32_bf16 v[48:51], v[72:75], v[64:67], v[48:51]
  s_waitcnt vmcnt(0)
  ds_write_b128 v1, v[112:115] offset:0
  ds_write_b128 v1, v[116:119] offset:1024
  v_cvt_pk_bf16_f32 v52, v36, v37
  v_cvt_pk_bf16_f32 v53, v38, v39
  v_cvt_pk_bf16_f32 v54, v44, v45
  v_cvt_pk_bf16_f32 v55, v46, v47
  ds_write_b128 v1, v[52:55] offset:8192
  v_cvt_pk_bf16_f32 v56, v40, v41
  v_cvt_pk_bf16_f32 v57, v42, v43
  v_cvt_pk_bf16_f32 v58, v48, v49
  v_cvt_pk_bf16_f32 v59, v50, v51
  ds_write_b128 v1, v[56:59] offset:9216
  buffer_load_dword v120, v21, s[16:19], s41 offen
  s_waitcnt lgkmcnt(0)
  s_barrier
  ds_read_b128 v[76:79], v13 offset:0
  ds_read_b128 v[80:83], v13 offset:1024
  ds_read_b128 v[84:87], v13 offset:8192
  ds_read_b128 v[88:91], v13 offset:9216
  ds_read_b128 v[104:107], v13 offset:2048
  ds_read_b128 v[108:111], v13 offset:3072
  ds_read_b128 v[112:115], v13 offset:10240
  ds_read_b128 v[116:119], v13 offset:11264
  s_waitcnt lgkmcnt(4)
  v_mfma_f32_16x16x32_bf16 v[36:39], v[76:79], v[84:87], 0
  v_mfma_f32_16x16x32_bf16 v[40:43], v[76:79], v[88:91], 0
  v_mfma_f32_16x16x32_bf16 v[44:47], v[80:83], v[88:91], 0
  ds_read_b128 v[76:79], v13 offset:4096
  ds_read_b128 v[80:83], v13 offset:5120
  ds_read_b128 v[84:87], v13 offset:12288
  ds_read_b128 v[88:91], v13 offset:13312
  s_waitcnt lgkmcnt(4)
  v_mfma_f32_16x16x32_bf16 v[36:39], v[104:107], v[112:115], v[36:39]
  v_mfma_f32_16x16x32_bf16 v[40:43], v[104:107], v[116:119], v[40:43]
  v_mfma_f32_16x16x32_bf16 v[44:47], v[108:111], v[116:119], v[44:47]
  ds_read_b128 v[104:107], v13 offset:6144
  ds_read_b128 v[108:111], v13 offset:7168
  ds_read_b128 v[112:115], v13 offset:14336
  ds_read_b128 v[116:119], v13 offset:15360
  s_waitcnt lgkmcnt(4)
  v_mfma_f32_16x16x32_bf16 v[36:39], v[76:79], v[84:87], v[36:39]
  v_mfma_f32_16x16x32_bf16 v[40:43], v[76:79], v[88:91], v[40:43]
  v_mfma_f32_16x16x32_bf16 v[44:47], v[80:83], v[88:91], v[44:47]
  s_waitcnt lgkmcnt(0)
  v_mfma_f32_16x16x32_bf16 v[36:39], v[104:107], v[112:115], v[36:39]
  v_mfma_f32_16x16x32_bf16 v[40:43], v[104:107], v[116:119], v[40:43]
  v_mfma_f32_16x16x32_bf16 v[44:47], v[108:111], v[116:119], v[44:47]
  s_cmp_lt_u32 s42, 63
  s_cbranch_scc1 AS_NT
  s_lshl_b32 s34, s4, 20
  s_add_u32 s34, s34, 100663296
  s_lshl_b32 s33, s5, 10
  s_add_u32 s45, s33, s34
  s_lshl_b32 s33, s5, 15
  s_add_u32 s46, s33, s34
  v_lshlrev_b32 v24, 2, v13
  s_lshl_b32 s33, s4, 5
  s_add_u32 s33, s33, s5
  s_lshl_b32 s33, s33, 2
  s_add_u32 s33, s33, s3
  s_lshl_b32 s33, s33, 13
  s_add_u32 s33, s33, 100663296
  buffer_load_dword v25, v24, s[8:11], s33 offen sc1
  s_add_u32 s33, s33, 4096
  buffer_load_dword v24, v24, s[8:11], s33 offen sc1
AS_NT:
  s_lshl_b32 s37, s3, 11
  s_lshl_b32 s38, s42, 13
  s_add_u32 s38, s38, 524288
  s_cmp_ge_u32 s42, 62
  s_cselect_b32 s33, 8192, 0
  s_sub_u32 s33, s38, s33
  s_lshl_b32 s34, s5, 6
  s_add_u32 s33, s33, s34
  s_add_u32 s33, s33, s37
AS_LP:
  buffer_load_dword v0, off, s[8:11], s33 sc1
  s_waitcnt vmcnt(0)
  v_cmp_ne_u32 vcc, -1, v0
  s_cbranch_vccnz AS_MP
  s_sleep 4
  s_sub_u32 s6, s6, 1
  s_cbranch_scc1 GIVEUP
  s_branch AS_LP
AS_MP:
  buffer_load_dwordx4 v[56:59], v1, s[8:11], s38 offen sc1
  buffer_load_dwordx4 v[60:63], v1, s[8:11], s38 offen offset:1024 sc1
  s_waitcnt vmcnt(0)
  v_max3_u32 v0, v56, v57, v58
  v_max3_u32 v24, v59, v60, v61
  v_max_u32 v0, v0, v62
  v_max3_u32 v0, v0, v24, v63
  v_cmp_eq_u32 vcc, -1, v0
  s_cbranch_vccz AS_MOK
  s_sleep 2
  s_sub_u32 s6, s6, 1
  s_cbranch_scc1 GIVEUP
  s_branch AS_MP
AS_MOK:
  ds_write_b128 v1, v[56:59] offset:16384
  ds_write_b128 v1, v[60:63] offset:17408
  v_mov_b64 v[88:89], 0
  v_mov_b64 v[90:91], 0
  v_mov_b64 v[92:93], 0
  v_mov_b64 v[94:95], 0
  v_mov_b64 v[96:97], 0
  v_mov_b64 v[98:99], 0
  v_mov_b64 v[100:101], 0
  v_mov_b64 v[102:103], 0
  v_mov_b32 v24, s49
  v_cndmask_b32 v36, v24, v36, s[64:65]
  v_cndmask_b32 v44, v24, v44, s[64:65]
  v_cndmask_b32 v37, v24, v37, s[66:67]
  v_cndmask_b32 v45, v24, v45, s[66:67]
  v_cndmask_b32 v38, v24, v38, s[68:69]
  v_cndmask_b32 v46, v24, v46, s[68:69]
  v_cndmask_b32 v39, v24, v39, s[70:71]
  v_cndmask_b32 v47, v24, v47, s[70:71]
  s_waitcnt lgkmcnt(0)
  s_barrier
  ds_read_b128 v[64:67], v10 offset:16384
  ds_read_b128 v[68:71], v10 offset:17408
  ds_read_b128 v[72:75], v11 offset:16384
  ds_read_b128 v[76:79], v11 offset:17408
  ds_read_b128 v[80:83], v12 offset:16384
  ds_read_b128 v[84:87], v12 offset:17408
  v_smfmac_f32_16x16x64_bf16 v[88:91], v[56:59], a[0:7], v16
  v_smfmac_f32_16x16x64_bf16 v[92:95], v[56:59], a[8:15], v16
  v_smfmac_f32_16x16x64_bf16 v[88:91], v[60:63], a[16:23], v16
  v_smfmac_f32_16x16x64_bf16 v[92:95], v[60:63], a[24:31], v16
  s_waitcnt lgkmcnt(5)
  v_smfmac_f32_16x16x64_bf16 v[88:91], v[64:67], a[32:39], v16
  v_smfmac_f32_16x16x64_bf16 v[92:95], v[64:67], a[40:47], v16
  s_waitcnt lgkmcnt(4)
  v_smfmac_f32_16x16x64_bf16 v[88:91], v[68:71], a[48:55], v16
  v_smfmac_f32_16x16x64_bf16 v[92:95], v[68:71], a[56:63], v16
  s_waitcnt lgkmcnt(3)
  v_smfmac_f32_16x16x64_bf16 v[88:91], v[72:75], a[64:71], v16
  v_smfmac_f32_16x16x64_bf16 v[92:95], v[72:75], a[72:79], v16
  s_waitcnt lgkmcnt(2)
  v_smfmac_f32_16x16x64_bf16 v[88:91], v[76:79], a[80:87], v16
  v_smfmac_f32_16x16x64_bf16 v[92:95], v[76:79], a[88:95], v16
  s_waitcnt lgkmcnt(1)
  v_smfmac_f32_16x16x64_bf16 v[88:91], v[80:83], a[96:103], v16
  v_smfmac_f32_16x16x64_bf16 v[92:95], v[80:83], a[104:111], v16
  s_waitcnt lgkmcnt(0)
  v_smfmac_f32_16x16x64_bf16 v[88:91], v[84:87], a[112:119], v16
  v_smfmac_f32_16x16x64_bf16 v[92:95], v[84:87], a[120:127], v16
  v_smfmac_f32_16x16x64_bf16 v[96:99], v[56:59], a[128:135], v16
  v_smfmac_f32_16x16x64_bf16 v[100:103], v[56:59], a[136:143], v16
  v_smfmac_f32_16x16x64_bf16 v[96:99], v[60:63], a[144:151], v16
  v_smfmac_f32_16x16x64_bf16 v[100:103], v[60:63], a[152:159], v16
  v_add_f32 v88, v88, v90
  v_add_f32 v89, v89, v91
  v_smfmac_f32_16x16x64_bf16 v[96:99], v[64:67], a[160:167], v16
  v_smfmac_f32_16x16x64_bf16 v[100:103], v[64:67], a[168:175], v16
  v_add_f32 v92, v92, v94
  v_add_f32 v93, v93, v95
  v_smfmac_f32_16x16x64_bf16 v[96:99], v[68:71], a[176:183], v16
  v_smfmac_f32_16x16x64_bf16 v[100:103], v[68:71], a[184:191], v16
  v_cvt_pk_bf16_f32 v88, v88, v89
  v_cvt_pk_bf16_f32 v92, v92, v93
  v_smfmac_f32_16x16x64_bf16 v[96:99], v[72:75], a[192:199], v16
  v_smfmac_f32_16x16x64_bf16 v[100:103], v[72:75], a[200:207], v16
  ds_write_b32 v14, v88
  ds_write_b32 v14, v92 offset:512
  v_smfmac_f32_16x16x64_bf16 v[96:99], v[76:79], a[208:215], v16
  v_smfmac_f32_16x16x64_bf16 v[100:103], v[76:79], a[216:223], v16
  v_smfmac_f32_16x16x64_bf16 v[96:99], v[80:83], a[224:231], v16
  v_smfmac_f32_16x16x64_bf16 v[100:103], v[80:83], a[232:239], v16
  v_smfmac_f32_16x16x64_bf16 v[96:99], v[84:87], a[240:247], v16
  v_smfmac_f32_16x16x64_bf16 v[100:103], v[84:87], a[248:255], v16
  s_waitcnt lgkmcnt(0)
  s_barrier
  ds_read_b64_tr_b16 v[104:105], v15 offset:0
  ds_read_b64_tr_b16 v[106:107], v15 offset:512
  ds_read_b128 v[56:59], v13 offset:8192
  ds_read_b128 v[60:63], v13 offset:9216
  ds_read_b64_tr_b16 v[108:109], v15 offset:1024
  ds_read_b64_tr_b16 v[110:111], v15 offset:1536
  ds_read_b128 v[64:67], v13 offset:10240
  ds_read_b128 v[68:71], v13 offset:11264
  ds_read_b64_tr_b16 v[112:113], v15 offset:2048
  ds_read_b64_tr_b16 v[114:115], v15 offset:2560
  ds_read_b128 v[72:75], v13 offset:12288
  ds_read_b128 v[76:79], v13 offset:13312
  ds_read_b64_tr_b16 v[116:117], v15 offset:3072
  ds_read_b64_tr_b16 v[118:119], v15 offset:3584
  ds_read_b128 v[80:83], v13 offset:14336
  ds_read_b128 v[84:87], v13 offset:15360
  v_add_f32 v96, v96, v98
  v_add_f32 v97, v97, v99
  v_add_f32 v100, v100, v102
  v_add_f32 v101, v101, v103
  v_cvt_pk_bf16_f32 v96, v96, v97
  v_cvt_pk_bf16_f32 v97, v100, v101
  v_mov_b64 v[98:99], 0
  s_waitcnt lgkmcnt(12)
  v_mfma_f32_16x16x32_bf16 v[48:51], v[104:107], v[56:59], 0
  v_mfma_f32_16x16x32_bf16 v[52:55], v[104:107], v[60:63], 0
  s_waitcnt lgkmcnt(8)
  v_mfma_f32_16x16x32_bf16 v[48:51], v[108:111], v[64:67], v[48:51]
  v_mfma_f32_16x16x32_bf16 v[52:55], v[108:111], v[68:71], v[52:55]
  s_waitcnt lgkmcnt(4)
  v_mfma_f32_16x16x32_bf16 v[48:51], v[112:115], v[72:75], v[48:51]
  v_mfma_f32_16x16x32_bf16 v[52:55], v[112:115], v[76:79], v[52:55]
  s_waitcnt lgkmcnt(0)
  v_mfma_f32_16x16x32_bf16 v[48:51], v[116:119], v[80:83], v[48:51]
  v_mfma_f32_16x16x32_bf16 v[52:55], v[116:119], v[84:87], v[52:55]
  v_max3_f32 v0, v36, v37, v38
  v_max3_f32 v24, v40, v41, v42
  v_max3_f32 v25, v43, v44, v45
  v_max3_f32 v24, v24, v46, v47
  v_max_f32 v0, v0, v39
  v_max_f32 v24, v24, v25
  v_mov_b64 v[58:59], 0
  v_mov_b64 v[64:65], 0
  v_mov_b64 v[66:67], 0
  v_mov_b64 v[68:69], 0
  v_mov_b64 v[70:71], 0
  v_mov_b64 v[72:73], 0
  v_mov_b64 v[74:75], 0
  v_mov_b64 v[76:77], 0
  v_mov_b64 v[78:79], 0
  v_mov_b32 v80, 0x3f803f80
  v_mov_b32 v81, 0x3f803f80
  v_mov_b64 v[82:83], v[80:81]
  v_max3_f32 v0, v0, v48, v49
  v_max3_f32 v24, v24, v52, v53
  v_mov_b32 v25, v0
  v_mov_b32 v26, v24
  s_nop 0
  v_permlane16_swap_b32 v0, v25
  v_permlane16_swap_b32 v24, v26
  v_max_f32 v0, v0, v25
  v_max_f32 v24, v24, v26
  v_mov_b32 v25, v0
  v_mov_b32 v26, v24
  s_nop 0
  v_permlane32_swap_b32 v0, v25
  v_permlane32_swap_b32 v24, v26
  v_max_f32 v0, v0, v25
  v_max_f32 v24, v24, v26
  v_mul_f32 v0, s44, v0
  v_mul_f32 v24, s44, v24
  v_fma_f32 v36, v36, s44, -v0
  v_fma_f32 v37, v37, s44, -v0
  v_fma_f32 v38, v38, s44, -v0
  v_fma_f32 v39, v39, s44, -v0
  v_fma_f32 v48, v48, s44, -v0
  v_fma_f32 v49, v49, s44, -v0
  v_fma_f32 v40, v40, s44, -v24
  v_fma_f32 v41, v41, s44, -v24
  v_fma_f32 v42, v42, s44, -v24
  v_fma_f32 v43, v43, s44, -v24
  v_fma_f32 v44, v44, s44, -v24
  v_fma_f32 v45, v45, s44, -v24
  v_fma_f32 v46, v46, s44, -v24
  v_fma_f32 v47, v47, s44, -v24
  v_fma_f32 v52, v52, s44, -v24
  v_fma_f32 v53, v53, s44, -v24
  v_exp_f32 v36, v36
  v_exp_f32 v37, v37
  v_exp_f32 v38, v38
  v_exp_f32 v39, v39
  v_exp_f32 v48, v48
  v_exp_f32 v49, v49
  v_exp_f32 v40, v40
  v_exp_f32 v41, v41
  v_exp_f32 v42, v42
  v_exp_f32 v43, v43
  v_exp_f32 v44, v44
  v_exp_f32 v45, v45
  v_exp_f32 v46, v46
  v_exp_f32 v47, v47
  v_exp_f32 v52, v52
  v_exp_f32 v53, v53
  v_cvt_pk_bf16_f32 v56, v36, v37
  v_cvt_pk_bf16_f32 v57, v38, v39
  v_cvt_pk_bf16_f32 v64, v48, v49
  v_cvt_pk_bf16_f32 v69, v48, v49
  v_cvt_pk_bf16_f32 v60, v40, v41
  v_cvt_pk_bf16_f32 v61, v42, v43
  v_cvt_pk_bf16_f32 v62, v44, v45
  v_cvt_pk_bf16_f32 v63, v46, v47
  v_cvt_pk_bf16_f32 v72, v52, v53
  v_cvt_pk_bf16_f32 v77, v52, v53
  v_mfma_f32_16x16x32_bf16 v[84:87], v[80:83], v[56:59], 0
  v_mfma_f32_16x16x32_bf16 v[88:91], v[80:83], v[60:63], 0
  v_mfma_f32_16x16x32_bf16 v[84:87], v[80:83], v[64:67], v[84:87]
  v_mfma_f32_16x16x32_bf16 v[88:91], v[80:83], v[72:75], v[88:91]
  v_mfma_f32_16x16x32_bf16 v[104:107], v[28:31], v[56:59], 0
  v_mfma_f32_16x16x32_bf16 v[108:111], v[32:35], v[56:59], 0
  v_mfma_f32_16x16x32_bf16 v[104:107], v[96:99], v[64:67], v[104:107]
  v_mfma_f32_16x16x32_bf16 v[108:111], v[96:99], v[68:71], v[108:111]
  v_rcp_f32 v0, v84
  v_rcp_f32 v24, v88
  v_mfma_f32_16x16x32_bf16 v[112:115], v[28:31], v[60:63], 0
  v_mfma_f32_16x16x32_bf16 v[116:119], v[32:35], v[60:63], 0
  v_mfma_f32_16x16x32_bf16 v[112:115], v[96:99], v[72:75], v[112:115]
  v_mfma_f32_16x16x32_bf16 v[116:119], v[96:99], v[76:79], v[116:119]
  v_mul_f32 v104, v104, v0
  v_mul_f32 v105, v105, v0
  v_mul_f32 v106, v106, v0
  v_mul_f32 v107, v107, v0
  v_cvt_pk_bf16_f32 v104, v104, v105
  v_cvt_pk_bf16_f32 v105, v106, v107
  ds_write_b32 v17, v104 offset:0
  ds_write_b32 v17, v105 offset:8
  v_mul_f32 v108, v108, v0
  v_mul_f32 v109, v109, v0
  v_mul_f32 v110, v110, v0
  v_mul_f32 v111, v111, v0
  v_cvt_pk_bf16_f32 v108, v108, v109
  v_cvt_pk_bf16_f32 v109, v110, v111
  ds_write_b32 v17, v108 offset:256
  ds_write_b32 v17, v109 offset:264
  v_mul_f32 v112, v112, v24
  v_mul_f32 v113, v113, v24
  v_mul_f32 v114, v114, v24
  v_mul_f32 v115, v115, v24
  v_cvt_pk_bf16_f32 v112, v112, v113
  v_cvt_pk_bf16_f32 v113, v114, v115
  ds_write_b32 v17, v112 offset:4096
  ds_write_b32 v17, v113 offset:4104
  v_mul_f32 v116, v116, v24
  v_mul_f32 v117, v117, v24
  v_mul_f32 v118, v118, v24
  v_mul_f32 v119, v119, v24
  v_cvt_pk_bf16_f32 v116, v116, v117
  v_cvt_pk_bf16_f32 v117, v118, v119
  ds_write_b32 v17, v116 offset:4352
  ds_write_b32 v17, v117 offset:4360
  s_waitcnt lgkmcnt(0)
  s_barrier
  ds_read_b128 v[56:59], v13 offset:16384
  ds_read_b128 v[60:63], v13 offset:17408
  ds_read_b128 v[64:67], v13 offset:18432
  ds_read_b128 v[68:71], v13 offset:19456
  ds_read_b128 v[72:75], v13 offset:20480
  ds_read_b128 v[76:79], v13 offset:21504
  ds_read_b128 v[80:83], v13 offset:22528
  ds_read_b128 v[84:87], v13 offset:23552
  s_waitcnt lgkmcnt(0)
  s_cmp_ge_u32 s48, 64
  s_cbranch_scc1 AS_NOKV
  s_bitcmp1_b64 s[50:51], s48
  s_cbranch_scc1 AS_HNOK
  s_mov_b32 s33, 81920
AS_HN:
  buffer_load_dword v24, v13, s[8:11], s33 offen sc1
  s_waitcnt vmcnt(0)
  v_cmp_ne_u32 s[50:51], 0, v24
  s_nop 3
  s_bitcmp1_b64 s[50:51], s48
  s_cbranch_scc1 AS_HNOK
  s_sleep 2
  s_sub_u32 s6, s6, 1
  s_cbranch_scc1 GIVEUP
  s_branch AS_HN
AS_HNOK:
  s_lshl_b32 s33, s48, 15
  s_add_u32 s33, s33, 2097152
  s_lshl_b32 s34, s3, 8
  s_add_u32 s34, s34, s33
  s_lshl_b32 s35, s3, 13
  s_barrier
  v_mfma_f32_16x16x32_bf16 v[88:91], v[56:59], v[128:131], 0
  s_add_u32 s39, s34, 0
  s_add_u32 m0, s35, 0
  v_mfma_f32_16x16x32_bf16 v[92:95], v[56:59], v[144:147], 0
  buffer_load_dwordx4 v19, s[8:11], s39 offen sc1 lds
  v_mfma_f32_16x16x32_bf16 v[96:99], v[56:59], v[160:163], 0
  s_add_u32 s39, s34, 16384
  s_add_u32 m0, s35, 2048
  v_mfma_f32_16x16x32_bf16 v[100:103], v[56:59], v[176:179], 0
  buffer_load_dwordx4 v19, s[8:11], s39 offen sc1 lds
  v_mfma_f32_16x16x32_bf16 v[104:107], v[56:59], v[192:195], 0
  s_add_u32 s39, s34, 128
  s_add_u32 m0, s35, 4096
  v_mfma_f32_16x16x32_bf16 v[108:111], v[56:59], v[208:211], 0
  buffer_load_dwordx4 v19, s[8:11], s39 offen sc1 lds
  v_mfma_f32_16x16x32_bf16 v[112:115], v[56:59], v[224:227], 0
  s_add_u32 s39, s34, 16512
  s_add_u32 m0, s35, 6144
  v_mfma_f32_16x16x32_bf16 v[116:119], v[56:59], v[240:243], 0
  buffer_load_dwordx4 v19, s[8:11], s39 offen sc1 lds
  v_xor_b32 v19, 64, v19
  v_mfma_f32_16x16x32_bf16 v[88:91], v[60:63], v[132:135], v[88:91]
  s_add_u32 s39, s34, 8192
  s_add_u32 m0, s35, 1024
  v_mfma_f32_16x16x32_bf16 v[92:95], v[60:63], v[148:151], v[92:95]
  buffer_load_dwordx4 v19, s[8:11], s39 offen sc1 lds
  v_mfma_f32_16x16x32_bf16 v[96:99], v[60:63], v[164:167], v[96:99]
  s_add_u32 s39, s34, 24576
  s_add_u32 m0, s35, 3072
  v_mfma_f32_16x16x32_bf16 v[100:103], v[60:63], v[180:183], v[100:103]
  buffer_load_dwordx4 v19, s[8:11], s39 offen sc1 lds
  v_mfma_f32_16x16x32_bf16 v[104:107], v[60:63], v[196:199], v[104:107]
  s_add_u32 s39, s34, 8320
  s_add_u32 m0, s35, 5120
  v_mfma_f32_16x16x32_bf16 v[108:111], v[60:63], v[212:215], v[108:111]
  buffer_load_dwordx4 v19, s[8:11], s39 offen sc1 lds
  v_mfma_f32_16x16x32_bf16 v[112:115], v[60:63], v[228:231], v[112:115]
  s_add_u32 s39, s34, 24704
  s_add_u32 m0, s35, 7168
  v_mfma_f32_16x16x32_bf16 v[116:119], v[60:63], v[244:247], v[116:119]
  buffer_load_dwordx4 v19, s[8:11], s39 offen sc1 lds
  v_xor_b32 v19, 64, v19
  v_mfma_f32_16x16x32_bf16 v[88:91], v[64:67], v[136:139], v[88:91]
  v_mfma_f32_16x16x32_bf16 v[92:95], v[64:67], v[152:155], v[92:95]
  v_mfma_f32_16x16x32_bf16 v[96:99], v[64:67], v[168:171], v[96:99]
  v_mfma_f32_16x16x32_bf16 v[100:103], v[64:67], v[184:187], v[100:103]
  v_mfma_f32_16x16x32_bf16 v[104:107], v[64:67], v[200:203], v[104:107]
  v_mfma_f32_16x16x32_bf16 v[108:111], v[64:67], v[216:219], v[108:111]
  v_mfma_f32_16x16x32_bf16 v[112:115], v[64:67], v[232:235], v[112:115]
  v_mfma_f32_16x16x32_bf16 v[116:119], v[64:67], v[248:251], v[116:119]
  v_mfma_f32_16x16x32_bf16 v[88:91], v[68:71], v[140:143], v[88:91]
  v_mfma_f32_16x16x32_bf16 v[92:95], v[68:71], v[156:159], v[92:95]
  v_mfma_f32_16x16x32_bf16 v[96:99], v[68:71], v[172:175], v[96:99]
  v_mfma_f32_16x16x32_bf16 v[100:103], v[68:71], v[188:191], v[100:103]
  v_mfma_f32_16x16x32_bf16 v[104:107], v[68:71], v[204:207], v[104:107]
  v_mfma_f32_16x16x32_bf16 v[108:111], v[68:71], v[220:223], v[108:111]
  v_mfma_f32_16x16x32_bf16 v[112:115], v[68:71], v[236:239], v[112:115]
  v_mfma_f32_16x16x32_bf16 v[116:119], v[68:71], v[252:255], v[116:119]
  v_mfma_f32_16x16x32_bf16 v[28:31], v[72:75], v[128:131], 0
  v_mfma_f32_16x16x32_bf16 v[32:35], v[72:75], v[144:147], 0
  v_mfma_f32_16x16x32_bf16 v[36:39], v[72:75], v[160:163], 0
  v_cvt_pk_bf16_f32 v60, v88, v92
  v_mfma_f32_16x16x32_bf16 v[40:43], v[72:75], v[176:179], 0
  v_cvt_pk_bf16_f32 v61, v96, v100
  v_mfma_f32_16x16x32_bf16 v[44:47], v[72:75], v[192:195], 0
  v_cvt_pk_bf16_f32 v62, v104, v108
  v_mfma_f32_16x16x32_bf16 v[48:51], v[72:75], v[208:211], 0
  v_cvt_pk_bf16_f32 v63, v112, v116
  v_mfma_f32_16x16x32_bf16 v[52:55], v[72:75], v[224:227], 0
  s_add_u32 s36, s45, 0
  buffer_store_dwordx4 v[60:63], v18, s[8:11], s36 offen sc1
  v_mfma_f32_16x16x32_bf16 v[56:59], v[72:75], v[240:243], 0
  v_cvt_pk_bf16_f32 v64, v89, v93
  v_mfma_f32_16x16x32_bf16 v[28:31], v[76:79], v[132:135], v[28:31]
  v_cvt_pk_bf16_f32 v65, v97, v101
  v_mfma_f32_16x16x32_bf16 v[32:35], v[76:79], v[148:151], v[32:35]
  v_cvt_pk_bf16_f32 v66, v105, v109
  v_mfma_f32_16x16x32_bf16 v[36:39], v[76:79], v[164:167], v[36:39]
  v_cvt_pk_bf16_f32 v67, v113, v117
  v_mfma_f32_16x16x32_bf16 v[40:43], v[76:79], v[180:183], v[40:43]
  s_add_u32 s36, s45, 32768
  buffer_store_dwordx4 v[64:67], v18, s[8:11], s36 offen sc1
  v_mfma_f32_16x16x32_bf16 v[44:47], v[76:79], v[196:199], v[44:47]
  v_cvt_pk_bf16_f32 v60, v90, v94
  v_mfma_f32_16x16x32_bf16 v[48:51], v[76:79], v[212:215], v[48:51]
  v_cvt_pk_bf16_f32 v61, v98, v102
  v_mfma_f32_16x16x32_bf16 v[52:55], v[76:79], v[228:231], v[52:55]
  v_cvt_pk_bf16_f32 v62, v106, v110
  v_mfma_f32_16x16x32_bf16 v[56:59], v[76:79], v[244:247], v[56:59]
  v_cvt_pk_bf16_f32 v63, v114, v118
  v_mfma_f32_16x16x32_bf16 v[28:31], v[80:83], v[136:139], v[28:31]
  s_add_u32 s36, s45, 65536
  buffer_store_dwordx4 v[60:63], v18, s[8:11], s36 offen sc1
  v_mfma_f32_16x16x32_bf16 v[32:35], v[80:83], v[152:155], v[32:35]
  v_cvt_pk_bf16_f32 v64, v91, v95
  v_mfma_f32_16x16x32_bf16 v[36:39], v[80:83], v[168:171], v[36:39]
  v_cvt_pk_bf16_f32 v65, v99, v103
  v_mfma_f32_16x16x32_bf16 v[40:43], v[80:83], v[184:187], v[40:43]
  v_cvt_pk_bf16_f32 v66, v107, v111
  v_mfma_f32_16x16x32_bf16 v[44:47], v[80:83], v[200:203], v[44:47]
  v_cvt_pk_bf16_f32 v67, v115, v119
  v_mfma_f32_16x16x32_bf16 v[48:51], v[80:83], v[216:219], v[48:51]
  s_add_u32 s36, s45, 98304
  buffer_store_dwordx4 v[64:67], v18, s[8:11], s36 offen sc1
  v_mfma_f32_16x16x32_bf16 v[52:55], v[80:83], v[232:235], v[52:55]
  v_mfma_f32_16x16x32_bf16 v[56:59], v[80:83], v[248:251], v[56:59]
  v_mfma_f32_16x16x32_bf16 v[28:31], v[84:87], v[140:143], v[28:31]
  v_mfma_f32_16x16x32_bf16 v[32:35], v[84:87], v[156:159], v[32:35]
  v_mfma_f32_16x16x32_bf16 v[36:39], v[84:87], v[172:175], v[36:39]
  v_mfma_f32_16x16x32_bf16 v[40:43], v[84:87], v[188:191], v[40:43]
  v_mfma_f32_16x16x32_bf16 v[44:47], v[84:87], v[204:207], v[44:47]
  v_mfma_f32_16x16x32_bf16 v[48:51], v[84:87], v[220:223], v[48:51]
  v_mfma_f32_16x16x32_bf16 v[52:55], v[84:87], v[236:239], v[52:55]
  v_mfma_f32_16x16x32_bf16 v[56:59], v[84:87], v[252:255], v[56:59]
  v_cvt_pk_bf16_f32 v60, v28, v32
  v_cvt_pk_bf16_f32 v61, v36, v40
  v_cvt_pk_bf16_f32 v62, v44, v48
  s_nop 3
  v_cvt_pk_bf16_f32 v63, v52, v56
  s_add_u32 s36, s45, 524288
  buffer_store_dwordx4 v[60:63], v18, s[8:11], s36 offen sc1
  v_cvt_pk_bf16_f32 v64, v29, v33
  v_cvt_pk_bf16_f32 v65, v37, v41
  v_cvt_pk_bf16_f32 v66, v45, v49
  v_cvt_pk_bf16_f32 v67, v53, v57
  s_add_u32 s36, s45, 557056
  buffer_store_dwordx4 v[64:67], v18, s[8:11], s36 offen sc1
  v_cvt_pk_bf16_f32 v60, v30, v34
  v_cvt_pk_bf16_f32 v61, v38, v42
  v_cvt_pk_bf16_f32 v62, v46, v50
  v_cvt_pk_bf16_f32 v63, v54, v58
  s_add_u32 s36, s45, 589824
  buffer_store_dwordx4 v[60:63], v18, s[8:11], s36 offen sc1
  v_cvt_pk_bf16_f32 v64, v31, v35
  v_cvt_pk_bf16_f32 v65, v39, v43
  v_cvt_pk_bf16_f32 v66, v47, v51
  v_cvt_pk_bf16_f32 v67, v55, v59
  s_add_u32 s36, s45, 622592
  buffer_store_dwordx4 v[64:67], v18, s[8:11], s36 offen sc1
  s_add_u32 s43, s43, 1
  s_lshl_b32 s33, s5, 2
  s_add_u32 s33, s33, s47
  v_mov_b32 v0, s43
  s_waitcnt vmcnt(0)
  s_mov_b64 exec, 1
  buffer_store_dword v0, off, s[8:11], s33 sc1
  s_mov_b64 exec, -1
  s_xor_b32 s45, s45, 0x100000
  s_barrier
  ds_read_b128 v[60:63], v6 offset:0
  ds_read_b128 v[64:67], v6 offset:2048
  v_xor_b32 v6, 64, v6
  ds_read_b128 v[68:71], v6 offset:0
  ds_read_b128 v[72:75], v6 offset:2048
  v_xor_b32 v6, 64, v6
  ds_read_b128 v[76:79], v6 offset:4096
  ds_read_b128 v[80:83], v6 offset:6144
  v_xor_b32 v6, 64, v6
  s_waitcnt lgkmcnt(4)
  v_mfma_f32_16x16x32_bf16 v[28:31], a[0:3], v[60:63], 0
  ds_read_b128 v[84:87], v6 offset:4096
  v_mfma_f32_16x16x32_bf16 v[32:35], a[0:3], v[64:67], 0
  ds_read_b128 v[88:91], v6 offset:6144
  v_mfma_f32_16x16x32_bf16 v[36:39], a[8:11], v[60:63], 0
  v_xor_b32 v6, 64, v6
  v_mfma_f32_16x16x32_bf16 v[40:43], a[8:11], v[64:67], 0
  v_mfma_f32_16x16x32_bf16 v[44:47], v[60:63], a[128:131], 0
  v_mfma_f32_16x16x32_bf16 v[48:51], v[64:67], a[128:131], 0
  v_mfma_f32_16x16x32_bf16 v[52:55], v[60:63], a[136:139], 0
  v_mfma_f32_16x16x32_bf16 v[56:59], v[64:67], a[136:139], 0
  s_waitcnt lgkmcnt(4)
  v_mfma_f32_16x16x32_bf16 v[28:31], a[4:7], v[68:71], v[28:31]
  ds_read_b128 v[60:63], v7 offset:0
  v_mfma_f32_16x16x32_bf16 v[32:35], a[4:7], v[72:75], v[32:35]
  ds_read_b128 v[64:67], v7 offset:2048
  v_mfma_f32_16x16x32_bf16 v[36:39], a[12:15], v[68:71], v[36:39]
  v_xor_b32 v7, 64, v7
  v_mfma_f32_16x16x32_bf16 v[40:43], a[12:15], v[72:75], v[40:43]
  v_mfma_f32_16x16x32_bf16 v[44:47], v[68:71], a[132:135], v[44:47]
  v_mfma_f32_16x16x32_bf16 v[48:51], v[72:75], a[132:135], v[48:51]
  v_mfma_f32_16x16x32_bf16 v[52:55], v[68:71], a[140:143], v[52:55]
  v_mfma_f32_16x16x32_bf16 v[56:59], v[72:75], a[140:143], v[56:59]
  s_waitcnt lgkmcnt(4)
  v_mfma_f32_16x16x32_bf16 v[28:31], a[16:19], v[76:79], v[28:31]
  ds_read_b128 v[68:71], v7 offset:0
  v_mfma_f32_16x16x32_bf16 v[32:35], a[16:19], v[80:83], v[32:35]
  ds_read_b128 v[72:75], v7 offset:2048
  v_mfma_f32_16x16x32_bf16 v[36:39], a[24:27], v[76:79], v[36:39]
  v_xor_b32 v7, 64, v7
  v_mfma_f32_16x16x32_bf16 v[40:43], a[24:27], v[80:83], v[40:43]
  v_mfma_f32_16x16x32_bf16 v[44:47], v[76:79], a[144:147], v[44:47]
  v_mfma_f32_16x16x32_bf16 v[48:51], v[80:83], a[144:147], v[48:51]
  v_mfma_f32_16x16x32_bf16 v[52:55], v[76:79], a[152:155], v[52:55]
  v_mfma_f32_16x16x32_bf16 v[56:59], v[80:83], a[152:155], v[56:59]
  s_waitcnt lgkmcnt(4)
  v_mfma_f32_16x16x32_bf16 v[28:31], a[20:23], v[84:87], v[28:31]
  ds_read_b128 v[76:79], v7 offset:4096
  v_mfma_f32_16x16x32_bf16 v[32:35], a[20:23], v[88:91], v[32:35]
  ds_read_b128 v[80:83], v7 offset:6144
  v_mfma_f32_16x16x32_bf16 v[36:39], a[28:31], v[84:87], v[36:39]
  v_xor_b32 v7, 64, v7
  v_mfma_f32_16x16x32_bf16 v[40:43], a[28:31], v[88:91], v[40:43]
  v_mfma_f32_16x16x32_bf16 v[44:47], v[84:87], a[148:151], v[44:47]
  v_mfma_f32_16x16x32_bf16 v[48:51], v[88:91], a[148:151], v[48:51]
  v_mfma_f32_16x16x32_bf16 v[52:55], v[84:87], a[156:159], v[52:55]
  v_mfma_f32_16x16x32_bf16 v[56:59], v[88:91], a[156:159], v[56:59]
  s_waitcnt lgkmcnt(4)
  v_mfma_f32_16x16x32_bf16 v[28:31], a[32:35], v[60:63], v[28:31]
  ds_read_b128 v[84:87], v7 offset:4096
  v_mfma_f32_16x16x32_bf16 v[32:35], a[32:35], v[64:67], v[32:35]
  ds_read_b128 v[88:91], v7 offset:6144
  v_mfma_f32_16x16x32_bf16 v[36:39], a[40:43], v[60:63], v[36:39]
  v_xor_b32 v7, 64, v7
  v_mfma_f32_16x16x32_bf16 v[40:43], a[40:43], v[64:67], v[40:43]
  v_mfma_f32_16x16x32_bf16 v[44:47], v[60:63], a[160:163], v[44:47]
  v_mfma_f32_16x16x32_bf16 v[48:51], v[64:67], a[160:163], v[48:51]
  v_mfma_f32_16x16x32_bf16 v[52:55], v[60:63], a[168:171], v[52:55]
  v_mfma_f32_16x16x32_bf16 v[56:59], v[64:67], a[168:171], v[56:59]
  s_waitcnt lgkmcnt(4)
  v_mfma_f32_16x16x32_bf16 v[28:31], a[36:39], v[68:71], v[28:31]
  ds_read_b128 v[60:63], v8 offset:0
  v_mfma_f32_16x16x32_bf16 v[32:35], a[36:39], v[72:75], v[32:35]
  ds_read_b128 v[64:67], v8 offset:2048
  v_mfma_f32_16x16x32_bf16 v[36:39], a[44:47], v[68:71], v[36:39]
  v_xor_b32 v8, 64, v8
  v_mfma_f32_16x16x32_bf16 v[40:43], a[44:47], v[72:75], v[40:43]
  v_mfma_f32_16x16x32_bf16 v[44:47], v[68:71], a[164:167], v[44:47]
  v_mfma_f32_16x16x32_bf16 v[48:51], v[72:75], a[164:167], v[48:51]
  v_mfma_f32_16x16x32_bf16 v[52:55], v[68:71], a[172:175], v[52:55]
  v_mfma_f32_16x16x32_bf16 v[56:59], v[72:75], a[172:175], v[56:59]
  s_waitcnt lgkmcnt(4)
  v_mfma_f32_16x16x32_bf16 v[28:31], a[48:51], v[76:79], v[28:31]
  ds_read_b128 v[68:71], v8 offset:0
  v_mfma_f32_16x16x32_bf16 v[32:35], a[48:51], v[80:83], v[32:35]
  ds_read_b128 v[72:75], v8 offset:2048
  v_mfma_f32_16x16x32_bf16 v[36:39], a[56:59], v[76:79], v[36:39]
  v_xor_b32 v8, 64, v8
  v_mfma_f32_16x16x32_bf16 v[40:43], a[56:59], v[80:83], v[40:43]
  v_mfma_f32_16x16x32_bf16 v[44:47], v[76:79], a[176:179], v[44:47]
  v_mfma_f32_16x16x32_bf16 v[48:51], v[80:83], a[176:179], v[48:51]
  v_mfma_f32_16x16x32_bf16 v[52:55], v[76:79], a[184:187], v[52:55]
  v_mfma_f32_16x16x32_bf16 v[56:59], v[80:83], a[184:187], v[56:59]
  s_waitcnt lgkmcnt(4)
  v_mfma_f32_16x16x32_bf16 v[28:31], a[52:55], v[84:87], v[28:31]
  ds_read_b128 v[76:79], v8 offset:4096
  v_mfma_f32_16x16x32_bf16 v[32:35], a[52:55], v[88:91], v[32:35]
  ds_read_b128 v[80:83], v8 offset:6144
  v_mfma_f32_16x16x32_bf16 v[36:39], a[60:63], v[84:87], v[36:39]
  v_xor_b32 v8, 64, v8
  v_mfma_f32_16x16x32_bf16 v[40:43], a[60:63], v[88:91], v[40:43]
  v_mfma_f32_16x16x32_bf16 v[44:47], v[84:87], a[180:183], v[44:47]
  v_mfma_f32_16x16x32_bf16 v[48:51], v[88:91], a[180:183], v[48:51]
  v_mfma_f32_16x16x32_bf16 v[52:55], v[84:87], a[188:191], v[52:55]
  v_mfma_f32_16x16x32_bf16 v[56:59], v[88:91], a[188:191], v[56:59]
  s_waitcnt lgkmcnt(4)
  v_mfma_f32_16x16x32_bf16 v[28:31], a[64:67], v[60:63], v[28:31]
  ds_read_b128 v[84:87], v8 offset:4096
  v_mfma_f32_16x16x32_bf16 v[32:35], a[64:67], v[64:67], v[32:35]
  ds_read_b128 v[88:91], v8 offset:6144
  v_mfma_f32_16x16x32_bf16 v[36:39], a[72:75], v[60:63], v[36:39]
  v_xor_b32 v8, 64, v8
  v_mfma_f32_16x16x32_bf16 v[40:43], a[72:75], v[64:67], v[40:43]
  v_mfma_f32_16x16x32_bf16 v[44:47], v[60:63], a[192:195], v[44:47]
  v_mfma_f32_16x16x32_bf16 v[48:51], v[64:67], a[192:195], v[48:51]
  v_mfma_f32_16x16x32_bf16 v[52:55], v[60:63], a[200:203], v[52:55]
  v_mfma_f32_16x16x32_bf16 v[56:59], v[64:67], a[200:203], v[56:59]
  s_waitcnt lgkmcnt(4)
  v_mfma_f32_16x16x32_bf16 v[28:31], a[68:71], v[68:71], v[28:31]
  ds_read_b128 v[60:63], v9 offset:0
  v_mfma_f32_16x16x32_bf16 v[32:35], a[68:71], v[72:75], v[32:35]
  ds_read_b128 v[64:67], v9 offset:2048
  v_mfma_f32_16x16x32_bf16 v[36:39], a[76:79], v[68:71], v[36:39]
  v_xor_b32 v9, 64, v9
  v_mfma_f32_16x16x32_bf16 v[40:43], a[76:79], v[72:75], v[40:43]
  buffer_load_dword v108, v23, s[8:11], s47 offen sc1
  v_mfma_f32_16x16x32_bf16 v[44:47], v[68:71], a[196:199], v[44:47]
  v_mfma_f32_16x16x32_bf16 v[48:51], v[72:75], a[196:199], v[48:51]
  v_mfma_f32_16x16x32_bf16 v[52:55], v[68:71], a[204:207], v[52:55]
  v_mfma_f32_16x16x32_bf16 v[56:59], v[72:75], a[204:207], v[56:59]
  s_waitcnt lgkmcnt(4)
  v_mfma_f32_16x16x32_bf16 v[28:31], a[80:83], v[76:79], v[28:31]
  ds_read_b128 v[68:71], v9 offset:0
  v_mfma_f32_16x16x32_bf16 v[32:35], a[80:83], v[80:83], v[32:35]
  ds_read_b128 v[72:75], v9 offset:2048
  v_mfma_f32_16x16x32_bf16 v[36:39], a[88:91], v[76:79], v[36:39]
  v_xor_b32 v9, 64, v9
  v_mfma_f32_16x16x32_bf16 v[40:43], a[88:91], v[80:83], v[40:43]
  v_mfma_f32_16x16x32_bf16 v[44:47], v[76:79], a[208:211], v[44:47]
  v_mfma_f32_16x16x32_bf16 v[48:51], v[80:83], a[208:211], v[48:51]
  v_mfma_f32_16x16x32_bf16 v[52:55], v[76:79], a[216:219], v[52:55]
  v_mfma_f32_16x16x32_bf16 v[56:59], v[80:83], a[216:219], v[56:59]
  s_waitcnt lgkmcnt(4)
  v_mfma_f32_16x16x32_bf16 v[28:31], a[84:87], v[84:87], v[28:31]
  ds_read_b128 v[76:79], v9 offset:4096
  v_mfma_f32_16x16x32_bf16 v[32:35], a[84:87], v[88:91], v[32:35]
  ds_read_b128 v[80:83], v9 offset:6144
  v_mfma_f32_16x16x32_bf16 v[36:39], a[92:95], v[84:87], v[36:39]
  v_xor_b32 v9, 64, v9
  v_mfma_f32_16x16x32_bf16 v[40:43], a[92:95], v[88:91], v[40:43]
  v_mfma_f32_16x16x32_bf16 v[44:47], v[84:87], a[212:215], v[44:47]
  v_mfma_f32_16x16x32_bf16 v[48:51], v[88:91], a[212:215], v[48:51]
  v_mfma_f32_16x16x32_bf16 v[52:55], v[84:87], a[220:223], v[52:55]
  v_mfma_f32_16x16x32_bf16 v[56:59], v[88:91], a[220:223], v[56:59]
  s_waitcnt lgkmcnt(4)
  v_mfma_f32_16x16x32_bf16 v[28:31], a[96:99], v[60:63], v[28:31]
  ds_read_b128 v[84:87], v9 offset:4096
  v_mfma_f32_16x16x32_bf16 v[32:35], a[96:99], v[64:67], v[32:35]
  ds_read_b128 v[88:91], v9 offset:6144
  v_mfma_f32_16x16x32_bf16 v[36:39], a[104:107], v[60:63], v[36:39]
  v_xor_b32 v9, 64, v9
  v_mfma_f32_16x16x32_bf16 v[40:43], a[104:107], v[64:67], v[40:43]
  v_mfma_f32_16x16x32_bf16 v[44:47], v[60:63], a[224:227], v[44:47]
  v_mfma_f32_16x16x32_bf16 v[48:51], v[64:67], a[224:227], v[48:51]
  v_mfma_f32_16x16x32_bf16 v[52:55], v[60:63], a[232:235], v[52:55]
  v_mfma_f32_16x16x32_bf16 v[56:59], v[64:67], a[232:235], v[56:59]
  s_waitcnt lgkmcnt(4)
  v_mfma_f32_16x16x32_bf16 v[28:31], a[100:103], v[68:71], v[28:31]
  s_lshl_b32 s33, s48, 18
  v_mfma_f32_16x16x32_bf16 v[32:35], a[100:103], v[72:75], v[32:35]
  s_lshl_b32 s34, s5, 13
  v_mfma_f32_16x16x32_bf16 v[36:39], a[108:111], v[68:71], v[36:39]
  s_add_u32 s33, s33, s34
  v_mfma_f32_16x16x32_bf16 v[40:43], a[108:111], v[72:75], v[40:43]
  s_add_u32 s34, s33, 16777216
  v_mfma_f32_16x16x32_bf16 v[44:47], v[68:71], a[228:231], v[44:47]
  s_add_u32 s35, s33, 33554432
  v_mfma_f32_16x16x32_bf16 v[48:51], v[72:75], a[228:231], v[48:51]
  v_mfma_f32_16x16x32_bf16 v[52:55], v[68:71], a[236:239], v[52:55]
  v_mfma_f32_16x16x32_bf16 v[56:59], v[72:75], a[236:239], v[56:59]
  s_waitcnt lgkmcnt(2)
  v_mfma_f32_16x16x32_bf16 v[28:31], a[112:115], v[76:79], v[28:31]
  s_lshl_b32 s33, s5, 10
  v_mfma_f32_16x16x32_bf16 v[32:35], a[112:115], v[80:83], v[32:35]
  s_lshl_b32 s37, s48, 4
  v_mfma_f32_16x16x32_bf16 v[36:39], a[120:123], v[76:79], v[36:39]
  s_add_u32 s33, s33, s37
  v_mfma_f32_16x16x32_bf16 v[40:43], a[120:123], v[80:83], v[40:43]
  s_lshl_b32 s37, s3, 2
  v_mfma_f32_16x16x32_bf16 v[44:47], v[76:79], a[240:243], v[44:47]
  s_add_u32 s33, s33, s37
  v_mfma_f32_16x16x32_bf16 v[48:51], v[80:83], a[240:243], v[48:51]
  s_add_u32 s37, s33, 0
  v_mfma_f32_16x16x32_bf16 v[52:55], v[76:79], a[248:251], v[52:55]
  v_mfma_f32_16x16x32_bf16 v[56:59], v[80:83], a[248:251], v[56:59]
  s_waitcnt lgkmcnt(0)
  s_barrier
  v_mfma_f32_16x16x32_bf16 v[28:31], a[116:119], v[84:87], v[28:31]
  v_mfma_f32_16x16x32_bf16 v[32:35], a[116:119], v[88:91], v[32:35]
  v_mfma_f32_16x16x32_bf16 v[36:39], a[124:127], v[84:87], v[36:39]
  v_mfma_f32_16x16x32_bf16 v[40:43], a[124:127], v[88:91], v[40:43]
  v_mfma_f32_16x16x32_bf16 v[44:47], v[84:87], a[244:247], v[44:47]
  v_mfma_f32_16x16x32_bf16 v[48:51], v[88:91], a[244:247], v[48:51]
  v_mfma_f32_16x16x32_bf16 v[52:55], v[84:87], a[252:255], v[52:55]
  v_mfma_f32_16x16x32_bf16 v[56:59], v[88:91], a[252:255], v[56:59]
  s_waitcnt vmcnt(0)
  v_cmp_gt_u32 vcc, s43, v108
  s_cbranch_vccz AGPOK_39
AGP_38:
  buffer_load_dword v108, v23, s[8:11], s47 offen sc1
  s_waitcnt vmcnt(0)
  v_cmp_gt_u32 vcc, s43, v108
  s_cbranch_vccz AGPOK_39
  s_sleep 1
  s_sub_u32 s6, s6, 1
  s_cbranch_scc1 GIVEUP
  s_branch AGP_38
AGPOK_39:
  buffer_load_dwordx4 v[60:63], v20, s[8:11], s46 offen sc1
  s_add_u32 s36, s46, 4096
  buffer_load_dwordx4 v[64:67], v20, s[8:11], s36 offen sc1
  s_add_u32 s36, s46, 8192
  buffer_load_dwordx4 v[68:71], v20, s[8:11], s36 offen sc1
  s_add_u32 s36, s46, 12288
  buffer_load_dwordx4 v[72:75], v20, s[8:11], s36 offen sc1
  s_add_u32 s36, s46, 16384
  buffer_load_dwordx4 v[76:79], v20, s[8:11], s36 offen sc1
  s_add_u32 s36, s46, 20480
  buffer_load_dwordx4 v[80:83], v20, s[8:11], s36 offen sc1
  s_add_u32 s36, s46, 24576
  buffer_load_dwordx4 v[84:87], v20, s[8:11], s36 offen sc1
  s_add_u32 s36, s46, 28672
  buffer_load_dwordx4 v[88:91], v20, s[8:11], s36 offen sc1
  s_xor_b32 s46, s46, 0x100000
  v_cvt_pk_bf16_f32 v104, v28, v29
  v_cvt_pk_bf16_f32 v105, v30, v31
  v_cvt_pk_bf16_f32 v106, v36, v37
  v_cvt_pk_bf16_f32 v107, v38, v39
  buffer_store_dwordx4 v[104:107], v1, s[8:11], s34 offen offset:0 sc1
  v_cvt_pk_bf16_f32 v108, v32, v33
  v_cvt_pk_bf16_f32 v109, v34, v35
  v_cvt_pk_bf16_f32 v110, v40, v41
  v_cvt_pk_bf16_f32 v111, v42, v43
  buffer_store_dwordx4 v[108:111], v1, s[8:11], s34 offen offset:1024 sc1
  v_cvt_pk_bf16_f32 v112, v44, v45
  v_cvt_pk_bf16_f32 v113, v46, v47
  v_cvt_pk_bf16_f32 v114, v48, v49
  v_cvt_pk_bf16_f32 v115, v50, v51
  buffer_store_dwordx4 v[112:115], v1, s[8:11], s35 offen offset:0 sc1
  v_cvt_pk_bf16_f32 v116, v52, v53
  v_cvt_pk_bf16_f32 v117, v54, v55
  v_cvt_pk_bf16_f32 v118, v56, v57
  v_cvt_pk_bf16_f32 v119, v58, v59
  buffer_store_dwordx4 v[116:119], v1, s[8:11], s35 offen offset:1024 sc1
  v_cndmask_b32 v92, 0, v22, s[52:53]
  v_cndmask_b32 v93, 0, v22, s[54:55]
  v_cndmask_b32 v94, 0, v22, s[56:57]
  v_cndmask_b32 v95, 0, v22, s[58:59]
  s_waitcnt vmcnt(11)
  s_nop 0
  v_mfma_f32_16x16x32_bf16 v[96:99], v[92:95], v[60:63], 0
  s_waitcnt vmcnt(10)
  v_mfma_f32_16x16x32_bf16 v[96:99], v[92:95], v[64:67], v[96:99]
  s_waitcnt vmcnt(9)
  v_mfma_f32_16x16x32_bf16 v[96:99], v[92:95], v[68:71], v[96:99]
  s_waitcnt vmcnt(8)
  v_mfma_f32_16x16x32_bf16 v[96:99], v[92:95], v[72:75], v[96:99]
  s_waitcnt vmcnt(7)
  v_mfma_f32_16x16x32_bf16 v[96:99], v[92:95], v[76:79], v[96:99]
  s_waitcnt vmcnt(6)
  v_mfma_f32_16x16x32_bf16 v[96:99], v[92:95], v[80:83], v[96:99]
  s_waitcnt vmcnt(5)
  v_mfma_f32_16x16x32_bf16 v[96:99], v[92:95], v[84:87], v[96:99]
  s_waitcnt vmcnt(4)
  v_mfma_f32_16x16x32_bf16 v[96:99], v[92:95], v[88:91], v[96:99]
  v_and_b32 v121, 0xffff0000, v120
  v_lshlrev_b32 v120, 16, v120
  s_nop 4
  v_cvt_pk_bf16_f32 v0, v96, v97
  v_and_b32 v97, 0xffff0000, v0
  v_lshlrev_b32 v96, 16, v0
  v_mul_f32 v96, v96, v122
  v_mul_f32 v97, v97, v123
  v_cvt_pk_bf16_f32 v0, v96, v97
  v_and_b32 v97, 0xffff0000, v0
  v_lshlrev_b32 v96, 16, v0
  v_add_f32 v96, v96, v120
  v_add_f32 v97, v97, v121
  v_cvt_pk_bf16_f32 v100, v96, v97
  v_and_b32 v97, 0xffff0000, v100
  v_lshlrev_b32 v96, 16, v100
  v_min_u32 v100, -2, v100
  s_add_u32 s34, s41, 6291456
  buffer_store_dword v100, v21, s[8:11], s34 offen sc1
  v_add_f32 v102, v96, v97
  s_nop 1
  v_add_f32_dpp v102, v102, v102 row_ror:1 row_mask:0xf bank_mask:0xf
  s_nop 1
  v_add_f32_dpp v102, v102, v102 row_ror:2 row_mask:0xf bank_mask:0xf
  s_nop 1
  v_add_f32_dpp v102, v102, v102 row_ror:4 row_mask:0xf bank_mask:0xf
  s_nop 1
  v_add_f32_dpp v102, v102, v102 row_ror:8 row_mask:0xf bank_mask:0xf
  v_mov_b32 v0, v102
  s_nop 1
  v_permlane16_swap_b32 v102, v0
  v_add_f32 v102, v102, v0
  v_mov_b32 v0, v102
  s_nop 1
  v_permlane32_swap_b32 v102, v0
  v_add_f32 v102, v102, v0
  v_mul_f32 v102, 0x3c000000, v102
  v_sub_f32 v24, v96, v102
  v_sub_f32 v25, v97, v102
  v_mul_f32 v103, v24, v24
  v_fmac_f32 v103, v25, v25
  s_nop 1
  v_add_f32_dpp v103, v103, v103 row_ror:1 row_mask:0xf bank_mask:0xf
  s_nop 1
  v_add_f32_dpp v103, v103, v103 row_ror:2 row_mask:0xf bank_mask:0xf
  s_nop 1
  v_add_f32_dpp v103, v103, v103 row_ror:4 row_mask:0xf bank_mask:0xf
  s_nop 1
  v_add_f32_dpp v103, v103, v103 row_ror:8 row_mask:0xf bank_mask:0xf
  v_mov_b32 v0, v103
  s_nop 1
  v_permlane16_swap_b32 v103, v0
  v_add_f32 v103, v103, v0
  v_mov_b32 v0, v103
  s_nop 1
  v_permlane32_swap_b32 v103, v0
  v_add_f32 v103, v103, v0
  s_lshl_b32 s33, s3, 3
  s_add_u32 s33, s33, 28672
  v_mov_b32 v0, s33
  s_mov_b64 exec, 1
  ds_write_b64 v0, v[102:103]
  s_mov_b64 exec, -1
  v_mov_b32 v0, 2
  s_waitcnt vmcnt(1)
  s_mov_b64 exec, 1
  buffer_store_dword v0, off, s[8:11], s37 sc1
  s_mov_b64 exec, -1
  s_branch AS_NORM
AS_NOKV:
  v_mfma_f32_16x16x32_bf16 v[88:91], v[56:59], v[128:131], 0
  v_mfma_f32_16x16x32_bf16 v[92:95], v[56:59], v[144:147], 0
  v_mfma_f32_16x16x32_bf16 v[96:99], v[56:59], v[160:163], 0
  v_mfma_f32_16x16x32_bf16 v[100:103], v[56:59], v[176:179], 0
  v_mfma_f32_16x16x32_bf16 v[104:107], v[56:59], v[192:195], 0
  v_mfma_f32_16x16x32_bf16 v[108:111], v[56:59], v[208:211], 0
  v_mfma_f32_16x16x32_bf16 v[112:115], v[56:59], v[224:227], 0
  v_mfma_f32_16x16x32_bf16 v[116:119], v[56:59], v[240:243], 0
  v_mfma_f32_16x16x32_bf16 v[88:91], v[60:63], v[132:135], v[88:91]
  v_mfma_f32_16x16x32_bf16 v[92:95], v[60:63], v[148:151], v[92:95]
  v_mfma_f32_16x16x32_bf16 v[96:99], v[60:63], v[164:167], v[96:99]
  v_mfma_f32_16x16x32_bf16 v[100:103], v[60:63], v[180:183], v[100:103]
  v_mfma_f32_16x16x32_bf16 v[104:107], v[60:63], v[196:199], v[104:107]
  v_mfma_f32_16x16x32_bf16 v[108:111], v[60:63], v[212:215], v[108:111]
  v_mfma_f32_16x16x32_bf16 v[112:115], v[60:63], v[228:231], v[112:115]
  v_mfma_f32_16x16x32_bf16 v[116:119], v[60:63], v[244:247], v[116:119]
  v_mfma_f32_16x16x32_bf16 v[88:91], v[64:67], v[136:139], v[88:91]
  v_mfma_f32_16x16x32_bf16 v[92:95], v[64:67], v[152:155], v[92:95]
  v_mfma_f32_16x16x32_bf16 v[96:99], v[64:67], v[168:171], v[96:99]
  v_mfma_f32_16x16x32_bf16 v[100:103], v[64:67], v[184:187], v[100:103]
  v_mfma_f32_16x16x32_bf16 v[104:107], v[64:67], v[200:203], v[104:107]
  v_mfma_f32_16x16x32_bf16 v[108:111], v[64:67], v[216:219], v[108:111]
  v_mfma_f32_16x16x32_bf16 v[112:115], v[64:67], v[232:235], v[112:115]
  v_mfma_f32_16x16x32_bf16 v[116:119], v[64:67], v[248:251], v[116:119]
  v_mfma_f32_16x16x32_bf16 v[88:91], v[68:71], v[140:143], v[88:91]
  v_mfma_f32_16x16x32_bf16 v[92:95], v[68:71], v[156:159], v[92:95]
  v_mfma_f32_16x16x32_bf16 v[96:99], v[68:71], v[172:175], v[96:99]
  v_mfma_f32_16x16x32_bf16 v[100:103], v[68:71], v[188:191], v[100:103]
  v_mfma_f32_16x16x32_bf16 v[104:107], v[68:71], v[204:207], v[104:107]
  v_mfma_f32_16x16x32_bf16 v[108:111], v[68:71], v[220:223], v[108:111]
  v_mfma_f32_16x16x32_bf16 v[112:115], v[68:71], v[236:239], v[112:115]
  v_mfma_f32_16x16x32_bf16 v[116:119], v[68:71], v[252:255], v[116:119]
  v_mfma_f32_16x16x32_bf16 v[28:31], v[72:75], v[128:131], 0
  v_mfma_f32_16x16x32_bf16 v[32:35], v[72:75], v[144:147], 0
  v_mfma_f32_16x16x32_bf16 v[36:39], v[72:75], v[160:163], 0
  v_cvt_pk_bf16_f32 v60, v88, v92
  v_mfma_f32_16x16x32_bf16 v[40:43], v[72:75], v[176:179], 0
  v_cvt_pk_bf16_f32 v61, v96, v100
  v_mfma_f32_16x16x32_bf16 v[44:47], v[72:75], v[192:195], 0
  v_cvt_pk_bf16_f32 v62, v104, v108
  v_mfma_f32_16x16x32_bf16 v[48:51], v[72:75], v[208:211], 0
  v_cvt_pk_bf16_f32 v63, v112, v116
  v_mfma_f32_16x16x32_bf16 v[52:55], v[72:75], v[224:227], 0
  s_add_u32 s36, s45, 0
  buffer_store_dwordx4 v[60:63], v18, s[8:11], s36 offen sc1
  v_mfma_f32_16x16x32_bf16 v[56:59], v[72:75], v[240:243], 0
  v_cvt_pk_bf16_f32 v64, v89, v93
  v_mfma_f32_16x16x32_bf16 v[28:31], v[76:79], v[132:135], v[28:31]
  v_cvt_pk_bf16_f32 v65, v97, v101
  v_mfma_f32_16x16x32_bf16 v[32:35], v[76:79], v[148:151], v[32:35]
  v_cvt_pk_bf16_f32 v66, v105, v109
  v_mfma_f32_16x16x32_bf16 v[36:39], v[76:79], v[164:167], v[36:39]
  v_cvt_pk_bf16_f32 v67, v113, v117
  v_mfma_f32_16x16x32_bf16 v[40:43], v[76:79], v[180:183], v[40:43]
  s_add_u32 s36, s45, 32768
  buffer_store_dwordx4 v[64:67], v18, s[8:11], s36 offen sc1
  v_mfma_f32_16x16x32_bf16 v[44:47], v[76:79], v[196:199], v[44:47]
  v_cvt_pk_bf16_f32 v60, v90, v94
  v_mfma_f32_16x16x32_bf16 v[48:51], v[76:79], v[212:215], v[48:51]
  v_cvt_pk_bf16_f32 v61, v98, v102
  v_mfma_f32_16x16x32_bf16 v[52:55], v[76:79], v[228:231], v[52:55]
  v_cvt_pk_bf16_f32 v62, v106, v110
  v_mfma_f32_16x16x32_bf16 v[56:59], v[76:79], v[244:247], v[56:59]
  v_cvt_pk_bf16_f32 v63, v114, v118
  v_mfma_f32_16x16x32_bf16 v[28:31], v[80:83], v[136:139], v[28:31]
  s_add_u32 s36, s45, 65536
  buffer_store_dwordx4 v[60:63], v18, s[8:11], s36 offen sc1
  v_mfma_f32_16x16x32_bf16 v[32:35], v[80:83], v[152:155], v[32:35]
  v_cvt_pk_bf16_f32 v64, v91, v95
  v_mfma_f32_16x16x32_bf16 v[36:39], v[80:83], v[168:171], v[36:39]
  v_cvt_pk_bf16_f32 v65, v99, v103
  v_mfma_f32_16x16x32_bf16 v[40:43], v[80:83], v[184:187], v[40:43]
  v_cvt_pk_bf16_f32 v66, v107, v111
  v_mfma_f32_16x16x32_bf16 v[44:47], v[80:83], v[200:203], v[44:47]
  v_cvt_pk_bf16_f32 v67, v115, v119
  v_mfma_f32_16x16x32_bf16 v[48:51], v[80:83], v[216:219], v[48:51]
  s_add_u32 s36, s45, 98304
  buffer_store_dwordx4 v[64:67], v18, s[8:11], s36 offen sc1
  v_mfma_f32_16x16x32_bf16 v[52:55], v[80:83], v[232:235], v[52:55]
  v_mfma_f32_16x16x32_bf16 v[56:59], v[80:83], v[248:251], v[56:59]
  v_mfma_f32_16x16x32_bf16 v[28:31], v[84:87], v[140:143], v[28:31]
  v_mfma_f32_16x16x32_bf16 v[32:35], v[84:87], v[156:159], v[32:35]
  v_mfma_f32_16x16x32_bf16 v[36:39], v[84:87], v[172:175], v[36:39]
  v_mfma_f32_16x16x32_bf16 v[40:43], v[84:87], v[188:191], v[40:43]
  v_mfma_f32_16x16x32_bf16 v[44:47], v[84:87], v[204:207], v[44:47]
  v_mfma_f32_16x16x32_bf16 v[48:51], v[84:87], v[220:223], v[48:51]
  v_mfma_f32_16x16x32_bf16 v[52:55], v[84:87], v[236:239], v[52:55]
  v_mfma_f32_16x16x32_bf16 v[56:59], v[84:87], v[252:255], v[56:59]
  v_cvt_pk_bf16_f32 v60, v28, v32
  v_cvt_pk_bf16_f32 v61, v36, v40
  v_cvt_pk_bf16_f32 v62, v44, v48
  s_nop 3
  v_cvt_pk_bf16_f32 v63, v52, v56
  s_add_u32 s36, s45, 524288
  buffer_store_dwordx4 v[60:63], v18, s[8:11], s36 offen sc1
  v_cvt_pk_bf16_f32 v64, v29, v33
  v_cvt_pk_bf16_f32 v65, v37, v41
  v_cvt_pk_bf16_f32 v66, v45, v49
  v_cvt_pk_bf16_f32 v67, v53, v57
  s_add_u32 s36, s45, 557056
  buffer_store_dwordx4 v[64:67], v18, s[8:11], s36 offen sc1
  v_cvt_pk_bf16_f32 v60, v30, v34
  v_cvt_pk_bf16_f32 v61, v38, v42
  v_cvt_pk_bf16_f32 v62, v46, v50
  v_cvt_pk_bf16_f32 v63, v54, v58
  s_add_u32 s36, s45, 589824
  buffer_store_dwordx4 v[60:63], v18, s[8:11], s36 offen sc1
  v_cvt_pk_bf16_f32 v64, v31, v35
  v_cvt_pk_bf16_f32 v65, v39, v43
  v_cvt_pk_bf16_f32 v66, v47, v51
  v_cvt_pk_bf16_f32 v67, v55, v59
  s_add_u32 s36, s45, 622592
  buffer_store_dwordx4 v[64:67], v18, s[8:11], s36 offen sc1
  v_cndmask_b32 v92, 0, v22, s[52:53]
  v_cndmask_b32 v93, 0, v22, s[54:55]
  v_cndmask_b32 v94, 0, v22, s[56:57]
  v_cndmask_b32 v95, 0, v22, s[58:59]
  s_cmp_lt_u32 s42, 63
  s_cbranch_scc1 AS_SG
  s_branch AS_TAIL
AS_SG:
  s_add_u32 s43, s43, 1
  s_lshl_b32 s33, s5, 2
  s_add_u32 s33, s33, s47
  v_mov_b32 v0, s43
  s_waitcnt vmcnt(0)
  s_mov_b64 exec, 1
  buffer_store_dword v0, off, s[8:11], s33 sc1
  s_mov_b64 exec, -1
  s_xor_b32 s45, s45, 0x100000
AGP_40:
  buffer_load_dword v0, v23, s[8:11], s47 offen sc1
  s_waitcnt vmcnt(0)
  v_cmp_gt_u32 vcc, s43, v0
  s_cbranch_vccz AGPOK_41
  s_sleep 1
  s_sub_u32 s6, s6, 1
  s_cbranch_scc1 GIVEUP
  s_branch AGP_40
AGPOK_41:
AS_TAIL:
AT_42:
  buffer_load_dwordx4 v[60:63], v20, s[8:11], s46 offen sc1
  s_add_u32 s36, s46, 4096
  buffer_load_dwordx4 v[64:67], v20, s[8:11], s36 offen sc1
  s_add_u32 s36, s46, 8192
  buffer_load_dwordx4 v[68:71], v20, s[8:11], s36 offen sc1
  s_add_u32 s36, s46, 12288
  buffer_load_dwordx4 v[72:75], v20, s[8:11], s36 offen sc1
  s_add_u32 s36, s46, 16384
  buffer_load_dwordx4 v[76:79], v20, s[8:11], s36 offen sc1
  s_add_u32 s36, s46, 20480
  buffer_load_dwordx4 v[80:83], v20, s[8:11], s36 offen sc1
  s_add_u32 s36, s46, 24576
  buffer_load_dwordx4 v[84:87], v20, s[8:11], s36 offen sc1
  s_add_u32 s36, s46, 28672
  buffer_load_dwordx4 v[88:91], v20, s[8:11], s36 offen sc1
  s_waitcnt vmcnt(0)
  v_max3_u32 v0, v60, v64, v68
  v_max3_u32 v0, v0, v72, v76
  v_max3_u32 v0, v0, v80, v84
  v_max_u32 v0, v0, v88
  v_cmp_eq_u32 vcc, -1, v0
  s_cbranch_vccz ATOK_43
  s_sub_u32 s6, s6, 1
  s_cbranch_scc1 GIVEUP
  s_branch AT_42
ATOK_43:
  s_xor_b32 s46, s46, 0x100000
  v_mfma_f32_16x16x32_bf16 v[96:99], v[92:95], v[60:63], 0
  v_mfma_f32_16x16x32_bf16 v[96:99], v[92:95], v[64:67], v[96:99]
  v_mfma_f32_16x16x32_bf16 v[96:99], v[92:95], v[68:71], v[96:99]
  v_mfma_f32_16x16x32_bf16 v[96:99], v[92:95], v[72:75], v[96:99]
  v_mfma_f32_16x16x32_bf16 v[96:99], v[92:95], v[76:79], v[96:99]
  v_mfma_f32_16x16x32_bf16 v[96:99], v[92:95], v[80:83], v[96:99]
  v_mfma_f32_16x16x32_bf16 v[96:99], v[92:95], v[84:87], v[96:99]
  v_mfma_f32_16x16x32_bf16 v[96:99], v[92:95], v[88:91], v[96:99]
  v_and_b32 v121, 0xffff0000, v120
  v_lshlrev_b32 v120, 16, v120
  s_nop 4
  v_cvt_pk_bf16_f32 v0, v96, v97
  v_and_b32 v97, 0xffff0000, v0
  v_lshlrev_b32 v96, 16, v0
  v_mul_f32 v96, v96, v122
  v_mul_f32 v97, v97, v123
  v_cvt_pk_bf16_f32 v0, v96, v97
  v_and_b32 v97, 0xffff0000, v0
  v_lshlrev_b32 v96, 16, v0
  v_add_f32 v96, v96, v120
  v_add_f32 v97, v97, v121
  v_cvt_pk_bf16_f32 v100, v96, v97
  v_and_b32 v97, 0xffff0000, v100
  v_lshlrev_b32 v96, 16, v100
  v_min_u32 v100, -2, v100
  s_add_u32 s34, s41, 6291456
  buffer_store_dword v100, v21, s[8:11], s34 offen sc1
  v_add_f32 v102, v96, v97
  s_nop 1
  v_add_f32_dpp v102, v102, v102 row_ror:1 row_mask:0xf bank_mask:0xf
  s_nop 1
  v_add_f32_dpp v102, v102, v102 row_ror:2 row_mask:0xf bank_mask:0xf
  s_nop 1
  v_add_f32_dpp v102, v102, v102 row_ror:4 row_mask:0xf bank_mask:0xf
  s_nop 1
  v_add_f32_dpp v102, v102, v102 row_ror:8 row_mask:0xf bank_mask:0xf
  v_mov_b32 v0, v102
  s_nop 1
  v_permlane16_swap_b32 v102, v0
  v_add_f32 v102, v102, v0
  v_mov_b32 v0, v102
  s_nop 1
  v_permlane32_swap_b32 v102, v0
  v_add_f32 v102, v102, v0
  v_mul_f32 v102, 0x3c000000, v102
  v_sub_f32 v24, v96, v102
  v_sub_f32 v25, v97, v102
  v_mul_f32 v103, v24, v24
  v_fmac_f32 v103, v25, v25
  s_nop 1
  v_add_f32_dpp v103, v103, v103 row_ror:1 row_mask:0xf bank_mask:0xf
  s_nop 1
  v_add_f32_dpp v103, v103, v103 row_ror:2 row_mask:0xf bank_mask:0xf
  s_nop 1
  v_add_f32_dpp v103, v103, v103 row_ror:4 row_mask:0xf bank_mask:0xf
  s_nop 1
  v_add_f32_dpp v103, v103, v103 row_ror:8 row_mask:0xf bank_mask:0xf
  v_mov_b32 v0, v103
  s_nop 1
  v_permlane16_swap_b32 v103, v0
  v_add_f32 v103, v103, v0
  v_mov_b32 v0, v103
  s_nop 1
  v_permlane32_swap_b32 v103, v0
  v_add_f32 v103, v103, v0
  s_lshl_b32 s33, s3, 3
  s_add_u32 s33, s33, 28672
  v_mov_b32 v0, s33
  s_mov_b64 exec, 1
  ds_write_b64 v0, v[102:103]
  s_mov_b64 exec, -1
AS_NORM:
  v_mov_b32 v24, 28672
  s_waitcnt lgkmcnt(0)
  s_barrier
  ds_read_b128 v[104:107], v24
  ds_read_b128 v[108:111], v24 offset:16
  s_waitcnt lgkmcnt(0)
  v_add_f32 v102, v104, v106
  v_add_f32 v0, v108, v110
  v_add_f32 v102, v102, v0
  v_mul_f32 v102, 0x3e800000, v102
  v_add_f32 v103, v105, v107
  v_add_f32 v0, v109, v111
  v_add_f32 v103, v103, v0
  v_sub_f32 v104, v104, v102
  v_sub_f32 v106, v106, v102
  v_sub_f32 v108, v108, v102
  v_sub_f32 v110, v110, v102
  v_mul_f32 v0, v104, v104
  v_fmac_f32 v0, v106, v106
  v_fmac_f32 v0, v108, v108
  v_fmac_f32 v0, v110, v110
  v_fmac_f32 v103, 0x43000000, v0
  v_mul_f32 v103, 0x3b000000, v103
  v_cvt_pk_bf16_f32 v0, v102, v103
  v_and_b32 v103, 0xffff0000, v0
  v_lshlrev_b32 v102, 16, v0
  v_add_f32 v103, 0x3727c5ac, v103
  v_cvt_pk_bf16_f32 v103, v103, v103
  v_lshlrev_b32 v103, 16, v103
  v_sqrt_f32 v103, v103
  s_nop 0
  v_cvt_pk_bf16_f32 v103, v103, v103
  v_lshlrev_b32 v103, 16, v103
  v_rcp_f32 v103, v103
  v_sub_f32 v96, v96, v102
  v_sub_f32 v97, v97, v102
  v_cvt_pk_bf16_f32 v0, v96, v97
  v_and_b32 v97, 0xffff0000, v0
  v_lshlrev_b32 v96, 16, v0
  v_mul_f32 v96, v96, v103
  v_mul_f32 v97, v97, v103
  v_cvt_pk_bf16_f32 v0, v96, v97
  v_and_b32 v97, 0xffff0000, v0
  v_lshlrev_b32 v96, 16, v0
  v_mul_f32 v96, v96, v124
  v_mul_f32 v97, v97, v125
  v_cvt_pk_bf16_f32 v0, v96, v97
  v_and_b32 v97, 0xffff0000, v0
  v_lshlrev_b32 v96, 16, v0
  v_add_f32 v96, v96, v126
  v_add_f32 v97, v97, v127
  v_cvt_pk_bf16_f32 v96, v96, v97
  v_min_u32 v96, -2, v96
  s_add_u32 s34, s41, 4194304
  buffer_store_dword v96, v21, s[8:11], s34 offen sc1
  s_lshr_b32 s37, s41, 6
  s_lshl_b32 s33, s3, 2
  s_add_u32 s33, s33, s37
  s_add_u32 s37, s33, 32768
  s_add_u32 s42, s42, 5
  s_cmp_ge_u32 s42, 64
  s_cbranch_scc1 AS_FIN
  s_barrier
  s_lshl_b32 s33, s42, 15
  s_add_u32 s33, s33, 2097152
  s_lshl_b32 s34, s3, 8
  s_add_u32 s34, s34, s33
  s_lshl_b32 s35, s3, 13
  s_add_u32 s39, s34, 0
  s_add_u32 m0, s35, 0
  s_nop 0
  buffer_load_dwordx4 v19, s[8:11], s39 offen sc1 lds
  s_add_u32 s39, s34, 16384
  s_add_u32 m0, s35, 2048
  s_nop 0
  buffer_load_dwordx4 v19, s[8:11], s39 offen sc1 lds
  s_add_u32 s39, s34, 128
  s_add_u32 m0, s35, 4096
  s_nop 0
  buffer_load_dwordx4 v19, s[8:11], s39 offen sc1 lds
  s_add_u32 s39, s34, 16512
  s_add_u32 m0, s35, 6144
  s_nop 0
  buffer_load_dwordx4 v19, s[8:11], s39 offen sc1 lds
  v_xor_b32 v19, 64, v19
  s_add_u32 s39, s34, 8192
  s_add_u32 m0, s35, 1024
  s_nop 0
  buffer_load_dwordx4 v19, s[8:11], s39 offen sc1 lds
  s_add_u32 s39, s34, 24576
  s_add_u32 m0, s35, 3072
  s_nop 0
  buffer_load_dwordx4 v19, s[8:11], s39 offen sc1 lds
  s_add_u32 s39, s34, 8320
  s_add_u32 m0, s35, 5120
  s_nop 0
  buffer_load_dwordx4 v19, s[8:11], s39 offen sc1 lds
  s_add_u32 s39, s34, 24704
  s_add_u32 m0, s35, 7168
  s_nop 0
  buffer_load_dwordx4 v19, s[8:11], s39 offen sc1 lds
  v_xor_b32 v19, 64, v19
  s_lshl_b32 s33, s42, 18
  s_lshl_b32 s34, s5, 13
  s_add_u32 s33, s33, s34
  s_add_u32 s34, s33, 16777216
  s_add_u32 s35, s33, 33554432
  buffer_load_dwordx4 v[112:115], v1, s[8:11], s34 offen offset:0 sc1
  buffer_load_dwordx4 v[116:119], v1, s[8:11], s34 offen offset:1024 sc1
  buffer_load_dwordx4 v[28:31], v1, s[8:11], s35 offen offset:0 sc1
  buffer_load_dwordx4 v[32:35], v1, s[8:11], s35 offen offset:1024 sc1
  v_mov_b32 v0, 2
  s_waitcnt vmcnt(12)
  s_mov_b64 exec, 1
  buffer_store_dword v0, off, s[8:11], s37 sc1
  s_mov_b64 exec, -1
  s_waitcnt vmcnt(5)
  s_branch AS_LOOP
AS_FIN:
  v_mov_b32 v0, 2
  s_waitcnt vmcnt(0)
  s_mov_b64 exec, 1
  buffer_store_dword v0, off, s[8:11], s37 sc1
  s_mov_b64 exec, -1
  s_waitcnt vmcnt(0)
  s_waitcnt vmcnt(0)
  s_endpgm
FFN_ROLE:
  v_mov_b32 v27, v0
  v_lshlrev_b32 v13, 4, v27
  v_and_b32 v26, 15, v27
  v_lshrrev_b32 v25, 4, v27
  s_lshl_b32 s33, s3, 8
  v_lshlrev_b32 v28, 17, v25
  v_lshlrev_b32 v29, 4, v26
  v_add3_u32 v18, v28, v29, s33
  v_lshlrev_b32 v28, 10, v25
  v_add3_u32 v20, v28, v29, s33
  v_lshrrev_b32 v28, 3, v27
  v_lshlrev_b32 v28, 10, v28
  v_and_b32 v29, 7, v27
  v_xor_b32 v29, v29, v25
  v_lshlrev_b32 v29, 4, v29
  v_add_u32 v19, v28, v29
  v_lshrrev_b32 v28, 1, v25
  v_lshlrev_b32 v28, 7, v28
  v_lshlrev_b32 v30, 3, v26
  v_add3_u32 v28, v28, v30, s33
  v_and_b32 v30, 1, v25
  v_lshlrev_b32 v30, 2, v30
  v_add_u32 v21, v28, v30
  v_and_b32 v29, 3, v26
  v_mov_b32 v30, 0x3f80
  v_mov_b32 v31, 0x3f800000
  v_cmp_eq_u32 vcc, 0, v29
  s_nop 1
  v_cndmask_b32 v30, v31, v30, vcc
  v_cmp_gt_u32 vcc, 2, v29
  s_nop 1
  v_cndmask_b32 v22, 0, v30, vcc
  s_mov_b32 s52, 0xf000f
  s_mov_b32 s53, 0xf000f
  s_mov_b32 s54, 0xf000f0
  s_mov_b32 s55, 0xf000f0
  s_mov_b32 s56, 0xf000f00
  s_mov_b32 s57, 0xf000f00
  s_mov_b32 s58, 0xf000f000
  s_mov_b32 s59, 0xf000f000
  v_and_b32 v28, 31, v27
  v_lshlrev_b32 v23, 2, v28
  s_lshl_b32 s33, s4, 21
  s_add_u32 s33, s33, 67108864
  s_lshl_b32 s34, s5, 10
  s_add_u32 s45, s33, s34
  s_lshl_b32 s34, s5, 15
  s_add_u32 s46, s33, s34
  s_lshl_b32 s33, s4, 9
  s_lshl_b32 s34, s3, 7
  s_add_u32 s33, s33, s34
  s_add_u32 s47, s33, 65536
  s_mov_b32 s43, 0
  s_mov_b32 s28, s90
  s_mov_b32 s29, s91
  s_mov_b32 s30, 2097152
  s_mov_b32 s31, 0x00020000
  v_mov_b32 v28, 2147483648
  v_cmp_gt_u32 vcc, 2, v25
  s_nop 1
  v_cndmask_b32 v1, v28, v20, vcc
  s_lshr_b32 s33, s3, 1
  s_lshl_b32 s33, s33, 10
  s_and_b32 s34, s3, 1
  s_lshl_b32 s34, s34, 3
  s_add_u32 s33, s33, s34
  s_add_u32 s33, s33, 32768
  v_add_u32 v2, s33, v13
  v_lshlrev_b32 v28, 2, v23
  s_lshl_b32 s33, s3, 2
  v_add_u32 v3, s33, v28
  v_lshrrev_b32 v28, 1, v26
  v_xor_b32 v28, v28, v25
  v_lshlrev_b32 v28, 4, v28
  v_lshlrev_b32 v29, 7, v26
  v_add_u32 v6, v28, v29
  v_xor_b32 v7, 64, v6
  s_mov_b32 s16, s64
  s_mov_b32 s17, s65
  s_mov_b32 s18, 2097152
  s_mov_b32 s19, 0x00020000
  s_mov_b32 s20, s86
  s_mov_b32 s21, s87
  s_mov_b32 s22, 1024
  s_mov_b32 s23, 0x00020000
  s_mov_b32 s24, s88
  s_mov_b32 s25, s89
  s_mov_b32 s26, 3145728
  s_mov_b32 s27, 0x00020000
  s_sub_u32 s42, s4, 6
  s_mov_b32 s41, s42
  s_lshl_b32 s42, s42, 5
  s_add_u32 s42, s42, s5
  v_lshrrev_b32 v28, 1, v27
  v_lshlrev_b32 v28, 2, v28
  s_lshl_b32 s33, s3, 7
  v_add_u32 v28, s33, v28
  v_lshlrev_b32 v29, 1, v28
  buffer_load_dwordx2 v[96:97], v29, s[20:23], 0 offen
  s_mov_b32 s33, 6144
  v_mul_lo_u32 v28, v28, s33
  v_and_b32 v29, 1, v27
  v_lshlrev_b32 v29, 4, v29
  v_add_u32 v28, v28, v29
  s_lshl_b32 s33, s42, 5
  s_add_u32 s33, s33, 0
  buffer_load_dwordx4 v[128:131], v28, s[24:27], s33 offen
  s_add_u32 s33, s33, 6144
  buffer_load_dwordx4 v[132:135], v28, s[24:27], s33 offen
  s_add_u32 s33, s33, 6144
  buffer_load_dwordx4 v[136:139], v28, s[24:27], s33 offen
  s_add_u32 s33, s33, 6144
  buffer_load_dwordx4 v[140:143], v28, s[24:27], s33 offen
  s_lshl_b32 s37, s42, 15
  s_lshl_b32 s34, s3, 13
  s_add_u32 s37, s37, s34
  s_add_u32 s34, s37, 4096
  buffer_load_dwordx4 v[64:67], v13, s[16:19], s37 offen offset:0
  buffer_load_dwordx4 v[68:71], v13, s[16:19], s37 offen offset:1024
  buffer_load_dwordx4 v[72:75], v13, s[16:19], s37 offen offset:2048
  buffer_load_dwordx4 v[76:79], v13, s[16:19], s37 offen offset:3072
  buffer_load_dwordx4 v[80:83], v13, s[16:19], s34 offen offset:0
  buffer_load_dwordx4 v[84:87], v13, s[16:19], s34 offen offset:1024
  buffer_load_dwordx4 v[88:91], v13, s[16:19], s34 offen offset:2048
  buffer_load_dwordx4 v[92:95], v13, s[16:19], s34 offen offset:3072
  s_waitcnt vmcnt(13)
  s_barrier
  s_cmp_lg_u32 s3, 0
  s_cbranch_scc1 SIG_44
  s_lshl_b32 s33, s4, 2
  v_mov_b32 v0, s32
  s_mov_b64 exec, 1
  buffer_atomic_add v0, off, s[12:15], s33 offset:160 sc1
  s_mov_b64 exec, -1
SIG_44:
  s_waitcnt vmcnt(12)
  v_and_b32 v29, 0xffff0000, v96
  v_lshlrev_b32 v28, 16, v96
  v_and_b32 v31, 0xffff0000, v97
  v_lshlrev_b32 v30, 16, v97
  v_mul_f32 v104, 0xbfb8aa3b, v28
  v_mul_f32 v105, 0xbfb8aa3b, v29
  v_mul_f32 v106, 0xbfb8aa3b, v30
  v_mul_f32 v107, 0xbfb8aa3b, v31
  v_exp_f32 v104, v104
  v_exp_f32 v105, v105
  v_exp_f32 v106, v106
  v_exp_f32 v107, v107
  v_add_f32 v104, 1.0, v104
  v_add_f32 v105, 1.0, v105
  v_add_f32 v106, 1.0, v106
  v_add_f32 v107, 1.0, v107
  v_rcp_f32 v104, v104
  v_rcp_f32 v105, v105
  v_rcp_f32 v106, v106
  v_rcp_f32 v107, v107
  v_mul_f32 v28, v28, v104
  v_mul_f32 v29, v29, v105
  v_mul_f32 v30, v30, v106
  v_mul_f32 v31, v31, v107
  v_cvt_pk_bf16_f32 v0, v28, v29
  v_and_b32 v29, 0xffff0000, v0
  v_lshlrev_b32 v28, 16, v0
  v_cvt_pk_bf16_f32 v0, v30, v31
  v_and_b32 v31, 0xffff0000, v0
  v_lshlrev_b32 v30, 16, v0
  s_waitcnt vmcnt(11)
  v_and_b32 v105, 0xffff0000, v128
  v_lshlrev_b32 v104, 16, v128
  v_and_b32 v107, 0xffff0000, v129
  v_lshlrev_b32 v106, 16, v129
  v_and_b32 v109, 0xffff0000, v130
  v_lshlrev_b32 v108, 16, v130
  v_and_b32 v111, 0xffff0000, v131
  v_lshlrev_b32 v110, 16, v131
  v_pk_mul_f32 v[44:45], v[104:105], v[28:29] op_sel:[0,0] op_sel_hi:[1,0]
  v_pk_mul_f32 v[46:47], v[106:107], v[28:29] op_sel:[0,0] op_sel_hi:[1,0]
  v_pk_mul_f32 v[48:49], v[108:109], v[28:29] op_sel:[0,0] op_sel_hi:[1,0]
  v_pk_mul_f32 v[50:51], v[110:111], v[28:29] op_sel:[0,0] op_sel_hi:[1,0]
  s_waitcnt vmcnt(10)
  v_and_b32 v105, 0xffff0000, v132
  v_lshlrev_b32 v104, 16, v132
  v_and_b32 v107, 0xffff0000, v133
  v_lshlrev_b32 v106, 16, v133
  v_and_b32 v109, 0xffff0000, v134
  v_lshlrev_b32 v108, 16, v134
  v_and_b32 v111, 0xffff0000, v135
  v_lshlrev_b32 v110, 16, v135
  v_pk_fma_f32 v[44:45], v[104:105], v[28:29], v[44:45] op_sel:[0,1,0] op_sel_hi:[1,1,1]
  v_pk_fma_f32 v[46:47], v[106:107], v[28:29], v[46:47] op_sel:[0,1,0] op_sel_hi:[1,1,1]
  v_pk_fma_f32 v[48:49], v[108:109], v[28:29], v[48:49] op_sel:[0,1,0] op_sel_hi:[1,1,1]
  v_pk_fma_f32 v[50:51], v[110:111], v[28:29], v[50:51] op_sel:[0,1,0] op_sel_hi:[1,1,1]
  s_waitcnt vmcnt(9)
  v_and_b32 v105, 0xffff0000, v136
  v_lshlrev_b32 v104, 16, v136
  v_and_b32 v107, 0xffff0000, v137
  v_lshlrev_b32 v106, 16, v137
  v_and_b32 v109, 0xffff0000, v138
  v_lshlrev_b32 v108, 16, v138
  v_and_b32 v111, 0xffff0000, v139
  v_lshlrev_b32 v110, 16, v139
  v_pk_fma_f32 v[44:45], v[104:105], v[30:31], v[44:45] op_sel:[0,0,0] op_sel_hi:[1,0,1]
  v_pk_fma_f32 v[46:47], v[106:107], v[30:31], v[46:47] op_sel:[0,0,0] op_sel_hi:[1,0,1]
  v_pk_fma_f32 v[48:49], v[108:109], v[30:31], v[48:49] op_sel:[0,0,0] op_sel_hi:[1,0,1]
  v_pk_fma_f32 v[50:51], v[110:111], v[30:31], v[50:51] op_sel:[0,0,0] op_sel_hi:[1,0,1]
  s_waitcnt vmcnt(8)
  v_and_b32 v105, 0xffff0000, v140
  v_lshlrev_b32 v104, 16, v140
  v_and_b32 v107, 0xffff0000, v141
  v_lshlrev_b32 v106, 16, v141
  v_and_b32 v109, 0xffff0000, v142
  v_lshlrev_b32 v108, 16, v142
  v_and_b32 v111, 0xffff0000, v143
  v_lshlrev_b32 v110, 16, v143
  v_pk_fma_f32 v[44:45], v[104:105], v[30:31], v[44:45] op_sel:[0,1,0] op_sel_hi:[1,1,1]
  v_pk_fma_f32 v[46:47], v[106:107], v[30:31], v[46:47] op_sel:[0,1,0] op_sel_hi:[1,1,1]
  v_pk_fma_f32 v[48:49], v[108:109], v[30:31], v[48:49] op_sel:[0,1,0] op_sel_hi:[1,1,1]
  v_pk_fma_f32 v[50:51], v[110:111], v[30:31], v[50:51] op_sel:[0,1,0] op_sel_hi:[1,1,1]
  v_add_f32_dpp v44, v44, v44 row_ror:2 row_mask:0xf bank_mask:0xf
  v_add_f32_dpp v45, v45, v45 row_ror:2 row_mask:0xf bank_mask:0xf
  v_add_f32_dpp v46, v46, v46 row_ror:2 row_mask:0xf bank_mask:0xf
  v_add_f32_dpp v47, v47, v47 row_ror:2 row_mask:0xf bank_mask:0xf
  v_add_f32_dpp v48, v48, v48 row_ror:2 row_mask:0xf bank_mask:0xf
  v_add_f32_dpp v49, v49, v49 row_ror:2 row_mask:0xf bank_mask:0xf
  v_add_f32_dpp v50, v50, v50 row_ror:2 row_mask:0xf bank_mask:0xf
  v_add_f32_dpp v51, v51, v51 row_ror:2 row_mask:0xf bank_mask:0xf
  v_add_f32_dpp v44, v44, v44 row_ror:4 row_mask:0xf bank_mask:0xf
  v_add_f32_dpp v45, v45, v45 row_ror:4 row_mask:0xf bank_mask:0xf
  v_add_f32_dpp v46, v46, v46 row_ror:4 row_mask:0xf bank_mask:0xf
  v_add_f32_dpp v47, v47, v47 row_ror:4 row_mask:0xf bank_mask:0xf
  v_add_f32_dpp v48, v48, v48 row_ror:4 row_mask:0xf bank_mask:0xf
  v_add_f32_dpp v49, v49, v49 row_ror:4 row_mask:0xf bank_mask:0xf
  v_add_f32_dpp v50, v50, v50 row_ror:4 row_mask:0xf bank_mask:0xf
  v_add_f32_dpp v51, v51, v51 row_ror:4 row_mask:0xf bank_mask:0xf
  v_add_f32_dpp v44, v44, v44 row_ror:8 row_mask:0xf bank_mask:0xf
  v_add_f32_dpp v45, v45, v45 row_ror:8 row_mask:0xf bank_mask:0xf
  v_add_f32_dpp v46, v46, v46 row_ror:8 row_mask:0xf bank_mask:0xf
  v_add_f32_dpp v47, v47, v47 row_ror:8 row_mask:0xf bank_mask:0xf
  v_add_f32_dpp v48, v48, v48 row_ror:8 row_mask:0xf bank_mask:0xf
  v_add_f32_dpp v49, v49, v49 row_ror:8 row_mask:0xf bank_mask:0xf
  v_add_f32_dpp v50, v50, v50 row_ror:8 row_mask:0xf bank_mask:0xf
  v_add_f32_dpp v51, v51, v51 row_ror:8 row_mask:0xf bank_mask:0xf
  v_mov_b32 v104, v44
  v_mov_b32 v105, v45
  v_mov_b32 v106, v46
  v_mov_b32 v107, v47
  v_mov_b32 v108, v48
  v_mov_b32 v109, v49
  v_mov_b32 v110, v50
  v_mov_b32 v111, v51
  v_permlane16_swap_b32 v44, v104
  v_permlane16_swap_b32 v45, v105
  v_permlane16_swap_b32 v46, v106
  v_permlane16_swap_b32 v47, v107
  v_permlane16_swap_b32 v48, v108
  v_permlane16_swap_b32 v49, v109
  v_permlane16_swap_b32 v50, v110
  v_permlane16_swap_b32 v51, v111
  v_add_f32 v44, v44, v104
  v_add_f32 v45, v45, v105
  v_add_f32 v46, v46, v106
  v_add_f32 v47, v47, v107
  v_add_f32 v48, v48, v108
  v_add_f32 v49, v49, v109
  v_add_f32 v50, v50, v110
  v_add_f32 v51, v51, v111
  v_mov_b32 v104, v44
  v_mov_b32 v105, v45
  v_mov_b32 v106, v46
  v_mov_b32 v107, v47
  v_mov_b32 v108, v48
  v_mov_b32 v109, v49
  v_mov_b32 v110, v50
  v_mov_b32 v111, v51
  v_permlane32_swap_b32 v44, v104
  v_permlane32_swap_b32 v45, v105
  v_permlane32_swap_b32 v46, v106
  v_permlane32_swap_b32 v47, v107
  v_permlane32_swap_b32 v48, v108
  v_permlane32_swap_b32 v49, v109
  v_permlane32_swap_b32 v50, v110
  v_permlane32_swap_b32 v51, v111
  v_add_f32 v44, v44, v104
  v_add_f32 v45, v45, v105
  v_add_f32 v46, v46, v106
  v_add_f32 v47, v47, v107
  v_add_f32 v48, v48, v108
  v_add_f32 v49, v49, v109
  v_add_f32 v50, v50, v110
  v_add_f32 v51, v51, v111
  v_lshlrev_b32 v28, 5, v27
  s_lshl_b32 s33, s3, 8
  v_add_u32 v28, s33, v28
  s_mov_b64 exec, 3
  ds_write_b128 v28, v[44:47]
  ds_write_b128 v28, v[48:51] offset:16
  s_mov_b64 exec, -1
  s_waitcnt lgkmcnt(0)
  s_barrier
  s_cmp_lg_u32 s3, 0
  s_cbranch_scc1 F_M1
  v_lshlrev_b32 v28, 2, v27
  ds_read_b32 v44, v28 offset:0
  ds_read_b32 v45, v28 offset:256
  ds_read_b32 v46, v28 offset:512
  ds_read_b32 v47, v28 offset:768
  s_waitcnt lgkmcnt(0)
  v_add_f32 v44, v44, v45
  v_add_f32 v46, v46, v47
  v_add_f32 v44, v44, v46
  v_cvt_pk_bf16_f32 v44, v44, v44
  v_lshlrev_b32 v44, 16, v44
  s_lshr_b32 s33, s42, 5
  s_cmp_eq_u32 s33, 1
  s_cselect_b32 s34, 1.0, 0
  v_add_f32 v44, s34, v44
  v_cvt_pk_bf16_f32 v44, v44, v44
  v_lshlrev_b32 v44, 16, v44
  s_lshl_b32 s33, s42, 6
  s_add_u32 s33, s33, 131072
  s_mov_b32 exec_hi, 0
  s_mov_b32 exec_lo, 0xffff
  buffer_store_dword v44, v28, s[8:11], s33 offen sc1
  v_mov_b32 v0, 1
  s_waitcnt vmcnt(0)
  s_mov_b64 exec, 1
  buffer_atomic_add v0, off, s[12:15], 0 offset:0 sc1
  s_mov_b64 exec, -1
F_M1:
  s_waitcnt vmcnt(0)
  v_and_b32 v193, 0xffff0000, v64
  v_lshlrev_b32 v192, 16, v64
  v_and_b32 v195, 0xffff0000, v65
  v_lshlrev_b32 v194, 16, v65
  v_and_b32 v197, 0xffff0000, v66
  v_lshlrev_b32 v196, 16, v66
  v_and_b32 v199, 0xffff0000, v67
  v_lshlrev_b32 v198, 16, v67
  v_and_b32 v201, 0xffff0000, v68
  v_lshlrev_b32 v200, 16, v68
  v_and_b32 v203, 0xffff0000, v69
  v_lshlrev_b32 v202, 16, v69
  v_and_b32 v205, 0xffff0000, v70
  v_lshlrev_b32 v204, 16, v70
  v_and_b32 v207, 0xffff0000, v71
  v_lshlrev_b32 v206, 16, v71
  v_and_b32 v209, 0xffff0000, v72
  v_lshlrev_b32 v208, 16, v72
  v_and_b32 v211, 0xffff0000, v73
  v_lshlrev_b32 v210, 16, v73
  v_and_b32 v213, 0xffff0000, v74
  v_lshlrev_b32 v212, 16, v74
  v_and_b32 v215, 0xffff0000, v75
  v_lshlrev_b32 v214, 16, v75
  v_and_b32 v217, 0xffff0000, v76
  v_lshlrev_b32 v216, 16, v76
  v_and_b32 v219, 0xffff0000, v77
  v_lshlrev_b32 v218, 16, v77
  v_and_b32 v221, 0xffff0000, v78
  v_lshlrev_b32 v220, 16, v78
  v_and_b32 v223, 0xffff0000, v79
  v_lshlrev_b32 v222, 16, v79
  v_and_b32 v225, 0xffff0000, v80
  v_lshlrev_b32 v224, 16, v80
  v_and_b32 v227, 0xffff0000, v81
  v_lshlrev_b32 v226, 16, v81
  v_and_b32 v229, 0xffff0000, v82
  v_lshlrev_b32 v228, 16, v82
  v_and_b32 v231, 0xffff0000, v83
  v_lshlrev_b32 v230, 16, v83
  v_and_b32 v233, 0xffff0000, v84
  v_lshlrev_b32 v232, 16, v84
  v_and_b32 v235, 0xffff0000, v85
  v_lshlrev_b32 v234, 16, v85
  v_and_b32 v237, 0xffff0000, v86
  v_lshlrev_b32 v236, 16, v86
  v_and_b32 v239, 0xffff0000, v87
  v_lshlrev_b32 v238, 16, v87
  v_and_b32 v241, 0xffff0000, v88
  v_lshlrev_b32 v240, 16, v88
  v_and_b32 v243, 0xffff0000, v89
  v_lshlrev_b32 v242, 16, v89
  v_and_b32 v245, 0xffff0000, v90
  v_lshlrev_b32 v244, 16, v90
  v_and_b32 v247, 0xffff0000, v91
  v_lshlrev_b32 v246, 16, v91
  v_and_b32 v249, 0xffff0000, v92
  v_lshlrev_b32 v248, 16, v92
  v_and_b32 v251, 0xffff0000, v93
  v_lshlrev_b32 v250, 16, v93
  v_and_b32 v253, 0xffff0000, v94
  v_lshlrev_b32 v252, 16, v94
  v_and_b32 v255, 0xffff0000, v95
  v_lshlrev_b32 v254, 16, v95
  v_pk_add_f32 v[28:29], v[192:193], v[194:195]
  v_pk_add_f32 v[32:33], v[200:201], v[202:203]
  v_pk_add_f32 v[36:37], v[208:209], v[210:211]
  v_pk_add_f32 v[40:41], v[216:217], v[218:219]
  v_pk_add_f32 v[44:45], v[224:225], v[226:227]
  v_pk_add_f32 v[48:49], v[232:233], v[234:235]
  v_pk_add_f32 v[52:53], v[240:241], v[242:243]
  v_pk_add_f32 v[56:57], v[248:249], v[250:251]
  v_pk_add_f32 v[30:31], v[196:197], v[198:199]
  v_pk_add_f32 v[34:35], v[204:205], v[206:207]
  v_pk_add_f32 v[38:39], v[212:213], v[214:215]
  v_pk_add_f32 v[42:43], v[220:221], v[222:223]
  v_pk_add_f32 v[46:47], v[228:229], v[230:231]
  v_pk_add_f32 v[50:51], v[236:237], v[238:239]
  v_pk_add_f32 v[54:55], v[244:245], v[246:247]
  v_pk_add_f32 v[58:59], v[252:253], v[254:255]
  v_pk_add_f32 v[28:29], v[28:29], v[30:31]
  v_pk_add_f32 v[32:33], v[32:33], v[34:35]
  v_pk_add_f32 v[36:37], v[36:37], v[38:39]
  v_pk_add_f32 v[40:41], v[40:41], v[42:43]
  v_pk_add_f32 v[44:45], v[44:45], v[46:47]
  v_pk_add_f32 v[48:49], v[48:49], v[50:51]
  v_pk_add_f32 v[52:53], v[52:53], v[54:55]
  v_pk_add_f32 v[56:57], v[56:57], v[58:59]
  v_add_f32 v104, v28, v29
  v_add_f32 v106, v32, v33
  v_add_f32 v108, v36, v37
  v_add_f32 v110, v40, v41
  v_add_f32 v112, v44, v45
  v_add_f32 v114, v48, v49
  v_add_f32 v116, v52, v53
  v_add_f32 v118, v56, v57
  v_add_f32_dpp v104, v104, v104 row_ror:1 row_mask:0xf bank_mask:0xf
  v_add_f32_dpp v106, v106, v106 row_ror:1 row_mask:0xf bank_mask:0xf
  v_add_f32_dpp v108, v108, v108 row_ror:1 row_mask:0xf bank_mask:0xf
  v_add_f32_dpp v110, v110, v110 row_ror:1 row_mask:0xf bank_mask:0xf
  v_add_f32_dpp v112, v112, v112 row_ror:1 row_mask:0xf bank_mask:0xf
  v_add_f32_dpp v114, v114, v114 row_ror:1 row_mask:0xf bank_mask:0xf
  v_add_f32_dpp v116, v116, v116 row_ror:1 row_mask:0xf bank_mask:0xf
  v_add_f32_dpp v118, v118, v118 row_ror:1 row_mask:0xf bank_mask:0xf
  v_add_f32_dpp v104, v104, v104 row_ror:2 row_mask:0xf bank_mask:0xf
  v_add_f32_dpp v106, v106, v106 row_ror:2 row_mask:0xf bank_mask:0xf
  v_add_f32_dpp v108, v108, v108 row_ror:2 row_mask:0xf bank_mask:0xf
  v_add_f32_dpp v110, v110, v110 row_ror:2 row_mask:0xf bank_mask:0xf
  v_add_f32_dpp v112, v112, v112 row_ror:2 row_mask:0xf bank_mask:0xf
  v_add_f32_dpp v114, v114, v114 row_ror:2 row_mask:0xf bank_mask:0xf
  v_add_f32_dpp v116, v116, v116 row_ror:2 row_mask:0xf bank_mask:0xf
  v_add_f32_dpp v118, v118, v118 row_ror:2 row_mask:0xf bank_mask:0xf
  v_add_f32_dpp v104, v104, v104 row_ror:4 row_mask:0xf bank_mask:0xf
  v_add_f32_dpp v106, v106, v106 row_ror:4 row_mask:0xf bank_mask:0xf
  v_add_f32_dpp v108, v108, v108 row_ror:4 row_mask:0xf bank_mask:0xf
  v_add_f32_dpp v110, v110, v110 row_ror:4 row_mask:0xf bank_mask:0xf
  v_add_f32_dpp v112, v112, v112 row_ror:4 row_mask:0xf bank_mask:0xf
  v_add_f32_dpp v114, v114, v114 row_ror:4 row_mask:0xf bank_mask:0xf
  v_add_f32_dpp v116, v116, v116 row_ror:4 row_mask:0xf bank_mask:0xf
  v_add_f32_dpp v118, v118, v118 row_ror:4 row_mask:0xf bank_mask:0xf
  v_add_f32_dpp v104, v104, v104 row_ror:8 row_mask:0xf bank_mask:0xf
  v_add_f32_dpp v106, v106, v106 row_ror:8 row_mask:0xf bank_mask:0xf
  v_add_f32_dpp v108, v108, v108 row_ror:8 row_mask:0xf bank_mask:0xf
  v_add_f32_dpp v110, v110, v110 row_ror:8 row_mask:0xf bank_mask:0xf
  v_add_f32_dpp v112, v112, v112 row_ror:8 row_mask:0xf bank_mask:0xf
  v_add_f32_dpp v114, v114, v114 row_ror:8 row_mask:0xf bank_mask:0xf
  v_add_f32_dpp v116, v116, v116 row_ror:8 row_mask:0xf bank_mask:0xf
  v_add_f32_dpp v118, v118, v118 row_ror:8 row_mask:0xf bank_mask:0xf
  v_mov_b32 v28, v104
  v_mov_b32 v29, v106
  v_mov_b32 v30, v108
  v_mov_b32 v31, v110
  v_mov_b32 v32, v112
  v_mov_b32 v33, v114
  v_mov_b32 v34, v116
  v_mov_b32 v35, v118
  v_permlane16_swap_b32 v104, v28
  v_permlane16_swap_b32 v106, v29
  v_permlane16_swap_b32 v108, v30
  v_permlane16_swap_b32 v110, v31
  v_permlane16_swap_b32 v112, v32
  v_permlane16_swap_b32 v114, v33
  v_permlane16_swap_b32 v116, v34
  v_permlane16_swap_b32 v118, v35
  v_add_f32 v104, v104, v28
  v_add_f32 v106, v106, v29
  v_add_f32 v108, v108, v30
  v_add_f32 v110, v110, v31
  v_add_f32 v112, v112, v32
  v_add_f32 v114, v114, v33
  v_add_f32 v116, v116, v34
  v_add_f32 v118, v118, v35
  v_mov_b32 v28, v104
  v_mov_b32 v29, v106
  v_mov_b32 v30, v108
  v_mov_b32 v31, v110
  v_mov_b32 v32, v112
  v_mov_b32 v33, v114
  v_mov_b32 v34, v116
  v_mov_b32 v35, v118
  v_permlane32_swap_b32 v104, v28
  v_permlane32_swap_b32 v106, v29
  v_permlane32_swap_b32 v108, v30
  v_permlane32_swap_b32 v110, v31
  v_permlane32_swap_b32 v112, v32
  v_permlane32_swap_b32 v114, v33
  v_permlane32_swap_b32 v116, v34
  v_permlane32_swap_b32 v118, v35
  v_add_f32 v104, v104, v28
  v_add_f32 v106, v106, v29
  v_add_f32 v108, v108, v30
  v_add_f32 v110, v110, v31
  v_add_f32 v112, v112, v32
  v_add_f32 v114, v114, v33
  v_add_f32 v116, v116, v34
  v_add_f32 v118, v118, v35
  v_mul_f32 v104, 0x3b000000, v104
  v_mul_f32 v106, 0x3b000000, v106
  v_mul_f32 v108, 0x3b000000, v108
  v_mul_f32 v110, 0x3b000000, v110
  v_mul_f32 v112, 0x3b000000, v112
  v_mul_f32 v114, 0x3b000000, v114
  v_mul_f32 v116, 0x3b000000, v116
  v_mul_f32 v118, 0x3b000000, v118
  v_pk_add_f32 v[28:29], v[192:193], v[104:105] op_sel:[0,0] op_sel_hi:[1,0] neg_lo:[0,1] neg_hi:[0,1]
  v_pk_add_f32 v[32:33], v[200:201], v[106:107] op_sel:[0,0] op_sel_hi:[1,0] neg_lo:[0,1] neg_hi:[0,1]
  v_pk_add_f32 v[36:37], v[208:209], v[108:109] op_sel:[0,0] op_sel_hi:[1,0] neg_lo:[0,1] neg_hi:[0,1]
  v_pk_add_f32 v[40:41], v[216:217], v[110:111] op_sel:[0,0] op_sel_hi:[1,0] neg_lo:[0,1] neg_hi:[0,1]
  v_pk_add_f32 v[44:45], v[224:225], v[112:113] op_sel:[0,0] op_sel_hi:[1,0] neg_lo:[0,1] neg_hi:[0,1]
  v_pk_add_f32 v[48:49], v[232:233], v[114:115] op_sel:[0,0] op_sel_hi:[1,0] neg_lo:[0,1] neg_hi:[0,1]
  v_pk_add_f32 v[52:53], v[240:241], v[116:117] op_sel:[0,0] op_sel_hi:[1,0] neg_lo:[0,1] neg_hi:[0,1]
  v_pk_add_f32 v[56:57], v[248:249], v[118:119] op_sel:[0,0] op_sel_hi:[1,0] neg_lo:[0,1] neg_hi:[0,1]
  v_pk_mul_f32 v[30:31], v[28:29], v[28:29]
  v_pk_mul_f32 v[34:35], v[32:33], v[32:33]
  v_pk_mul_f32 v[38:39], v[36:37], v[36:37]
  v_pk_mul_f32 v[42:43], v[40:41], v[40:41]
  v_pk_mul_f32 v[46:47], v[44:45], v[44:45]
  v_pk_mul_f32 v[50:51], v[48:49], v[48:49]
  v_pk_mul_f32 v[54:55], v[52:53], v[52:53]
  v_pk_mul_f32 v[58:59], v[56:57], v[56:57]
  v_pk_add_f32 v[28:29], v[194:195], v[104:105] op_sel:[0,0] op_sel_hi:[1,0] neg_lo:[0,1] neg_hi:[0,1]
  v_pk_add_f32 v[32:33], v[202:203], v[106:107] op_sel:[0,0] op_sel_hi:[1,0] neg_lo:[0,1] neg_hi:[0,1]
  v_pk_add_f32 v[36:37], v[210:211], v[108:109] op_sel:[0,0] op_sel_hi:[1,0] neg_lo:[0,1] neg_hi:[0,1]
  v_pk_add_f32 v[40:41], v[218:219], v[110:111] op_sel:[0,0] op_sel_hi:[1,0] neg_lo:[0,1] neg_hi:[0,1]
  v_pk_add_f32 v[44:45], v[226:227], v[112:113] op_sel:[0,0] op_sel_hi:[1,0] neg_lo:[0,1] neg_hi:[0,1]
  v_pk_add_f32 v[48:49], v[234:235], v[114:115] op_sel:[0,0] op_sel_hi:[1,0] neg_lo:[0,1] neg_hi:[0,1]
  v_pk_add_f32 v[52:53], v[242:243], v[116:117] op_sel:[0,0] op_sel_hi:[1,0] neg_lo:[0,1] neg_hi:[0,1]
  v_pk_add_f32 v[56:57], v[250:251], v[118:119] op_sel:[0,0] op_sel_hi:[1,0] neg_lo:[0,1] neg_hi:[0,1]
  v_pk_fma_f32 v[30:31], v[28:29], v[28:29], v[30:31]
  v_pk_fma_f32 v[34:35], v[32:33], v[32:33], v[34:35]
  v_pk_fma_f32 v[38:39], v[36:37], v[36:37], v[38:39]
  v_pk_fma_f32 v[42:43], v[40:41], v[40:41], v[42:43]
  v_pk_fma_f32 v[46:47], v[44:45], v[44:45], v[46:47]
  v_pk_fma_f32 v[50:51], v[48:49], v[48:49], v[50:51]
  v_pk_fma_f32 v[54:55], v[52:53], v[52:53], v[54:55]
  v_pk_fma_f32 v[58:59], v[56:57], v[56:57], v[58:59]
  v_pk_add_f32 v[28:29], v[196:197], v[104:105] op_sel:[0,0] op_sel_hi:[1,0] neg_lo:[0,1] neg_hi:[0,1]
  v_pk_add_f32 v[32:33], v[204:205], v[106:107] op_sel:[0,0] op_sel_hi:[1,0] neg_lo:[0,1] neg_hi:[0,1]
  v_pk_add_f32 v[36:37], v[212:213], v[108:109] op_sel:[0,0] op_sel_hi:[1,0] neg_lo:[0,1] neg_hi:[0,1]
  v_pk_add_f32 v[40:41], v[220:221], v[110:111] op_sel:[0,0] op_sel_hi:[1,0] neg_lo:[0,1] neg_hi:[0,1]
  v_pk_add_f32 v[44:45], v[228:229], v[112:113] op_sel:[0,0] op_sel_hi:[1,0] neg_lo:[0,1] neg_hi:[0,1]
  v_pk_add_f32 v[48:49], v[236:237], v[114:115] op_sel:[0,0] op_sel_hi:[1,0] neg_lo:[0,1] neg_hi:[0,1]
  v_pk_add_f32 v[52:53], v[244:245], v[116:117] op_sel:[0,0] op_sel_hi:[1,0] neg_lo:[0,1] neg_hi:[0,1]
  v_pk_add_f32 v[56:57], v[252:253], v[118:119] op_sel:[0,0] op_sel_hi:[1,0] neg_lo:[0,1] neg_hi:[0,1]
  v_pk_fma_f32 v[30:31], v[28:29], v[28:29], v[30:31]
  v_pk_fma_f32 v[34:35], v[32:33], v[32:33], v[34:35]
  v_pk_fma_f32 v[38:39], v[36:37], v[36:37], v[38:39]
  v_pk_fma_f32 v[42:43], v[40:41], v[40:41], v[42:43]
  v_pk_fma_f32 v[46:47], v[44:45], v[44:45], v[46:47]
  v_pk_fma_f32 v[50:51], v[48:49], v[48:49], v[50:51]
  v_pk_fma_f32 v[54:55], v[52:53], v[52:53], v[54:55]
  v_pk_fma_f32 v[58:59], v[56:57], v[56:57], v[58:59]
  v_pk_add_f32 v[28:29], v[198:199], v[104:105] op_sel:[0,0] op_sel_hi:[1,0] neg_lo:[0,1] neg_hi:[0,1]
  v_pk_add_f32 v[32:33], v[206:207], v[106:107] op_sel:[0,0] op_sel_hi:[1,0] neg_lo:[0,1] neg_hi:[0,1]
  v_pk_add_f32 v[36:37], v[214:215], v[108:109] op_sel:[0,0] op_sel_hi:[1,0] neg_lo:[0,1] neg_hi:[0,1]
  v_pk_add_f32 v[40:41], v[222:223], v[110:111] op_sel:[0,0] op_sel_hi:[1,0] neg_lo:[0,1] neg_hi:[0,1]
  v_pk_add_f32 v[44:45], v[230:231], v[112:113] op_sel:[0,0] op_sel_hi:[1,0] neg_lo:[0,1] neg_hi:[0,1]
  v_pk_add_f32 v[48:49], v[238:239], v[114:115] op_sel:[0,0] op_sel_hi:[1,0] neg_lo:[0,1] neg_hi:[0,1]
  v_pk_add_f32 v[52:53], v[246:247], v[116:117] op_sel:[0,0] op_sel_hi:[1,0] neg_lo:[0,1] neg_hi:[0,1]
  v_pk_add_f32 v[56:57], v[254:255], v[118:119] op_sel:[0,0] op_sel_hi:[1,0] neg_lo:[0,1] neg_hi:[0,1]
  v_pk_fma_f32 v[30:31], v[28:29], v[28:29], v[30:31]
  v_pk_fma_f32 v[34:35], v[32:33], v[32:33], v[34:35]
  v_pk_fma_f32 v[38:39], v[36:37], v[36:37], v[38:39]
  v_pk_fma_f32 v[42:43], v[40:41], v[40:41], v[42:43]
  v_pk_fma_f32 v[46:47], v[44:45], v[44:45], v[46:47]
  v_pk_fma_f32 v[50:51], v[48:49], v[48:49], v[50:51]
  v_pk_fma_f32 v[54:55], v[52:53], v[52:53], v[54:55]
  v_pk_fma_f32 v[58:59], v[56:57], v[56:57], v[58:59]
  v_add_f32 v105, v30, v31
  v_add_f32 v107, v34, v35
  v_add_f32 v109, v38, v39
  v_add_f32 v111, v42, v43
  v_add_f32 v113, v46, v47
  v_add_f32 v115, v50, v51
  v_add_f32 v117, v54, v55
  v_add_f32 v119, v58, v59
  v_add_f32_dpp v105, v105, v105 row_ror:1 row_mask:0xf bank_mask:0xf
  v_add_f32_dpp v107, v107, v107 row_ror:1 row_mask:0xf bank_mask:0xf
  v_add_f32_dpp v109, v109, v109 row_ror:1 row_mask:0xf bank_mask:0xf
  v_add_f32_dpp v111, v111, v111 row_ror:1 row_mask:0xf bank_mask:0xf
  v_add_f32_dpp v113, v113, v113 row_ror:1 row_mask:0xf bank_mask:0xf
  v_add_f32_dpp v115, v115, v115 row_ror:1 row_mask:0xf bank_mask:0xf
  v_add_f32_dpp v117, v117, v117 row_ror:1 row_mask:0xf bank_mask:0xf
  v_add_f32_dpp v119, v119, v119 row_ror:1 row_mask:0xf bank_mask:0xf
  v_add_f32_dpp v105, v105, v105 row_ror:2 row_mask:0xf bank_mask:0xf
  v_add_f32_dpp v107, v107, v107 row_ror:2 row_mask:0xf bank_mask:0xf
  v_add_f32_dpp v109, v109, v109 row_ror:2 row_mask:0xf bank_mask:0xf
  v_add_f32_dpp v111, v111, v111 row_ror:2 row_mask:0xf bank_mask:0xf
  v_add_f32_dpp v113, v113, v113 row_ror:2 row_mask:0xf bank_mask:0xf
  v_add_f32_dpp v115, v115, v115 row_ror:2 row_mask:0xf bank_mask:0xf
  v_add_f32_dpp v117, v117, v117 row_ror:2 row_mask:0xf bank_mask:0xf
  v_add_f32_dpp v119, v119, v119 row_ror:2 row_mask:0xf bank_mask:0xf
  v_add_f32_dpp v105, v105, v105 row_ror:4 row_mask:0xf bank_mask:0xf
  v_add_f32_dpp v107, v107, v107 row_ror:4 row_mask:0xf bank_mask:0xf
  v_add_f32_dpp v109, v109, v109 row_ror:4 row_mask:0xf bank_mask:0xf
  v_add_f32_dpp v111, v111, v111 row_ror:4 row_mask:0xf bank_mask:0xf
  v_add_f32_dpp v113, v113, v113 row_ror:4 row_mask:0xf bank_mask:0xf
  v_add_f32_dpp v115, v115, v115 row_ror:4 row_mask:0xf bank_mask:0xf
  v_add_f32_dpp v117, v117, v117 row_ror:4 row_mask:0xf bank_mask:0xf
  v_add_f32_dpp v119, v119, v119 row_ror:4 row_mask:0xf bank_mask:0xf
  v_add_f32_dpp v105, v105, v105 row_ror:8 row_mask:0xf bank_mask:0xf
  v_add_f32_dpp v107, v107, v107 row_ror:8 row_mask:0xf bank_mask:0xf
  v_add_f32_dpp v109, v109, v109 row_ror:8 row_mask:0xf bank_mask:0xf
  v_add_f32_dpp v111, v111, v111 row_ror:8 row_mask:0xf bank_mask:0xf
  v_add_f32_dpp v113, v113, v113 row_ror:8 row_mask:0xf bank_mask:0xf
  v_add_f32_dpp v115, v115, v115 row_ror:8 row_mask:0xf bank_mask:0xf
  v_add_f32_dpp v117, v117, v117 row_ror:8 row_mask:0xf bank_mask:0xf
  v_add_f32_dpp v119, v119, v119 row_ror:8 row_mask:0xf bank_mask:0xf
  v_mov_b32 v28, v105
  v_mov_b32 v29, v107
  v_mov_b32 v30, v109
  v_mov_b32 v31, v111
  v_mov_b32 v32, v113
  v_mov_b32 v33, v115
  v_mov_b32 v34, v117
  v_mov_b32 v35, v119
  v_permlane16_swap_b32 v105, v28
  v_permlane16_swap_b32 v107, v29
  v_permlane16_swap_b32 v109, v30
  v_permlane16_swap_b32 v111, v31
  v_permlane16_swap_b32 v113, v32
  v_permlane16_swap_b32 v115, v33
  v_permlane16_swap_b32 v117, v34
  v_permlane16_swap_b32 v119, v35
  v_add_f32 v105, v105, v28
  v_add_f32 v107, v107, v29
  v_add_f32 v109, v109, v30
  v_add_f32 v111, v111, v31
  v_add_f32 v113, v113, v32
  v_add_f32 v115, v115, v33
  v_add_f32 v117, v117, v34
  v_add_f32 v119, v119, v35
  v_mov_b32 v28, v105
  v_mov_b32 v29, v107
  v_mov_b32 v30, v109
  v_mov_b32 v31, v111
  v_mov_b32 v32, v113
  v_mov_b32 v33, v115
  v_mov_b32 v34, v117
  v_mov_b32 v35, v119
  v_permlane32_swap_b32 v105, v28
  v_permlane32_swap_b32 v107, v29
  v_permlane32_swap_b32 v109, v30
  v_permlane32_swap_b32 v111, v31
  v_permlane32_swap_b32 v113, v32
  v_permlane32_swap_b32 v115, v33
  v_permlane32_swap_b32 v117, v34
  v_permlane32_swap_b32 v119, v35
  v_add_f32 v105, v105, v28
  v_add_f32 v107, v107, v29
  v_add_f32 v109, v109, v30
  v_add_f32 v111, v111, v31
  v_add_f32 v113, v113, v32
  v_add_f32 v115, v115, v33
  v_add_f32 v117, v117, v34
  v_add_f32 v119, v119, v35
  v_mul_f32 v105, 0x3b000000, v105
  v_mul_f32 v107, 0x3b000000, v107
  v_mul_f32 v109, 0x3b000000, v109
  v_mul_f32 v111, 0x3b000000, v111
  v_mul_f32 v113, 0x3b000000, v113
  v_mul_f32 v115, 0x3b000000, v115
  v_mul_f32 v117, 0x3b000000, v117
  v_mul_f32 v119, 0x3b000000, v119
  v_cvt_pk_bf16_f32 v28, v104, v105
  v_cvt_pk_bf16_f32 v29, v106, v107
  v_cvt_pk_bf16_f32 v30, v108, v109
  v_cvt_pk_bf16_f32 v31, v110, v111
  v_cvt_pk_bf16_f32 v32, v112, v113
  v_cvt_pk_bf16_f32 v33, v114, v115
  v_cvt_pk_bf16_f32 v34, v116, v117
  v_cvt_pk_bf16_f32 v35, v118, v119
  v_and_b32 v105, 0xffff0000, v28
  v_and_b32 v107, 0xffff0000, v29
  v_and_b32 v109, 0xffff0000, v30
  v_and_b32 v111, 0xffff0000, v31
  v_and_b32 v113, 0xffff0000, v32
  v_and_b32 v115, 0xffff0000, v33
  v_and_b32 v117, 0xffff0000, v34
  v_and_b32 v119, 0xffff0000, v35
  v_lshlrev_b32 v104, 16, v28
  v_lshlrev_b32 v106, 16, v29
  v_lshlrev_b32 v108, 16, v30
  v_lshlrev_b32 v110, 16, v31
  v_lshlrev_b32 v112, 16, v32
  v_lshlrev_b32 v114, 16, v33
  v_lshlrev_b32 v116, 16, v34
  v_lshlrev_b32 v118, 16, v35
  v_add_f32 v105, 0x3727c5ac, v105
  v_add_f32 v107, 0x3727c5ac, v107
  v_add_f32 v109, 0x3727c5ac, v109
  v_add_f32 v111, 0x3727c5ac, v111
  v_add_f32 v113, 0x3727c5ac, v113
  v_add_f32 v115, 0x3727c5ac, v115
  v_add_f32 v117, 0x3727c5ac, v117
  v_add_f32 v119, 0x3727c5ac, v119
  v_cvt_pk_bf16_f32 v105, v105, v105
  v_cvt_pk_bf16_f32 v107, v107, v107
  v_cvt_pk_bf16_f32 v109, v109, v109
  v_cvt_pk_bf16_f32 v111, v111, v111
  v_cvt_pk_bf16_f32 v113, v113, v113
  v_cvt_pk_bf16_f32 v115, v115, v115
  v_cvt_pk_bf16_f32 v117, v117, v117
  v_cvt_pk_bf16_f32 v119, v119, v119
  v_lshlrev_b32 v105, 16, v105
  v_lshlrev_b32 v107, 16, v107
  v_lshlrev_b32 v109, 16, v109
  v_lshlrev_b32 v111, 16, v111
  v_lshlrev_b32 v113, 16, v113
  v_lshlrev_b32 v115, 16, v115
  v_lshlrev_b32 v117, 16, v117
  v_lshlrev_b32 v119, 16, v119
  v_sqrt_f32 v105, v105
  v_sqrt_f32 v107, v107
  v_sqrt_f32 v109, v109
  v_sqrt_f32 v111, v111
  v_sqrt_f32 v113, v113
  v_sqrt_f32 v115, v115
  v_sqrt_f32 v117, v117
  v_sqrt_f32 v119, v119
  v_cvt_pk_bf16_f32 v105, v105, v105
  v_cvt_pk_bf16_f32 v107, v107, v107
  v_cvt_pk_bf16_f32 v109, v109, v109
  v_cvt_pk_bf16_f32 v111, v111, v111
  v_cvt_pk_bf16_f32 v113, v113, v113
  v_cvt_pk_bf16_f32 v115, v115, v115
  v_cvt_pk_bf16_f32 v117, v117, v117
  v_cvt_pk_bf16_f32 v119, v119, v119
  v_lshlrev_b32 v105, 16, v105
  v_lshlrev_b32 v107, 16, v107
  v_lshlrev_b32 v109, 16, v109
  v_lshlrev_b32 v111, 16, v111
  v_lshlrev_b32 v113, 16, v113
  v_lshlrev_b32 v115, 16, v115
  v_lshlrev_b32 v117, 16, v117
  v_lshlrev_b32 v119, 16, v119
  v_rcp_f32 v105, v105
  v_rcp_f32 v107, v107
  v_rcp_f32 v109, v109
  v_rcp_f32 v111, v111
  v_rcp_f32 v113, v113
  v_rcp_f32 v115, v115
  v_rcp_f32 v117, v117
  v_rcp_f32 v119, v119
  v_pk_add_f32 v[192:193], v[192:193], v[104:105] op_sel:[0,0] op_sel_hi:[1,0] neg_lo:[0,1] neg_hi:[0,1]
  v_pk_add_f32 v[194:195], v[194:195], v[104:105] op_sel:[0,0] op_sel_hi:[1,0] neg_lo:[0,1] neg_hi:[0,1]
  v_pk_add_f32 v[196:197], v[196:197], v[104:105] op_sel:[0,0] op_sel_hi:[1,0] neg_lo:[0,1] neg_hi:[0,1]
  v_pk_add_f32 v[198:199], v[198:199], v[104:105] op_sel:[0,0] op_sel_hi:[1,0] neg_lo:[0,1] neg_hi:[0,1]
  v_cvt_pk_bf16_f32 v28, v192, v193
  v_cvt_pk_bf16_f32 v29, v194, v195
  v_cvt_pk_bf16_f32 v30, v196, v197
  v_cvt_pk_bf16_f32 v31, v198, v199
  v_and_b32 v193, 0xffff0000, v28
  v_lshlrev_b32 v192, 16, v28
  v_and_b32 v195, 0xffff0000, v29
  v_lshlrev_b32 v194, 16, v29
  v_and_b32 v197, 0xffff0000, v30
  v_lshlrev_b32 v196, 16, v30
  v_and_b32 v199, 0xffff0000, v31
  v_lshlrev_b32 v198, 16, v31
  v_pk_mul_f32 v[192:193], v[192:193], v[104:105] op_sel:[0,1] op_sel_hi:[1,1]
  v_pk_mul_f32 v[194:195], v[194:195], v[104:105] op_sel:[0,1] op_sel_hi:[1,1]
  v_pk_mul_f32 v[196:197], v[196:197], v[104:105] op_sel:[0,1] op_sel_hi:[1,1]
  v_pk_mul_f32 v[198:199], v[198:199], v[104:105] op_sel:[0,1] op_sel_hi:[1,1]
  v_cvt_pk_bf16_f32 v28, v192, v193
  v_cvt_pk_bf16_f32 v29, v194, v195
  v_cvt_pk_bf16_f32 v30, v196, v197
  v_cvt_pk_bf16_f32 v31, v198, v199
  v_and_b32 v193, 0xffff0000, v28
  v_lshlrev_b32 v192, 16, v28
  v_and_b32 v195, 0xffff0000, v29
  v_lshlrev_b32 v194, 16, v29
  v_and_b32 v197, 0xffff0000, v30
  v_lshlrev_b32 v196, 16, v30
  v_and_b32 v199, 0xffff0000, v31
  v_lshlrev_b32 v198, 16, v31
  v_pk_add_f32 v[200:201], v[200:201], v[106:107] op_sel:[0,0] op_sel_hi:[1,0] neg_lo:[0,1] neg_hi:[0,1]
  v_pk_add_f32 v[202:203], v[202:203], v[106:107] op_sel:[0,0] op_sel_hi:[1,0] neg_lo:[0,1] neg_hi:[0,1]
  v_pk_add_f32 v[204:205], v[204:205], v[106:107] op_sel:[0,0] op_sel_hi:[1,0] neg_lo:[0,1] neg_hi:[0,1]
  v_pk_add_f32 v[206:207], v[206:207], v[106:107] op_sel:[0,0] op_sel_hi:[1,0] neg_lo:[0,1] neg_hi:[0,1]
  v_cvt_pk_bf16_f32 v28, v200, v201
  v_cvt_pk_bf16_f32 v29, v202, v203
  v_cvt_pk_bf16_f32 v30, v204, v205
  v_cvt_pk_bf16_f32 v31, v206, v207
  v_and_b32 v201, 0xffff0000, v28
  v_lshlrev_b32 v200, 16, v28
  v_and_b32 v203, 0xffff0000, v29
  v_lshlrev_b32 v202, 16, v29
  v_and_b32 v205, 0xffff0000, v30
  v_lshlrev_b32 v204, 16, v30
  v_and_b32 v207, 0xffff0000, v31
  v_lshlrev_b32 v206, 16, v31
  v_pk_mul_f32 v[200:201], v[200:201], v[106:107] op_sel:[0,1] op_sel_hi:[1,1]
  v_pk_mul_f32 v[202:203], v[202:203], v[106:107] op_sel:[0,1] op_sel_hi:[1,1]
  v_pk_mul_f32 v[204:205], v[204:205], v[106:107] op_sel:[0,1] op_sel_hi:[1,1]
  v_pk_mul_f32 v[206:207], v[206:207], v[106:107] op_sel:[0,1] op_sel_hi:[1,1]
  v_cvt_pk_bf16_f32 v28, v200, v201
  v_cvt_pk_bf16_f32 v29, v202, v203
  v_cvt_pk_bf16_f32 v30, v204, v205
  v_cvt_pk_bf16_f32 v31, v206, v207
  v_and_b32 v201, 0xffff0000, v28
  v_lshlrev_b32 v200, 16, v28
  v_and_b32 v203, 0xffff0000, v29
  v_lshlrev_b32 v202, 16, v29
  v_and_b32 v205, 0xffff0000, v30
  v_lshlrev_b32 v204, 16, v30
  v_and_b32 v207, 0xffff0000, v31
  v_lshlrev_b32 v206, 16, v31
  v_pk_add_f32 v[208:209], v[208:209], v[108:109] op_sel:[0,0] op_sel_hi:[1,0] neg_lo:[0,1] neg_hi:[0,1]
  v_pk_add_f32 v[210:211], v[210:211], v[108:109] op_sel:[0,0] op_sel_hi:[1,0] neg_lo:[0,1] neg_hi:[0,1]
  v_pk_add_f32 v[212:213], v[212:213], v[108:109] op_sel:[0,0] op_sel_hi:[1,0] neg_lo:[0,1] neg_hi:[0,1]
  v_pk_add_f32 v[214:215], v[214:215], v[108:109] op_sel:[0,0] op_sel_hi:[1,0] neg_lo:[0,1] neg_hi:[0,1]
  v_cvt_pk_bf16_f32 v28, v208, v209
  v_cvt_pk_bf16_f32 v29, v210, v211
  v_cvt_pk_bf16_f32 v30, v212, v213
  v_cvt_pk_bf16_f32 v31, v214, v215
  v_and_b32 v209, 0xffff0000, v28
  v_lshlrev_b32 v208, 16, v28
  v_and_b32 v211, 0xffff0000, v29
  v_lshlrev_b32 v210, 16, v29
  v_and_b32 v213, 0xffff0000, v30
  v_lshlrev_b32 v212, 16, v30
  v_and_b32 v215, 0xffff0000, v31
  v_lshlrev_b32 v214, 16, v31
  v_pk_mul_f32 v[208:209], v[208:209], v[108:109] op_sel:[0,1] op_sel_hi:[1,1]
  v_pk_mul_f32 v[210:211], v[210:211], v[108:109] op_sel:[0,1] op_sel_hi:[1,1]
  v_pk_mul_f32 v[212:213], v[212:213], v[108:109] op_sel:[0,1] op_sel_hi:[1,1]
  v_pk_mul_f32 v[214:215], v[214:215], v[108:109] op_sel:[0,1] op_sel_hi:[1,1]
  v_cvt_pk_bf16_f32 v28, v208, v209
  v_cvt_pk_bf16_f32 v29, v210, v211
  v_cvt_pk_bf16_f32 v30, v212, v213
  v_cvt_pk_bf16_f32 v31, v214, v215
  v_and_b32 v209, 0xffff0000, v28
  v_lshlrev_b32 v208, 16, v28
  v_and_b32 v211, 0xffff0000, v29
  v_lshlrev_b32 v210, 16, v29
  v_and_b32 v213, 0xffff0000, v30
  v_lshlrev_b32 v212, 16, v30
  v_and_b32 v215, 0xffff0000, v31
  v_lshlrev_b32 v214, 16, v31
  v_pk_add_f32 v[216:217], v[216:217], v[110:111] op_sel:[0,0] op_sel_hi:[1,0] neg_lo:[0,1] neg_hi:[0,1]
  v_pk_add_f32 v[218:219], v[218:219], v[110:111] op_sel:[0,0] op_sel_hi:[1,0] neg_lo:[0,1] neg_hi:[0,1]
  v_pk_add_f32 v[220:221], v[220:221], v[110:111] op_sel:[0,0] op_sel_hi:[1,0] neg_lo:[0,1] neg_hi:[0,1]
  v_pk_add_f32 v[222:223], v[222:223], v[110:111] op_sel:[0,0] op_sel_hi:[1,0] neg_lo:[0,1] neg_hi:[0,1]
  v_cvt_pk_bf16_f32 v28, v216, v217
  v_cvt_pk_bf16_f32 v29, v218, v219
  v_cvt_pk_bf16_f32 v30, v220, v221
  v_cvt_pk_bf16_f32 v31, v222, v223
  v_and_b32 v217, 0xffff0000, v28
  v_lshlrev_b32 v216, 16, v28
  v_and_b32 v219, 0xffff0000, v29
  v_lshlrev_b32 v218, 16, v29
  v_and_b32 v221, 0xffff0000, v30
  v_lshlrev_b32 v220, 16, v30
  v_and_b32 v223, 0xffff0000, v31
  v_lshlrev_b32 v222, 16, v31
  v_pk_mul_f32 v[216:217], v[216:217], v[110:111] op_sel:[0,1] op_sel_hi:[1,1]
  v_pk_mul_f32 v[218:219], v[218:219], v[110:111] op_sel:[0,1] op_sel_hi:[1,1]
  v_pk_mul_f32 v[220:221], v[220:221], v[110:111] op_sel:[0,1] op_sel_hi:[1,1]
  v_pk_mul_f32 v[222:223], v[222:223], v[110:111] op_sel:[0,1] op_sel_hi:[1,1]
  v_cvt_pk_bf16_f32 v28, v216, v217
  v_cvt_pk_bf16_f32 v29, v218, v219
  v_cvt_pk_bf16_f32 v30, v220, v221
  v_cvt_pk_bf16_f32 v31, v222, v223
  v_and_b32 v217, 0xffff0000, v28
  v_lshlrev_b32 v216, 16, v28
  v_and_b32 v219, 0xffff0000, v29
  v_lshlrev_b32 v218, 16, v29
  v_and_b32 v221, 0xffff0000, v30
  v_lshlrev_b32 v220, 16, v30
  v_and_b32 v223, 0xffff0000, v31
  v_lshlrev_b32 v222, 16, v31
  v_pk_add_f32 v[224:225], v[224:225], v[112:113] op_sel:[0,0] op_sel_hi:[1,0] neg_lo:[0,1] neg_hi:[0,1]
  v_pk_add_f32 v[226:227], v[226:227], v[112:113] op_sel:[0,0] op_sel_hi:[1,0] neg_lo:[0,1] neg_hi:[0,1]
  v_pk_add_f32 v[228:229], v[228:229], v[112:113] op_sel:[0,0] op_sel_hi:[1,0] neg_lo:[0,1] neg_hi:[0,1]
  v_pk_add_f32 v[230:231], v[230:231], v[112:113] op_sel:[0,0] op_sel_hi:[1,0] neg_lo:[0,1] neg_hi:[0,1]
  v_cvt_pk_bf16_f32 v28, v224, v225
  v_cvt_pk_bf16_f32 v29, v226, v227
  v_cvt_pk_bf16_f32 v30, v228, v229
  v_cvt_pk_bf16_f32 v31, v230, v231
  v_and_b32 v225, 0xffff0000, v28
  v_lshlrev_b32 v224, 16, v28
  v_and_b32 v227, 0xffff0000, v29
  v_lshlrev_b32 v226, 16, v29
  v_and_b32 v229, 0xffff0000, v30
  v_lshlrev_b32 v228, 16, v30
  v_and_b32 v231, 0xffff0000, v31
  v_lshlrev_b32 v230, 16, v31
  v_pk_mul_f32 v[224:225], v[224:225], v[112:113] op_sel:[0,1] op_sel_hi:[1,1]
  v_pk_mul_f32 v[226:227], v[226:227], v[112:113] op_sel:[0,1] op_sel_hi:[1,1]
  v_pk_mul_f32 v[228:229], v[228:229], v[112:113] op_sel:[0,1] op_sel_hi:[1,1]
  v_pk_mul_f32 v[230:231], v[230:231], v[112:113] op_sel:[0,1] op_sel_hi:[1,1]
  v_cvt_pk_bf16_f32 v28, v224, v225
  v_cvt_pk_bf16_f32 v29, v226, v227
  v_cvt_pk_bf16_f32 v30, v228, v229
  v_cvt_pk_bf16_f32 v31, v230, v231
  v_and_b32 v225, 0xffff0000, v28
  v_lshlrev_b32 v224, 16, v28
  v_and_b32 v227, 0xffff0000, v29
  v_lshlrev_b32 v226, 16, v29
  v_and_b32 v229, 0xffff0000, v30
  v_lshlrev_b32 v228, 16, v30
  v_and_b32 v231, 0xffff0000, v31
  v_lshlrev_b32 v230, 16, v31
  v_pk_add_f32 v[232:233], v[232:233], v[114:115] op_sel:[0,0] op_sel_hi:[1,0] neg_lo:[0,1] neg_hi:[0,1]
  v_pk_add_f32 v[234:235], v[234:235], v[114:115] op_sel:[0,0] op_sel_hi:[1,0] neg_lo:[0,1] neg_hi:[0,1]
  v_pk_add_f32 v[236:237], v[236:237], v[114:115] op_sel:[0,0] op_sel_hi:[1,0] neg_lo:[0,1] neg_hi:[0,1]
  v_pk_add_f32 v[238:239], v[238:239], v[114:115] op_sel:[0,0] op_sel_hi:[1,0] neg_lo:[0,1] neg_hi:[0,1]
  v_cvt_pk_bf16_f32 v28, v232, v233
  v_cvt_pk_bf16_f32 v29, v234, v235
  v_cvt_pk_bf16_f32 v30, v236, v237
  v_cvt_pk_bf16_f32 v31, v238, v239
  v_and_b32 v233, 0xffff0000, v28
  v_lshlrev_b32 v232, 16, v28
  v_and_b32 v235, 0xffff0000, v29
  v_lshlrev_b32 v234, 16, v29
  v_and_b32 v237, 0xffff0000, v30
  v_lshlrev_b32 v236, 16, v30
  v_and_b32 v239, 0xffff0000, v31
  v_lshlrev_b32 v238, 16, v31
  v_pk_mul_f32 v[232:233], v[232:233], v[114:115] op_sel:[0,1] op_sel_hi:[1,1]
  v_pk_mul_f32 v[234:235], v[234:235], v[114:115] op_sel:[0,1] op_sel_hi:[1,1]
  v_pk_mul_f32 v[236:237], v[236:237], v[114:115] op_sel:[0,1] op_sel_hi:[1,1]
  v_pk_mul_f32 v[238:239], v[238:239], v[114:115] op_sel:[0,1] op_sel_hi:[1,1]
  v_cvt_pk_bf16_f32 v28, v232, v233
  v_cvt_pk_bf16_f32 v29, v234, v235
  v_cvt_pk_bf16_f32 v30, v236, v237
  v_cvt_pk_bf16_f32 v31, v238, v239
  v_and_b32 v233, 0xffff0000, v28
  v_lshlrev_b32 v232, 16, v28
  v_and_b32 v235, 0xffff0000, v29
  v_lshlrev_b32 v234, 16, v29
  v_and_b32 v237, 0xffff0000, v30
  v_lshlrev_b32 v236, 16, v30
  v_and_b32 v239, 0xffff0000, v31
  v_lshlrev_b32 v238, 16, v31
  v_pk_add_f32 v[240:241], v[240:241], v[116:117] op_sel:[0,0] op_sel_hi:[1,0] neg_lo:[0,1] neg_hi:[0,1]
  v_pk_add_f32 v[242:243], v[242:243], v[116:117] op_sel:[0,0] op_sel_hi:[1,0] neg_lo:[0,1] neg_hi:[0,1]
  v_pk_add_f32 v[244:245], v[244:245], v[116:117] op_sel:[0,0] op_sel_hi:[1,0] neg_lo:[0,1] neg_hi:[0,1]
  v_pk_add_f32 v[246:247], v[246:247], v[116:117] op_sel:[0,0] op_sel_hi:[1,0] neg_lo:[0,1] neg_hi:[0,1]
  v_cvt_pk_bf16_f32 v28, v240, v241
  v_cvt_pk_bf16_f32 v29, v242, v243
  v_cvt_pk_bf16_f32 v30, v244, v245
  v_cvt_pk_bf16_f32 v31, v246, v247
  v_and_b32 v241, 0xffff0000, v28
  v_lshlrev_b32 v240, 16, v28
  v_and_b32 v243, 0xffff0000, v29
  v_lshlrev_b32 v242, 16, v29
  v_and_b32 v245, 0xffff0000, v30
  v_lshlrev_b32 v244, 16, v30
  v_and_b32 v247, 0xffff0000, v31
  v_lshlrev_b32 v246, 16, v31
  v_pk_mul_f32 v[240:241], v[240:241], v[116:117] op_sel:[0,1] op_sel_hi:[1,1]
  v_pk_mul_f32 v[242:243], v[242:243], v[116:117] op_sel:[0,1] op_sel_hi:[1,1]
  v_pk_mul_f32 v[244:245], v[244:245], v[116:117] op_sel:[0,1] op_sel_hi:[1,1]
  v_pk_mul_f32 v[246:247], v[246:247], v[116:117] op_sel:[0,1] op_sel_hi:[1,1]
  v_cvt_pk_bf16_f32 v28, v240, v241
  v_cvt_pk_bf16_f32 v29, v242, v243
  v_cvt_pk_bf16_f32 v30, v244, v245
  v_cvt_pk_bf16_f32 v31, v246, v247
  v_and_b32 v241, 0xffff0000, v28
  v_lshlrev_b32 v240, 16, v28
  v_and_b32 v243, 0xffff0000, v29
  v_lshlrev_b32 v242, 16, v29
  v_and_b32 v245, 0xffff0000, v30
  v_lshlrev_b32 v244, 16, v30
  v_and_b32 v247, 0xffff0000, v31
  v_lshlrev_b32 v246, 16, v31
  v_pk_add_f32 v[248:249], v[248:249], v[118:119] op_sel:[0,0] op_sel_hi:[1,0] neg_lo:[0,1] neg_hi:[0,1]
  v_pk_add_f32 v[250:251], v[250:251], v[118:119] op_sel:[0,0] op_sel_hi:[1,0] neg_lo:[0,1] neg_hi:[0,1]
  v_pk_add_f32 v[252:253], v[252:253], v[118:119] op_sel:[0,0] op_sel_hi:[1,0] neg_lo:[0,1] neg_hi:[0,1]
  v_pk_add_f32 v[254:255], v[254:255], v[118:119] op_sel:[0,0] op_sel_hi:[1,0] neg_lo:[0,1] neg_hi:[0,1]
  v_cvt_pk_bf16_f32 v28, v248, v249
  v_cvt_pk_bf16_f32 v29, v250, v251
  v_cvt_pk_bf16_f32 v30, v252, v253
  v_cvt_pk_bf16_f32 v31, v254, v255
  v_and_b32 v249, 0xffff0000, v28
  v_lshlrev_b32 v248, 16, v28
  v_and_b32 v251, 0xffff0000, v29
  v_lshlrev_b32 v250, 16, v29
  v_and_b32 v253, 0xffff0000, v30
  v_lshlrev_b32 v252, 16, v30
  v_and_b32 v255, 0xffff0000, v31
  v_lshlrev_b32 v254, 16, v31
  v_pk_mul_f32 v[248:249], v[248:249], v[118:119] op_sel:[0,1] op_sel_hi:[1,1]
  v_pk_mul_f32 v[250:251], v[250:251], v[118:119] op_sel:[0,1] op_sel_hi:[1,1]
  v_pk_mul_f32 v[252:253], v[252:253], v[118:119] op_sel:[0,1] op_sel_hi:[1,1]
  v_pk_mul_f32 v[254:255], v[254:255], v[118:119] op_sel:[0,1] op_sel_hi:[1,1]
  v_cvt_pk_bf16_f32 v28, v248, v249
  v_cvt_pk_bf16_f32 v29, v250, v251
  v_cvt_pk_bf16_f32 v30, v252, v253
  v_cvt_pk_bf16_f32 v31, v254, v255
  v_and_b32 v249, 0xffff0000, v28
  v_lshlrev_b32 v248, 16, v28
  v_and_b32 v251, 0xffff0000, v29
  v_lshlrev_b32 v250, 16, v29
  v_and_b32 v253, 0xffff0000, v30
  v_lshlrev_b32 v252, 16, v30
  v_and_b32 v255, 0xffff0000, v31
  v_lshlrev_b32 v254, 16, v31
F_MP:
  buffer_load_dword v0, off, s[12:15], 0 offset:0 sc1
  s_waitcnt vmcnt(0)
  v_cmp_le_u32 vcc, 64, v0
  s_cbranch_vccnz F_MPOK
  s_sleep 1
  s_sub_u32 s6, s6, 1
  s_cbranch_scc1 GIVEUP
  s_branch F_MP
F_MPOK:
  v_lshlrev_b32 v0, 1, v13
  s_mov_b32 s33, 131072
  buffer_load_dwordx4 v[40:43], v0, s[8:11], s33 offen offset:2048 sc1
  buffer_load_dwordx4 v[44:47], v0, s[8:11], s33 offen offset:2064 sc1
  buffer_load_dwordx4 v[32:35], v0, s[8:11], s33 offen sc1
  buffer_load_dwordx4 v[36:39], v0, s[8:11], s33 offen offset:16 sc1
  s_add_u32 s37, s37, 2097152
  s_add_u32 s34, s37, 4096
  s_waitcnt vmcnt(0)
  v_pk_mul_f32 v[192:193], v[192:193], v[40:41]
  v_pk_mul_f32 v[194:195], v[194:195], v[42:43]
  v_pk_mul_f32 v[196:197], v[196:197], v[44:45]
  v_pk_mul_f32 v[198:199], v[198:199], v[46:47]
  v_cvt_pk_bf16_f32 v28, v192, v193
  v_cvt_pk_bf16_f32 v29, v194, v195
  v_cvt_pk_bf16_f32 v30, v196, v197
  v_cvt_pk_bf16_f32 v31, v198, v199
  v_and_b32 v193, 0xffff0000, v28
  v_lshlrev_b32 v192, 16, v28
  v_and_b32 v195, 0xffff0000, v29
  v_lshlrev_b32 v194, 16, v29
  v_and_b32 v197, 0xffff0000, v30
  v_lshlrev_b32 v196, 16, v30
  v_and_b32 v199, 0xffff0000, v31
  v_lshlrev_b32 v198, 16, v31
  v_pk_add_f32 v[192:193], v[192:193], v[32:33]
  v_pk_add_f32 v[194:195], v[194:195], v[34:35]
  v_pk_add_f32 v[196:197], v[196:197], v[36:37]
  v_pk_add_f32 v[198:199], v[198:199], v[38:39]
  v_cvt_pk_bf16_f32 v64, v192, v193
  v_cvt_pk_bf16_f32 v65, v194, v195
  v_cvt_pk_bf16_f32 v66, v196, v197
  v_cvt_pk_bf16_f32 v67, v198, v199
  buffer_store_dwordx4 v[64:67], v13, s[8:11], s37 offen offset:0 sc1
  v_pk_mul_f32 v[200:201], v[200:201], v[40:41]
  v_pk_mul_f32 v[202:203], v[202:203], v[42:43]
  v_pk_mul_f32 v[204:205], v[204:205], v[44:45]
  v_pk_mul_f32 v[206:207], v[206:207], v[46:47]
  v_cvt_pk_bf16_f32 v28, v200, v201
  v_cvt_pk_bf16_f32 v29, v202, v203
  v_cvt_pk_bf16_f32 v30, v204, v205
  v_cvt_pk_bf16_f32 v31, v206, v207
  v_and_b32 v201, 0xffff0000, v28
  v_lshlrev_b32 v200, 16, v28
  v_and_b32 v203, 0xffff0000, v29
  v_lshlrev_b32 v202, 16, v29
  v_and_b32 v205, 0xffff0000, v30
  v_lshlrev_b32 v204, 16, v30
  v_and_b32 v207, 0xffff0000, v31
  v_lshlrev_b32 v206, 16, v31
  v_pk_add_f32 v[200:201], v[200:201], v[32:33]
  v_pk_add_f32 v[202:203], v[202:203], v[34:35]
  v_pk_add_f32 v[204:205], v[204:205], v[36:37]
  v_pk_add_f32 v[206:207], v[206:207], v[38:39]
  v_cvt_pk_bf16_f32 v68, v200, v201
  v_cvt_pk_bf16_f32 v69, v202, v203
  v_cvt_pk_bf16_f32 v70, v204, v205
  v_cvt_pk_bf16_f32 v71, v206, v207
  buffer_store_dwordx4 v[68:71], v13, s[8:11], s37 offen offset:1024 sc1
  v_pk_mul_f32 v[208:209], v[208:209], v[40:41]
  v_pk_mul_f32 v[210:211], v[210:211], v[42:43]
  v_pk_mul_f32 v[212:213], v[212:213], v[44:45]
  v_pk_mul_f32 v[214:215], v[214:215], v[46:47]
  v_cvt_pk_bf16_f32 v28, v208, v209
  v_cvt_pk_bf16_f32 v29, v210, v211
  v_cvt_pk_bf16_f32 v30, v212, v213
  v_cvt_pk_bf16_f32 v31, v214, v215
  v_and_b32 v209, 0xffff0000, v28
  v_lshlrev_b32 v208, 16, v28
  v_and_b32 v211, 0xffff0000, v29
  v_lshlrev_b32 v210, 16, v29
  v_and_b32 v213, 0xffff0000, v30
  v_lshlrev_b32 v212, 16, v30
  v_and_b32 v215, 0xffff0000, v31
  v_lshlrev_b32 v214, 16, v31
  v_pk_add_f32 v[208:209], v[208:209], v[32:33]
  v_pk_add_f32 v[210:211], v[210:211], v[34:35]
  v_pk_add_f32 v[212:213], v[212:213], v[36:37]
  v_pk_add_f32 v[214:215], v[214:215], v[38:39]
  v_cvt_pk_bf16_f32 v72, v208, v209
  v_cvt_pk_bf16_f32 v73, v210, v211
  v_cvt_pk_bf16_f32 v74, v212, v213
  v_cvt_pk_bf16_f32 v75, v214, v215
  buffer_store_dwordx4 v[72:75], v13, s[8:11], s37 offen offset:2048 sc1
  v_pk_mul_f32 v[216:217], v[216:217], v[40:41]
  v_pk_mul_f32 v[218:219], v[218:219], v[42:43]
  v_pk_mul_f32 v[220:221], v[220:221], v[44:45]
  v_pk_mul_f32 v[222:223], v[222:223], v[46:47]
  v_cvt_pk_bf16_f32 v28, v216, v217
  v_cvt_pk_bf16_f32 v29, v218, v219
  v_cvt_pk_bf16_f32 v30, v220, v221
  v_cvt_pk_bf16_f32 v31, v222, v223
  v_and_b32 v217, 0xffff0000, v28
  v_lshlrev_b32 v216, 16, v28
  v_and_b32 v219, 0xffff0000, v29
  v_lshlrev_b32 v218, 16, v29
  v_and_b32 v221, 0xffff0000, v30
  v_lshlrev_b32 v220, 16, v30
  v_and_b32 v223, 0xffff0000, v31
  v_lshlrev_b32 v222, 16, v31
  v_pk_add_f32 v[216:217], v[216:217], v[32:33]
  v_pk_add_f32 v[218:219], v[218:219], v[34:35]
  v_pk_add_f32 v[220:221], v[220:221], v[36:37]
  v_pk_add_f32 v[222:223], v[222:223], v[38:39]
  v_cvt_pk_bf16_f32 v76, v216, v217
  v_cvt_pk_bf16_f32 v77, v218, v219
  v_cvt_pk_bf16_f32 v78, v220, v221
  v_cvt_pk_bf16_f32 v79, v222, v223
  buffer_store_dwordx4 v[76:79], v13, s[8:11], s37 offen offset:3072 sc1
  v_pk_mul_f32 v[224:225], v[224:225], v[40:41]
  v_pk_mul_f32 v[226:227], v[226:227], v[42:43]
  v_pk_mul_f32 v[228:229], v[228:229], v[44:45]
  v_pk_mul_f32 v[230:231], v[230:231], v[46:47]
  v_cvt_pk_bf16_f32 v28, v224, v225
  v_cvt_pk_bf16_f32 v29, v226, v227
  v_cvt_pk_bf16_f32 v30, v228, v229
  v_cvt_pk_bf16_f32 v31, v230, v231
  v_and_b32 v225, 0xffff0000, v28
  v_lshlrev_b32 v224, 16, v28
  v_and_b32 v227, 0xffff0000, v29
  v_lshlrev_b32 v226, 16, v29
  v_and_b32 v229, 0xffff0000, v30
  v_lshlrev_b32 v228, 16, v30
  v_and_b32 v231, 0xffff0000, v31
  v_lshlrev_b32 v230, 16, v31
  v_pk_add_f32 v[224:225], v[224:225], v[32:33]
  v_pk_add_f32 v[226:227], v[226:227], v[34:35]
  v_pk_add_f32 v[228:229], v[228:229], v[36:37]
  v_pk_add_f32 v[230:231], v[230:231], v[38:39]
  v_cvt_pk_bf16_f32 v80, v224, v225
  v_cvt_pk_bf16_f32 v81, v226, v227
  v_cvt_pk_bf16_f32 v82, v228, v229
  v_cvt_pk_bf16_f32 v83, v230, v231
  buffer_store_dwordx4 v[80:83], v13, s[8:11], s34 offen offset:0 sc1
  v_pk_mul_f32 v[232:233], v[232:233], v[40:41]
  v_pk_mul_f32 v[234:235], v[234:235], v[42:43]
  v_pk_mul_f32 v[236:237], v[236:237], v[44:45]
  v_pk_mul_f32 v[238:239], v[238:239], v[46:47]
  v_cvt_pk_bf16_f32 v28, v232, v233
  v_cvt_pk_bf16_f32 v29, v234, v235
  v_cvt_pk_bf16_f32 v30, v236, v237
  v_cvt_pk_bf16_f32 v31, v238, v239
  v_and_b32 v233, 0xffff0000, v28
  v_lshlrev_b32 v232, 16, v28
  v_and_b32 v235, 0xffff0000, v29
  v_lshlrev_b32 v234, 16, v29
  v_and_b32 v237, 0xffff0000, v30
  v_lshlrev_b32 v236, 16, v30
  v_and_b32 v239, 0xffff0000, v31
  v_lshlrev_b32 v238, 16, v31
  v_pk_add_f32 v[232:233], v[232:233], v[32:33]
  v_pk_add_f32 v[234:235], v[234:235], v[34:35]
  v_pk_add_f32 v[236:237], v[236:237], v[36:37]
  v_pk_add_f32 v[238:239], v[238:239], v[38:39]
  v_cvt_pk_bf16_f32 v84, v232, v233
  v_cvt_pk_bf16_f32 v85, v234, v235
  v_cvt_pk_bf16_f32 v86, v236, v237
  v_cvt_pk_bf16_f32 v87, v238, v239
  buffer_store_dwordx4 v[84:87], v13, s[8:11], s34 offen offset:1024 sc1
  v_pk_mul_f32 v[240:241], v[240:241], v[40:41]
  v_pk_mul_f32 v[242:243], v[242:243], v[42:43]
  v_pk_mul_f32 v[244:245], v[244:245], v[44:45]
  v_pk_mul_f32 v[246:247], v[246:247], v[46:47]
  v_cvt_pk_bf16_f32 v28, v240, v241
  v_cvt_pk_bf16_f32 v29, v242, v243
  v_cvt_pk_bf16_f32 v30, v244, v245
  v_cvt_pk_bf16_f32 v31, v246, v247
  v_and_b32 v241, 0xffff0000, v28
  v_lshlrev_b32 v240, 16, v28
  v_and_b32 v243, 0xffff0000, v29
  v_lshlrev_b32 v242, 16, v29
  v_and_b32 v245, 0xffff0000, v30
  v_lshlrev_b32 v244, 16, v30
  v_and_b32 v247, 0xffff0000, v31
  v_lshlrev_b32 v246, 16, v31
  v_pk_add_f32 v[240:241], v[240:241], v[32:33]
  v_pk_add_f32 v[242:243], v[242:243], v[34:35]
  v_pk_add_f32 v[244:245], v[244:245], v[36:37]
  v_pk_add_f32 v[246:247], v[246:247], v[38:39]
  v_cvt_pk_bf16_f32 v88, v240, v241
  v_cvt_pk_bf16_f32 v89, v242, v243
  v_cvt_pk_bf16_f32 v90, v244, v245
  v_cvt_pk_bf16_f32 v91, v246, v247
  buffer_store_dwordx4 v[88:91], v13, s[8:11], s34 offen offset:2048 sc1
  v_pk_mul_f32 v[248:249], v[248:249], v[40:41]
  v_pk_mul_f32 v[250:251], v[250:251], v[42:43]
  v_pk_mul_f32 v[252:253], v[252:253], v[44:45]
  v_pk_mul_f32 v[254:255], v[254:255], v[46:47]
  v_cvt_pk_bf16_f32 v28, v248, v249
  v_cvt_pk_bf16_f32 v29, v250, v251
  v_cvt_pk_bf16_f32 v30, v252, v253
  v_cvt_pk_bf16_f32 v31, v254, v255
  v_and_b32 v249, 0xffff0000, v28
  v_lshlrev_b32 v248, 16, v28
  v_and_b32 v251, 0xffff0000, v29
  v_lshlrev_b32 v250, 16, v29
  v_and_b32 v253, 0xffff0000, v30
  v_lshlrev_b32 v252, 16, v30
  v_and_b32 v255, 0xffff0000, v31
  v_lshlrev_b32 v254, 16, v31
  v_pk_add_f32 v[248:249], v[248:249], v[32:33]
  v_pk_add_f32 v[250:251], v[250:251], v[34:35]
  v_pk_add_f32 v[252:253], v[252:253], v[36:37]
  v_pk_add_f32 v[254:255], v[254:255], v[38:39]
  v_cvt_pk_bf16_f32 v92, v248, v249
  v_cvt_pk_bf16_f32 v93, v250, v251
  v_cvt_pk_bf16_f32 v94, v252, v253
  v_cvt_pk_bf16_f32 v95, v254, v255
  buffer_store_dwordx4 v[92:95], v13, s[8:11], s34 offen offset:3072 sc1
  v_and_b32 v25, 7, v27
  v_lshlrev_b32 v25, 2, v25
RDY_45:
  buffer_load_dword v24, v25, s[12:15], 0 offen offset:160 sc1
  s_waitcnt vmcnt(0)
  v_readlane_b32 s33, v24, s4
  v_and_b32 v24, 63, v24
  v_cmp_ne_u32 vcc, 32, v24
  s_cbranch_vccz RDYOK_46
  s_sleep 4
  s_sub_u32 s6, s6, 1
  s_cbranch_scc1 GIVEUP
  s_branch RDY_45
RDYOK_46:
  s_bfe_u32 s34, s33, 0x80006
  s_mul_i32 s34, s34, s34
  s_lshr_b32 s33, s33, 14
  s_lshl_b32 s33, s33, 5
  s_cmp_lg_u32 s33, s34
  s_cselect_b32 s7, 1, 0
  s_lshl_b32 s33, s42, 4
  s_add_u32 s33, s33, 81920
  v_mov_b32 v0, 1
  s_barrier
  s_cmp_lg_u32 s3, 0
  s_cbranch_scc1 F_HDONE
  s_mov_b64 exec, 1
  buffer_store_dword v0, off, s[8:11], s33 sc1
  s_mov_b64 exec, -1
F_HDONE:
  v_lshrrev_b32 v28, 2, v27
  v_lshlrev_b32 v28, 3, v28
  s_lshl_b32 s33, s3, 7
  v_add_u32 v28, s33, v28
  v_lshlrev_b32 v29, 1, v28
  buffer_load_dwordx4 v[96:99], v29, s[20:23], 0 offen
  s_mov_b32 s33, 6144
  v_mul_lo_u32 v28, v28, s33
  v_and_b32 v29, 3, v27
  v_lshlrev_b32 v29, 4, v29
  v_add_u32 v28, v28, v29
  s_lshl_b32 s33, s42, 6
  s_add_u32 s33, s33, 2048
  buffer_load_dwordx4 v[128:131], v28, s[24:27], s33 offen
  s_add_u32 s33, s33, 6144
  buffer_load_dwordx4 v[132:135], v28, s[24:27], s33 offen
  s_add_u32 s33, s33, 6144
  buffer_load_dwordx4 v[136:139], v28, s[24:27], s33 offen
  s_add_u32 s33, s33, 6144
  buffer_load_dwordx4 v[140:143], v28, s[24:27], s33 offen
  s_add_u32 s33, s33, 6144
  buffer_load_dwordx4 v[144:147], v28, s[24:27], s33 offen
  s_add_u32 s33, s33, 6144
  buffer_load_dwordx4 v[148:151], v28, s[24:27], s33 offen
  s_add_u32 s33, s33, 6144
  buffer_load_dwordx4 v[152:155], v28, s[24:27], s33 offen
  s_add_u32 s33, s33, 6144
  buffer_load_dwordx4 v[156:159], v28, s[24:27], s33 offen
  s_waitcnt vmcnt(8)
  v_and_b32 v29, 0xffff0000, v96
  v_lshlrev_b32 v28, 16, v96
  v_and_b32 v31, 0xffff0000, v97
  v_lshlrev_b32 v30, 16, v97
  v_and_b32 v33, 0xffff0000, v98
  v_lshlrev_b32 v32, 16, v98
  v_and_b32 v35, 0xffff0000, v99
  v_lshlrev_b32 v34, 16, v99
  v_mul_f32 v104, 0xbfb8aa3b, v28
  v_mul_f32 v105, 0xbfb8aa3b, v29
  v_mul_f32 v106, 0xbfb8aa3b, v30
  v_mul_f32 v107, 0xbfb8aa3b, v31
  v_mul_f32 v108, 0xbfb8aa3b, v32
  v_mul_f32 v109, 0xbfb8aa3b, v33
  v_mul_f32 v110, 0xbfb8aa3b, v34
  v_mul_f32 v111, 0xbfb8aa3b, v35
  v_exp_f32 v104, v104
  v_exp_f32 v105, v105
  v_exp_f32 v106, v106
  v_exp_f32 v107, v107
  v_exp_f32 v108, v108
  v_exp_f32 v109, v109
  v_exp_f32 v110, v110
  v_exp_f32 v111, v111
  v_add_f32 v104, 1.0, v104
  v_add_f32 v105, 1.0, v105
  v_add_f32 v106, 1.0, v106
  v_add_f32 v107, 1.0, v107
  v_add_f32 v108, 1.0, v108
  v_add_f32 v109, 1.0, v109
  v_add_f32 v110, 1.0, v110
  v_add_f32 v111, 1.0, v111
  v_rcp_f32 v104, v104
  v_rcp_f32 v105, v105
  v_rcp_f32 v106, v106
  v_rcp_f32 v107, v107
  v_rcp_f32 v108, v108
  v_rcp_f32 v109, v109
  v_rcp_f32 v110, v110
  v_rcp_f32 v111, v111
  v_mul_f32 v28, v28, v104
  v_mul_f32 v29, v29, v105
  v_mul_f32 v30, v30, v106
  v_mul_f32 v31, v31, v107
  v_mul_f32 v32, v32, v108
  v_mul_f32 v33, v33, v109
  v_mul_f32 v34, v34, v110
  v_mul_f32 v35, v35, v111
  v_cvt_pk_bf16_f32 v0, v28, v29
  v_and_b32 v29, 0xffff0000, v0
  v_lshlrev_b32 v28, 16, v0
  v_cvt_pk_bf16_f32 v0, v30, v31
  v_and_b32 v31, 0xffff0000, v0
  v_lshlrev_b32 v30, 16, v0
  v_cvt_pk_bf16_f32 v0, v32, v33
  v_and_b32 v33, 0xffff0000, v0
  v_lshlrev_b32 v32, 16, v0
  v_cvt_pk_bf16_f32 v0, v34, v35
  v_and_b32 v35, 0xffff0000, v0
  v_lshlrev_b32 v34, 16, v0
  s_waitcnt vmcnt(7)
  v_and_b32 v105, 0xffff0000, v128
  v_lshlrev_b32 v104, 16, v128
  v_and_b32 v107, 0xffff0000, v129
  v_lshlrev_b32 v106, 16, v129
  v_and_b32 v109, 0xffff0000, v130
  v_lshlrev_b32 v108, 16, v130
  v_and_b32 v111, 0xffff0000, v131
  v_lshlrev_b32 v110, 16, v131
  v_pk_mul_f32 v[44:45], v[104:105], v[28:29] op_sel:[0,0] op_sel_hi:[1,0]
  v_pk_mul_f32 v[46:47], v[106:107], v[28:29] op_sel:[0,0] op_sel_hi:[1,0]
  v_pk_mul_f32 v[48:49], v[108:109], v[28:29] op_sel:[0,0] op_sel_hi:[1,0]
  v_pk_mul_f32 v[50:51], v[110:111], v[28:29] op_sel:[0,0] op_sel_hi:[1,0]
  s_waitcnt vmcnt(6)
  v_and_b32 v105, 0xffff0000, v132
  v_lshlrev_b32 v104, 16, v132
  v_and_b32 v107, 0xffff0000, v133
  v_lshlrev_b32 v106, 16, v133
  v_and_b32 v109, 0xffff0000, v134
  v_lshlrev_b32 v108, 16, v134
  v_and_b32 v111, 0xffff0000, v135
  v_lshlrev_b32 v110, 16, v135
  v_pk_fma_f32 v[44:45], v[104:105], v[28:29], v[44:45] op_sel:[0,1,0] op_sel_hi:[1,1,1]
  v_pk_fma_f32 v[46:47], v[106:107], v[28:29], v[46:47] op_sel:[0,1,0] op_sel_hi:[1,1,1]
  v_pk_fma_f32 v[48:49], v[108:109], v[28:29], v[48:49] op_sel:[0,1,0] op_sel_hi:[1,1,1]
  v_pk_fma_f32 v[50:51], v[110:111], v[28:29], v[50:51] op_sel:[0,1,0] op_sel_hi:[1,1,1]
  s_waitcnt vmcnt(5)
  v_and_b32 v105, 0xffff0000, v136
  v_lshlrev_b32 v104, 16, v136
  v_and_b32 v107, 0xffff0000, v137
  v_lshlrev_b32 v106, 16, v137
  v_and_b32 v109, 0xffff0000, v138
  v_lshlrev_b32 v108, 16, v138
  v_and_b32 v111, 0xffff0000, v139
  v_lshlrev_b32 v110, 16, v139
  v_pk_fma_f32 v[44:45], v[104:105], v[30:31], v[44:45] op_sel:[0,0,0] op_sel_hi:[1,0,1]
  v_pk_fma_f32 v[46:47], v[106:107], v[30:31], v[46:47] op_sel:[0,0,0] op_sel_hi:[1,0,1]
  v_pk_fma_f32 v[48:49], v[108:109], v[30:31], v[48:49] op_sel:[0,0,0] op_sel_hi:[1,0,1]
  v_pk_fma_f32 v[50:51], v[110:111], v[30:31], v[50:51] op_sel:[0,0,0] op_sel_hi:[1,0,1]
  s_waitcnt vmcnt(4)
  v_and_b32 v105, 0xffff0000, v140
  v_lshlrev_b32 v104, 16, v140
  v_and_b32 v107, 0xffff0000, v141
  v_lshlrev_b32 v106, 16, v141
  v_and_b32 v109, 0xffff0000, v142
  v_lshlrev_b32 v108, 16, v142
  v_and_b32 v111, 0xffff0000, v143
  v_lshlrev_b32 v110, 16, v143
  v_pk_fma_f32 v[44:45], v[104:105], v[30:31], v[44:45] op_sel:[0,1,0] op_sel_hi:[1,1,1]
  v_pk_fma_f32 v[46:47], v[106:107], v[30:31], v[46:47] op_sel:[0,1,0] op_sel_hi:[1,1,1]
  v_pk_fma_f32 v[48:49], v[108:109], v[30:31], v[48:49] op_sel:[0,1,0] op_sel_hi:[1,1,1]
  v_pk_fma_f32 v[50:51], v[110:111], v[30:31], v[50:51] op_sel:[0,1,0] op_sel_hi:[1,1,1]
  s_waitcnt vmcnt(3)
  v_and_b32 v105, 0xffff0000, v144
  v_lshlrev_b32 v104, 16, v144
  v_and_b32 v107, 0xffff0000, v145
  v_lshlrev_b32 v106, 16, v145
  v_and_b32 v109, 0xffff0000, v146
  v_lshlrev_b32 v108, 16, v146
  v_and_b32 v111, 0xffff0000, v147
  v_lshlrev_b32 v110, 16, v147
  v_pk_fma_f32 v[44:45], v[104:105], v[32:33], v[44:45] op_sel:[0,0,0] op_sel_hi:[1,0,1]
  v_pk_fma_f32 v[46:47], v[106:107], v[32:33], v[46:47] op_sel:[0,0,0] op_sel_hi:[1,0,1]
  v_pk_fma_f32 v[48:49], v[108:109], v[32:33], v[48:49] op_sel:[0,0,0] op_sel_hi:[1,0,1]
  v_pk_fma_f32 v[50:51], v[110:111], v[32:33], v[50:51] op_sel:[0,0,0] op_sel_hi:[1,0,1]
  s_waitcnt vmcnt(2)
  v_and_b32 v105, 0xffff0000, v148
  v_lshlrev_b32 v104, 16, v148
  v_and_b32 v107, 0xffff0000, v149
  v_lshlrev_b32 v106, 16, v149
  v_and_b32 v109, 0xffff0000, v150
  v_lshlrev_b32 v108, 16, v150
  v_and_b32 v111, 0xffff0000, v151
  v_lshlrev_b32 v110, 16, v151
  v_pk_fma_f32 v[44:45], v[104:105], v[32:33], v[44:45] op_sel:[0,1,0] op_sel_hi:[1,1,1]
  v_pk_fma_f32 v[46:47], v[106:107], v[32:33], v[46:47] op_sel:[0,1,0] op_sel_hi:[1,1,1]
  v_pk_fma_f32 v[48:49], v[108:109], v[32:33], v[48:49] op_sel:[0,1,0] op_sel_hi:[1,1,1]
  v_pk_fma_f32 v[50:51], v[110:111], v[32:33], v[50:51] op_sel:[0,1,0] op_sel_hi:[1,1,1]
  s_waitcnt vmcnt(1)
  v_and_b32 v105, 0xffff0000, v152
  v_lshlrev_b32 v104, 16, v152
  v_and_b32 v107, 0xffff0000, v153
  v_lshlrev_b32 v106, 16, v153
  v_and_b32 v109, 0xffff0000, v154
  v_lshlrev_b32 v108, 16, v154
  v_and_b32 v111, 0xffff0000, v155
  v_lshlrev_b32 v110, 16, v155
  v_pk_fma_f32 v[44:45], v[104:105], v[34:35], v[44:45] op_sel:[0,0,0] op_sel_hi:[1,0,1]
  v_pk_fma_f32 v[46:47], v[106:107], v[34:35], v[46:47] op_sel:[0,0,0] op_sel_hi:[1,0,1]
  v_pk_fma_f32 v[48:49], v[108:109], v[34:35], v[48:49] op_sel:[0,0,0] op_sel_hi:[1,0,1]
  v_pk_fma_f32 v[50:51], v[110:111], v[34:35], v[50:51] op_sel:[0,0,0] op_sel_hi:[1,0,1]
  s_waitcnt vmcnt(0)
  v_and_b32 v105, 0xffff0000, v156
  v_lshlrev_b32 v104, 16, v156
  v_and_b32 v107, 0xffff0000, v157
  v_lshlrev_b32 v106, 16, v157
  v_and_b32 v109, 0xffff0000, v158
  v_lshlrev_b32 v108, 16, v158
  v_and_b32 v111, 0xffff0000, v159
  v_lshlrev_b32 v110, 16, v159
  v_pk_fma_f32 v[44:45], v[104:105], v[34:35], v[44:45] op_sel:[0,1,0] op_sel_hi:[1,1,1]
  v_pk_fma_f32 v[46:47], v[106:107], v[34:35], v[46:47] op_sel:[0,1,0] op_sel_hi:[1,1,1]
  v_pk_fma_f32 v[48:49], v[108:109], v[34:35], v[48:49] op_sel:[0,1,0] op_sel_hi:[1,1,1]
  v_pk_fma_f32 v[50:51], v[110:111], v[34:35], v[50:51] op_sel:[0,1,0] op_sel_hi:[1,1,1]
  v_add_f32_dpp v44, v44, v44 row_ror:4 row_mask:0xf bank_mask:0xf
  v_add_f32_dpp v45, v45, v45 row_ror:4 row_mask:0xf bank_mask:0xf
  v_add_f32_dpp v46, v46, v46 row_ror:4 row_mask:0xf bank_mask:0xf
  v_add_f32_dpp v47, v47, v47 row_ror:4 row_mask:0xf bank_mask:0xf
  v_add_f32_dpp v48, v48, v48 row_ror:4 row_mask:0xf bank_mask:0xf
  v_add_f32_dpp v49, v49, v49 row_ror:4 row_mask:0xf bank_mask:0xf
  v_add_f32_dpp v50, v50, v50 row_ror:4 row_mask:0xf bank_mask:0xf
  v_add_f32_dpp v51, v51, v51 row_ror:4 row_mask:0xf bank_mask:0xf
  v_add_f32_dpp v44, v44, v44 row_ror:8 row_mask:0xf bank_mask:0xf
  v_add_f32_dpp v45, v45, v45 row_ror:8 row_mask:0xf bank_mask:0xf
  v_add_f32_dpp v46, v46, v46 row_ror:8 row_mask:0xf bank_mask:0xf
  v_add_f32_dpp v47, v47, v47 row_ror:8 row_mask:0xf bank_mask:0xf
  v_add_f32_dpp v48, v48, v48 row_ror:8 row_mask:0xf bank_mask:0xf
  v_add_f32_dpp v49, v49, v49 row_ror:8 row_mask:0xf bank_mask:0xf
  v_add_f32_dpp v50, v50, v50 row_ror:8 row_mask:0xf bank_mask:0xf
  v_add_f32_dpp v51, v51, v51 row_ror:8 row_mask:0xf bank_mask:0xf
  v_mov_b32 v104, v44
  v_mov_b32 v105, v45
  v_mov_b32 v106, v46
  v_mov_b32 v107, v47
  v_mov_b32 v108, v48
  v_mov_b32 v109, v49
  v_mov_b32 v110, v50
  v_mov_b32 v111, v51
  v_permlane16_swap_b32 v44, v104
  v_permlane16_swap_b32 v45, v105
  v_permlane16_swap_b32 v46, v106
  v_permlane16_swap_b32 v47, v107
  v_permlane16_swap_b32 v48, v108
  v_permlane16_swap_b32 v49, v109
  v_permlane16_swap_b32 v50, v110
  v_permlane16_swap_b32 v51, v111
  v_add_f32 v44, v44, v104
  v_add_f32 v45, v45, v105
  v_add_f32 v46, v46, v106
  v_add_f32 v47, v47, v107
  v_add_f32 v48, v48, v108
  v_add_f32 v49, v49, v109
  v_add_f32 v50, v50, v110
  v_add_f32 v51, v51, v111
  v_mov_b32 v104, v44
  v_mov_b32 v105, v45
  v_mov_b32 v106, v46
  v_mov_b32 v107, v47
  v_mov_b32 v108, v48
  v_mov_b32 v109, v49
  v_mov_b32 v110, v50
  v_mov_b32 v111, v51
  v_permlane32_swap_b32 v44, v104
  v_permlane32_swap_b32 v45, v105
  v_permlane32_swap_b32 v46, v106
  v_permlane32_swap_b32 v47, v107
  v_permlane32_swap_b32 v48, v108
  v_permlane32_swap_b32 v49, v109
  v_permlane32_swap_b32 v50, v110
  v_permlane32_swap_b32 v51, v111
  v_add_f32 v44, v44, v104
  v_add_f32 v45, v45, v105
  v_add_f32 v46, v46, v106
  v_add_f32 v47, v47, v107
  v_add_f32 v48, v48, v108
  v_add_f32 v49, v49, v109
  v_add_f32 v50, v50, v110
  v_add_f32 v51, v51, v111
  v_lshlrev_b32 v28, 5, v27
  s_lshl_b32 s33, s3, 8
  v_add_u32 v28, s33, v28
  s_mov_b64 exec, 15
  ds_write_b128 v28, v[44:47]
  ds_write_b128 v28, v[48:51] offset:16
  s_mov_b64 exec, -1
  s_waitcnt lgkmcnt(0)
  s_barrier
  s_cmp_lg_u32 s3, 0
  s_cbranch_scc1 F_M2
  v_lshlrev_b32 v28, 2, v27
  ds_read_b32 v44, v28 offset:0
  ds_read_b32 v45, v28 offset:256
  ds_read_b32 v46, v28 offset:512
  ds_read_b32 v47, v28 offset:768
  s_waitcnt lgkmcnt(0)
  v_add_f32 v44, v44, v45
  v_add_f32 v46, v46, v47
  v_add_f32 v44, v44, v46
  v_cvt_pk_bf16_f32 v44, v44, v44
  v_lshlrev_b32 v44, 16, v44
  s_lshr_b32 s33, s42, 4
  s_cmp_eq_u32 s33, 2
  s_cselect_b32 s34, 1.0, 0
  v_add_f32 v44, s34, v44
  v_cvt_pk_bf16_f32 v44, v44, v44
  v_lshlrev_b32 v44, 16, v44
  s_lshl_b32 s33, s42, 7
  s_add_u32 s33, s33, 135168
  s_mov_b32 exec_hi, 0
  s_mov_b32 exec_lo, 0xffffffff
  buffer_store_dword v44, v28, s[8:11], s33 offen sc1
  v_mov_b32 v0, 1
  s_waitcnt vmcnt(0)
  s_mov_b64 exec, 1
  buffer_atomic_add v0, off, s[12:15], 0 offset:4 sc1
  s_mov_b64 exec, -1
F_M2:
  s_lshl_b32 s33, s5, 6
  s_add_u32 s33, s33, 548864
F_G:
  buffer_load_dword v0, off, s[8:11], s33 sc1
  s_waitcnt vmcnt(0)
  v_cmp_ne_u32 vcc, -1, v0
  s_cbranch_vccnz F_GOK
  s_sleep 8
  s_sub_u32 s6, s6, 1
  s_cbranch_scc1 GIVEUP
  s_branch F_G
F_GOK:
  s_mov_b32 s16, s80
  s_mov_b32 s17, s81
  s_mov_b32 s18, 1409024
  s_mov_b32 s19, 0x00020000
  s_mov_b32 s20, s82
  s_mov_b32 s21, s83
  s_mov_b32 s22, 1409024
  s_mov_b32 s23, 0x00020000
  s_mov_b32 s24, s84
  s_mov_b32 s25, s85
  s_mov_b32 s26, 1409024
  s_mov_b32 s27, 0x00020000
  s_cmp_ge_u32 s5, 22
  s_cbranch_scc1 F_WDONE
  s_cmp_eq_u32 s5, 21
  s_cselect_b32 s33, 3, 7
  v_and_b32 v28, s33, v27
  v_lshlrev_b32 v28, 4, v28
  v_lshrrev_b32 v29, 3, v27
  s_mov_b32 s33, 2752
  v_mul_lo_u32 v29, v29, s33
  s_lshl_b32 s33, s5, 7
  v_add3_u32 v28, v28, v29, s33
  s_mul_i32 s34, s3, 352256
  s_lshl_b32 s35, s3, 14
  s_add_u32 m0, s35, 32768
  s_nop 0
  buffer_load_dwordx4 v28, s[16:19], s34 offen lds
  s_add_u32 m0, s35, 98304
  s_nop 0
  buffer_load_dwordx4 v28, s[20:23], s34 offen lds
  s_add_u32 s34, s34, 22016
  s_add_u32 m0, s35, 33792
  s_nop 0
  buffer_load_dwordx4 v28, s[16:19], s34 offen lds
  s_add_u32 m0, s35, 99328
  s_nop 0
  buffer_load_dwordx4 v28, s[20:23], s34 offen lds
  s_add_u32 s34, s34, 22016
  s_add_u32 m0, s35, 34816
  s_nop 0
  buffer_load_dwordx4 v28, s[16:19], s34 offen lds
  s_add_u32 m0, s35, 100352
  s_nop 0
  buffer_load_dwordx4 v28, s[20:23], s34 offen lds
  s_add_u32 s34, s34, 22016
  s_add_u32 m0, s35, 35840
  s_nop 0
  buffer_load_dwordx4 v28, s[16:19], s34 offen lds
  s_add_u32 m0, s35, 101376
  s_nop 0
  buffer_load_dwordx4 v28, s[20:23], s34 offen lds
  s_add_u32 s34, s34, 22016
  s_add_u32 m0, s35, 36864
  s_nop 0
  buffer_load_dwordx4 v28, s[16:19], s34 offen lds
  s_add_u32 m0, s35, 102400
  s_nop 0
  buffer_load_dwordx4 v28, s[20:23], s34 offen lds
  s_add_u32 s34, s34, 22016
  s_add_u32 m0, s35, 37888
  s_nop 0
  buffer_load_dwordx4 v28, s[16:19], s34 offen lds
  s_add_u32 m0, s35, 103424
  s_nop 0
  buffer_load_dwordx4 v28, s[20:23], s34 offen lds
  s_add_u32 s34, s34, 22016
  s_add_u32 m0, s35, 38912
  s_nop 0
  buffer_load_dwordx4 v28, s[16:19], s34 offen lds
  s_add_u32 m0, s35, 104448
  s_nop 0
  buffer_load_dwordx4 v28, s[20:23], s34 offen lds
  s_add_u32 s34, s34, 22016
  s_add_u32 m0, s35, 39936
  s_nop 0
  buffer_load_dwordx4 v28, s[16:19], s34 offen lds
  s_add_u32 m0, s35, 105472
  s_nop 0
  buffer_load_dwordx4 v28, s[20:23], s34 offen lds
  s_add_u32 s34, s34, 22016
  s_add_u32 m0, s35, 40960
  s_nop 0
  buffer_load_dwordx4 v28, s[16:19], s34 offen lds
  s_add_u32 m0, s35, 106496
  s_nop 0
  buffer_load_dwordx4 v28, s[20:23], s34 offen lds
  s_add_u32 s34, s34, 22016
  s_add_u32 m0, s35, 41984
  s_nop 0
  buffer_load_dwordx4 v28, s[16:19], s34 offen lds
  s_add_u32 m0, s35, 107520
  s_nop 0
  buffer_load_dwordx4 v28, s[20:23], s34 offen lds
  s_add_u32 s34, s34, 22016
  s_add_u32 m0, s35, 43008
  s_nop 0
  buffer_load_dwordx4 v28, s[16:19], s34 offen lds
  s_add_u32 m0, s35, 108544
  s_nop 0
  buffer_load_dwordx4 v28, s[20:23], s34 offen lds
  s_add_u32 s34, s34, 22016
  s_add_u32 m0, s35, 44032
  s_nop 0
  buffer_load_dwordx4 v28, s[16:19], s34 offen lds
  s_add_u32 m0, s35, 109568
  s_nop 0
  buffer_load_dwordx4 v28, s[20:23], s34 offen lds
  s_add_u32 s34, s34, 22016
  s_add_u32 m0, s35, 45056
  s_nop 0
  buffer_load_dwordx4 v28, s[16:19], s34 offen lds
  s_add_u32 m0, s35, 110592
  s_nop 0
  buffer_load_dwordx4 v28, s[20:23], s34 offen lds
  s_add_u32 s34, s34, 22016
  s_add_u32 m0, s35, 46080
  s_nop 0
  buffer_load_dwordx4 v28, s[16:19], s34 offen lds
  s_add_u32 m0, s35, 111616
  s_nop 0
  buffer_load_dwordx4 v28, s[20:23], s34 offen lds
  s_add_u32 s34, s34, 22016
  s_add_u32 m0, s35, 47104
  s_nop 0
  buffer_load_dwordx4 v28, s[16:19], s34 offen lds
  s_add_u32 m0, s35, 112640
  s_nop 0
  buffer_load_dwordx4 v28, s[20:23], s34 offen lds
  s_add_u32 s34, s34, 22016
  s_add_u32 m0, s35, 48128
  s_nop 0
  buffer_load_dwordx4 v28, s[16:19], s34 offen lds
  s_add_u32 m0, s35, 113664
  s_nop 0
  buffer_load_dwordx4 v28, s[20:23], s34 offen lds
  v_lshrrev_b32 v29, 4, v27
  v_lshlrev_b32 v30, 12, v29
  v_and_b32 v31, 15, v27
  v_lshlrev_b32 v32, 3, v31
  s_lshl_b32 s33, s5, 16
  s_lshl_b32 s34, s3, 8
  s_add_u32 s33, s33, s34
  v_add3_u32 v30, v30, v32, s33
  v_add_u32 v32, 0x8000, v30
  s_mov_b32 s33, 16384
  s_mov_b32 s39, 0x05040100
  s_mov_b32 s40, 0x07060302
  v_lshlrev_b32 v33, 3, v29
  v_lshrrev_b32 v34, 2, v31
  v_add_u32 v33, v33, v34
  v_lshlrev_b32 v33, 7, v33
  v_and_b32 v34, 3, v31
  v_lshlrev_b32 v34, 3, v34
  s_lshl_b32 s34, s3, 5
  s_add_u32 s34, s34, 32768
  v_add3_u32 v33, v33, v34, s34
  v_add_u32 v34, 65536, v33
  s_waitcnt vmcnt(0)
  buffer_load_dwordx2 v[192:193], v30, s[24:27], 0 offen offset:0
  buffer_load_dwordx2 v[194:195], v30, s[24:27], 0 offen offset:1024
  buffer_load_dwordx2 v[196:197], v30, s[24:27], 0 offen offset:2048
  buffer_load_dwordx2 v[198:199], v30, s[24:27], 0 offen offset:3072
  buffer_load_dwordx2 v[200:201], v30, s[24:27], s33 offen offset:0
  buffer_load_dwordx2 v[202:203], v30, s[24:27], s33 offen offset:1024
  buffer_load_dwordx2 v[204:205], v30, s[24:27], s33 offen offset:2048
  buffer_load_dwordx2 v[206:207], v30, s[24:27], s33 offen offset:3072
  buffer_load_dwordx2 v[208:209], v32, s[24:27], 0 offen offset:0
  buffer_load_dwordx2 v[210:211], v32, s[24:27], 0 offen offset:1024
  buffer_load_dwordx2 v[212:213], v32, s[24:27], 0 offen offset:2048
  buffer_load_dwordx2 v[214:215], v32, s[24:27], 0 offen offset:3072
  buffer_load_dwordx2 v[216:217], v32, s[24:27], s33 offen offset:0
  buffer_load_dwordx2 v[218:219], v32, s[24:27], s33 offen offset:1024
  buffer_load_dwordx2 v[220:221], v32, s[24:27], s33 offen offset:2048
  buffer_load_dwordx2 v[222:223], v32, s[24:27], s33 offen offset:3072
  buffer_load_dwordx2 v[224:225], v30, s[24:27], 0 offen offset:128
  buffer_load_dwordx2 v[226:227], v30, s[24:27], 0 offen offset:1152
  buffer_load_dwordx2 v[228:229], v30, s[24:27], 0 offen offset:2176
  buffer_load_dwordx2 v[230:231], v30, s[24:27], 0 offen offset:3200
  buffer_load_dwordx2 v[232:233], v30, s[24:27], s33 offen offset:128
  buffer_load_dwordx2 v[234:235], v30, s[24:27], s33 offen offset:1152
  buffer_load_dwordx2 v[236:237], v30, s[24:27], s33 offen offset:2176
  buffer_load_dwordx2 v[238:239], v30, s[24:27], s33 offen offset:3200
  buffer_load_dwordx2 v[240:241], v32, s[24:27], 0 offen offset:128
  buffer_load_dwordx2 v[242:243], v32, s[24:27], 0 offen offset:1152
  buffer_load_dwordx2 v[244:245], v32, s[24:27], 0 offen offset:2176
  buffer_load_dwordx2 v[246:247], v32, s[24:27], 0 offen offset:3200
  buffer_load_dwordx2 v[248:249], v32, s[24:27], s33 offen offset:128
  buffer_load_dwordx2 v[250:251], v32, s[24:27], s33 offen offset:1152
  buffer_load_dwordx2 v[252:253], v32, s[24:27], s33 offen offset:2176
  buffer_load_dwordx2 v[254:255], v32, s[24:27], s33 offen offset:3200
  s_barrier
  ds_read_b64_tr_b16 a[0:1], v33 offset:0
  ds_read_b64_tr_b16 a[2:3], v33 offset:512
  ds_read_b64_tr_b16 a[4:5], v33 offset:4096
  ds_read_b64_tr_b16 a[6:7], v33 offset:4608
  ds_read_b64_tr_b16 a[8:9], v33 offset:8192
  ds_read_b64_tr_b16 a[10:11], v33 offset:8704
  ds_read_b64_tr_b16 a[12:13], v33 offset:12288
  ds_read_b64_tr_b16 a[14:15], v33 offset:12800
  s_waitcnt lgkmcnt(0)
  ds_read_b64_tr_b16 a[16:17], v33 offset:16384
  ds_read_b64_tr_b16 a[18:19], v33 offset:16896
  ds_read_b64_tr_b16 a[20:21], v33 offset:20480
  ds_read_b64_tr_b16 a[22:23], v33 offset:20992
  ds_read_b64_tr_b16 a[24:25], v33 offset:24576
  ds_read_b64_tr_b16 a[26:27], v33 offset:25088
  ds_read_b64_tr_b16 a[28:29], v33 offset:28672
  ds_read_b64_tr_b16 a[30:31], v33 offset:29184
  s_waitcnt lgkmcnt(0)
  ds_read_b64_tr_b16 a[32:33], v33 offset:32768
  ds_read_b64_tr_b16 a[34:35], v33 offset:33280
  ds_read_b64_tr_b16 a[36:37], v33 offset:36864
  ds_read_b64_tr_b16 a[38:39], v33 offset:37376
  ds_read_b64_tr_b16 a[40:41], v33 offset:40960
  ds_read_b64_tr_b16 a[42:43], v33 offset:41472
  ds_read_b64_tr_b16 a[44:45], v33 offset:45056
  ds_read_b64_tr_b16 a[46:47], v33 offset:45568
  s_waitcnt lgkmcnt(0)
  ds_read_b64_tr_b16 a[48:49], v33 offset:49152
  ds_read_b64_tr_b16 a[50:51], v33 offset:49664
  ds_read_b64_tr_b16 a[52:53], v33 offset:53248
  ds_read_b64_tr_b16 a[54:55], v33 offset:53760
  ds_read_b64_tr_b16 a[56:57], v33 offset:57344
  ds_read_b64_tr_b16 a[58:59], v33 offset:57856
  ds_read_b64_tr_b16 a[60:61], v33 offset:61440
  ds_read_b64_tr_b16 a[62:63], v33 offset:61952
  s_waitcnt lgkmcnt(0)
  ds_read_b64_tr_b16 a[64:65], v34 offset:0
  ds_read_b64_tr_b16 a[66:67], v34 offset:512
  ds_read_b64_tr_b16 a[68:69], v34 offset:4096
  ds_read_b64_tr_b16 a[70:71], v34 offset:4608
  ds_read_b64_tr_b16 a[72:73], v34 offset:8192
  ds_read_b64_tr_b16 a[74:75], v34 offset:8704
  ds_read_b64_tr_b16 a[76:77], v34 offset:12288
  ds_read_b64_tr_b16 a[78:79], v34 offset:12800
  s_waitcnt lgkmcnt(0)
  ds_read_b64_tr_b16 a[80:81], v34 offset:16384
  ds_read_b64_tr_b16 a[82:83], v34 offset:16896
  ds_read_b64_tr_b16 a[84:85], v34 offset:20480
  ds_read_b64_tr_b16 a[86:87], v34 offset:20992
  ds_read_b64_tr_b16 a[88:89], v34 offset:24576
  ds_read_b64_tr_b16 a[90:91], v34 offset:25088
  ds_read_b64_tr_b16 a[92:93], v34 offset:28672
  ds_read_b64_tr_b16 a[94:95], v34 offset:29184
  s_waitcnt lgkmcnt(0)
  ds_read_b64_tr_b16 a[96:97], v34 offset:32768
  ds_read_b64_tr_b16 a[98:99], v34 offset:33280
  ds_read_b64_tr_b16 a[100:101], v34 offset:36864
  ds_read_b64_tr_b16 a[102:103], v34 offset:37376
  ds_read_b64_tr_b16 a[104:105], v34 offset:40960
  ds_read_b64_tr_b16 a[106:107], v34 offset:41472
  ds_read_b64_tr_b16 a[108:109], v34 offset:45056
  ds_read_b64_tr_b16 a[110:111], v34 offset:45568
  s_waitcnt lgkmcnt(0)
  ds_read_b64_tr_b16 a[112:113], v34 offset:49152
  ds_read_b64_tr_b16 a[114:115], v34 offset:49664
  ds_read_b64_tr_b16 a[116:117], v34 offset:53248
  ds_read_b64_tr_b16 a[118:119], v34 offset:53760
  ds_read_b64_tr_b16 a[120:121], v34 offset:57344
  ds_read_b64_tr_b16 a[122:123], v34 offset:57856
  ds_read_b64_tr_b16 a[124:125], v34 offset:61440
  ds_read_b64_tr_b16 a[126:127], v34 offset:61952
  s_waitcnt lgkmcnt(0)
  s_waitcnt vmcnt(0)
  v_perm_b32 v128, v194, v192, s39
  v_perm_b32 v129, v198, v196, s39
  v_perm_b32 v130, v202, v200, s39
  v_perm_b32 v131, v206, v204, s39
  v_perm_b32 v136, v194, v192, s40
  v_perm_b32 v137, v198, v196, s40
  v_perm_b32 v138, v202, v200, s40
  v_perm_b32 v139, v206, v204, s40
  v_perm_b32 v144, v195, v193, s39
  v_perm_b32 v145, v199, v197, s39
  v_perm_b32 v146, v203, v201, s39
  v_perm_b32 v147, v207, v205, s39
  v_perm_b32 v152, v195, v193, s40
  v_perm_b32 v153, v199, v197, s40
  v_perm_b32 v154, v203, v201, s40
  v_perm_b32 v155, v207, v205, s40
  v_perm_b32 v132, v210, v208, s39
  v_perm_b32 v133, v214, v212, s39
  v_perm_b32 v134, v218, v216, s39
  v_perm_b32 v135, v222, v220, s39
  v_perm_b32 v140, v210, v208, s40
  v_perm_b32 v141, v214, v212, s40
  v_perm_b32 v142, v218, v216, s40
  v_perm_b32 v143, v222, v220, s40
  v_perm_b32 v148, v211, v209, s39
  v_perm_b32 v149, v215, v213, s39
  v_perm_b32 v150, v219, v217, s39
  v_perm_b32 v151, v223, v221, s39
  v_perm_b32 v156, v211, v209, s40
  v_perm_b32 v157, v215, v213, s40
  v_perm_b32 v158, v219, v217, s40
  v_perm_b32 v159, v223, v221, s40
  v_perm_b32 v160, v226, v224, s39
  v_perm_b32 v161, v230, v228, s39
  v_perm_b32 v162, v234, v232, s39
  v_perm_b32 v163, v238, v236, s39
  v_perm_b32 v168, v226, v224, s40
  v_perm_b32 v169, v230, v228, s40
  v_perm_b32 v170, v234, v232, s40
  v_perm_b32 v171, v238, v236, s40
  v_perm_b32 v176, v227, v225, s39
  v_perm_b32 v177, v231, v229, s39
  v_perm_b32 v178, v235, v233, s39
  v_perm_b32 v179, v239, v237, s39
  v_perm_b32 v184, v227, v225, s40
  v_perm_b32 v185, v231, v229, s40
  v_perm_b32 v186, v235, v233, s40
  v_perm_b32 v187, v239, v237, s40
  v_perm_b32 v164, v242, v240, s39
  v_perm_b32 v165, v246, v244, s39
  v_perm_b32 v166, v250, v248, s39
  v_perm_b32 v167, v254, v252, s39
  v_perm_b32 v172, v242, v240, s40
  v_perm_b32 v173, v246, v244, s40
  v_perm_b32 v174, v250, v248, s40
  v_perm_b32 v175, v254, v252, s40
  v_perm_b32 v180, v243, v241, s39
  v_perm_b32 v181, v247, v245, s39
  v_perm_b32 v182, v251, v249, s39
  v_perm_b32 v183, v255, v253, s39
  v_perm_b32 v188, v243, v241, s40
  v_perm_b32 v189, v247, v245, s40
  v_perm_b32 v190, v251, v249, s40
  v_perm_b32 v191, v255, v253, s40
  s_barrier
F_WDONE:
F_MQ:
  buffer_load_dword v0, off, s[12:15], 0 offset:4 sc1
  s_waitcnt vmcnt(0)
  v_cmp_le_u32 vcc, 64, v0
  s_cbranch_vccnz F_MQOK
  s_sleep 1
  s_sub_u32 s6, s6, 1
  s_cbranch_scc1 GIVEUP
  s_branch F_MQ
F_MQOK:
  v_lshlrev_b32 v24, 1, v21
  s_mov_b32 s34, 141312
  buffer_load_dwordx2 v[4:5], v24, s[8:11], s34 offen sc1
  s_waitcnt vmcnt(0)
  s_cmp_lg_u32 s7, 0
  s_cbranch_scc1 FS_ENTRY
FF_ENTRY:
  v_cndmask_b32 v216, 0, v22, s[52:53]
  v_cndmask_b32 v217, 0, v22, s[54:55]
  v_cndmask_b32 v218, 0, v22, s[56:57]
  v_cndmask_b32 v219, 0, v22, s[58:59]
  s_mov_b32 s44, 0
  s_mov_b32 s49, 0
FF_LOOP:
  s_cmp_ge_u32 s5, 22
  s_cbranch_scc1 FF_NOP
  s_lshl_b32 s33, s41, 9
  s_add_u32 s33, s33, 32768
FF_HP:
  buffer_load_dword v0, v3, s[8:11], s33 offen sc1
  s_waitcnt vmcnt(0)
  v_cmp_gt_u32 vcc, 2, v0
  s_cbranch_vccz FF_HOK
  s_sleep 2
  s_sub_u32 s6, s6, 1
  s_cbranch_scc1 GIVEUP
  s_branch FF_HP
FF_HOK:
  s_lshl_b32 s33, s41, 15
  s_add_u32 s33, s33, 4194304
  s_lshl_b32 s34, s3, 8
  s_add_u32 s34, s34, s33
  s_lshl_b32 s35, s3, 13
  s_add_u32 s35, s35, s49
  s_add_u32 s39, s34, 0
  s_add_u32 m0, s35, 0
  s_nop 0
  buffer_load_dwordx4 v19, s[8:11], s39 offen sc1 lds
  s_add_u32 s39, s34, 16384
  s_add_u32 m0, s35, 2048
  s_nop 0
  buffer_load_dwordx4 v19, s[8:11], s39 offen sc1 lds
  s_add_u32 s39, s34, 128
  s_add_u32 m0, s35, 4096
  s_nop 0
  buffer_load_dwordx4 v19, s[8:11], s39 offen sc1 lds
  s_add_u32 s39, s34, 16512
  s_add_u32 m0, s35, 6144
  s_nop 0
  buffer_load_dwordx4 v19, s[8:11], s39 offen sc1 lds
  v_xor_b32 v19, 64, v19
  s_add_u32 s39, s34, 8192
  s_add_u32 m0, s35, 1024
  s_nop 0
  buffer_load_dwordx4 v19, s[8:11], s39 offen sc1 lds
  s_add_u32 s39, s34, 24576
  s_add_u32 m0, s35, 3072
  s_nop 0
  buffer_load_dwordx4 v19, s[8:11], s39 offen sc1 lds
  s_add_u32 s39, s34, 8320
  s_add_u32 m0, s35, 5120
  s_nop 0
  buffer_load_dwordx4 v19, s[8:11], s39 offen sc1 lds
  s_add_u32 s39, s34, 24704
  s_add_u32 m0, s35, 7168
  s_nop 0
  buffer_load_dwordx4 v19, s[8:11], s39 offen sc1 lds
  v_xor_b32 v19, 64, v19
  s_add_u32 s33, s41, 2
  s_lshl_b32 s33, s33, 9
  s_add_u32 s33, s33, 32768
  s_cmp_ge_u32 s41, 62
  s_cselect_b32 s33, 98304, s33
  buffer_load_dword v226, v3, s[8:11], s33 offen sc1
  s_waitcnt vmcnt(0)
FF_TOP:
  s_barrier
  ds_read_b128 v[28:31], v6 offset:0
  ds_read_b128 v[32:35], v6 offset:2048
  ds_read_b128 v[36:39], v7 offset:0
  ds_read_b128 v[40:43], v7 offset:2048
  ds_read_b128 v[44:47], v6 offset:4096
  ds_read_b128 v[48:51], v6 offset:6144
  buffer_load_dword v227, v23, s[8:11], s47 offen sc1
  s_xor_b32 s49, s49, 0x10000
  v_cmp_gt_u32 s[64:65], 2, v226
  s_mov_b32 s48, 0
  ds_read_b128 v[52:55], v7 offset:4096
  ds_read_b128 v[56:59], v7 offset:6144
  s_waitcnt lgkmcnt(6)
  v_mfma_f32_16x16x32_bf16 v[60:63], a[0:3], v[28:31], 0
  v_mfma_f32_16x16x32_bf16 v[68:71], a[64:67], v[28:31], 0
  v_mfma_f32_16x16x32_bf16 v[64:67], a[0:3], v[32:35], 0
  v_mfma_f32_16x16x32_bf16 v[72:75], a[64:67], v[32:35], 0
  ds_read_b128 v[28:31], v6 offset:8192
  ds_read_b128 v[32:35], v6 offset:10240
  s_waitcnt lgkmcnt(6)
  v_mfma_f32_16x16x32_bf16 v[60:63], a[4:7], v[36:39], v[60:63]
  v_mfma_f32_16x16x32_bf16 v[68:71], a[68:71], v[36:39], v[68:71]
  v_mfma_f32_16x16x32_bf16 v[64:67], a[4:7], v[40:43], v[64:67]
  v_mfma_f32_16x16x32_bf16 v[72:75], a[68:71], v[40:43], v[72:75]
  ds_read_b128 v[36:39], v7 offset:8192
  ds_read_b128 v[40:43], v7 offset:10240
  s_waitcnt lgkmcnt(6)
  v_mfma_f32_16x16x32_bf16 v[60:63], a[8:11], v[44:47], v[60:63]
  v_mfma_f32_16x16x32_bf16 v[68:71], a[72:75], v[44:47], v[68:71]
  v_mfma_f32_16x16x32_bf16 v[64:67], a[8:11], v[48:51], v[64:67]
  v_mfma_f32_16x16x32_bf16 v[72:75], a[72:75], v[48:51], v[72:75]
  ds_read_b128 v[44:47], v6 offset:12288
  ds_read_b128 v[48:51], v6 offset:14336
  s_waitcnt lgkmcnt(6)
  v_mfma_f32_16x16x32_bf16 v[60:63], a[12:15], v[52:55], v[60:63]
  v_mfma_f32_16x16x32_bf16 v[68:71], a[76:79], v[52:55], v[68:71]
  v_mfma_f32_16x16x32_bf16 v[64:67], a[12:15], v[56:59], v[64:67]
  v_mfma_f32_16x16x32_bf16 v[72:75], a[76:79], v[56:59], v[72:75]
  ds_read_b128 v[52:55], v7 offset:12288
  ds_read_b128 v[56:59], v7 offset:14336
  s_waitcnt lgkmcnt(6)
  v_mfma_f32_16x16x32_bf16 v[60:63], a[16:19], v[28:31], v[60:63]
  v_mfma_f32_16x16x32_bf16 v[68:71], a[80:83], v[28:31], v[68:71]
  v_mfma_f32_16x16x32_bf16 v[64:67], a[16:19], v[32:35], v[64:67]
  v_mfma_f32_16x16x32_bf16 v[72:75], a[80:83], v[32:35], v[72:75]
  ds_read_b128 v[28:31], v6 offset:16384
  ds_read_b128 v[32:35], v6 offset:18432
  s_waitcnt lgkmcnt(6)
  v_mfma_f32_16x16x32_bf16 v[60:63], a[20:23], v[36:39], v[60:63]
  v_mfma_f32_16x16x32_bf16 v[68:71], a[84:87], v[36:39], v[68:71]
  v_mfma_f32_16x16x32_bf16 v[64:67], a[20:23], v[40:43], v[64:67]
  v_mfma_f32_16x16x32_bf16 v[72:75], a[84:87], v[40:43], v[72:75]
  ds_read_b128 v[36:39], v7 offset:16384
  ds_read_b128 v[40:43], v7 offset:18432
  s_waitcnt lgkmcnt(6)
  v_mfma_f32_16x16x32_bf16 v[60:63], a[24:27], v[44:47], v[60:63]
  v_mfma_f32_16x16x32_bf16 v[68:71], a[88:91], v[44:47], v[68:71]
  v_mfma_f32_16x16x32_bf16 v[64:67], a[24:27], v[48:51], v[64:67]
  v_mfma_f32_16x16x32_bf16 v[72:75], a[88:91], v[48:51], v[72:75]
  ds_read_b128 v[44:47], v6 offset:20480
  ds_read_b128 v[48:51], v6 offset:22528
  s_waitcnt vmcnt(0)
  s_cmp_eq_u32 s44, 0
  s_cbranch_scc1 FF_NP
  v_cmp_gt_u32 vcc, s43, v227
  s_cbranch_vccz FGPOK_48
FGP_47:
  buffer_load_dword v227, v23, s[8:11], s47 offen sc1
  s_waitcnt vmcnt(0)
  v_cmp_gt_u32 vcc, s43, v227
  s_cbranch_vccz FGPOK_48
  s_sleep 1
  s_sub_u32 s6, s6, 1
  s_cbranch_scc1 GIVEUP
  s_branch FGP_47
FGPOK_48:
  s_add_u32 s37, s50, 6291456
  buffer_load_dword v224, v21, s[8:11], s37 offen sc1
  buffer_load_dwordx4 v[192:195], v20, s[8:11], s46 offen sc1
  s_add_u32 s36, s46, 4096
  buffer_load_dwordx4 v[196:199], v20, s[8:11], s36 offen sc1
  s_add_u32 s36, s46, 8192
  buffer_load_dwordx4 v[200:203], v20, s[8:11], s36 offen sc1
  s_add_u32 s36, s46, 12288
  buffer_load_dwordx4 v[204:207], v20, s[8:11], s36 offen sc1
  s_add_u32 s36, s46, 16384
  buffer_load_dwordx4 v[208:211], v20, s[8:11], s36 offen sc1
  s_add_u32 s36, s46, 20480
  buffer_load_dwordx4 v[212:215], v1, s[8:11], s36 offen sc1
  s_xor_b32 s46, s46, 0x100000
FF_NP:
  s_cmp_lg_u64 s[64:65], 0
  s_cbranch_scc1 FF_NF
  s_mov_b32 s48, 1
  s_add_u32 s33, s41, 2
  s_lshl_b32 s33, s33, 15
  s_add_u32 s33, s33, 4194304
  s_lshl_b32 s34, s3, 8
  s_add_u32 s34, s34, s33
  s_lshl_b32 s35, s3, 13
  s_add_u32 s35, s35, s49
  s_add_u32 s39, s34, 0
  s_add_u32 m0, s35, 0
  s_nop 0
  buffer_load_dwordx4 v19, s[8:11], s39 offen sc1 lds
  s_add_u32 s39, s34, 16384
  s_add_u32 m0, s35, 2048
  s_nop 0
  buffer_load_dwordx4 v19, s[8:11], s39 offen sc1 lds
  s_add_u32 s39, s34, 128
  s_add_u32 m0, s35, 4096
  s_nop 0
  buffer_load_dwordx4 v19, s[8:11], s39 offen sc1 lds
  s_add_u32 s39, s34, 16512
  s_add_u32 m0, s35, 6144
  s_nop 0
  buffer_load_dwordx4 v19, s[8:11], s39 offen sc1 lds
  v_xor_b32 v19, 64, v19
  s_add_u32 s39, s34, 8192
  s_add_u32 m0, s35, 1024
  s_nop 0
  buffer_load_dwordx4 v19, s[8:11], s39 offen sc1 lds
  s_add_u32 s39, s34, 24576
  s_add_u32 m0, s35, 3072
  s_nop 0
  buffer_load_dwordx4 v19, s[8:11], s39 offen sc1 lds
  s_add_u32 s39, s34, 8320
  s_add_u32 m0, s35, 5120
  s_nop 0
  buffer_load_dwordx4 v19, s[8:11], s39 offen sc1 lds
  s_add_u32 s39, s34, 24704
  s_add_u32 m0, s35, 7168
  s_nop 0
  buffer_load_dwordx4 v19, s[8:11], s39 offen sc1 lds
  v_xor_b32 v19, 64, v19
  s_branch FF_NG
FF_NF:
  s_add_u32 s33, s41, 2
  s_lshl_b32 s33, s33, 9
  s_add_u32 s33, s33, 32768
  s_cmp_ge_u32 s41, 62
  s_cselect_b32 s33, 98304, s33
  buffer_load_dword v226, v3, s[8:11], s33 offen sc1
FF_NG:
  s_waitcnt lgkmcnt(6)
  v_mfma_f32_16x16x32_bf16 v[60:63], a[28:31], v[52:55], v[60:63]
  v_mfma_f32_16x16x32_bf16 v[68:71], a[92:95], v[52:55], v[68:71]
  v_mfma_f32_16x16x32_bf16 v[64:67], a[28:31], v[56:59], v[64:67]
  v_mfma_f32_16x16x32_bf16 v[72:75], a[92:95], v[56:59], v[72:75]
  ds_read_b128 v[52:55], v7 offset:20480
  ds_read_b128 v[56:59], v7 offset:22528
  s_waitcnt lgkmcnt(6)
  v_mfma_f32_16x16x32_bf16 v[60:63], a[32:35], v[28:31], v[60:63]
  v_mfma_f32_16x16x32_bf16 v[68:71], a[96:99], v[28:31], v[68:71]
  v_mfma_f32_16x16x32_bf16 v[64:67], a[32:35], v[32:35], v[64:67]
  v_mfma_f32_16x16x32_bf16 v[72:75], a[96:99], v[32:35], v[72:75]
  ds_read_b128 v[28:31], v6 offset:24576
  ds_read_b128 v[32:35], v6 offset:26624
  s_waitcnt lgkmcnt(6)
  v_mfma_f32_16x16x32_bf16 v[60:63], a[36:39], v[36:39], v[60:63]
  v_mfma_f32_16x16x32_bf16 v[68:71], a[100:103], v[36:39], v[68:71]
  v_mfma_f32_16x16x32_bf16 v[64:67], a[36:39], v[40:43], v[64:67]
  v_mfma_f32_16x16x32_bf16 v[72:75], a[100:103], v[40:43], v[72:75]
  ds_read_b128 v[36:39], v7 offset:24576
  ds_read_b128 v[40:43], v7 offset:26624
  s_waitcnt lgkmcnt(6)
  v_mfma_f32_16x16x32_bf16 v[60:63], a[40:43], v[44:47], v[60:63]
  v_mfma_f32_16x16x32_bf16 v[68:71], a[104:107], v[44:47], v[68:71]
  v_mfma_f32_16x16x32_bf16 v[64:67], a[40:43], v[48:51], v[64:67]
  v_mfma_f32_16x16x32_bf16 v[72:75], a[104:107], v[48:51], v[72:75]
  ds_read_b128 v[44:47], v6 offset:28672
  ds_read_b128 v[48:51], v6 offset:30720
  s_waitcnt lgkmcnt(6)
  v_mfma_f32_16x16x32_bf16 v[60:63], a[44:47], v[52:55], v[60:63]
  v_mfma_f32_16x16x32_bf16 v[68:71], a[108:111], v[52:55], v[68:71]
  v_mfma_f32_16x16x32_bf16 v[64:67], a[44:47], v[56:59], v[64:67]
  v_mfma_f32_16x16x32_bf16 v[72:75], a[108:111], v[56:59], v[72:75]
  ds_read_b128 v[52:55], v7 offset:28672
  ds_read_b128 v[56:59], v7 offset:30720
  s_waitcnt lgkmcnt(6)
  v_mfma_f32_16x16x32_bf16 v[60:63], a[48:51], v[28:31], v[60:63]
  v_mfma_f32_16x16x32_bf16 v[68:71], a[112:115], v[28:31], v[68:71]
  v_mfma_f32_16x16x32_bf16 v[64:67], a[48:51], v[32:35], v[64:67]
  v_mfma_f32_16x16x32_bf16 v[72:75], a[112:115], v[32:35], v[72:75]
  s_waitcnt lgkmcnt(4)
  v_mfma_f32_16x16x32_bf16 v[60:63], a[52:55], v[36:39], v[60:63]
  v_mfma_f32_16x16x32_bf16 v[68:71], a[116:119], v[36:39], v[68:71]
  v_mfma_f32_16x16x32_bf16 v[64:67], a[52:55], v[40:43], v[64:67]
  v_mfma_f32_16x16x32_bf16 v[72:75], a[116:119], v[40:43], v[72:75]
  s_waitcnt lgkmcnt(2)
  v_mfma_f32_16x16x32_bf16 v[60:63], a[56:59], v[44:47], v[60:63]
  v_mfma_f32_16x16x32_bf16 v[68:71], a[120:123], v[44:47], v[68:71]
  v_mfma_f32_16x16x32_bf16 v[64:67], a[56:59], v[48:51], v[64:67]
  v_mfma_f32_16x16x32_bf16 v[72:75], a[120:123], v[48:51], v[72:75]
  s_waitcnt lgkmcnt(0)
  v_mfma_f32_16x16x32_bf16 v[60:63], a[60:63], v[52:55], v[60:63]
  v_mfma_f32_16x16x32_bf16 v[68:71], a[124:127], v[52:55], v[68:71]
  v_mfma_f32_16x16x32_bf16 v[64:67], a[60:63], v[56:59], v[64:67]
  v_mfma_f32_16x16x32_bf16 v[72:75], a[124:127], v[56:59], v[72:75]
  v_cvt_pk_bf16_f32 v28, v60, v61
  v_and_b32 v61, 0xffff0000, v28
  v_lshlrev_b32 v60, 16, v28
  v_cvt_pk_bf16_f32 v29, v62, v63
  v_and_b32 v63, 0xffff0000, v29
  v_lshlrev_b32 v62, 16, v29
  v_cvt_pk_bf16_f32 v30, v64, v65
  v_and_b32 v65, 0xffff0000, v30
  v_lshlrev_b32 v64, 16, v30
  v_cvt_pk_bf16_f32 v31, v66, v67
  v_and_b32 v67, 0xffff0000, v31
  v_lshlrev_b32 v66, 16, v31
  v_mul_f32 v28, 0xbfb8aa3b, v60
  v_mul_f32 v29, 0xbfb8aa3b, v61
  v_mul_f32 v30, 0xbfb8aa3b, v62
  v_mul_f32 v31, 0xbfb8aa3b, v63
  v_mul_f32 v32, 0xbfb8aa3b, v64
  v_mul_f32 v33, 0xbfb8aa3b, v65
  v_mul_f32 v34, 0xbfb8aa3b, v66
  v_mul_f32 v35, 0xbfb8aa3b, v67
  v_exp_f32 v28, v28
  v_exp_f32 v29, v29
  v_exp_f32 v30, v30
  v_exp_f32 v31, v31
  v_exp_f32 v32, v32
  v_exp_f32 v33, v33
  v_exp_f32 v34, v34
  v_exp_f32 v35, v35
  v_add_f32 v28, 1.0, v28
  v_add_f32 v29, 1.0, v29
  v_add_f32 v30, 1.0, v30
  v_add_f32 v31, 1.0, v31
  v_add_f32 v32, 1.0, v32
  v_add_f32 v33, 1.0, v33
  v_add_f32 v34, 1.0, v34
  v_add_f32 v35, 1.0, v35
  v_rcp_f32 v28, v28
  v_rcp_f32 v29, v29
  v_rcp_f32 v30, v30
  v_rcp_f32 v31, v31
  v_rcp_f32 v32, v32
  v_rcp_f32 v33, v33
  v_rcp_f32 v34, v34
  v_rcp_f32 v35, v35
  v_mul_f32 v60, v60, v28
  v_mul_f32 v61, v61, v29
  v_mul_f32 v62, v62, v30
  v_mul_f32 v63, v63, v31
  v_mul_f32 v64, v64, v32
  v_mul_f32 v65, v65, v33
  v_mul_f32 v66, v66, v34
  v_mul_f32 v67, v67, v35
  v_cvt_pk_bf16_f32 v28, v60, v61
  v_and_b32 v61, 0xffff0000, v28
  v_lshlrev_b32 v60, 16, v28
  v_cvt_pk_bf16_f32 v32, v68, v69
  v_and_b32 v69, 0xffff0000, v32
  v_lshlrev_b32 v68, 16, v32
  v_cvt_pk_bf16_f32 v29, v62, v63
  v_and_b32 v63, 0xffff0000, v29
  v_lshlrev_b32 v62, 16, v29
  v_cvt_pk_bf16_f32 v33, v70, v71
  v_and_b32 v71, 0xffff0000, v33
  v_lshlrev_b32 v70, 16, v33
  v_cvt_pk_bf16_f32 v30, v64, v65
  v_and_b32 v65, 0xffff0000, v30
  v_lshlrev_b32 v64, 16, v30
  v_cvt_pk_bf16_f32 v34, v72, v73
  v_and_b32 v73, 0xffff0000, v34
  v_lshlrev_b32 v72, 16, v34
  v_cvt_pk_bf16_f32 v31, v66, v67
  v_and_b32 v67, 0xffff0000, v31
  v_lshlrev_b32 v66, 16, v31
  v_cvt_pk_bf16_f32 v35, v74, v75
  v_and_b32 v75, 0xffff0000, v35
  v_lshlrev_b32 v74, 16, v35
  v_pk_mul_f32 v[60:61], v[60:61], v[68:69]
  v_pk_mul_f32 v[62:63], v[62:63], v[70:71]
  v_pk_mul_f32 v[64:65], v[64:65], v[72:73]
  v_pk_mul_f32 v[66:67], v[66:67], v[74:75]
  v_cvt_pk_bf16_f32 v68, v60, v61
  v_cvt_pk_bf16_f32 v69, v62, v63
  v_cvt_pk_bf16_f32 v70, v64, v65
  v_cvt_pk_bf16_f32 v71, v66, v67
  ds_write_b64 v2, v[68:69]
  ds_write_b64 v2, v[70:71] offset:2048
  v_xor_b32 v6, 0x10000, v6
  v_xor_b32 v7, 0x10000, v7
  s_waitcnt lgkmcnt(0)
  s_barrier
  ds_read_b128 v[76:79], v13 offset:32768
  ds_read_b128 v[80:83], v13 offset:33792
  ds_read_b128 v[84:87], v13 offset:34816
  ds_read_b128 v[88:91], v13 offset:35840
  s_cmp_eq_u32 s44, 0
  s_cbranch_scc1 FF_ND
  s_cmp_eq_u32 s48, 0
  s_cbranch_scc1 FF_W0
  s_waitcnt vmcnt(8)
  s_branch FF_W1
FF_W0:
  s_waitcnt vmcnt(1)
FF_W1:
  v_mfma_f32_16x16x32_bf16 v[220:223], v[216:219], v[192:195], 0
  v_mfma_f32_16x16x32_bf16 v[220:223], v[216:219], v[196:199], v[220:223]
  v_mfma_f32_16x16x32_bf16 v[220:223], v[216:219], v[200:203], v[220:223]
  v_mfma_f32_16x16x32_bf16 v[220:223], v[216:219], v[204:207], v[220:223]
  v_mfma_f32_16x16x32_bf16 v[220:223], v[216:219], v[208:211], v[220:223]
  v_mfma_f32_16x16x32_bf16 v[220:223], v[216:219], v[212:215], v[220:223]
  v_and_b32 v225, 0xffff0000, v224
  v_lshlrev_b32 v224, 16, v224
  s_nop 4
  v_cvt_pk_bf16_f32 v0, v220, v221
  v_and_b32 v221, 0xffff0000, v0
  v_lshlrev_b32 v220, 16, v0
  v_pk_mul_f32 v[220:221], v[220:221], v[4:5]
  v_cvt_pk_bf16_f32 v0, v220, v221
  v_and_b32 v221, 0xffff0000, v0
  v_lshlrev_b32 v220, 16, v0
  v_pk_add_f32 v[220:221], v[220:221], v[224:225]
  v_cvt_pk_bf16_f32 v220, v220, v221
  buffer_store_dword v220, v21, s[28:31], s50 offen
FF_ND:
  s_waitcnt lgkmcnt(0)
  v_mfma_f32_16x16x32_bf16 v[92:95], v[76:79], v[128:131], 0
  v_mfma_f32_16x16x32_bf16 v[96:99], v[76:79], v[136:139], 0
  v_mfma_f32_16x16x32_bf16 v[100:103], v[76:79], v[144:147], 0
  v_mfma_f32_16x16x32_bf16 v[104:107], v[76:79], v[152:155], 0
  v_mfma_f32_16x16x32_bf16 v[108:111], v[76:79], v[160:163], 0
  v_mfma_f32_16x16x32_bf16 v[112:115], v[76:79], v[168:171], 0
  v_mfma_f32_16x16x32_bf16 v[116:119], v[76:79], v[176:179], 0
  v_mfma_f32_16x16x32_bf16 v[120:123], v[76:79], v[184:187], 0
  v_mfma_f32_16x16x32_bf16 v[92:95], v[80:83], v[132:135], v[92:95]
  v_mfma_f32_16x16x32_bf16 v[96:99], v[80:83], v[140:143], v[96:99]
  v_mfma_f32_16x16x32_bf16 v[100:103], v[80:83], v[148:151], v[100:103]
  v_mfma_f32_16x16x32_bf16 v[104:107], v[80:83], v[156:159], v[104:107]
  v_mfma_f32_16x16x32_bf16 v[108:111], v[80:83], v[164:167], v[108:111]
  v_mfma_f32_16x16x32_bf16 v[112:115], v[80:83], v[172:175], v[112:115]
  v_mfma_f32_16x16x32_bf16 v[116:119], v[80:83], v[180:183], v[116:119]
  v_mfma_f32_16x16x32_bf16 v[120:123], v[80:83], v[188:191], v[120:123]
  v_mfma_f32_16x16x32_bf16 v[28:31], v[84:87], v[128:131], 0
  v_mfma_f32_16x16x32_bf16 v[32:35], v[84:87], v[136:139], 0
  v_mfma_f32_16x16x32_bf16 v[36:39], v[84:87], v[144:147], 0
  v_cvt_pk_bf16_f32 v60, v92, v96
  v_cvt_pk_bf16_f32 v61, v100, v104
  v_mfma_f32_16x16x32_bf16 v[40:43], v[84:87], v[152:155], 0
  v_cvt_pk_bf16_f32 v62, v108, v112
  v_cvt_pk_bf16_f32 v63, v116, v120
  v_mfma_f32_16x16x32_bf16 v[44:47], v[84:87], v[160:163], 0
  s_add_u32 s36, s45, 0
  buffer_store_dwordx4 v[60:63], v18, s[8:11], s36 offen
  v_cvt_pk_bf16_f32 v64, v93, v97
  v_mfma_f32_16x16x32_bf16 v[48:51], v[84:87], v[168:171], 0
  v_cvt_pk_bf16_f32 v65, v101, v105
  v_cvt_pk_bf16_f32 v66, v109, v113
  v_mfma_f32_16x16x32_bf16 v[52:55], v[84:87], v[176:179], 0
  v_cvt_pk_bf16_f32 v67, v117, v121
  s_add_u32 s36, s45, 32768
  buffer_store_dwordx4 v[64:67], v18, s[8:11], s36 offen
  v_mfma_f32_16x16x32_bf16 v[56:59], v[84:87], v[184:187], 0
  v_cvt_pk_bf16_f32 v60, v94, v98
  v_cvt_pk_bf16_f32 v61, v102, v106
  v_mfma_f32_16x16x32_bf16 v[28:31], v[88:91], v[132:135], v[28:31]
  v_cvt_pk_bf16_f32 v62, v110, v114
  v_cvt_pk_bf16_f32 v63, v118, v122
  v_mfma_f32_16x16x32_bf16 v[32:35], v[88:91], v[140:143], v[32:35]
  s_add_u32 s36, s45, 65536
  buffer_store_dwordx4 v[60:63], v18, s[8:11], s36 offen
  v_cvt_pk_bf16_f32 v64, v95, v99
  v_mfma_f32_16x16x32_bf16 v[36:39], v[88:91], v[148:151], v[36:39]
  v_cvt_pk_bf16_f32 v65, v103, v107
  v_cvt_pk_bf16_f32 v66, v111, v115
  v_mfma_f32_16x16x32_bf16 v[40:43], v[88:91], v[156:159], v[40:43]
  v_cvt_pk_bf16_f32 v67, v119, v123
  s_add_u32 s36, s45, 98304
  buffer_store_dwordx4 v[64:67], v18, s[8:11], s36 offen
  v_mfma_f32_16x16x32_bf16 v[44:47], v[88:91], v[164:167], v[44:47]
  v_mfma_f32_16x16x32_bf16 v[48:51], v[88:91], v[172:175], v[48:51]
  v_mfma_f32_16x16x32_bf16 v[52:55], v[88:91], v[180:183], v[52:55]
  v_mfma_f32_16x16x32_bf16 v[56:59], v[88:91], v[188:191], v[56:59]
  v_cvt_pk_bf16_f32 v60, v28, v32
  v_cvt_pk_bf16_f32 v61, v36, v40
  v_cvt_pk_bf16_f32 v62, v44, v48
  s_nop 3
  v_cvt_pk_bf16_f32 v63, v52, v56
  s_add_u32 s36, s45, 524288
  buffer_store_dwordx4 v[60:63], v18, s[8:11], s36 offen
  v_cvt_pk_bf16_f32 v64, v29, v33
  v_cvt_pk_bf16_f32 v65, v37, v41
  v_cvt_pk_bf16_f32 v66, v45, v49
  v_cvt_pk_bf16_f32 v67, v53, v57
  s_add_u32 s36, s45, 557056
  buffer_store_dwordx4 v[64:67], v18, s[8:11], s36 offen
  v_cvt_pk_bf16_f32 v60, v30, v34
  v_cvt_pk_bf16_f32 v61, v38, v42
  v_cvt_pk_bf16_f32 v62, v46, v50
  v_cvt_pk_bf16_f32 v63, v54, v58
  s_add_u32 s36, s45, 589824
  buffer_store_dwordx4 v[60:63], v18, s[8:11], s36 offen
  v_cvt_pk_bf16_f32 v64, v31, v35
  v_cvt_pk_bf16_f32 v65, v39, v43
  v_cvt_pk_bf16_f32 v66, v47, v51
  v_cvt_pk_bf16_f32 v67, v55, v59
  s_add_u32 s36, s45, 622592
  buffer_store_dwordx4 v[64:67], v18, s[8:11], s36 offen
  s_cmp_lg_u32 s48, 0
  s_cbranch_scc1 FF_L1
  s_waitcnt vmcnt(8)
  v_cmp_gt_u32 vcc, 2, v226
  s_cbranch_vccnz FF_L2
  s_mov_b32 s48, 1
  s_add_u32 s33, s41, 2
  s_lshl_b32 s33, s33, 15
  s_add_u32 s33, s33, 4194304
  s_lshl_b32 s34, s3, 8
  s_add_u32 s34, s34, s33
  s_lshl_b32 s35, s3, 13
  s_add_u32 s35, s35, s49
  s_add_u32 s39, s34, 0
  s_add_u32 m0, s35, 0
  s_nop 0
  buffer_load_dwordx4 v19, s[8:11], s39 offen sc1 lds
  s_add_u32 s39, s34, 16384
  s_add_u32 m0, s35, 2048
  s_nop 0
  buffer_load_dwordx4 v19, s[8:11], s39 offen sc1 lds
  s_add_u32 s39, s34, 128
  s_add_u32 m0, s35, 4096
  s_nop 0
  buffer_load_dwordx4 v19, s[8:11], s39 offen sc1 lds
  s_add_u32 s39, s34, 16512
  s_add_u32 m0, s35, 6144
  s_nop 0
  buffer_load_dwordx4 v19, s[8:11], s39 offen sc1 lds
  v_xor_b32 v19, 64, v19
  s_add_u32 s39, s34, 8192
  s_add_u32 m0, s35, 1024
  s_nop 0
  buffer_load_dwordx4 v19, s[8:11], s39 offen sc1 lds
  s_add_u32 s39, s34, 24576
  s_add_u32 m0, s35, 3072
  s_nop 0
  buffer_load_dwordx4 v19, s[8:11], s39 offen sc1 lds
  s_add_u32 s39, s34, 8320
  s_add_u32 m0, s35, 5120
  s_nop 0
  buffer_load_dwordx4 v19, s[8:11], s39 offen sc1 lds
  s_add_u32 s39, s34, 24704
  s_add_u32 m0, s35, 7168
  s_nop 0
  buffer_load_dwordx4 v19, s[8:11], s39 offen sc1 lds
  v_xor_b32 v19, 64, v19
  s_add_u32 s33, s41, 4
  s_lshl_b32 s33, s33, 9
  s_add_u32 s33, s33, 32768
  s_cmp_ge_u32 s41, 60
  s_cselect_b32 s33, 98304, s33
  buffer_load_dword v226, v3, s[8:11], s33 offen sc1
  s_add_u32 s43, s43, 1
  s_lshl_b32 s33, s5, 2
  s_add_u32 s33, s33, s47
  v_mov_b32 v0, s43
  s_waitcnt vmcnt(9)
  s_mov_b64 exec, 1
  buffer_store_dword v0, off, s[8:11], s33
  s_mov_b64 exec, -1
  s_xor_b32 s45, s45, 0x100000
  s_branch FF_L3
FF_L1:
  s_add_u32 s33, s41, 4
  s_lshl_b32 s33, s33, 9
  s_add_u32 s33, s33, 32768
  s_cmp_ge_u32 s41, 60
  s_cselect_b32 s33, 98304, s33
  buffer_load_dword v226, v3, s[8:11], s33 offen sc1
  s_add_u32 s43, s43, 1
  s_lshl_b32 s33, s5, 2
  s_add_u32 s33, s33, s47
  v_mov_b32 v0, s43
  s_waitcnt vmcnt(1)
  s_mov_b64 exec, 1
  buffer_store_dword v0, off, s[8:11], s33
  s_mov_b64 exec, -1
  s_xor_b32 s45, s45, 0x100000
FF_L3:
  s_lshl_b32 s50, s41, 5
  s_add_u32 s50, s50, s5
  s_lshl_b32 s50, s50, 10
  s_add_u32 s41, s41, 2
  s_mov_b32 s44, 1
  s_waitcnt vmcnt(1)
  s_branch FF_TOP
FF_L2:
  s_sub_u32 s33, s41, 30
  s_cmp_gt_u32 s33, 31
  s_cbranch_scc1 FF_L4
  s_add_u32 s33, s41, 2
  s_lshl_b32 s33, s33, 9
  s_add_u32 s33, s33, 32768
  s_cmp_ge_u32 s41, 62
  s_cselect_b32 s33, 98304, s33
  buffer_load_dword v226, v3, s[8:11], s33 offen sc1
  s_cmp_eq_u32 s41, 99
  s_cselect_b32 s38, 1, 2
  s_add_u32 s43, s43, 1
  s_lshl_b32 s33, s5, 2
  s_add_u32 s33, s33, s47
  v_mov_b32 v0, s43
  s_waitcnt vmcnt(0)
  s_mov_b64 exec, 1
  buffer_store_dword v0, off, s[8:11], s33
  s_mov_b64 exec, -1
  s_xor_b32 s45, s45, 0x100000
  s_branch FF_WC
FF_WP:
  s_add_u32 s33, s41, 2
  s_lshl_b32 s33, s33, 9
  s_add_u32 s33, s33, 32768
  s_cmp_ge_u32 s41, 62
  s_cselect_b32 s33, 98304, s33
  buffer_load_dword v226, v3, s[8:11], s33 offen sc1
  s_waitcnt vmcnt(0)
FF_WC:
  v_cmp_gt_u32 vcc, s38, v226
  s_cbranch_vccz FF_WOK
  s_sleep 2
  s_sub_u32 s6, s6, 1
  s_cbranch_scc1 GIVEUP
  s_branch FF_WP
FF_WOK:
  s_mov_b32 s48, 1
  s_add_u32 s33, s41, 2
  s_lshl_b32 s33, s33, 15
  s_add_u32 s33, s33, 4194304
  s_lshl_b32 s34, s3, 8
  s_add_u32 s34, s34, s33
  s_lshl_b32 s35, s3, 13
  s_add_u32 s35, s35, s49
  s_add_u32 s39, s34, 0
  s_add_u32 m0, s35, 0
  s_nop 0
  buffer_load_dwordx4 v19, s[8:11], s39 offen sc1 lds
  s_add_u32 s39, s34, 16384
  s_add_u32 m0, s35, 2048
  s_nop 0
  buffer_load_dwordx4 v19, s[8:11], s39 offen sc1 lds
  s_add_u32 s39, s34, 128
  s_add_u32 m0, s35, 4096
  s_nop 0
  buffer_load_dwordx4 v19, s[8:11], s39 offen sc1 lds
  s_add_u32 s39, s34, 16512
  s_add_u32 m0, s35, 6144
  s_nop 0
  buffer_load_dwordx4 v19, s[8:11], s39 offen sc1 lds
  v_xor_b32 v19, 64, v19
  s_add_u32 s39, s34, 8192
  s_add_u32 m0, s35, 1024
  s_nop 0
  buffer_load_dwordx4 v19, s[8:11], s39 offen sc1 lds
  s_add_u32 s39, s34, 24576
  s_add_u32 m0, s35, 3072
  s_nop 0
  buffer_load_dwordx4 v19, s[8:11], s39 offen sc1 lds
  s_add_u32 s39, s34, 8320
  s_add_u32 m0, s35, 5120
  s_nop 0
  buffer_load_dwordx4 v19, s[8:11], s39 offen sc1 lds
  s_add_u32 s39, s34, 24704
  s_add_u32 m0, s35, 7168
  s_nop 0
  buffer_load_dwordx4 v19, s[8:11], s39 offen sc1 lds
  v_xor_b32 v19, 64, v19
  s_add_u32 s33, s41, 4
  s_lshl_b32 s33, s33, 9
  s_add_u32 s33, s33, 32768
  s_cmp_ge_u32 s41, 60
  s_cselect_b32 s33, 98304, s33
  buffer_load_dword v226, v3, s[8:11], s33 offen sc1
  s_lshl_b32 s50, s41, 5
  s_add_u32 s50, s50, s5
  s_lshl_b32 s50, s50, 10
  s_add_u32 s41, s41, 2
  s_mov_b32 s44, 1
  s_waitcnt vmcnt(0)
  s_branch FF_TOP
FF_L4:
  s_mov_b32 s44, 0
FF_NOP:
FF_SIG:
  s_add_u32 s43, s43, 1
  s_lshl_b32 s33, s5, 2
  s_add_u32 s33, s33, s47
  v_mov_b32 v0, s43
  s_waitcnt vmcnt(0)
  s_mov_b64 exec, 1
  buffer_store_dword v0, off, s[8:11], s33
  s_mov_b64 exec, -1
  s_xor_b32 s45, s45, 0x100000
  s_lshl_b32 s50, s41, 5
  s_add_u32 s50, s50, s5
  s_lshl_b32 s50, s50, 10
  s_add_u32 s41, s41, 2
FF_RED:
FGP_49:
  buffer_load_dword v0, v23, s[8:11], s47 offen sc1
  s_waitcnt vmcnt(0)
  v_cmp_gt_u32 vcc, s43, v0
  s_cbranch_vccz FGPOK_50
  s_sleep 1
  s_sub_u32 s6, s6, 1
  s_cbranch_scc1 GIVEUP
  s_branch FGP_49
FGPOK_50:
  s_add_u32 s37, s50, 6291456
  buffer_load_dword v224, v21, s[8:11], s37 offen sc1
  buffer_load_dwordx4 v[192:195], v20, s[8:11], s46 offen sc1
  s_add_u32 s36, s46, 4096
  buffer_load_dwordx4 v[196:199], v20, s[8:11], s36 offen sc1
  s_add_u32 s36, s46, 8192
  buffer_load_dwordx4 v[200:203], v20, s[8:11], s36 offen sc1
  s_add_u32 s36, s46, 12288
  buffer_load_dwordx4 v[204:207], v20, s[8:11], s36 offen sc1
  s_add_u32 s36, s46, 16384
  buffer_load_dwordx4 v[208:211], v20, s[8:11], s36 offen sc1
  s_add_u32 s36, s46, 20480
  buffer_load_dwordx4 v[212:215], v1, s[8:11], s36 offen sc1
  s_xor_b32 s46, s46, 0x100000
  s_waitcnt vmcnt(5)
  v_mfma_f32_16x16x32_bf16 v[220:223], v[216:219], v[192:195], 0
  s_waitcnt vmcnt(4)
  v_mfma_f32_16x16x32_bf16 v[220:223], v[216:219], v[196:199], v[220:223]
  s_waitcnt vmcnt(3)
  v_mfma_f32_16x16x32_bf16 v[220:223], v[216:219], v[200:203], v[220:223]
  s_waitcnt vmcnt(2)
  v_mfma_f32_16x16x32_bf16 v[220:223], v[216:219], v[204:207], v[220:223]
  s_waitcnt vmcnt(1)
  v_mfma_f32_16x16x32_bf16 v[220:223], v[216:219], v[208:211], v[220:223]
  s_waitcnt vmcnt(0)
  v_mfma_f32_16x16x32_bf16 v[220:223], v[216:219], v[212:215], v[220:223]
FF_FIN:
  v_and_b32 v225, 0xffff0000, v224
  v_lshlrev_b32 v224, 16, v224
  s_nop 4
  v_cvt_pk_bf16_f32 v0, v220, v221
  v_and_b32 v221, 0xffff0000, v0
  v_lshlrev_b32 v220, 16, v0
  v_pk_mul_f32 v[220:221], v[220:221], v[4:5]
  v_cvt_pk_bf16_f32 v0, v220, v221
  v_and_b32 v221, 0xffff0000, v0
  v_lshlrev_b32 v220, 16, v0
  v_pk_add_f32 v[220:221], v[220:221], v[224:225]
  v_cvt_pk_bf16_f32 v220, v220, v221
  buffer_store_dword v220, v21, s[28:31], s50 offen
  s_cmp_lt_u32 s41, 64
  s_cbranch_scc1 FF_LOOP
  s_waitcnt vmcnt(0)
  s_waitcnt vmcnt(0)
  s_endpgm
FS_ENTRY:
  v_cndmask_b32 v216, 0, v22, s[52:53]
  v_cndmask_b32 v217, 0, v22, s[54:55]
  v_cndmask_b32 v218, 0, v22, s[56:57]
  v_cndmask_b32 v219, 0, v22, s[58:59]
  s_mov_b32 s44, 0
  s_mov_b32 s49, 0
FS_LOOP:
  s_cmp_ge_u32 s5, 22
  s_cbranch_scc1 FS_NOP
  s_lshl_b32 s33, s41, 9
  s_add_u32 s33, s33, 32768
FS_HP:
  buffer_load_dword v0, v3, s[8:11], s33 offen sc1
  s_waitcnt vmcnt(0)
  v_cmp_gt_u32 vcc, 2, v0
  s_cbranch_vccz FS_HOK
  s_sleep 2
  s_sub_u32 s6, s6, 1
  s_cbranch_scc1 GIVEUP
  s_branch FS_HP
FS_HOK:
  s_lshl_b32 s33, s41, 15
  s_add_u32 s33, s33, 4194304
  s_lshl_b32 s34, s3, 8
  s_add_u32 s34, s34, s33
  s_lshl_b32 s35, s3, 13
  s_add_u32 s35, s35, s49
  s_add_u32 s39, s34, 0
  s_add_u32 m0, s35, 0
  s_nop 0
  buffer_load_dwordx4 v19, s[8:11], s39 offen sc1 lds
  s_add_u32 s39, s34, 16384
  s_add_u32 m0, s35, 2048
  s_nop 0
  buffer_load_dwordx4 v19, s[8:11], s39 offen sc1 lds
  s_add_u32 s39, s34, 128
  s_add_u32 m0, s35, 4096
  s_nop 0
  buffer_load_dwordx4 v19, s[8:11], s39 offen sc1 lds
  s_add_u32 s39, s34, 16512
  s_add_u32 m0, s35, 6144
  s_nop 0
  buffer_load_dwordx4 v19, s[8:11], s39 offen sc1 lds
  v_xor_b32 v19, 64, v19
  s_add_u32 s39, s34, 8192
  s_add_u32 m0, s35, 1024
  s_nop 0
  buffer_load_dwordx4 v19, s[8:11], s39 offen sc1 lds
  s_add_u32 s39, s34, 24576
  s_add_u32 m0, s35, 3072
  s_nop 0
  buffer_load_dwordx4 v19, s[8:11], s39 offen sc1 lds
  s_add_u32 s39, s34, 8320
  s_add_u32 m0, s35, 5120
  s_nop 0
  buffer_load_dwordx4 v19, s[8:11], s39 offen sc1 lds
  s_add_u32 s39, s34, 24704
  s_add_u32 m0, s35, 7168
  s_nop 0
  buffer_load_dwordx4 v19, s[8:11], s39 offen sc1 lds
  v_xor_b32 v19, 64, v19
  s_add_u32 s33, s41, 2
  s_lshl_b32 s33, s33, 9
  s_add_u32 s33, s33, 32768
  s_cmp_ge_u32 s41, 62
  s_cselect_b32 s33, 98304, s33
  buffer_load_dword v226, v3, s[8:11], s33 offen sc1
  s_waitcnt vmcnt(0)
FS_TOP:
  s_barrier
  ds_read_b128 v[28:31], v6 offset:0
  ds_read_b128 v[32:35], v6 offset:2048
  ds_read_b128 v[36:39], v7 offset:0
  ds_read_b128 v[40:43], v7 offset:2048
  ds_read_b128 v[44:47], v6 offset:4096
  ds_read_b128 v[48:51], v6 offset:6144
  buffer_load_dword v227, v23, s[8:11], s47 offen sc1
  s_xor_b32 s49, s49, 0x10000
  v_cmp_gt_u32 s[64:65], 2, v226
  s_mov_b32 s48, 0
  ds_read_b128 v[52:55], v7 offset:4096
  ds_read_b128 v[56:59], v7 offset:6144
  s_waitcnt lgkmcnt(6)
  v_mfma_f32_16x16x32_bf16 v[60:63], a[0:3], v[28:31], 0
  v_mfma_f32_16x16x32_bf16 v[68:71], a[64:67], v[28:31], 0
  v_mfma_f32_16x16x32_bf16 v[64:67], a[0:3], v[32:35], 0
  v_mfma_f32_16x16x32_bf16 v[72:75], a[64:67], v[32:35], 0
  ds_read_b128 v[28:31], v6 offset:8192
  ds_read_b128 v[32:35], v6 offset:10240
  s_waitcnt lgkmcnt(6)
  v_mfma_f32_16x16x32_bf16 v[60:63], a[4:7], v[36:39], v[60:63]
  v_mfma_f32_16x16x32_bf16 v[68:71], a[68:71], v[36:39], v[68:71]
  v_mfma_f32_16x16x32_bf16 v[64:67], a[4:7], v[40:43], v[64:67]
  v_mfma_f32_16x16x32_bf16 v[72:75], a[68:71], v[40:43], v[72:75]
  ds_read_b128 v[36:39], v7 offset:8192
  ds_read_b128 v[40:43], v7 offset:10240
  s_waitcnt lgkmcnt(6)
  v_mfma_f32_16x16x32_bf16 v[60:63], a[8:11], v[44:47], v[60:63]
  v_mfma_f32_16x16x32_bf16 v[68:71], a[72:75], v[44:47], v[68:71]
  v_mfma_f32_16x16x32_bf16 v[64:67], a[8:11], v[48:51], v[64:67]
  v_mfma_f32_16x16x32_bf16 v[72:75], a[72:75], v[48:51], v[72:75]
  ds_read_b128 v[44:47], v6 offset:12288
  ds_read_b128 v[48:51], v6 offset:14336
  s_waitcnt lgkmcnt(6)
  v_mfma_f32_16x16x32_bf16 v[60:63], a[12:15], v[52:55], v[60:63]
  v_mfma_f32_16x16x32_bf16 v[68:71], a[76:79], v[52:55], v[68:71]
  v_mfma_f32_16x16x32_bf16 v[64:67], a[12:15], v[56:59], v[64:67]
  v_mfma_f32_16x16x32_bf16 v[72:75], a[76:79], v[56:59], v[72:75]
  ds_read_b128 v[52:55], v7 offset:12288
  ds_read_b128 v[56:59], v7 offset:14336
  s_waitcnt lgkmcnt(6)
  v_mfma_f32_16x16x32_bf16 v[60:63], a[16:19], v[28:31], v[60:63]
  v_mfma_f32_16x16x32_bf16 v[68:71], a[80:83], v[28:31], v[68:71]
  v_mfma_f32_16x16x32_bf16 v[64:67], a[16:19], v[32:35], v[64:67]
  v_mfma_f32_16x16x32_bf16 v[72:75], a[80:83], v[32:35], v[72:75]
  ds_read_b128 v[28:31], v6 offset:16384
  ds_read_b128 v[32:35], v6 offset:18432
  s_waitcnt lgkmcnt(6)
  v_mfma_f32_16x16x32_bf16 v[60:63], a[20:23], v[36:39], v[60:63]
  v_mfma_f32_16x16x32_bf16 v[68:71], a[84:87], v[36:39], v[68:71]
  v_mfma_f32_16x16x32_bf16 v[64:67], a[20:23], v[40:43], v[64:67]
  v_mfma_f32_16x16x32_bf16 v[72:75], a[84:87], v[40:43], v[72:75]
  ds_read_b128 v[36:39], v7 offset:16384
  ds_read_b128 v[40:43], v7 offset:18432
  s_waitcnt lgkmcnt(6)
  v_mfma_f32_16x16x32_bf16 v[60:63], a[24:27], v[44:47], v[60:63]
  v_mfma_f32_16x16x32_bf16 v[68:71], a[88:91], v[44:47], v[68:71]
  v_mfma_f32_16x16x32_bf16 v[64:67], a[24:27], v[48:51], v[64:67]
  v_mfma_f32_16x16x32_bf16 v[72:75], a[88:91], v[48:51], v[72:75]
  ds_read_b128 v[44:47], v6 offset:20480
  ds_read_b128 v[48:51], v6 offset:22528
  s_waitcnt vmcnt(0)
  s_cmp_eq_u32 s44, 0
  s_cbranch_scc1 FS_NP
  v_cmp_gt_u32 vcc, s43, v227
  s_cbranch_vccz FGPOK_52
FGP_51:
  buffer_load_dword v227, v23, s[8:11], s47 offen sc1
  s_waitcnt vmcnt(0)
  v_cmp_gt_u32 vcc, s43, v227
  s_cbranch_vccz FGPOK_52
  s_sleep 1
  s_sub_u32 s6, s6, 1
  s_cbranch_scc1 GIVEUP
  s_branch FGP_51
FGPOK_52:
  s_add_u32 s37, s50, 6291456
  buffer_load_dword v224, v21, s[8:11], s37 offen sc1
  buffer_load_dwordx4 v[192:195], v20, s[8:11], s46 offen sc1
  s_add_u32 s36, s46, 4096
  buffer_load_dwordx4 v[196:199], v20, s[8:11], s36 offen sc1
  s_add_u32 s36, s46, 8192
  buffer_load_dwordx4 v[200:203], v20, s[8:11], s36 offen sc1
  s_add_u32 s36, s46, 12288
  buffer_load_dwordx4 v[204:207], v20, s[8:11], s36 offen sc1
  s_add_u32 s36, s46, 16384
  buffer_load_dwordx4 v[208:211], v20, s[8:11], s36 offen sc1
  s_add_u32 s36, s46, 20480
  buffer_load_dwordx4 v[212:215], v1, s[8:11], s36 offen sc1
  s_xor_b32 s46, s46, 0x100000
FS_NP:
  s_cmp_lg_u64 s[64:65], 0
  s_cbranch_scc1 FS_NF
  s_mov_b32 s48, 1
  s_add_u32 s33, s41, 2
  s_lshl_b32 s33, s33, 15
  s_add_u32 s33, s33, 4194304
  s_lshl_b32 s34, s3, 8
  s_add_u32 s34, s34, s33
  s_lshl_b32 s35, s3, 13
  s_add_u32 s35, s35, s49
  s_add_u32 s39, s34, 0
  s_add_u32 m0, s35, 0
  s_nop 0
  buffer_load_dwordx4 v19, s[8:11], s39 offen sc1 lds
  s_add_u32 s39, s34, 16384
  s_add_u32 m0, s35, 2048
  s_nop 0
  buffer_load_dwordx4 v19, s[8:11], s39 offen sc1 lds
  s_add_u32 s39, s34, 128
  s_add_u32 m0, s35, 4096
  s_nop 0
  buffer_load_dwordx4 v19, s[8:11], s39 offen sc1 lds
  s_add_u32 s39, s34, 16512
  s_add_u32 m0, s35, 6144
  s_nop 0
  buffer_load_dwordx4 v19, s[8:11], s39 offen sc1 lds
  v_xor_b32 v19, 64, v19
  s_add_u32 s39, s34, 8192
  s_add_u32 m0, s35, 1024
  s_nop 0
  buffer_load_dwordx4 v19, s[8:11], s39 offen sc1 lds
  s_add_u32 s39, s34, 24576
  s_add_u32 m0, s35, 3072
  s_nop 0
  buffer_load_dwordx4 v19, s[8:11], s39 offen sc1 lds
  s_add_u32 s39, s34, 8320
  s_add_u32 m0, s35, 5120
  s_nop 0
  buffer_load_dwordx4 v19, s[8:11], s39 offen sc1 lds
  s_add_u32 s39, s34, 24704
  s_add_u32 m0, s35, 7168
  s_nop 0
  buffer_load_dwordx4 v19, s[8:11], s39 offen sc1 lds
  v_xor_b32 v19, 64, v19
  s_branch FS_NG
FS_NF:
  s_add_u32 s33, s41, 2
  s_lshl_b32 s33, s33, 9
  s_add_u32 s33, s33, 32768
  s_cmp_ge_u32 s41, 62
  s_cselect_b32 s33, 98304, s33
  buffer_load_dword v226, v3, s[8:11], s33 offen sc1
FS_NG:
  s_waitcnt lgkmcnt(6)
  v_mfma_f32_16x16x32_bf16 v[60:63], a[28:31], v[52:55], v[60:63]
  v_mfma_f32_16x16x32_bf16 v[68:71], a[92:95], v[52:55], v[68:71]
  v_mfma_f32_16x16x32_bf16 v[64:67], a[28:31], v[56:59], v[64:67]
  v_mfma_f32_16x16x32_bf16 v[72:75], a[92:95], v[56:59], v[72:75]
  ds_read_b128 v[52:55], v7 offset:20480
  ds_read_b128 v[56:59], v7 offset:22528
  s_waitcnt lgkmcnt(6)
  v_mfma_f32_16x16x32_bf16 v[60:63], a[32:35], v[28:31], v[60:63]
  v_mfma_f32_16x16x32_bf16 v[68:71], a[96:99], v[28:31], v[68:71]
  v_mfma_f32_16x16x32_bf16 v[64:67], a[32:35], v[32:35], v[64:67]
  v_mfma_f32_16x16x32_bf16 v[72:75], a[96:99], v[32:35], v[72:75]
  ds_read_b128 v[28:31], v6 offset:24576
  ds_read_b128 v[32:35], v6 offset:26624
  s_waitcnt lgkmcnt(6)
  v_mfma_f32_16x16x32_bf16 v[60:63], a[36:39], v[36:39], v[60:63]
  v_mfma_f32_16x16x32_bf16 v[68:71], a[100:103], v[36:39], v[68:71]
  v_mfma_f32_16x16x32_bf16 v[64:67], a[36:39], v[40:43], v[64:67]
  v_mfma_f32_16x16x32_bf16 v[72:75], a[100:103], v[40:43], v[72:75]
  ds_read_b128 v[36:39], v7 offset:24576
  ds_read_b128 v[40:43], v7 offset:26624
  s_waitcnt lgkmcnt(6)
  v_mfma_f32_16x16x32_bf16 v[60:63], a[40:43], v[44:47], v[60:63]
  v_mfma_f32_16x16x32_bf16 v[68:71], a[104:107], v[44:47], v[68:71]
  v_mfma_f32_16x16x32_bf16 v[64:67], a[40:43], v[48:51], v[64:67]
  v_mfma_f32_16x16x32_bf16 v[72:75], a[104:107], v[48:51], v[72:75]
  ds_read_b128 v[44:47], v6 offset:28672
  ds_read_b128 v[48:51], v6 offset:30720
  s_waitcnt lgkmcnt(6)
  v_mfma_f32_16x16x32_bf16 v[60:63], a[44:47], v[52:55], v[60:63]
  v_mfma_f32_16x16x32_bf16 v[68:71], a[108:111], v[52:55], v[68:71]
  v_mfma_f32_16x16x32_bf16 v[64:67], a[44:47], v[56:59], v[64:67]
  v_mfma_f32_16x16x32_bf16 v[72:75], a[108:111], v[56:59], v[72:75]
  ds_read_b128 v[52:55], v7 offset:28672
  ds_read_b128 v[56:59], v7 offset:30720
  s_waitcnt lgkmcnt(6)
  v_mfma_f32_16x16x32_bf16 v[60:63], a[48:51], v[28:31], v[60:63]
  v_mfma_f32_16x16x32_bf16 v[68:71], a[112:115], v[28:31], v[68:71]
  v_mfma_f32_16x16x32_bf16 v[64:67], a[48:51], v[32:35], v[64:67]
  v_mfma_f32_16x16x32_bf16 v[72:75], a[112:115], v[32:35], v[72:75]
  s_waitcnt lgkmcnt(4)
  v_mfma_f32_16x16x32_bf16 v[60:63], a[52:55], v[36:39], v[60:63]
  v_mfma_f32_16x16x32_bf16 v[68:71], a[116:119], v[36:39], v[68:71]
  v_mfma_f32_16x16x32_bf16 v[64:67], a[52:55], v[40:43], v[64:67]
  v_mfma_f32_16x16x32_bf16 v[72:75], a[116:119], v[40:43], v[72:75]
  s_waitcnt lgkmcnt(2)
  v_mfma_f32_16x16x32_bf16 v[60:63], a[56:59], v[44:47], v[60:63]
  v_mfma_f32_16x16x32_bf16 v[68:71], a[120:123], v[44:47], v[68:71]
  v_mfma_f32_16x16x32_bf16 v[64:67], a[56:59], v[48:51], v[64:67]
  v_mfma_f32_16x16x32_bf16 v[72:75], a[120:123], v[48:51], v[72:75]
  s_waitcnt lgkmcnt(0)
  v_mfma_f32_16x16x32_bf16 v[60:63], a[60:63], v[52:55], v[60:63]
  v_mfma_f32_16x16x32_bf16 v[68:71], a[124:127], v[52:55], v[68:71]
  v_mfma_f32_16x16x32_bf16 v[64:67], a[60:63], v[56:59], v[64:67]
  v_mfma_f32_16x16x32_bf16 v[72:75], a[124:127], v[56:59], v[72:75]
  v_cvt_pk_bf16_f32 v28, v60, v61
  v_and_b32 v61, 0xffff0000, v28
  v_lshlrev_b32 v60, 16, v28
  v_cvt_pk_bf16_f32 v29, v62, v63
  v_and_b32 v63, 0xffff0000, v29
  v_lshlrev_b32 v62, 16, v29
  v_cvt_pk_bf16_f32 v30, v64, v65
  v_and_b32 v65, 0xffff0000, v30
  v_lshlrev_b32 v64, 16, v30
  v_cvt_pk_bf16_f32 v31, v66, v67
  v_and_b32 v67, 0xffff0000, v31
  v_lshlrev_b32 v66, 16, v31
  v_mul_f32 v28, 0xbfb8aa3b, v60
  v_mul_f32 v29, 0xbfb8aa3b, v61
  v_mul_f32 v30, 0xbfb8aa3b, v62
  v_mul_f32 v31, 0xbfb8aa3b, v63
  v_mul_f32 v32, 0xbfb8aa3b, v64
  v_mul_f32 v33, 0xbfb8aa3b, v65
  v_mul_f32 v34, 0xbfb8aa3b, v66
  v_mul_f32 v35, 0xbfb8aa3b, v67
  v_exp_f32 v28, v28
  v_exp_f32 v29, v29
  v_exp_f32 v30, v30
  v_exp_f32 v31, v31
  v_exp_f32 v32, v32
  v_exp_f32 v33, v33
  v_exp_f32 v34, v34
  v_exp_f32 v35, v35
  v_add_f32 v28, 1.0, v28
  v_add_f32 v29, 1.0, v29
  v_add_f32 v30, 1.0, v30
  v_add_f32 v31, 1.0, v31
  v_add_f32 v32, 1.0, v32
  v_add_f32 v33, 1.0, v33
  v_add_f32 v34, 1.0, v34
  v_add_f32 v35, 1.0, v35
  v_rcp_f32 v28, v28
  v_rcp_f32 v29, v29
  v_rcp_f32 v30, v30
  v_rcp_f32 v31, v31
  v_rcp_f32 v32, v32
  v_rcp_f32 v33, v33
  v_rcp_f32 v34, v34
  v_rcp_f32 v35, v35
  v_mul_f32 v60, v60, v28
  v_mul_f32 v61, v61, v29
  v_mul_f32 v62, v62, v30
  v_mul_f32 v63, v63, v31
  v_mul_f32 v64, v64, v32
  v_mul_f32 v65, v65, v33
  v_mul_f32 v66, v66, v34
  v_mul_f32 v67, v67, v35
  v_cvt_pk_bf16_f32 v28, v60, v61
  v_and_b32 v61, 0xffff0000, v28
  v_lshlrev_b32 v60, 16, v28
  v_cvt_pk_bf16_f32 v32, v68, v69
  v_and_b32 v69, 0xffff0000, v32
  v_lshlrev_b32 v68, 16, v32
  v_cvt_pk_bf16_f32 v29, v62, v63
  v_and_b32 v63, 0xffff0000, v29
  v_lshlrev_b32 v62, 16, v29
  v_cvt_pk_bf16_f32 v33, v70, v71
  v_and_b32 v71, 0xffff0000, v33
  v_lshlrev_b32 v70, 16, v33
  v_cvt_pk_bf16_f32 v30, v64, v65
  v_and_b32 v65, 0xffff0000, v30
  v_lshlrev_b32 v64, 16, v30
  v_cvt_pk_bf16_f32 v34, v72, v73
  v_and_b32 v73, 0xffff0000, v34
  v_lshlrev_b32 v72, 16, v34
  v_cvt_pk_bf16_f32 v31, v66, v67
  v_and_b32 v67, 0xffff0000, v31
  v_lshlrev_b32 v66, 16, v31
  v_cvt_pk_bf16_f32 v35, v74, v75
  v_and_b32 v75, 0xffff0000, v35
  v_lshlrev_b32 v74, 16, v35
  v_pk_mul_f32 v[60:61], v[60:61], v[68:69]
  v_pk_mul_f32 v[62:63], v[62:63], v[70:71]
  v_pk_mul_f32 v[64:65], v[64:65], v[72:73]
  v_pk_mul_f32 v[66:67], v[66:67], v[74:75]
  v_cvt_pk_bf16_f32 v68, v60, v61
  v_cvt_pk_bf16_f32 v69, v62, v63
  v_cvt_pk_bf16_f32 v70, v64, v65
  v_cvt_pk_bf16_f32 v71, v66, v67
  ds_write_b64 v2, v[68:69]
  ds_write_b64 v2, v[70:71] offset:2048
  v_xor_b32 v6, 0x10000, v6
  v_xor_b32 v7, 0x10000, v7
  s_waitcnt lgkmcnt(0)
  s_barrier
  ds_read_b128 v[76:79], v13 offset:32768
  ds_read_b128 v[80:83], v13 offset:33792
  ds_read_b128 v[84:87], v13 offset:34816
  ds_read_b128 v[88:91], v13 offset:35840
  s_cmp_eq_u32 s44, 0
  s_cbranch_scc1 FS_ND
  s_cmp_eq_u32 s48, 0
  s_cbranch_scc1 FS_W0
  s_waitcnt vmcnt(8)
  s_branch FS_W1
FS_W0:
  s_waitcnt vmcnt(1)
FS_W1:
  v_mfma_f32_16x16x32_bf16 v[220:223], v[216:219], v[192:195], 0
  v_mfma_f32_16x16x32_bf16 v[220:223], v[216:219], v[196:199], v[220:223]
  v_mfma_f32_16x16x32_bf16 v[220:223], v[216:219], v[200:203], v[220:223]
  v_mfma_f32_16x16x32_bf16 v[220:223], v[216:219], v[204:207], v[220:223]
  v_mfma_f32_16x16x32_bf16 v[220:223], v[216:219], v[208:211], v[220:223]
  v_mfma_f32_16x16x32_bf16 v[220:223], v[216:219], v[212:215], v[220:223]
  v_and_b32 v225, 0xffff0000, v224
  v_lshlrev_b32 v224, 16, v224
  s_nop 4
  v_cvt_pk_bf16_f32 v0, v220, v221
  v_and_b32 v221, 0xffff0000, v0
  v_lshlrev_b32 v220, 16, v0
  v_pk_mul_f32 v[220:221], v[220:221], v[4:5]
  v_cvt_pk_bf16_f32 v0, v220, v221
  v_and_b32 v221, 0xffff0000, v0
  v_lshlrev_b32 v220, 16, v0
  v_pk_add_f32 v[220:221], v[220:221], v[224:225]
  v_cvt_pk_bf16_f32 v220, v220, v221
  buffer_store_dword v220, v21, s[28:31], s50 offen
FS_ND:
  s_waitcnt lgkmcnt(0)
  v_mfma_f32_16x16x32_bf16 v[92:95], v[76:79], v[128:131], 0
  v_mfma_f32_16x16x32_bf16 v[96:99], v[76:79], v[136:139], 0
  v_mfma_f32_16x16x32_bf16 v[100:103], v[76:79], v[144:147], 0
  v_mfma_f32_16x16x32_bf16 v[104:107], v[76:79], v[152:155], 0
  v_mfma_f32_16x16x32_bf16 v[108:111], v[76:79], v[160:163], 0
  v_mfma_f32_16x16x32_bf16 v[112:115], v[76:79], v[168:171], 0
  v_mfma_f32_16x16x32_bf16 v[116:119], v[76:79], v[176:179], 0
  v_mfma_f32_16x16x32_bf16 v[120:123], v[76:79], v[184:187], 0
  v_mfma_f32_16x16x32_bf16 v[92:95], v[80:83], v[132:135], v[92:95]
  v_mfma_f32_16x16x32_bf16 v[96:99], v[80:83], v[140:143], v[96:99]
  v_mfma_f32_16x16x32_bf16 v[100:103], v[80:83], v[148:151], v[100:103]
  v_mfma_f32_16x16x32_bf16 v[104:107], v[80:83], v[156:159], v[104:107]
  v_mfma_f32_16x16x32_bf16 v[108:111], v[80:83], v[164:167], v[108:111]
  v_mfma_f32_16x16x32_bf16 v[112:115], v[80:83], v[172:175], v[112:115]
  v_mfma_f32_16x16x32_bf16 v[116:119], v[80:83], v[180:183], v[116:119]
  v_mfma_f32_16x16x32_bf16 v[120:123], v[80:83], v[188:191], v[120:123]
  v_mfma_f32_16x16x32_bf16 v[28:31], v[84:87], v[128:131], 0
  v_mfma_f32_16x16x32_bf16 v[32:35], v[84:87], v[136:139], 0
  v_mfma_f32_16x16x32_bf16 v[36:39], v[84:87], v[144:147], 0
  v_cvt_pk_bf16_f32 v60, v92, v96
  v_cvt_pk_bf16_f32 v61, v100, v104
  v_mfma_f32_16x16x32_bf16 v[40:43], v[84:87], v[152:155], 0
  v_cvt_pk_bf16_f32 v62, v108, v112
  v_cvt_pk_bf16_f32 v63, v116, v120
  v_mfma_f32_16x16x32_bf16 v[44:47], v[84:87], v[160:163], 0
  s_add_u32 s36, s45, 0
  buffer_store_dwordx4 v[60:63], v18, s[8:11], s36 offen sc1
  v_cvt_pk_bf16_f32 v64, v93, v97
  v_mfma_f32_16x16x32_bf16 v[48:51], v[84:87], v[168:171], 0
  v_cvt_pk_bf16_f32 v65, v101, v105
  v_cvt_pk_bf16_f32 v66, v109, v113
  v_mfma_f32_16x16x32_bf16 v[52:55], v[84:87], v[176:179], 0
  v_cvt_pk_bf16_f32 v67, v117, v121
  s_add_u32 s36, s45, 32768
  buffer_store_dwordx4 v[64:67], v18, s[8:11], s36 offen sc1
  v_mfma_f32_16x16x32_bf16 v[56:59], v[84:87], v[184:187], 0
  v_cvt_pk_bf16_f32 v60, v94, v98
  v_cvt_pk_bf16_f32 v61, v102, v106
  v_mfma_f32_16x16x32_bf16 v[28:31], v[88:91], v[132:135], v[28:31]
  v_cvt_pk_bf16_f32 v62, v110, v114
  v_cvt_pk_bf16_f32 v63, v118, v122
  v_mfma_f32_16x16x32_bf16 v[32:35], v[88:91], v[140:143], v[32:35]
  s_add_u32 s36, s45, 65536
  buffer_store_dwordx4 v[60:63], v18, s[8:11], s36 offen sc1
  v_cvt_pk_bf16_f32 v64, v95, v99
  v_mfma_f32_16x16x32_bf16 v[36:39], v[88:91], v[148:151], v[36:39]
  v_cvt_pk_bf16_f32 v65, v103, v107
  v_cvt_pk_bf16_f32 v66, v111, v115
  v_mfma_f32_16x16x32_bf16 v[40:43], v[88:91], v[156:159], v[40:43]
  v_cvt_pk_bf16_f32 v67, v119, v123
  s_add_u32 s36, s45, 98304
  buffer_store_dwordx4 v[64:67], v18, s[8:11], s36 offen sc1
  v_mfma_f32_16x16x32_bf16 v[44:47], v[88:91], v[164:167], v[44:47]
  v_mfma_f32_16x16x32_bf16 v[48:51], v[88:91], v[172:175], v[48:51]
  v_mfma_f32_16x16x32_bf16 v[52:55], v[88:91], v[180:183], v[52:55]
  v_mfma_f32_16x16x32_bf16 v[56:59], v[88:91], v[188:191], v[56:59]
  v_cvt_pk_bf16_f32 v60, v28, v32
  v_cvt_pk_bf16_f32 v61, v36, v40
  v_cvt_pk_bf16_f32 v62, v44, v48
  s_nop 3
  v_cvt_pk_bf16_f32 v63, v52, v56
  s_add_u32 s36, s45, 524288
  buffer_store_dwordx4 v[60:63], v18, s[8:11], s36 offen sc1
  v_cvt_pk_bf16_f32 v64, v29, v33
  v_cvt_pk_bf16_f32 v65, v37, v41
  v_cvt_pk_bf16_f32 v66, v45, v49
  v_cvt_pk_bf16_f32 v67, v53, v57
  s_add_u32 s36, s45, 557056
  buffer_store_dwordx4 v[64:67], v18, s[8:11], s36 offen sc1
  v_cvt_pk_bf16_f32 v60, v30, v34
  v_cvt_pk_bf16_f32 v61, v38, v42
  v_cvt_pk_bf16_f32 v62, v46, v50
  v_cvt_pk_bf16_f32 v63, v54, v58
  s_add_u32 s36, s45, 589824
  buffer_store_dwordx4 v[60:63], v18, s[8:11], s36 offen sc1
  v_cvt_pk_bf16_f32 v64, v31, v35
  v_cvt_pk_bf16_f32 v65, v39, v43
  v_cvt_pk_bf16_f32 v66, v47, v51
  v_cvt_pk_bf16_f32 v67, v55, v59
  s_add_u32 s36, s45, 622592
  buffer_store_dwordx4 v[64:67], v18, s[8:11], s36 offen sc1
  s_cmp_lg_u32 s48, 0
  s_cbranch_scc1 FS_L1
  s_waitcnt vmcnt(8)
  v_cmp_gt_u32 vcc, 2, v226
  s_cbranch_vccnz FS_L2
  s_mov_b32 s48, 1
  s_add_u32 s33, s41, 2
  s_lshl_b32 s33, s33, 15
  s_add_u32 s33, s33, 4194304
  s_lshl_b32 s34, s3, 8
  s_add_u32 s34, s34, s33
  s_lshl_b32 s35, s3, 13
  s_add_u32 s35, s35, s49
  s_add_u32 s39, s34, 0
  s_add_u32 m0, s35, 0
  s_nop 0
  buffer_load_dwordx4 v19, s[8:11], s39 offen sc1 lds
  s_add_u32 s39, s34, 16384
  s_add_u32 m0, s35, 2048
  s_nop 0
  buffer_load_dwordx4 v19, s[8:11], s39 offen sc1 lds
  s_add_u32 s39, s34, 128
  s_add_u32 m0, s35, 4096
  s_nop 0
  buffer_load_dwordx4 v19, s[8:11], s39 offen sc1 lds
  s_add_u32 s39, s34, 16512
  s_add_u32 m0, s35, 6144
  s_nop 0
  buffer_load_dwordx4 v19, s[8:11], s39 offen sc1 lds
  v_xor_b32 v19, 64, v19
  s_add_u32 s39, s34, 8192
  s_add_u32 m0, s35, 1024
  s_nop 0
  buffer_load_dwordx4 v19, s[8:11], s39 offen sc1 lds
  s_add_u32 s39, s34, 24576
  s_add_u32 m0, s35, 3072
  s_nop 0
  buffer_load_dwordx4 v19, s[8:11], s39 offen sc1 lds
  s_add_u32 s39, s34, 8320
  s_add_u32 m0, s35, 5120
  s_nop 0
  buffer_load_dwordx4 v19, s[8:11], s39 offen sc1 lds
  s_add_u32 s39, s34, 24704
  s_add_u32 m0, s35, 7168
  s_nop 0
  buffer_load_dwordx4 v19, s[8:11], s39 offen sc1 lds
  v_xor_b32 v19, 64, v19
  s_add_u32 s33, s41, 4
  s_lshl_b32 s33, s33, 9
  s_add_u32 s33, s33, 32768
  s_cmp_ge_u32 s41, 60
  s_cselect_b32 s33, 98304, s33
  buffer_load_dword v226, v3, s[8:11], s33 offen sc1
  s_add_u32 s43, s43, 1
  s_lshl_b32 s33, s5, 2
  s_add_u32 s33, s33, s47
  v_mov_b32 v0, s43
  s_waitcnt vmcnt(9)
  s_mov_b64 exec, 1
  buffer_store_dword v0, off, s[8:11], s33 sc1
  s_mov_b64 exec, -1
  s_xor_b32 s45, s45, 0x100000
  s_branch FS_L3
FS_L1:
  s_add_u32 s33, s41, 4
  s_lshl_b32 s33, s33, 9
  s_add_u32 s33, s33, 32768
  s_cmp_ge_u32 s41, 60
  s_cselect_b32 s33, 98304, s33
  buffer_load_dword v226, v3, s[8:11], s33 offen sc1
  s_add_u32 s43, s43, 1
  s_lshl_b32 s33, s5, 2
  s_add_u32 s33, s33, s47
  v_mov_b32 v0, s43
  s_waitcnt vmcnt(1)
  s_mov_b64 exec, 1
  buffer_store_dword v0, off, s[8:11], s33 sc1
  s_mov_b64 exec, -1
  s_xor_b32 s45, s45, 0x100000
FS_L3:
  s_lshl_b32 s50, s41, 5
  s_add_u32 s50, s50, s5
  s_lshl_b32 s50, s50, 10
  s_add_u32 s41, s41, 2
  s_mov_b32 s44, 1
  s_waitcnt vmcnt(1)
  s_branch FS_TOP
FS_L2:
  s_sub_u32 s33, s41, 30
  s_cmp_gt_u32 s33, 31
  s_cbranch_scc1 FS_L4
  s_add_u32 s33, s41, 2
  s_lshl_b32 s33, s33, 9
  s_add_u32 s33, s33, 32768
  s_cmp_ge_u32 s41, 62
  s_cselect_b32 s33, 98304, s33
  buffer_load_dword v226, v3, s[8:11], s33 offen sc1
  s_cmp_eq_u32 s41, 99
  s_cselect_b32 s38, 1, 2
  s_add_u32 s43, s43, 1
  s_lshl_b32 s33, s5, 2
  s_add_u32 s33, s33, s47
  v_mov_b32 v0, s43
  s_waitcnt vmcnt(0)
  s_mov_b64 exec, 1
  buffer_store_dword v0, off, s[8:11], s33 sc1
  s_mov_b64 exec, -1
  s_xor_b32 s45, s45, 0x100000
  s_branch FS_WC
FS_WP:
  s_add_u32 s33, s41, 2
  s_lshl_b32 s33, s33, 9
  s_add_u32 s33, s33, 32768
  s_cmp_ge_u32 s41, 62
  s_cselect_b32 s33, 98304, s33
  buffer_load_dword v226, v3, s[8:11], s33 offen sc1
  s_waitcnt vmcnt(0)
FS_WC:
  v_cmp_gt_u32 vcc, s38, v226
  s_cbranch_vccz FS_WOK
  s_sleep 2
  s_sub_u32 s6, s6, 1
  s_cbranch_scc1 GIVEUP
  s_branch FS_WP
FS_WOK:
  s_mov_b32 s48, 1
  s_add_u32 s33, s41, 2
  s_lshl_b32 s33, s33, 15
  s_add_u32 s33, s33, 4194304
  s_lshl_b32 s34, s3, 8
  s_add_u32 s34, s34, s33
  s_lshl_b32 s35, s3, 13
  s_add_u32 s35, s35, s49
  s_add_u32 s39, s34, 0
  s_add_u32 m0, s35, 0
  s_nop 0
  buffer_load_dwordx4 v19, s[8:11], s39 offen sc1 lds
  s_add_u32 s39, s34, 16384
  s_add_u32 m0, s35, 2048
  s_nop 0
  buffer_load_dwordx4 v19, s[8:11], s39 offen sc1 lds
  s_add_u32 s39, s34, 128
  s_add_u32 m0, s35, 4096
  s_nop 0
  buffer_load_dwordx4 v19, s[8:11], s39 offen sc1 lds
  s_add_u32 s39, s34, 16512
  s_add_u32 m0, s35, 6144
  s_nop 0
  buffer_load_dwordx4 v19, s[8:11], s39 offen sc1 lds
  v_xor_b32 v19, 64, v19
  s_add_u32 s39, s34, 8192
  s_add_u32 m0, s35, 1024
  s_nop 0
  buffer_load_dwordx4 v19, s[8:11], s39 offen sc1 lds
  s_add_u32 s39, s34, 24576
  s_add_u32 m0, s35, 3072
  s_nop 0
  buffer_load_dwordx4 v19, s[8:11], s39 offen sc1 lds
  s_add_u32 s39, s34, 8320
  s_add_u32 m0, s35, 5120
  s_nop 0
  buffer_load_dwordx4 v19, s[8:11], s39 offen sc1 lds
  s_add_u32 s39, s34, 24704
  s_add_u32 m0, s35, 7168
  s_nop 0
  buffer_load_dwordx4 v19, s[8:11], s39 offen sc1 lds
  v_xor_b32 v19, 64, v19
  s_add_u32 s33, s41, 4
  s_lshl_b32 s33, s33, 9
  s_add_u32 s33, s33, 32768
  s_cmp_ge_u32 s41, 60
  s_cselect_b32 s33, 98304, s33
  buffer_load_dword v226, v3, s[8:11], s33 offen sc1
  s_lshl_b32 s50, s41, 5
  s_add_u32 s50, s50, s5
  s_lshl_b32 s50, s50, 10
  s_add_u32 s41, s41, 2
  s_mov_b32 s44, 1
  s_waitcnt vmcnt(0)
  s_branch FS_TOP
FS_L4:
  s_mov_b32 s44, 0
FS_NOP:
FS_SIG:
  s_add_u32 s43, s43, 1
  s_lshl_b32 s33, s5, 2
  s_add_u32 s33, s33, s47
  v_mov_b32 v0, s43
  s_waitcnt vmcnt(0)
  s_mov_b64 exec, 1
  buffer_store_dword v0, off, s[8:11], s33 sc1
  s_mov_b64 exec, -1
  s_xor_b32 s45, s45, 0x100000
  s_lshl_b32 s50, s41, 5
  s_add_u32 s50, s50, s5
  s_lshl_b32 s50, s50, 10
  s_add_u32 s41, s41, 2
FS_RED:
FGP_53:
  buffer_load_dword v0, v23, s[8:11], s47 offen sc1
  s_waitcnt vmcnt(0)
  v_cmp_gt_u32 vcc, s43, v0
  s_cbranch_vccz FGPOK_54
  s_sleep 1
  s_sub_u32 s6, s6, 1
  s_cbranch_scc1 GIVEUP
  s_branch FGP_53
FGPOK_54:
  s_add_u32 s37, s50, 6291456
  buffer_load_dword v224, v21, s[8:11], s37 offen sc1
  buffer_load_dwordx4 v[192:195], v20, s[8:11], s46 offen sc1
  s_add_u32 s36, s46, 4096
  buffer_load_dwordx4 v[196:199], v20, s[8:11], s36 offen sc1
  s_add_u32 s36, s46, 8192
  buffer_load_dwordx4 v[200:203], v20, s[8:11], s36 offen sc1
  s_add_u32 s36, s46, 12288
  buffer_load_dwordx4 v[204:207], v20, s[8:11], s36 offen sc1
  s_add_u32 s36, s46, 16384
  buffer_load_dwordx4 v[208:211], v20, s[8:11], s36 offen sc1
  s_add_u32 s36, s46, 20480
  buffer_load_dwordx4 v[212:215], v1, s[8:11], s36 offen sc1
  s_xor_b32 s46, s46, 0x100000
  s_waitcnt vmcnt(5)
  v_mfma_f32_16x16x32_bf16 v[220:223], v[216:219], v[192:195], 0
  s_waitcnt vmcnt(4)
  v_mfma_f32_16x16x32_bf16 v[220:223], v[216:219], v[196:199], v[220:223]
  s_waitcnt vmcnt(3)
  v_mfma_f32_16x16x32_bf16 v[220:223], v[216:219], v[200:203], v[220:223]
  s_waitcnt vmcnt(2)
  v_mfma_f32_16x16x32_bf16 v[220:223], v[216:219], v[204:207], v[220:223]
  s_waitcnt vmcnt(1)
  v_mfma_f32_16x16x32_bf16 v[220:223], v[216:219], v[208:211], v[220:223]
  s_waitcnt vmcnt(0)
  v_mfma_f32_16x16x32_bf16 v[220:223], v[216:219], v[212:215], v[220:223]
FS_FIN:
  v_and_b32 v225, 0xffff0000, v224
  v_lshlrev_b32 v224, 16, v224
  s_nop 4
  v_cvt_pk_bf16_f32 v0, v220, v221
  v_and_b32 v221, 0xffff0000, v0
  v_lshlrev_b32 v220, 16, v0
  v_pk_mul_f32 v[220:221], v[220:221], v[4:5]
  v_cvt_pk_bf16_f32 v0, v220, v221
  v_and_b32 v221, 0xffff0000, v0
  v_lshlrev_b32 v220, 16, v0
  v_pk_add_f32 v[220:221], v[220:221], v[224:225]
  v_cvt_pk_bf16_f32 v220, v220, v221
  buffer_store_dword v220, v21, s[28:31], s50 offen
  s_cmp_lt_u32 s41, 64
  s_cbranch_scc1 FS_LOOP
  s_waitcnt vmcnt(0)
  s_waitcnt vmcnt(0)
  s_endpgm
IDLE_ROLE:
  s_waitcnt vmcnt(0)
  s_barrier
  s_cmp_lg_u32 s3, 0
  s_cbranch_scc1 SIG_55
  s_lshl_b32 s33, s4, 2
  v_mov_b32 v10, s32
  s_mov_b64 exec, 1
  buffer_atomic_add v10, off, s[12:15], s33 offset:160 sc1
  s_mov_b64 exec, -1
SIG_55:
  s_waitcnt vmcnt(0)
GIVEUP:
EXIT:
  s_endpgm
.section .rodata,"a"
.p2align 6
.amdhsa_kernel adaLN_cond__memory_aug_recurrent_mem_tr__glu_gated_swiglu__prompt_kernel
  .amdhsa_next_free_vgpr 512
  .amdhsa_next_free_sgpr 102
  .amdhsa_accum_offset 256
  .amdhsa_group_segment_fixed_size 0
  .amdhsa_kernarg_size 128
  .amdhsa_user_sgpr_count 2
  .amdhsa_user_sgpr_kernarg_segment_ptr 1
  .amdhsa_system_sgpr_workgroup_id_x 1
.end_amdhsa_kernel
```
